```python
import torch

def _softmax(x, axis=-1):
    return torch.softmax(x, dim=axis)
def _gelu(x):
    return torch.nn.functional.gelu(x, approximate="tanh")
def _silu(x):
    return torch.nn.functional.silu(x)
def _sigmoid(x):
    return torch.sigmoid(x)
def _layernorm(x, axis=-1, eps=1e-5):
    m = x.mean(dim=axis, keepdim=True)
    v = x.var(dim=axis, keepdim=True, unbiased=False)
    return (x - m) / torch.sqrt(v + eps)
def _scatter_add(tgt, idx, src, axis=0):
    return tgt.clone().index_add_(axis, idx, src)
def _segment_sum(src, seg, n):
    out = torch.zeros((n,) + src.shape[1:], dtype=src.dtype)
    return out.index_add_(0, seg, src)
def _pad(x, pw):
    flat = tuple(v for pair in reversed(pw) for v in pair)
    return torch.nn.functional.pad(x, flat)

kernel_name = 'standalone__mha_block_cached__near_ridge'

def setup_inputs():

    _w = (lambda a: (lambda t: t.to(torch.bfloat16) if t.is_floating_point() else t)(torch.as_tensor(a)))
    B, Sq, D = 8, 240, 576
    H, Sk, Dh = 32, 2048, 128
    return {
        "x": _w((lambda *s: torch.randn(*s, dtype=torch.bfloat16) * 0.8)(B, Sq, D)),
        "k_cache": _w((lambda *s: torch.randn(*s, dtype=torch.bfloat16) * 0.8)(B, H, Sk, Dh)),
        "v_cache": _w((lambda *s: torch.randn(*s, dtype=torch.bfloat16) * 0.05)(B, H, Sk, Dh)),
        "wq": _w((lambda *s: torch.randn(*s, dtype=torch.bfloat16) * 0.8)(D, H * Dh) * (D ** -0.5)),
        "wo": _w((lambda *s: torch.randn(*s, dtype=torch.bfloat16) * 0.05)(H * Dh, D) * ((H * Dh) ** -0.5)),
    }

def reference(x, k_cache, v_cache, wq, wo):
    B, Sq, D = x.shape
    H, Dh = 32, 128
    q = (lambda x, *d: x.permute(*d))((x @ wq).reshape(B, Sq, H, Dh), 0, 2, 1, 3)
    scores = torch.einsum("bhqd,bhkd->bhqk", q, k_cache) * (Dh ** -0.5)
    p = _softmax(scores, axis=-1)
    o = torch.einsum("bhqk,bhkd->bhqd", p, v_cache)
    return (lambda x, *d: x.permute(*d))(o, 0, 2, 1, 3).reshape(B, Sq, H * Dh) @ wo
```

```asm
; @launch grid=(256,1,1) block=(256,1,1) lds=163840
.amdgcn_target "amdgcn-amd-amdhsa--gfx950"
.text
.globl standalone__mha_block_cached__near_ridge_kernel
.p2align 8
.type standalone__mha_block_cached__near_ridge_kernel,@function
standalone__mha_block_cached__near_ridge_kernel:
    s_cmp_ge_u32 s2, 256
    s_cbranch_scc1 L1_done
    s_load_dwordx8 s[36:43], s[0:1], 0
    s_load_dwordx2 s[44:45], s[0:1], 56
    s_load_dwordx4 s[80:83], s[0:1], 32
    s_load_dwordx2 s[84:85], s[0:1], 48
    v_and_b32 v221, 63, v0
    v_lshrrev_b32 v222, 6, v0
    s_and_b32 s46, s2, 7
    s_lshr_b32 s47, s2, 3
    v_readfirstlane_b32 s3, v222
    s_and_b32 s48, s46, 1
    s_lshl_b32 s48, s48, 2
    s_and_b32 s49, s47, 3
    s_add_u32 s32, s48, s49
    s_lshr_b32 s48, s46, 1
    s_lshl_b32 s48, s48, 3
    s_lshr_b32 s53, s47, 2
    s_add_u32 s33, s48, s53
    s_lshl_b32 s49, s49, 1
    s_add_u32 s50, s49, s53
    s_cmp_ge_u32 s50, 9
    s_cselect_b32 s49, 9, 0
    s_sub_u32 s50, s50, s49
    s_mov_b32 s4, s50
    s_mul_i32 s31, s2, 1
    s_and_b32 s31, s31, 63
    s_lshl_b32 s34, s3, 13
    s_lshl_b32 s35, s3, 12
    v_lshrrev_b32 v222, 3, v221
    s_lshl_b32 s46, s3, 6
    v_add_u32 v222, s46, v222
    v_mul_u32_u24 v222, 1152, v222
    v_and_b32 v223, 7, v221
    v_lshrrev_b32 v224, 4, v221
    v_xor_b32 v225, v223, v224
    v_lshl_add_u32 v218, v225, 4, v222
    v_xor_b32 v225, 4, v225
    v_lshl_add_u32 v219, v225, 4, v222
    v_and_b32 v223, 15, v221
    v_lshlrev_b32 v225, 2, v224
    v_xor_b32 v225, v223, v225
    s_lshl_b32 s46, s3, 4
    v_add_u32 v226, s46, v224
    v_lshlrev_b32 v226, 13, v226
    v_lshl_add_u32 v220, v225, 4, v226
    s_waitcnt lgkmcnt(0)
    s_mul_i32 s46, s32, 276480
    s_add_u32 s16, s36, s46
    s_addc_u32 s17, s37, 0
    s_mov_b32 s18, 276480
    s_mov_b32 s19, 0x20000
    s_lshl_b32 s46, s33, 8
    s_add_u32 s20, s42, s46
    s_addc_u32 s21, s43, 0
    s_sub_u32 s22, 4718592, s46
    s_mov_b32 s23, 0x20000
    s_getpc_b64 s[58:59]
L1_pc:
    s_cmp_eq_u32 s3, 3
    s_cbranch_scc1 L1_w3
    s_lshl_b32 s51, s50, 7
    s_lshl_b32 s52, s50, 19
    s_add_u32 m0, s34, 16384
    s_add_u32 s46, s51, 0
    buffer_load_dwordx4 v218, s[16:19], s46 offen  lds
    s_add_u32 m0, s34, 17408
    s_add_u32 s46, s51, 9216
    buffer_load_dwordx4 v219, s[16:19], s46 offen  lds
    s_add_u32 m0, s34, 18432
    s_add_u32 s46, s51, 18432
    buffer_load_dwordx4 v218, s[16:19], s46 offen  lds
    s_add_u32 m0, s34, 19456
    s_add_u32 s46, s51, 27648
    buffer_load_dwordx4 v219, s[16:19], s46 offen  lds
    s_add_u32 m0, s34, 20480
    s_add_u32 s46, s51, 36864
    buffer_load_dwordx4 v218, s[16:19], s46 offen  lds
    s_add_u32 m0, s34, 21504
    s_add_u32 s46, s51, 46080
    buffer_load_dwordx4 v219, s[16:19], s46 offen  lds
    s_add_u32 m0, s34, 22528
    s_add_u32 s46, s51, 55296
    buffer_load_dwordx4 v218, s[16:19], s46 offen  lds
    s_add_u32 m0, s34, 23552
    s_add_u32 s46, s51, 64512
    buffer_load_dwordx4 v219, s[16:19], s46 offen  lds
    s_add_u32 s50, s50, 1
    s_cmp_eq_u32 s50, 9
    s_cselect_b32 s50, 0, s50
    s_add_u32 m0, s35, 114688
    s_add_u32 s46, s52, 0
    buffer_load_dwordx4 v220, s[20:23], s46 offen  lds
    s_add_u32 m0, s35, 115712
    s_add_u32 s46, s52, 32768
    buffer_load_dwordx4 v220, s[20:23], s46 offen  lds
    s_add_u32 m0, s35, 116736
    s_add_u32 s46, s52, 65536
    buffer_load_dwordx4 v220, s[20:23], s46 offen  lds
    s_add_u32 m0, s35, 117760
    s_add_u32 s46, s52, 98304
    buffer_load_dwordx4 v220, s[20:23], s46 offen  lds
    s_lshl_b32 s46, s32, 5
    s_add_u32 s46, s46, s33
    s_lshl_b32 s46, s46, 19
    s_add_u32 s8, s38, s46
    s_addc_u32 s9, s39, 0
    s_mov_b32 s10, 524288
    s_mov_b32 s11, 0x20000
    s_add_u32 s12, s40, s46
    s_addc_u32 s13, s41, 0
    s_mov_b32 s14, 524288
    s_mov_b32 s15, 0x20000
    s_mov_b32 s24, s44
    s_mov_b32 s25, s45
    s_mov_b32 s26, 0x2A00000
    s_mov_b32 s27, 0x20000
    v_and_b32 v222, 15, v221
    v_lshrrev_b32 v223, 4, v221
    v_bfe_u32 v224, v221, 2, 2
    v_and_b32 v225, 3, v221
    v_add_u32 v226, 0, v223
    v_xor_b32 v226, v226, v222
    v_lshlrev_b32 v226, 4, v226
    v_lshl_add_u32 v192, v222, 8, v226
    v_add_u32 v226, 4, v223
    v_xor_b32 v226, v226, v222
    v_lshlrev_b32 v226, 4, v226
    v_lshl_add_u32 v193, v222, 8, v226
    v_add_u32 v226, 8, v223
    v_xor_b32 v226, v226, v222
    v_lshlrev_b32 v226, 4, v226
    v_lshl_add_u32 v194, v222, 8, v226
    v_add_u32 v226, 12, v223
    v_xor_b32 v226, v226, v222
    v_lshlrev_b32 v226, 4, v226
    v_lshl_add_u32 v195, v222, 8, v226
    v_lshl_add_u32 v227, v223, 2, v224
    v_and_b32 v228, 7, v227
    v_lshrrev_b32 v229, 1, v225
    v_and_b32 v230, 1, v225
    v_lshlrev_b32 v230, 3, v230
    v_lshl_add_u32 v230, v227, 8, v230
    v_add_u32 v230, 65536, v230
    v_xor_b32 v226, 0, v228
    v_lshl_add_u32 v226, v226, 1, v229
    v_lshl_add_u32 v196, v226, 4, v230
    v_xor_b32 v226, 1, v228
    v_lshl_add_u32 v226, v226, 1, v229
    v_lshl_add_u32 v197, v226, 4, v230
    v_xor_b32 v226, 2, v228
    v_lshl_add_u32 v226, v226, 1, v229
    v_lshl_add_u32 v198, v226, 4, v230
    v_xor_b32 v226, 3, v228
    v_lshl_add_u32 v226, v226, 1, v229
    v_lshl_add_u32 v199, v226, 4, v230
    v_xor_b32 v226, 4, v228
    v_lshl_add_u32 v226, v226, 1, v229
    v_lshl_add_u32 v200, v226, 4, v230
    v_xor_b32 v226, 5, v228
    v_lshl_add_u32 v226, v226, 1, v229
    v_lshl_add_u32 v201, v226, 4, v230
    v_xor_b32 v226, 6, v228
    v_lshl_add_u32 v226, v226, 1, v229
    v_lshl_add_u32 v202, v226, 4, v230
    v_xor_b32 v226, 7, v228
    v_lshl_add_u32 v226, v226, 1, v229
    v_lshl_add_u32 v203, v226, 4, v230
    v_bfe_u32 v227, v222, 1, 3
    v_lshlrev_b32 v228, 7, v222
    v_add_u32 v228, s34, v228
    v_add_u32 v226, 0, v223
    v_xor_b32 v226, v226, v227
    v_lshl_add_u32 v210, v226, 4, v228
    v_add_u32 v212, 65536, v210
    v_add_u32 v226, 4, v223
    v_xor_b32 v226, v226, v227
    v_lshl_add_u32 v211, v226, 4, v228
    v_add_u32 v213, 65536, v211
    v_lshl_add_u32 v227, v223, 3, v224
    v_lshlrev_b32 v227, 8, v227
    v_add_u32 v227, 114688, v227
    v_xor_b32 v226, 0, v224
    v_lshl_add_u32 v226, v226, 2, v225
    v_lshl_add_u32 v214, v226, 4, v227
    v_xor_b32 v226, 1, v224
    v_lshl_add_u32 v226, v226, 2, v225
    v_lshl_add_u32 v215, v226, 4, v227
    v_xor_b32 v226, 2, v224
    v_lshl_add_u32 v226, v226, 2, v225
    v_lshl_add_u32 v216, v226, 4, v227
    v_xor_b32 v226, 3, v224
    v_lshl_add_u32 v226, v226, 2, v225
    v_lshl_add_u32 v217, v226, 4, v227
    v_add_u32 v226, 0, v223
    v_xor_b32 v226, v226, v222
    v_lshlrev_b32 v226, 4, v226
    v_lshl_add_u32 v204, v223, 8, v226
    v_add_u32 v226, 4, v223
    v_xor_b32 v226, v226, v222
    v_lshlrev_b32 v226, 4, v226
    v_lshl_add_u32 v205, v223, 8, v226
    v_add_u32 v226, 8, v223
    v_xor_b32 v226, v226, v222
    v_lshlrev_b32 v226, 4, v226
    v_lshl_add_u32 v206, v223, 8, v226
    v_add_u32 v226, 12, v223
    v_xor_b32 v226, v226, v222
    v_lshlrev_b32 v226, 4, v226
    v_lshl_add_u32 v207, v223, 8, v226
    v_add_u32 v226, 0, v223
    v_lshlrev_b32 v226, 1, v226
    v_xor_b32 v226, v226, v222
    v_lshlrev_b32 v226, 4, v226
    v_lshl_add_u32 v208, v223, 8, v226
    v_add_u32 v226, 4, v223
    v_lshlrev_b32 v226, 1, v226
    v_xor_b32 v226, v226, v222
    v_lshlrev_b32 v226, 4, v226
    v_lshl_add_u32 v209, v223, 8, v226
    s_or_b32 s46, s2, s3
    s_cmp_lg_u32 s46, 0
    s_cbranch_scc1 L1_nonce0
    v_mov_b32 v243, 0
    s_mov_b32 s46, 17760256
    buffer_load_dword v243, v243, s[24:27], s46 offen sc1
L1_nonce0:
    s_lshl_b32 s51, s50, 7
    s_lshl_b32 s52, s50, 19
    s_add_u32 m0, s34, 49152
    s_add_u32 s46, s51, 0
    buffer_load_dwordx4 v218, s[16:19], s46 offen  lds
    s_add_u32 m0, s34, 50176
    s_add_u32 s46, s51, 9216
    buffer_load_dwordx4 v219, s[16:19], s46 offen  lds
    s_add_u32 m0, s34, 51200
    s_add_u32 s46, s51, 18432
    buffer_load_dwordx4 v218, s[16:19], s46 offen  lds
    s_add_u32 m0, s34, 52224
    s_add_u32 s46, s51, 27648
    buffer_load_dwordx4 v219, s[16:19], s46 offen  lds
    s_add_u32 m0, s34, 53248
    s_add_u32 s46, s51, 36864
    buffer_load_dwordx4 v218, s[16:19], s46 offen  lds
    s_add_u32 m0, s34, 54272
    s_add_u32 s46, s51, 46080
    buffer_load_dwordx4 v219, s[16:19], s46 offen  lds
    s_add_u32 m0, s34, 55296
    s_add_u32 s46, s51, 55296
    buffer_load_dwordx4 v218, s[16:19], s46 offen  lds
    s_add_u32 m0, s34, 56320
    s_add_u32 s46, s51, 64512
    buffer_load_dwordx4 v219, s[16:19], s46 offen  lds
    s_add_u32 s50, s50, 1
    s_cmp_eq_u32 s50, 9
    s_cselect_b32 s50, 0, s50
    s_add_u32 m0, s35, 131072
    s_add_u32 s46, s52, 0
    buffer_load_dwordx4 v220, s[20:23], s46 offen  lds
    s_add_u32 m0, s35, 132096
    s_add_u32 s46, s52, 32768
    buffer_load_dwordx4 v220, s[20:23], s46 offen  lds
    s_add_u32 m0, s35, 133120
    s_add_u32 s46, s52, 65536
    buffer_load_dwordx4 v220, s[20:23], s46 offen  lds
    s_add_u32 m0, s35, 134144
    s_add_u32 s46, s52, 98304
    buffer_load_dwordx4 v220, s[20:23], s46 offen  lds
    s_lshr_b32 s46, s2, 3
    s_lshl_b32 s46, s46, 2
    s_add_u32 s46, s46, s3
    s_mul_i32 s46, s46, 640
    v_lshlrev_b32 v234, 7, v221
    v_add_u32 v234, s46, v234
    v_min_u32 v234, L1_done-L1_pc, v234
    v_mov_b32 v237, s59
    v_add_co_u32 v236, vcc, s58, v234
    s_nop 1
    v_addc_co_u32 v237, vcc, 0, v237, vcc
    v_cmp_gt_u32 vcc, 5, v221
    s_and_saveexec_b64 s[48:49], vcc
    global_load_dword v235, v[236:237], off
    s_mov_b64 exec, s[48:49]
    s_waitcnt vmcnt(13)
    s_barrier
    s_or_b32 s46, s2, s3
    s_cmp_lg_u32 s46, 0
    s_cbranch_scc1 L1_nonce1
    v_add_u32 v243, 1, v243
    v_or_b32 v243, 0x80000000, v243
    v_mov_b32 v222, 0
    s_mov_b32 s76, s84
    s_mov_b32 s77, s85
    s_mov_b32 s78, 256
    s_mov_b32 s79, 0x20000
    s_mov_b32 s46, 17760256
    v_cmp_eq_u32 vcc, 0, v221
    s_and_saveexec_b64 s[48:49], vcc
    buffer_store_dword v243, v222, s[24:27], s46 offen sc1
    buffer_store_dword v243, v222, s[76:79], 0 offen sc1
    s_mov_b64 exec, s[48:49]
L1_nonce1:
    ds_read_b128 a[64:67], v210 offset:16384
    ds_read_b64_tr_b16 a[0:1], v214 offset:0
    ds_read_b64_tr_b16 a[2:3], v214 offset:1024
    ds_read_b128 a[68:71], v210 offset:18432
    ds_read_b128 a[72:75], v210 offset:20480
    ds_read_b128 a[76:79], v210 offset:22528
    ds_read_b64_tr_b16 a[4:5], v214 offset:8
    ds_read_b64_tr_b16 a[6:7], v214 offset:1032
    ds_read_b64_tr_b16 a[8:9], v215 offset:0
    ds_read_b64_tr_b16 a[10:11], v215 offset:1024
    ds_read_b64_tr_b16 a[12:13], v215 offset:8
    ds_read_b64_tr_b16 a[14:15], v215 offset:1032
    ds_read_b64_tr_b16 a[16:17], v216 offset:0
    ds_read_b64_tr_b16 a[18:19], v216 offset:1024
    ds_read_b64_tr_b16 a[20:21], v216 offset:8
    ds_read_b64_tr_b16 a[22:23], v216 offset:1032
    ds_read_b64_tr_b16 a[24:25], v217 offset:0
    ds_read_b64_tr_b16 a[26:27], v217 offset:1024
    ds_read_b64_tr_b16 a[28:29], v217 offset:8
    ds_read_b64_tr_b16 a[30:31], v217 offset:1032
    s_waitcnt lgkmcnt(0)
    v_mfma_f32_16x16x32_bf16 v[0:3], a[0:3], a[64:67], 0
    s_lshl_b32 s51, s50, 7
    s_lshl_b32 s52, s50, 19
    ds_read_b128 a[80:83], v211 offset:16384
    v_mfma_f32_16x16x32_bf16 v[4:7], a[0:3], a[68:71], 0
    s_add_u32 m0, s34, 81920
    ds_read_b64_tr_b16 a[32:33], v214 offset:8192
    v_mfma_f32_16x16x32_bf16 v[8:11], a[0:3], a[72:75], 0
    s_add_u32 s46, s51, 0
    ds_read_b64_tr_b16 a[34:35], v214 offset:9216
    buffer_load_dwordx4 v218, s[16:19], s46 offen  lds
    v_mfma_f32_16x16x32_bf16 v[12:15], a[0:3], a[76:79], 0
    ds_read_b128 a[84:87], v211 offset:18432
    v_mfma_f32_16x16x32_bf16 v[16:19], a[4:7], a[64:67], 0
    v_mfma_f32_16x16x32_bf16 v[20:23], a[4:7], a[68:71], 0
    ds_read_b128 a[88:91], v211 offset:20480
    v_mfma_f32_16x16x32_bf16 v[24:27], a[4:7], a[72:75], 0
    s_add_u32 m0, s34, 82944
    ds_read_b128 a[92:95], v211 offset:22528
    v_mfma_f32_16x16x32_bf16 v[28:31], a[4:7], a[76:79], 0
    s_add_u32 s46, s51, 9216
    ds_read_b64_tr_b16 a[36:37], v214 offset:8200
    buffer_load_dwordx4 v219, s[16:19], s46 offen  lds
    v_mfma_f32_16x16x32_bf16 v[32:35], a[8:11], a[64:67], 0
    v_mfma_f32_16x16x32_bf16 v[36:39], a[8:11], a[68:71], 0
    ds_read_b64_tr_b16 a[38:39], v214 offset:9224
    v_mfma_f32_16x16x32_bf16 v[40:43], a[8:11], a[72:75], 0
    ds_read_b64_tr_b16 a[40:41], v215 offset:8192
    v_mfma_f32_16x16x32_bf16 v[44:47], a[8:11], a[76:79], 0
    s_add_u32 m0, s34, 83968
    ds_read_b64_tr_b16 a[42:43], v215 offset:9216
    v_mfma_f32_16x16x32_bf16 v[48:51], a[12:15], a[64:67], 0
    s_add_u32 s46, s51, 18432
    buffer_load_dwordx4 v218, s[16:19], s46 offen  lds
    v_mfma_f32_16x16x32_bf16 v[52:55], a[12:15], a[68:71], 0
    ds_read_b64_tr_b16 a[44:45], v215 offset:8200
    v_mfma_f32_16x16x32_bf16 v[56:59], a[12:15], a[72:75], 0
    ds_read_b64_tr_b16 a[46:47], v215 offset:9224
    v_mfma_f32_16x16x32_bf16 v[60:63], a[12:15], a[76:79], 0
    ds_read_b64_tr_b16 a[48:49], v216 offset:8192
    v_mfma_f32_16x16x32_bf16 v[64:67], a[16:19], a[64:67], 0
    s_add_u32 m0, s34, 84992
    ds_read_b64_tr_b16 a[50:51], v216 offset:9216
    v_mfma_f32_16x16x32_bf16 v[68:71], a[16:19], a[68:71], 0
    s_add_u32 s46, s51, 27648
    buffer_load_dwordx4 v219, s[16:19], s46 offen  lds
    v_mfma_f32_16x16x32_bf16 v[72:75], a[16:19], a[72:75], 0
    ds_read_b64_tr_b16 a[52:53], v216 offset:8200
    v_mfma_f32_16x16x32_bf16 v[76:79], a[16:19], a[76:79], 0
    ds_read_b64_tr_b16 a[54:55], v216 offset:9224
    v_mfma_f32_16x16x32_bf16 v[80:83], a[20:23], a[64:67], 0
    ds_read_b64_tr_b16 a[56:57], v217 offset:8192
    v_mfma_f32_16x16x32_bf16 v[84:87], a[20:23], a[68:71], 0
    s_add_u32 m0, s34, 86016
    v_mfma_f32_16x16x32_bf16 v[88:91], a[20:23], a[72:75], 0
    s_add_u32 s46, s51, 36864
    ds_read_b64_tr_b16 a[58:59], v217 offset:9216
    buffer_load_dwordx4 v218, s[16:19], s46 offen  lds
    v_mfma_f32_16x16x32_bf16 v[92:95], a[20:23], a[76:79], 0
    ds_read_b64_tr_b16 a[60:61], v217 offset:8200
    v_mfma_f32_16x16x32_bf16 v[96:99], a[24:27], a[64:67], 0
    ds_read_b64_tr_b16 a[62:63], v217 offset:9224
    v_mfma_f32_16x16x32_bf16 v[100:103], a[24:27], a[68:71], 0
    v_mfma_f32_16x16x32_bf16 v[104:107], a[24:27], a[72:75], 0
    s_add_u32 m0, s34, 87040
    v_mfma_f32_16x16x32_bf16 v[108:111], a[24:27], a[76:79], 0
    s_add_u32 s46, s51, 46080
    buffer_load_dwordx4 v219, s[16:19], s46 offen  lds
    v_mfma_f32_16x16x32_bf16 v[112:115], a[28:31], a[64:67], 0
    v_mfma_f32_16x16x32_bf16 v[116:119], a[28:31], a[68:71], 0
    v_mfma_f32_16x16x32_bf16 v[120:123], a[28:31], a[72:75], 0
    v_mfma_f32_16x16x32_bf16 v[124:127], a[28:31], a[76:79], 0
    s_waitcnt lgkmcnt(0)
    s_waitcnt vmcnt(7)
    s_barrier
    v_mfma_f32_16x16x32_bf16 v[0:3], a[32:35], a[80:83], v[0:3]
    ds_read_b128 a[64:67], v210 offset:49152
    v_mfma_f32_16x16x32_bf16 v[4:7], a[32:35], a[84:87], v[4:7]
    s_add_u32 m0, s34, 88064
    ds_read_b64_tr_b16 a[0:1], v214 offset:16384
    v_mfma_f32_16x16x32_bf16 v[8:11], a[32:35], a[88:91], v[8:11]
    s_add_u32 s46, s51, 55296
    ds_read_b64_tr_b16 a[2:3], v214 offset:17408
    buffer_load_dwordx4 v218, s[16:19], s46 offen  lds
    v_mfma_f32_16x16x32_bf16 v[12:15], a[32:35], a[92:95], v[12:15]
    ds_read_b128 a[68:71], v210 offset:51200
    v_mfma_f32_16x16x32_bf16 v[16:19], a[36:39], a[80:83], v[16:19]
    v_mfma_f32_16x16x32_bf16 v[20:23], a[36:39], a[84:87], v[20:23]
    ds_read_b128 a[72:75], v210 offset:53248
    v_mfma_f32_16x16x32_bf16 v[24:27], a[36:39], a[88:91], v[24:27]
    s_add_u32 m0, s34, 89088
    ds_read_b128 a[76:79], v210 offset:55296
    v_mfma_f32_16x16x32_bf16 v[28:31], a[36:39], a[92:95], v[28:31]
    s_add_u32 s46, s51, 64512
    ds_read_b64_tr_b16 a[4:5], v214 offset:16392
    buffer_load_dwordx4 v219, s[16:19], s46 offen  lds
    v_mfma_f32_16x16x32_bf16 v[32:35], a[40:43], a[80:83], v[32:35]
    s_add_u32 s50, s50, 1
    v_mfma_f32_16x16x32_bf16 v[36:39], a[40:43], a[84:87], v[36:39]
    s_cmp_eq_u32 s50, 9
    ds_read_b64_tr_b16 a[6:7], v214 offset:17416
    v_mfma_f32_16x16x32_bf16 v[40:43], a[40:43], a[88:91], v[40:43]
    s_cselect_b32 s50, 0, s50
    ds_read_b64_tr_b16 a[8:9], v215 offset:16384
    v_mfma_f32_16x16x32_bf16 v[44:47], a[40:43], a[92:95], v[44:47]
    s_add_u32 m0, s35, 147456
    ds_read_b64_tr_b16 a[10:11], v215 offset:17408
    v_mfma_f32_16x16x32_bf16 v[48:51], a[44:47], a[80:83], v[48:51]
    s_add_u32 s46, s52, 0
    buffer_load_dwordx4 v220, s[20:23], s46 offen  lds
    v_mfma_f32_16x16x32_bf16 v[52:55], a[44:47], a[84:87], v[52:55]
    ds_read_b64_tr_b16 a[12:13], v215 offset:16392
    v_mfma_f32_16x16x32_bf16 v[56:59], a[44:47], a[88:91], v[56:59]
    ds_read_b64_tr_b16 a[14:15], v215 offset:17416
    v_mfma_f32_16x16x32_bf16 v[60:63], a[44:47], a[92:95], v[60:63]
    ds_read_b64_tr_b16 a[16:17], v216 offset:16384
    v_mfma_f32_16x16x32_bf16 v[64:67], a[48:51], a[80:83], v[64:67]
    s_add_u32 m0, s35, 148480
    ds_read_b64_tr_b16 a[18:19], v216 offset:17408
    v_mfma_f32_16x16x32_bf16 v[68:71], a[48:51], a[84:87], v[68:71]
    s_add_u32 s46, s52, 32768
    buffer_load_dwordx4 v220, s[20:23], s46 offen  lds
    v_mfma_f32_16x16x32_bf16 v[72:75], a[48:51], a[88:91], v[72:75]
    ds_read_b64_tr_b16 a[20:21], v216 offset:16392
    v_mfma_f32_16x16x32_bf16 v[76:79], a[48:51], a[92:95], v[76:79]
    ds_read_b64_tr_b16 a[22:23], v216 offset:17416
    v_mfma_f32_16x16x32_bf16 v[80:83], a[52:55], a[80:83], v[80:83]
    ds_read_b64_tr_b16 a[24:25], v217 offset:16384
    v_mfma_f32_16x16x32_bf16 v[84:87], a[52:55], a[84:87], v[84:87]
    s_add_u32 m0, s35, 149504
    v_mfma_f32_16x16x32_bf16 v[88:91], a[52:55], a[88:91], v[88:91]
    s_add_u32 s46, s52, 65536
    ds_read_b64_tr_b16 a[26:27], v217 offset:17408
    buffer_load_dwordx4 v220, s[20:23], s46 offen  lds
    v_mfma_f32_16x16x32_bf16 v[92:95], a[52:55], a[92:95], v[92:95]
    ds_read_b64_tr_b16 a[28:29], v217 offset:16392
    v_mfma_f32_16x16x32_bf16 v[96:99], a[56:59], a[80:83], v[96:99]
    ds_read_b64_tr_b16 a[30:31], v217 offset:17416
    v_mfma_f32_16x16x32_bf16 v[100:103], a[56:59], a[84:87], v[100:103]
    v_mfma_f32_16x16x32_bf16 v[104:107], a[56:59], a[88:91], v[104:107]
    s_add_u32 m0, s35, 150528
    v_mfma_f32_16x16x32_bf16 v[108:111], a[56:59], a[92:95], v[108:111]
    s_add_u32 s46, s52, 98304
    buffer_load_dwordx4 v220, s[20:23], s46 offen  lds
    v_mfma_f32_16x16x32_bf16 v[112:115], a[60:63], a[80:83], v[112:115]
    v_mfma_f32_16x16x32_bf16 v[116:119], a[60:63], a[84:87], v[116:119]
    v_mfma_f32_16x16x32_bf16 v[120:123], a[60:63], a[88:91], v[120:123]
    v_mfma_f32_16x16x32_bf16 v[124:127], a[60:63], a[92:95], v[124:127]
    s_waitcnt lgkmcnt(0)
    v_mfma_f32_16x16x32_bf16 v[0:3], a[0:3], a[64:67], v[0:3]
    s_lshl_b32 s51, s50, 7
    s_lshl_b32 s52, s50, 19
    ds_read_b128 a[80:83], v211 offset:49152
    v_mfma_f32_16x16x32_bf16 v[4:7], a[0:3], a[68:71], v[4:7]
    s_add_u32 m0, s34, 16384
    ds_read_b64_tr_b16 a[32:33], v214 offset:24576
    v_mfma_f32_16x16x32_bf16 v[8:11], a[0:3], a[72:75], v[8:11]
    s_add_u32 s46, s51, 0
    ds_read_b64_tr_b16 a[34:35], v214 offset:25600
    buffer_load_dwordx4 v218, s[16:19], s46 offen  lds
    v_mfma_f32_16x16x32_bf16 v[12:15], a[0:3], a[76:79], v[12:15]
    ds_read_b128 a[84:87], v211 offset:51200
    v_mfma_f32_16x16x32_bf16 v[16:19], a[4:7], a[64:67], v[16:19]
    v_mfma_f32_16x16x32_bf16 v[20:23], a[4:7], a[68:71], v[20:23]
    ds_read_b128 a[88:91], v211 offset:53248
    v_mfma_f32_16x16x32_bf16 v[24:27], a[4:7], a[72:75], v[24:27]
    s_add_u32 m0, s34, 17408
    ds_read_b128 a[92:95], v211 offset:55296
    v_mfma_f32_16x16x32_bf16 v[28:31], a[4:7], a[76:79], v[28:31]
    s_add_u32 s46, s51, 9216
    ds_read_b64_tr_b16 a[36:37], v214 offset:24584
    buffer_load_dwordx4 v219, s[16:19], s46 offen  lds
    v_mfma_f32_16x16x32_bf16 v[32:35], a[8:11], a[64:67], v[32:35]
    v_mfma_f32_16x16x32_bf16 v[36:39], a[8:11], a[68:71], v[36:39]
    ds_read_b64_tr_b16 a[38:39], v214 offset:25608
    v_mfma_f32_16x16x32_bf16 v[40:43], a[8:11], a[72:75], v[40:43]
    ds_read_b64_tr_b16 a[40:41], v215 offset:24576
    v_mfma_f32_16x16x32_bf16 v[44:47], a[8:11], a[76:79], v[44:47]
    s_add_u32 m0, s34, 18432
    ds_read_b64_tr_b16 a[42:43], v215 offset:25600
    v_mfma_f32_16x16x32_bf16 v[48:51], a[12:15], a[64:67], v[48:51]
    s_add_u32 s46, s51, 18432
    buffer_load_dwordx4 v218, s[16:19], s46 offen  lds
    v_mfma_f32_16x16x32_bf16 v[52:55], a[12:15], a[68:71], v[52:55]
    ds_read_b64_tr_b16 a[44:45], v215 offset:24584
    v_mfma_f32_16x16x32_bf16 v[56:59], a[12:15], a[72:75], v[56:59]
    ds_read_b64_tr_b16 a[46:47], v215 offset:25608
    v_mfma_f32_16x16x32_bf16 v[60:63], a[12:15], a[76:79], v[60:63]
    ds_read_b64_tr_b16 a[48:49], v216 offset:24576
    v_mfma_f32_16x16x32_bf16 v[64:67], a[16:19], a[64:67], v[64:67]
    s_add_u32 m0, s34, 19456
    ds_read_b64_tr_b16 a[50:51], v216 offset:25600
    v_mfma_f32_16x16x32_bf16 v[68:71], a[16:19], a[68:71], v[68:71]
    s_add_u32 s46, s51, 27648
    buffer_load_dwordx4 v219, s[16:19], s46 offen  lds
    v_mfma_f32_16x16x32_bf16 v[72:75], a[16:19], a[72:75], v[72:75]
    ds_read_b64_tr_b16 a[52:53], v216 offset:24584
    v_mfma_f32_16x16x32_bf16 v[76:79], a[16:19], a[76:79], v[76:79]
    ds_read_b64_tr_b16 a[54:55], v216 offset:25608
    v_mfma_f32_16x16x32_bf16 v[80:83], a[20:23], a[64:67], v[80:83]
    ds_read_b64_tr_b16 a[56:57], v217 offset:24576
    v_mfma_f32_16x16x32_bf16 v[84:87], a[20:23], a[68:71], v[84:87]
    s_add_u32 m0, s34, 20480
    v_mfma_f32_16x16x32_bf16 v[88:91], a[20:23], a[72:75], v[88:91]
    s_add_u32 s46, s51, 36864
    ds_read_b64_tr_b16 a[58:59], v217 offset:25600
    buffer_load_dwordx4 v218, s[16:19], s46 offen  lds
    v_mfma_f32_16x16x32_bf16 v[92:95], a[20:23], a[76:79], v[92:95]
    ds_read_b64_tr_b16 a[60:61], v217 offset:24584
    v_mfma_f32_16x16x32_bf16 v[96:99], a[24:27], a[64:67], v[96:99]
    ds_read_b64_tr_b16 a[62:63], v217 offset:25608
    v_mfma_f32_16x16x32_bf16 v[100:103], a[24:27], a[68:71], v[100:103]
    v_mfma_f32_16x16x32_bf16 v[104:107], a[24:27], a[72:75], v[104:107]
    s_add_u32 m0, s34, 21504
    v_mfma_f32_16x16x32_bf16 v[108:111], a[24:27], a[76:79], v[108:111]
    s_add_u32 s46, s51, 46080
    buffer_load_dwordx4 v219, s[16:19], s46 offen  lds
    v_mfma_f32_16x16x32_bf16 v[112:115], a[28:31], a[64:67], v[112:115]
    v_mfma_f32_16x16x32_bf16 v[116:119], a[28:31], a[68:71], v[116:119]
    v_mfma_f32_16x16x32_bf16 v[120:123], a[28:31], a[72:75], v[120:123]
    v_mfma_f32_16x16x32_bf16 v[124:127], a[28:31], a[76:79], v[124:127]
    s_waitcnt lgkmcnt(0)
    s_waitcnt vmcnt(6)
    s_barrier
    v_mfma_f32_16x16x32_bf16 v[0:3], a[32:35], a[80:83], v[0:3]
    ds_read_b128 a[64:67], v212 offset:16384
    v_mfma_f32_16x16x32_bf16 v[4:7], a[32:35], a[84:87], v[4:7]
    s_add_u32 m0, s34, 22528
    ds_read_b64_tr_b16 a[0:1], v214 offset:32768
    v_mfma_f32_16x16x32_bf16 v[8:11], a[32:35], a[88:91], v[8:11]
    s_add_u32 s46, s51, 55296
    ds_read_b64_tr_b16 a[2:3], v214 offset:33792
    buffer_load_dwordx4 v218, s[16:19], s46 offen  lds
    v_mfma_f32_16x16x32_bf16 v[12:15], a[32:35], a[92:95], v[12:15]
    ds_read_b128 a[68:71], v212 offset:18432
    v_mfma_f32_16x16x32_bf16 v[16:19], a[36:39], a[80:83], v[16:19]
    v_mfma_f32_16x16x32_bf16 v[20:23], a[36:39], a[84:87], v[20:23]
    ds_read_b128 a[72:75], v212 offset:20480
    v_mfma_f32_16x16x32_bf16 v[24:27], a[36:39], a[88:91], v[24:27]
    s_add_u32 m0, s34, 23552
    ds_read_b128 a[76:79], v212 offset:22528
    v_mfma_f32_16x16x32_bf16 v[28:31], a[36:39], a[92:95], v[28:31]
    s_add_u32 s46, s51, 64512
    ds_read_b64_tr_b16 a[4:5], v214 offset:32776
    buffer_load_dwordx4 v219, s[16:19], s46 offen  lds
    v_mfma_f32_16x16x32_bf16 v[32:35], a[40:43], a[80:83], v[32:35]
    s_add_u32 s50, s50, 1
    v_mfma_f32_16x16x32_bf16 v[36:39], a[40:43], a[84:87], v[36:39]
    s_cmp_eq_u32 s50, 9
    ds_read_b64_tr_b16 a[6:7], v214 offset:33800
    v_mfma_f32_16x16x32_bf16 v[40:43], a[40:43], a[88:91], v[40:43]
    s_cselect_b32 s50, 0, s50
    ds_read_b64_tr_b16 a[8:9], v215 offset:32768
    v_mfma_f32_16x16x32_bf16 v[44:47], a[40:43], a[92:95], v[44:47]
    s_add_u32 m0, s35, 114688
    ds_read_b64_tr_b16 a[10:11], v215 offset:33792
    v_mfma_f32_16x16x32_bf16 v[48:51], a[44:47], a[80:83], v[48:51]
    s_add_u32 s46, s52, 0
    buffer_load_dwordx4 v220, s[20:23], s46 offen  lds
    v_mfma_f32_16x16x32_bf16 v[52:55], a[44:47], a[84:87], v[52:55]
    ds_read_b64_tr_b16 a[12:13], v215 offset:32776
    v_mfma_f32_16x16x32_bf16 v[56:59], a[44:47], a[88:91], v[56:59]
    ds_read_b64_tr_b16 a[14:15], v215 offset:33800
    v_mfma_f32_16x16x32_bf16 v[60:63], a[44:47], a[92:95], v[60:63]
    ds_read_b64_tr_b16 a[16:17], v216 offset:32768
    v_mfma_f32_16x16x32_bf16 v[64:67], a[48:51], a[80:83], v[64:67]
    s_add_u32 m0, s35, 115712
    ds_read_b64_tr_b16 a[18:19], v216 offset:33792
    v_mfma_f32_16x16x32_bf16 v[68:71], a[48:51], a[84:87], v[68:71]
    s_add_u32 s46, s52, 32768
    buffer_load_dwordx4 v220, s[20:23], s46 offen  lds
    v_mfma_f32_16x16x32_bf16 v[72:75], a[48:51], a[88:91], v[72:75]
    ds_read_b64_tr_b16 a[20:21], v216 offset:32776
    v_mfma_f32_16x16x32_bf16 v[76:79], a[48:51], a[92:95], v[76:79]
    ds_read_b64_tr_b16 a[22:23], v216 offset:33800
    v_mfma_f32_16x16x32_bf16 v[80:83], a[52:55], a[80:83], v[80:83]
    ds_read_b64_tr_b16 a[24:25], v217 offset:32768
    v_mfma_f32_16x16x32_bf16 v[84:87], a[52:55], a[84:87], v[84:87]
    s_add_u32 m0, s35, 116736
    v_mfma_f32_16x16x32_bf16 v[88:91], a[52:55], a[88:91], v[88:91]
    s_add_u32 s46, s52, 65536
    ds_read_b64_tr_b16 a[26:27], v217 offset:33792
    buffer_load_dwordx4 v220, s[20:23], s46 offen  lds
    v_mfma_f32_16x16x32_bf16 v[92:95], a[52:55], a[92:95], v[92:95]
    ds_read_b64_tr_b16 a[28:29], v217 offset:32776
    v_mfma_f32_16x16x32_bf16 v[96:99], a[56:59], a[80:83], v[96:99]
    ds_read_b64_tr_b16 a[30:31], v217 offset:33800
    v_mfma_f32_16x16x32_bf16 v[100:103], a[56:59], a[84:87], v[100:103]
    v_mfma_f32_16x16x32_bf16 v[104:107], a[56:59], a[88:91], v[104:107]
    s_add_u32 m0, s35, 117760
    v_mfma_f32_16x16x32_bf16 v[108:111], a[56:59], a[92:95], v[108:111]
    s_add_u32 s46, s52, 98304
    buffer_load_dwordx4 v220, s[20:23], s46 offen  lds
    v_mfma_f32_16x16x32_bf16 v[112:115], a[60:63], a[80:83], v[112:115]
    v_mfma_f32_16x16x32_bf16 v[116:119], a[60:63], a[84:87], v[116:119]
    v_mfma_f32_16x16x32_bf16 v[120:123], a[60:63], a[88:91], v[120:123]
    v_mfma_f32_16x16x32_bf16 v[124:127], a[60:63], a[92:95], v[124:127]
    s_waitcnt lgkmcnt(0)
    v_mfma_f32_16x16x32_bf16 v[0:3], a[0:3], a[64:67], v[0:3]
    s_lshl_b32 s51, s50, 7
    s_lshl_b32 s52, s50, 19
    ds_read_b128 a[80:83], v213 offset:16384
    v_mfma_f32_16x16x32_bf16 v[4:7], a[0:3], a[68:71], v[4:7]
    s_add_u32 m0, s34, 49152
    ds_read_b64_tr_b16 a[32:33], v214 offset:40960
    v_mfma_f32_16x16x32_bf16 v[8:11], a[0:3], a[72:75], v[8:11]
    s_add_u32 s46, s51, 0
    ds_read_b64_tr_b16 a[34:35], v214 offset:41984
    buffer_load_dwordx4 v218, s[16:19], s46 offen  lds
    v_mfma_f32_16x16x32_bf16 v[12:15], a[0:3], a[76:79], v[12:15]
    ds_read_b128 a[84:87], v213 offset:18432
    v_mfma_f32_16x16x32_bf16 v[16:19], a[4:7], a[64:67], v[16:19]
    v_mfma_f32_16x16x32_bf16 v[20:23], a[4:7], a[68:71], v[20:23]
    ds_read_b128 a[88:91], v213 offset:20480
    v_mfma_f32_16x16x32_bf16 v[24:27], a[4:7], a[72:75], v[24:27]
    s_add_u32 m0, s34, 50176
    ds_read_b128 a[92:95], v213 offset:22528
    v_mfma_f32_16x16x32_bf16 v[28:31], a[4:7], a[76:79], v[28:31]
    s_add_u32 s46, s51, 9216
    ds_read_b64_tr_b16 a[36:37], v214 offset:40968
    buffer_load_dwordx4 v219, s[16:19], s46 offen  lds
    v_mfma_f32_16x16x32_bf16 v[32:35], a[8:11], a[64:67], v[32:35]
    v_mfma_f32_16x16x32_bf16 v[36:39], a[8:11], a[68:71], v[36:39]
    ds_read_b64_tr_b16 a[38:39], v214 offset:41992
    v_mfma_f32_16x16x32_bf16 v[40:43], a[8:11], a[72:75], v[40:43]
    ds_read_b64_tr_b16 a[40:41], v215 offset:40960
    v_mfma_f32_16x16x32_bf16 v[44:47], a[8:11], a[76:79], v[44:47]
    s_add_u32 m0, s34, 51200
    ds_read_b64_tr_b16 a[42:43], v215 offset:41984
    v_mfma_f32_16x16x32_bf16 v[48:51], a[12:15], a[64:67], v[48:51]
    s_add_u32 s46, s51, 18432
    buffer_load_dwordx4 v218, s[16:19], s46 offen  lds
    v_mfma_f32_16x16x32_bf16 v[52:55], a[12:15], a[68:71], v[52:55]
    ds_read_b64_tr_b16 a[44:45], v215 offset:40968
    v_mfma_f32_16x16x32_bf16 v[56:59], a[12:15], a[72:75], v[56:59]
    ds_read_b64_tr_b16 a[46:47], v215 offset:41992
    v_mfma_f32_16x16x32_bf16 v[60:63], a[12:15], a[76:79], v[60:63]
    ds_read_b64_tr_b16 a[48:49], v216 offset:40960
    v_mfma_f32_16x16x32_bf16 v[64:67], a[16:19], a[64:67], v[64:67]
    s_add_u32 m0, s34, 52224
    ds_read_b64_tr_b16 a[50:51], v216 offset:41984
    v_mfma_f32_16x16x32_bf16 v[68:71], a[16:19], a[68:71], v[68:71]
    s_add_u32 s46, s51, 27648
    buffer_load_dwordx4 v219, s[16:19], s46 offen  lds
    v_mfma_f32_16x16x32_bf16 v[72:75], a[16:19], a[72:75], v[72:75]
    ds_read_b64_tr_b16 a[52:53], v216 offset:40968
    v_mfma_f32_16x16x32_bf16 v[76:79], a[16:19], a[76:79], v[76:79]
    ds_read_b64_tr_b16 a[54:55], v216 offset:41992
    v_mfma_f32_16x16x32_bf16 v[80:83], a[20:23], a[64:67], v[80:83]
    ds_read_b64_tr_b16 a[56:57], v217 offset:40960
    v_mfma_f32_16x16x32_bf16 v[84:87], a[20:23], a[68:71], v[84:87]
    s_add_u32 m0, s34, 53248
    v_mfma_f32_16x16x32_bf16 v[88:91], a[20:23], a[72:75], v[88:91]
    s_add_u32 s46, s51, 36864
    ds_read_b64_tr_b16 a[58:59], v217 offset:41984
    buffer_load_dwordx4 v218, s[16:19], s46 offen  lds
    v_mfma_f32_16x16x32_bf16 v[92:95], a[20:23], a[76:79], v[92:95]
    ds_read_b64_tr_b16 a[60:61], v217 offset:40968
    v_mfma_f32_16x16x32_bf16 v[96:99], a[24:27], a[64:67], v[96:99]
    ds_read_b64_tr_b16 a[62:63], v217 offset:41992
    v_mfma_f32_16x16x32_bf16 v[100:103], a[24:27], a[68:71], v[100:103]
    v_mfma_f32_16x16x32_bf16 v[104:107], a[24:27], a[72:75], v[104:107]
    s_add_u32 m0, s34, 54272
    v_mfma_f32_16x16x32_bf16 v[108:111], a[24:27], a[76:79], v[108:111]
    s_add_u32 s46, s51, 46080
    buffer_load_dwordx4 v219, s[16:19], s46 offen  lds
    v_mfma_f32_16x16x32_bf16 v[112:115], a[28:31], a[64:67], v[112:115]
    v_mfma_f32_16x16x32_bf16 v[116:119], a[28:31], a[68:71], v[116:119]
    v_mfma_f32_16x16x32_bf16 v[120:123], a[28:31], a[72:75], v[120:123]
    v_mfma_f32_16x16x32_bf16 v[124:127], a[28:31], a[76:79], v[124:127]
    s_waitcnt lgkmcnt(0)
    s_waitcnt vmcnt(6)
    s_barrier
    v_mfma_f32_16x16x32_bf16 v[0:3], a[32:35], a[80:83], v[0:3]
    ds_read_b128 a[64:67], v210 offset:16384
    v_mfma_f32_16x16x32_bf16 v[4:7], a[32:35], a[84:87], v[4:7]
    s_add_u32 m0, s34, 55296
    ds_read_b64_tr_b16 a[0:1], v214 offset:0
    v_mfma_f32_16x16x32_bf16 v[8:11], a[32:35], a[88:91], v[8:11]
    s_add_u32 s46, s51, 55296
    ds_read_b64_tr_b16 a[2:3], v214 offset:1024
    buffer_load_dwordx4 v218, s[16:19], s46 offen  lds
    v_mfma_f32_16x16x32_bf16 v[12:15], a[32:35], a[92:95], v[12:15]
    ds_read_b128 a[68:71], v210 offset:18432
    v_mfma_f32_16x16x32_bf16 v[16:19], a[36:39], a[80:83], v[16:19]
    v_mfma_f32_16x16x32_bf16 v[20:23], a[36:39], a[84:87], v[20:23]
    ds_read_b128 a[72:75], v210 offset:20480
    v_mfma_f32_16x16x32_bf16 v[24:27], a[36:39], a[88:91], v[24:27]
    s_add_u32 m0, s34, 56320
    ds_read_b128 a[76:79], v210 offset:22528
    v_mfma_f32_16x16x32_bf16 v[28:31], a[36:39], a[92:95], v[28:31]
    s_add_u32 s46, s51, 64512
    ds_read_b64_tr_b16 a[4:5], v214 offset:8
    buffer_load_dwordx4 v219, s[16:19], s46 offen  lds
    v_mfma_f32_16x16x32_bf16 v[32:35], a[40:43], a[80:83], v[32:35]
    s_add_u32 s50, s50, 1
    v_mfma_f32_16x16x32_bf16 v[36:39], a[40:43], a[84:87], v[36:39]
    s_cmp_eq_u32 s50, 9
    ds_read_b64_tr_b16 a[6:7], v214 offset:1032
    v_mfma_f32_16x16x32_bf16 v[40:43], a[40:43], a[88:91], v[40:43]
    s_cselect_b32 s50, 0, s50
    ds_read_b64_tr_b16 a[8:9], v215 offset:0
    v_mfma_f32_16x16x32_bf16 v[44:47], a[40:43], a[92:95], v[44:47]
    s_add_u32 m0, s35, 131072
    ds_read_b64_tr_b16 a[10:11], v215 offset:1024
    v_mfma_f32_16x16x32_bf16 v[48:51], a[44:47], a[80:83], v[48:51]
    s_add_u32 s46, s52, 0
    buffer_load_dwordx4 v220, s[20:23], s46 offen  lds
    v_mfma_f32_16x16x32_bf16 v[52:55], a[44:47], a[84:87], v[52:55]
    ds_read_b64_tr_b16 a[12:13], v215 offset:8
    v_mfma_f32_16x16x32_bf16 v[56:59], a[44:47], a[88:91], v[56:59]
    ds_read_b64_tr_b16 a[14:15], v215 offset:1032
    v_mfma_f32_16x16x32_bf16 v[60:63], a[44:47], a[92:95], v[60:63]
    ds_read_b64_tr_b16 a[16:17], v216 offset:0
    v_mfma_f32_16x16x32_bf16 v[64:67], a[48:51], a[80:83], v[64:67]
    s_add_u32 m0, s35, 132096
    ds_read_b64_tr_b16 a[18:19], v216 offset:1024
    v_mfma_f32_16x16x32_bf16 v[68:71], a[48:51], a[84:87], v[68:71]
    s_add_u32 s46, s52, 32768
    buffer_load_dwordx4 v220, s[20:23], s46 offen  lds
    v_mfma_f32_16x16x32_bf16 v[72:75], a[48:51], a[88:91], v[72:75]
    ds_read_b64_tr_b16 a[20:21], v216 offset:8
    v_mfma_f32_16x16x32_bf16 v[76:79], a[48:51], a[92:95], v[76:79]
    ds_read_b64_tr_b16 a[22:23], v216 offset:1032
    v_mfma_f32_16x16x32_bf16 v[80:83], a[52:55], a[80:83], v[80:83]
    ds_read_b64_tr_b16 a[24:25], v217 offset:0
    v_mfma_f32_16x16x32_bf16 v[84:87], a[52:55], a[84:87], v[84:87]
    s_add_u32 m0, s35, 133120
    v_mfma_f32_16x16x32_bf16 v[88:91], a[52:55], a[88:91], v[88:91]
    s_add_u32 s46, s52, 65536
    ds_read_b64_tr_b16 a[26:27], v217 offset:1024
    buffer_load_dwordx4 v220, s[20:23], s46 offen  lds
    v_mfma_f32_16x16x32_bf16 v[92:95], a[52:55], a[92:95], v[92:95]
    ds_read_b64_tr_b16 a[28:29], v217 offset:8
    v_mfma_f32_16x16x32_bf16 v[96:99], a[56:59], a[80:83], v[96:99]
    ds_read_b64_tr_b16 a[30:31], v217 offset:1032
    v_mfma_f32_16x16x32_bf16 v[100:103], a[56:59], a[84:87], v[100:103]
    v_mfma_f32_16x16x32_bf16 v[104:107], a[56:59], a[88:91], v[104:107]
    s_add_u32 m0, s35, 134144
    v_mfma_f32_16x16x32_bf16 v[108:111], a[56:59], a[92:95], v[108:111]
    s_add_u32 s46, s52, 98304
    buffer_load_dwordx4 v220, s[20:23], s46 offen  lds
    v_mfma_f32_16x16x32_bf16 v[112:115], a[60:63], a[80:83], v[112:115]
    v_mfma_f32_16x16x32_bf16 v[116:119], a[60:63], a[84:87], v[116:119]
    v_mfma_f32_16x16x32_bf16 v[120:123], a[60:63], a[88:91], v[120:123]
    v_mfma_f32_16x16x32_bf16 v[124:127], a[60:63], a[92:95], v[124:127]
    s_waitcnt lgkmcnt(0)
    v_mfma_f32_16x16x32_bf16 v[0:3], a[0:3], a[64:67], v[0:3]
    s_lshl_b32 s51, s50, 7
    s_lshl_b32 s52, s50, 19
    ds_read_b128 a[80:83], v211 offset:16384
    v_mfma_f32_16x16x32_bf16 v[4:7], a[0:3], a[68:71], v[4:7]
    s_add_u32 m0, s34, 81920
    ds_read_b64_tr_b16 a[32:33], v214 offset:8192
    v_mfma_f32_16x16x32_bf16 v[8:11], a[0:3], a[72:75], v[8:11]
    s_add_u32 s46, s51, 0
    ds_read_b64_tr_b16 a[34:35], v214 offset:9216
    buffer_load_dwordx4 v218, s[16:19], s46 offen  lds
    v_mfma_f32_16x16x32_bf16 v[12:15], a[0:3], a[76:79], v[12:15]
    ds_read_b128 a[84:87], v211 offset:18432
    v_mfma_f32_16x16x32_bf16 v[16:19], a[4:7], a[64:67], v[16:19]
    v_mfma_f32_16x16x32_bf16 v[20:23], a[4:7], a[68:71], v[20:23]
    ds_read_b128 a[88:91], v211 offset:20480
    v_mfma_f32_16x16x32_bf16 v[24:27], a[4:7], a[72:75], v[24:27]
    s_add_u32 m0, s34, 82944
    ds_read_b128 a[92:95], v211 offset:22528
    v_mfma_f32_16x16x32_bf16 v[28:31], a[4:7], a[76:79], v[28:31]
    s_add_u32 s46, s51, 9216
    ds_read_b64_tr_b16 a[36:37], v214 offset:8200
    buffer_load_dwordx4 v219, s[16:19], s46 offen  lds
    v_mfma_f32_16x16x32_bf16 v[32:35], a[8:11], a[64:67], v[32:35]
    v_mfma_f32_16x16x32_bf16 v[36:39], a[8:11], a[68:71], v[36:39]
    ds_read_b64_tr_b16 a[38:39], v214 offset:9224
    v_mfma_f32_16x16x32_bf16 v[40:43], a[8:11], a[72:75], v[40:43]
    ds_read_b64_tr_b16 a[40:41], v215 offset:8192
    v_mfma_f32_16x16x32_bf16 v[44:47], a[8:11], a[76:79], v[44:47]
    s_add_u32 m0, s34, 83968
    ds_read_b64_tr_b16 a[42:43], v215 offset:9216
    v_mfma_f32_16x16x32_bf16 v[48:51], a[12:15], a[64:67], v[48:51]
    s_add_u32 s46, s51, 18432
    buffer_load_dwordx4 v218, s[16:19], s46 offen  lds
    v_mfma_f32_16x16x32_bf16 v[52:55], a[12:15], a[68:71], v[52:55]
    ds_read_b64_tr_b16 a[44:45], v215 offset:8200
    v_mfma_f32_16x16x32_bf16 v[56:59], a[12:15], a[72:75], v[56:59]
    ds_read_b64_tr_b16 a[46:47], v215 offset:9224
    v_mfma_f32_16x16x32_bf16 v[60:63], a[12:15], a[76:79], v[60:63]
    ds_read_b64_tr_b16 a[48:49], v216 offset:8192
    v_mfma_f32_16x16x32_bf16 v[64:67], a[16:19], a[64:67], v[64:67]
    s_add_u32 m0, s34, 84992
    ds_read_b64_tr_b16 a[50:51], v216 offset:9216
    v_mfma_f32_16x16x32_bf16 v[68:71], a[16:19], a[68:71], v[68:71]
    s_add_u32 s46, s51, 27648
    buffer_load_dwordx4 v219, s[16:19], s46 offen  lds
    v_mfma_f32_16x16x32_bf16 v[72:75], a[16:19], a[72:75], v[72:75]
    ds_read_b64_tr_b16 a[52:53], v216 offset:8200
    v_mfma_f32_16x16x32_bf16 v[76:79], a[16:19], a[76:79], v[76:79]
    ds_read_b64_tr_b16 a[54:55], v216 offset:9224
    v_mfma_f32_16x16x32_bf16 v[80:83], a[20:23], a[64:67], v[80:83]
    ds_read_b64_tr_b16 a[56:57], v217 offset:8192
    v_mfma_f32_16x16x32_bf16 v[84:87], a[20:23], a[68:71], v[84:87]
    s_add_u32 m0, s34, 86016
    v_mfma_f32_16x16x32_bf16 v[88:91], a[20:23], a[72:75], v[88:91]
    s_add_u32 s46, s51, 36864
    ds_read_b64_tr_b16 a[58:59], v217 offset:9216
    buffer_load_dwordx4 v218, s[16:19], s46 offen  lds
    v_mfma_f32_16x16x32_bf16 v[92:95], a[20:23], a[76:79], v[92:95]
    ds_read_b64_tr_b16 a[60:61], v217 offset:8200
    v_mfma_f32_16x16x32_bf16 v[96:99], a[24:27], a[64:67], v[96:99]
    ds_read_b64_tr_b16 a[62:63], v217 offset:9224
    v_mfma_f32_16x16x32_bf16 v[100:103], a[24:27], a[68:71], v[100:103]
    v_mfma_f32_16x16x32_bf16 v[104:107], a[24:27], a[72:75], v[104:107]
    s_add_u32 m0, s34, 87040
    v_mfma_f32_16x16x32_bf16 v[108:111], a[24:27], a[76:79], v[108:111]
    s_add_u32 s46, s51, 46080
    buffer_load_dwordx4 v219, s[16:19], s46 offen  lds
    v_mfma_f32_16x16x32_bf16 v[112:115], a[28:31], a[64:67], v[112:115]
    v_mfma_f32_16x16x32_bf16 v[116:119], a[28:31], a[68:71], v[116:119]
    v_mfma_f32_16x16x32_bf16 v[120:123], a[28:31], a[72:75], v[120:123]
    v_mfma_f32_16x16x32_bf16 v[124:127], a[28:31], a[76:79], v[124:127]
    s_waitcnt lgkmcnt(0)
    s_waitcnt vmcnt(6)
    s_barrier
    v_mfma_f32_16x16x32_bf16 v[0:3], a[32:35], a[80:83], v[0:3]
    ds_read_b128 a[64:67], v210 offset:49152
    v_mfma_f32_16x16x32_bf16 v[4:7], a[32:35], a[84:87], v[4:7]
    s_add_u32 m0, s34, 88064
    ds_read_b64_tr_b16 a[0:1], v214 offset:16384
    v_mfma_f32_16x16x32_bf16 v[8:11], a[32:35], a[88:91], v[8:11]
    s_add_u32 s46, s51, 55296
    ds_read_b64_tr_b16 a[2:3], v214 offset:17408
    buffer_load_dwordx4 v218, s[16:19], s46 offen  lds
    v_mfma_f32_16x16x32_bf16 v[12:15], a[32:35], a[92:95], v[12:15]
    ds_read_b128 a[68:71], v210 offset:51200
    v_mfma_f32_16x16x32_bf16 v[16:19], a[36:39], a[80:83], v[16:19]
    v_mfma_f32_16x16x32_bf16 v[20:23], a[36:39], a[84:87], v[20:23]
    ds_read_b128 a[72:75], v210 offset:53248
    v_mfma_f32_16x16x32_bf16 v[24:27], a[36:39], a[88:91], v[24:27]
    s_add_u32 m0, s34, 89088
    ds_read_b128 a[76:79], v210 offset:55296
    v_mfma_f32_16x16x32_bf16 v[28:31], a[36:39], a[92:95], v[28:31]
    s_add_u32 s46, s51, 64512
    ds_read_b64_tr_b16 a[4:5], v214 offset:16392
    buffer_load_dwordx4 v219, s[16:19], s46 offen  lds
    v_mfma_f32_16x16x32_bf16 v[32:35], a[40:43], a[80:83], v[32:35]
    s_add_u32 s50, s50, 1
    v_mfma_f32_16x16x32_bf16 v[36:39], a[40:43], a[84:87], v[36:39]
    s_cmp_eq_u32 s50, 9
    ds_read_b64_tr_b16 a[6:7], v214 offset:17416
    v_mfma_f32_16x16x32_bf16 v[40:43], a[40:43], a[88:91], v[40:43]
    s_cselect_b32 s50, 0, s50
    ds_read_b64_tr_b16 a[8:9], v215 offset:16384
    v_mfma_f32_16x16x32_bf16 v[44:47], a[40:43], a[92:95], v[44:47]
    s_add_u32 m0, s35, 147456
    ds_read_b64_tr_b16 a[10:11], v215 offset:17408
    v_mfma_f32_16x16x32_bf16 v[48:51], a[44:47], a[80:83], v[48:51]
    s_add_u32 s46, s52, 0
    buffer_load_dwordx4 v220, s[20:23], s46 offen  lds
    v_mfma_f32_16x16x32_bf16 v[52:55], a[44:47], a[84:87], v[52:55]
    ds_read_b64_tr_b16 a[12:13], v215 offset:16392
    v_mfma_f32_16x16x32_bf16 v[56:59], a[44:47], a[88:91], v[56:59]
    ds_read_b64_tr_b16 a[14:15], v215 offset:17416
    v_mfma_f32_16x16x32_bf16 v[60:63], a[44:47], a[92:95], v[60:63]
    ds_read_b64_tr_b16 a[16:17], v216 offset:16384
    v_mfma_f32_16x16x32_bf16 v[64:67], a[48:51], a[80:83], v[64:67]
    s_add_u32 m0, s35, 148480
    ds_read_b64_tr_b16 a[18:19], v216 offset:17408
    v_mfma_f32_16x16x32_bf16 v[68:71], a[48:51], a[84:87], v[68:71]
    s_add_u32 s46, s52, 32768
    buffer_load_dwordx4 v220, s[20:23], s46 offen  lds
    v_mfma_f32_16x16x32_bf16 v[72:75], a[48:51], a[88:91], v[72:75]
    ds_read_b64_tr_b16 a[20:21], v216 offset:16392
    v_mfma_f32_16x16x32_bf16 v[76:79], a[48:51], a[92:95], v[76:79]
    ds_read_b64_tr_b16 a[22:23], v216 offset:17416
    v_mfma_f32_16x16x32_bf16 v[80:83], a[52:55], a[80:83], v[80:83]
    ds_read_b64_tr_b16 a[24:25], v217 offset:16384
    v_mfma_f32_16x16x32_bf16 v[84:87], a[52:55], a[84:87], v[84:87]
    s_add_u32 m0, s35, 149504
    v_mfma_f32_16x16x32_bf16 v[88:91], a[52:55], a[88:91], v[88:91]
    s_add_u32 s46, s52, 65536
    ds_read_b64_tr_b16 a[26:27], v217 offset:17408
    buffer_load_dwordx4 v220, s[20:23], s46 offen  lds
    v_mfma_f32_16x16x32_bf16 v[92:95], a[52:55], a[92:95], v[92:95]
    ds_read_b64_tr_b16 a[28:29], v217 offset:16392
    v_mfma_f32_16x16x32_bf16 v[96:99], a[56:59], a[80:83], v[96:99]
    ds_read_b64_tr_b16 a[30:31], v217 offset:17416
    v_mfma_f32_16x16x32_bf16 v[100:103], a[56:59], a[84:87], v[100:103]
    v_mfma_f32_16x16x32_bf16 v[104:107], a[56:59], a[88:91], v[104:107]
    s_add_u32 m0, s35, 150528
    v_mfma_f32_16x16x32_bf16 v[108:111], a[56:59], a[92:95], v[108:111]
    s_add_u32 s46, s52, 98304
    buffer_load_dwordx4 v220, s[20:23], s46 offen  lds
    v_mfma_f32_16x16x32_bf16 v[112:115], a[60:63], a[80:83], v[112:115]
    v_mfma_f32_16x16x32_bf16 v[116:119], a[60:63], a[84:87], v[116:119]
    v_mfma_f32_16x16x32_bf16 v[120:123], a[60:63], a[88:91], v[120:123]
    v_mfma_f32_16x16x32_bf16 v[124:127], a[60:63], a[92:95], v[124:127]
    s_waitcnt lgkmcnt(0)
    v_mfma_f32_16x16x32_bf16 v[0:3], a[0:3], a[64:67], v[0:3]
    s_lshl_b32 s51, s50, 7
    s_lshl_b32 s52, s50, 19
    ds_read_b128 a[80:83], v211 offset:49152
    v_mfma_f32_16x16x32_bf16 v[4:7], a[0:3], a[68:71], v[4:7]
    s_add_u32 m0, s34, 16384
    ds_read_b64_tr_b16 a[32:33], v214 offset:24576
    v_mfma_f32_16x16x32_bf16 v[8:11], a[0:3], a[72:75], v[8:11]
    s_add_u32 s46, s51, 0
    ds_read_b64_tr_b16 a[34:35], v214 offset:25600
    buffer_load_dwordx4 v218, s[16:19], s46 offen  lds
    v_mfma_f32_16x16x32_bf16 v[12:15], a[0:3], a[76:79], v[12:15]
    ds_read_b128 a[84:87], v211 offset:51200
    v_mfma_f32_16x16x32_bf16 v[16:19], a[4:7], a[64:67], v[16:19]
    v_mfma_f32_16x16x32_bf16 v[20:23], a[4:7], a[68:71], v[20:23]
    ds_read_b128 a[88:91], v211 offset:53248
    v_mfma_f32_16x16x32_bf16 v[24:27], a[4:7], a[72:75], v[24:27]
    s_add_u32 m0, s34, 17408
    ds_read_b128 a[92:95], v211 offset:55296
    v_mfma_f32_16x16x32_bf16 v[28:31], a[4:7], a[76:79], v[28:31]
    s_add_u32 s46, s51, 9216
    ds_read_b64_tr_b16 a[36:37], v214 offset:24584
    buffer_load_dwordx4 v219, s[16:19], s46 offen  lds
    v_mfma_f32_16x16x32_bf16 v[32:35], a[8:11], a[64:67], v[32:35]
    v_mfma_f32_16x16x32_bf16 v[36:39], a[8:11], a[68:71], v[36:39]
    ds_read_b64_tr_b16 a[38:39], v214 offset:25608
    v_mfma_f32_16x16x32_bf16 v[40:43], a[8:11], a[72:75], v[40:43]
    ds_read_b64_tr_b16 a[40:41], v215 offset:24576
    v_mfma_f32_16x16x32_bf16 v[44:47], a[8:11], a[76:79], v[44:47]
    s_add_u32 m0, s34, 18432
    ds_read_b64_tr_b16 a[42:43], v215 offset:25600
    v_mfma_f32_16x16x32_bf16 v[48:51], a[12:15], a[64:67], v[48:51]
    s_add_u32 s46, s51, 18432
    buffer_load_dwordx4 v218, s[16:19], s46 offen  lds
    v_mfma_f32_16x16x32_bf16 v[52:55], a[12:15], a[68:71], v[52:55]
    ds_read_b64_tr_b16 a[44:45], v215 offset:24584
    v_mfma_f32_16x16x32_bf16 v[56:59], a[12:15], a[72:75], v[56:59]
    ds_read_b64_tr_b16 a[46:47], v215 offset:25608
    v_mfma_f32_16x16x32_bf16 v[60:63], a[12:15], a[76:79], v[60:63]
    ds_read_b64_tr_b16 a[48:49], v216 offset:24576
    v_mfma_f32_16x16x32_bf16 v[64:67], a[16:19], a[64:67], v[64:67]
    s_add_u32 m0, s34, 19456
    ds_read_b64_tr_b16 a[50:51], v216 offset:25600
    v_mfma_f32_16x16x32_bf16 v[68:71], a[16:19], a[68:71], v[68:71]
    s_add_u32 s46, s51, 27648
    buffer_load_dwordx4 v219, s[16:19], s46 offen  lds
    v_mfma_f32_16x16x32_bf16 v[72:75], a[16:19], a[72:75], v[72:75]
    ds_read_b64_tr_b16 a[52:53], v216 offset:24584
    v_mfma_f32_16x16x32_bf16 v[76:79], a[16:19], a[76:79], v[76:79]
    ds_read_b64_tr_b16 a[54:55], v216 offset:25608
    v_mfma_f32_16x16x32_bf16 v[80:83], a[20:23], a[64:67], v[80:83]
    ds_read_b64_tr_b16 a[56:57], v217 offset:24576
    v_mfma_f32_16x16x32_bf16 v[84:87], a[20:23], a[68:71], v[84:87]
    s_add_u32 m0, s34, 20480
    v_mfma_f32_16x16x32_bf16 v[88:91], a[20:23], a[72:75], v[88:91]
    s_add_u32 s46, s51, 36864
    ds_read_b64_tr_b16 a[58:59], v217 offset:25600
    buffer_load_dwordx4 v218, s[16:19], s46 offen  lds
    v_mfma_f32_16x16x32_bf16 v[92:95], a[20:23], a[76:79], v[92:95]
    ds_read_b64_tr_b16 a[60:61], v217 offset:24584
    v_mfma_f32_16x16x32_bf16 v[96:99], a[24:27], a[64:67], v[96:99]
    ds_read_b64_tr_b16 a[62:63], v217 offset:25608
    v_mfma_f32_16x16x32_bf16 v[100:103], a[24:27], a[68:71], v[100:103]
    v_mfma_f32_16x16x32_bf16 v[104:107], a[24:27], a[72:75], v[104:107]
    s_add_u32 m0, s34, 21504
    v_mfma_f32_16x16x32_bf16 v[108:111], a[24:27], a[76:79], v[108:111]
    s_add_u32 s46, s51, 46080
    buffer_load_dwordx4 v219, s[16:19], s46 offen  lds
    v_mfma_f32_16x16x32_bf16 v[112:115], a[28:31], a[64:67], v[112:115]
    v_mfma_f32_16x16x32_bf16 v[116:119], a[28:31], a[68:71], v[116:119]
    v_mfma_f32_16x16x32_bf16 v[120:123], a[28:31], a[72:75], v[120:123]
    v_mfma_f32_16x16x32_bf16 v[124:127], a[28:31], a[76:79], v[124:127]
    s_waitcnt lgkmcnt(0)
    s_waitcnt vmcnt(6)
    s_barrier
    v_mfma_f32_16x16x32_bf16 v[0:3], a[32:35], a[80:83], v[0:3]
    ds_read_b128 a[64:67], v212 offset:16384
    v_mfma_f32_16x16x32_bf16 v[4:7], a[32:35], a[84:87], v[4:7]
    s_add_u32 m0, s34, 22528
    ds_read_b64_tr_b16 a[0:1], v214 offset:32768
    v_mfma_f32_16x16x32_bf16 v[8:11], a[32:35], a[88:91], v[8:11]
    s_add_u32 s46, s51, 55296
    ds_read_b64_tr_b16 a[2:3], v214 offset:33792
    buffer_load_dwordx4 v218, s[16:19], s46 offen  lds
    v_mfma_f32_16x16x32_bf16 v[12:15], a[32:35], a[92:95], v[12:15]
    ds_read_b128 a[68:71], v212 offset:18432
    v_mfma_f32_16x16x32_bf16 v[16:19], a[36:39], a[80:83], v[16:19]
    v_mfma_f32_16x16x32_bf16 v[20:23], a[36:39], a[84:87], v[20:23]
    ds_read_b128 a[72:75], v212 offset:20480
    v_mfma_f32_16x16x32_bf16 v[24:27], a[36:39], a[88:91], v[24:27]
    s_add_u32 m0, s34, 23552
    ds_read_b128 a[76:79], v212 offset:22528
    v_mfma_f32_16x16x32_bf16 v[28:31], a[36:39], a[92:95], v[28:31]
    s_add_u32 s46, s51, 64512
    ds_read_b64_tr_b16 a[4:5], v214 offset:32776
    buffer_load_dwordx4 v219, s[16:19], s46 offen  lds
    v_mfma_f32_16x16x32_bf16 v[32:35], a[40:43], a[80:83], v[32:35]
    s_add_u32 s50, s50, 1
    v_mfma_f32_16x16x32_bf16 v[36:39], a[40:43], a[84:87], v[36:39]
    s_cmp_eq_u32 s50, 9
    ds_read_b64_tr_b16 a[6:7], v214 offset:33800
    v_mfma_f32_16x16x32_bf16 v[40:43], a[40:43], a[88:91], v[40:43]
    s_cselect_b32 s50, 0, s50
    ds_read_b64_tr_b16 a[8:9], v215 offset:32768
    v_mfma_f32_16x16x32_bf16 v[44:47], a[40:43], a[92:95], v[44:47]
    s_add_u32 m0, s35, 114688
    ds_read_b64_tr_b16 a[10:11], v215 offset:33792
    v_mfma_f32_16x16x32_bf16 v[48:51], a[44:47], a[80:83], v[48:51]
    s_add_u32 s46, s52, 0
    buffer_load_dwordx4 v220, s[20:23], s46 offen  lds
    v_mfma_f32_16x16x32_bf16 v[52:55], a[44:47], a[84:87], v[52:55]
    ds_read_b64_tr_b16 a[12:13], v215 offset:32776
    v_mfma_f32_16x16x32_bf16 v[56:59], a[44:47], a[88:91], v[56:59]
    ds_read_b64_tr_b16 a[14:15], v215 offset:33800
    v_mfma_f32_16x16x32_bf16 v[60:63], a[44:47], a[92:95], v[60:63]
    ds_read_b64_tr_b16 a[16:17], v216 offset:32768
    v_mfma_f32_16x16x32_bf16 v[64:67], a[48:51], a[80:83], v[64:67]
    s_add_u32 m0, s35, 115712
    ds_read_b64_tr_b16 a[18:19], v216 offset:33792
    v_mfma_f32_16x16x32_bf16 v[68:71], a[48:51], a[84:87], v[68:71]
    s_add_u32 s46, s52, 32768
    buffer_load_dwordx4 v220, s[20:23], s46 offen  lds
    v_mfma_f32_16x16x32_bf16 v[72:75], a[48:51], a[88:91], v[72:75]
    ds_read_b64_tr_b16 a[20:21], v216 offset:32776
    v_mfma_f32_16x16x32_bf16 v[76:79], a[48:51], a[92:95], v[76:79]
    ds_read_b64_tr_b16 a[22:23], v216 offset:33800
    v_mfma_f32_16x16x32_bf16 v[80:83], a[52:55], a[80:83], v[80:83]
    ds_read_b64_tr_b16 a[24:25], v217 offset:32768
    v_mfma_f32_16x16x32_bf16 v[84:87], a[52:55], a[84:87], v[84:87]
    s_add_u32 m0, s35, 116736
    v_mfma_f32_16x16x32_bf16 v[88:91], a[52:55], a[88:91], v[88:91]
    s_add_u32 s46, s52, 65536
    ds_read_b64_tr_b16 a[26:27], v217 offset:33792
    buffer_load_dwordx4 v220, s[20:23], s46 offen  lds
    v_mfma_f32_16x16x32_bf16 v[92:95], a[52:55], a[92:95], v[92:95]
    ds_read_b64_tr_b16 a[28:29], v217 offset:32776
    v_mfma_f32_16x16x32_bf16 v[96:99], a[56:59], a[80:83], v[96:99]
    ds_read_b64_tr_b16 a[30:31], v217 offset:33800
    v_mfma_f32_16x16x32_bf16 v[100:103], a[56:59], a[84:87], v[100:103]
    v_mfma_f32_16x16x32_bf16 v[104:107], a[56:59], a[88:91], v[104:107]
    s_add_u32 m0, s35, 117760
    v_mfma_f32_16x16x32_bf16 v[108:111], a[56:59], a[92:95], v[108:111]
    s_add_u32 s46, s52, 98304
    buffer_load_dwordx4 v220, s[20:23], s46 offen  lds
    v_mfma_f32_16x16x32_bf16 v[112:115], a[60:63], a[80:83], v[112:115]
    v_mfma_f32_16x16x32_bf16 v[116:119], a[60:63], a[84:87], v[116:119]
    v_mfma_f32_16x16x32_bf16 v[120:123], a[60:63], a[88:91], v[120:123]
    v_mfma_f32_16x16x32_bf16 v[124:127], a[60:63], a[92:95], v[124:127]
    s_waitcnt lgkmcnt(0)
    v_mfma_f32_16x16x32_bf16 v[0:3], a[0:3], a[64:67], v[0:3]
    s_lshl_b32 s51, s50, 7
    s_lshl_b32 s52, s50, 19
    ds_read_b128 a[80:83], v213 offset:16384
    v_mfma_f32_16x16x32_bf16 v[4:7], a[0:3], a[68:71], v[4:7]
    s_add_u32 m0, s34, 49152
    ds_read_b64_tr_b16 a[32:33], v214 offset:40960
    v_mfma_f32_16x16x32_bf16 v[8:11], a[0:3], a[72:75], v[8:11]
    s_add_u32 s46, s51, 0
    ds_read_b64_tr_b16 a[34:35], v214 offset:41984
    buffer_load_dwordx4 v218, s[16:19], s46 offen  lds
    v_mfma_f32_16x16x32_bf16 v[12:15], a[0:3], a[76:79], v[12:15]
    ds_read_b128 a[84:87], v213 offset:18432
    v_mfma_f32_16x16x32_bf16 v[16:19], a[4:7], a[64:67], v[16:19]
    v_mfma_f32_16x16x32_bf16 v[20:23], a[4:7], a[68:71], v[20:23]
    ds_read_b128 a[88:91], v213 offset:20480
    v_mfma_f32_16x16x32_bf16 v[24:27], a[4:7], a[72:75], v[24:27]
    s_add_u32 m0, s34, 50176
    ds_read_b128 a[92:95], v213 offset:22528
    v_mfma_f32_16x16x32_bf16 v[28:31], a[4:7], a[76:79], v[28:31]
    s_add_u32 s46, s51, 9216
    ds_read_b64_tr_b16 a[36:37], v214 offset:40968
    buffer_load_dwordx4 v219, s[16:19], s46 offen  lds
    v_mfma_f32_16x16x32_bf16 v[32:35], a[8:11], a[64:67], v[32:35]
    v_mfma_f32_16x16x32_bf16 v[36:39], a[8:11], a[68:71], v[36:39]
    ds_read_b64_tr_b16 a[38:39], v214 offset:41992
    v_mfma_f32_16x16x32_bf16 v[40:43], a[8:11], a[72:75], v[40:43]
    ds_read_b64_tr_b16 a[40:41], v215 offset:40960
    v_mfma_f32_16x16x32_bf16 v[44:47], a[8:11], a[76:79], v[44:47]
    s_add_u32 m0, s34, 51200
    ds_read_b64_tr_b16 a[42:43], v215 offset:41984
    v_mfma_f32_16x16x32_bf16 v[48:51], a[12:15], a[64:67], v[48:51]
    s_add_u32 s46, s51, 18432
    buffer_load_dwordx4 v218, s[16:19], s46 offen  lds
    v_mfma_f32_16x16x32_bf16 v[52:55], a[12:15], a[68:71], v[52:55]
    ds_read_b64_tr_b16 a[44:45], v215 offset:40968
    v_mfma_f32_16x16x32_bf16 v[56:59], a[12:15], a[72:75], v[56:59]
    ds_read_b64_tr_b16 a[46:47], v215 offset:41992
    v_mfma_f32_16x16x32_bf16 v[60:63], a[12:15], a[76:79], v[60:63]
    ds_read_b64_tr_b16 a[48:49], v216 offset:40960
    v_mfma_f32_16x16x32_bf16 v[64:67], a[16:19], a[64:67], v[64:67]
    s_add_u32 m0, s34, 52224
    ds_read_b64_tr_b16 a[50:51], v216 offset:41984
    v_mfma_f32_16x16x32_bf16 v[68:71], a[16:19], a[68:71], v[68:71]
    s_add_u32 s46, s51, 27648
    buffer_load_dwordx4 v219, s[16:19], s46 offen  lds
    v_mfma_f32_16x16x32_bf16 v[72:75], a[16:19], a[72:75], v[72:75]
    ds_read_b64_tr_b16 a[52:53], v216 offset:40968
    v_mfma_f32_16x16x32_bf16 v[76:79], a[16:19], a[76:79], v[76:79]
    ds_read_b64_tr_b16 a[54:55], v216 offset:41992
    v_mfma_f32_16x16x32_bf16 v[80:83], a[20:23], a[64:67], v[80:83]
    ds_read_b64_tr_b16 a[56:57], v217 offset:40960
    v_mfma_f32_16x16x32_bf16 v[84:87], a[20:23], a[68:71], v[84:87]
    s_add_u32 m0, s34, 53248
    v_mfma_f32_16x16x32_bf16 v[88:91], a[20:23], a[72:75], v[88:91]
    s_add_u32 s46, s51, 36864
    ds_read_b64_tr_b16 a[58:59], v217 offset:41984
    buffer_load_dwordx4 v218, s[16:19], s46 offen  lds
    v_mfma_f32_16x16x32_bf16 v[92:95], a[20:23], a[76:79], v[92:95]
    ds_read_b64_tr_b16 a[60:61], v217 offset:40968
    v_mfma_f32_16x16x32_bf16 v[96:99], a[24:27], a[64:67], v[96:99]
    ds_read_b64_tr_b16 a[62:63], v217 offset:41992
    v_mfma_f32_16x16x32_bf16 v[100:103], a[24:27], a[68:71], v[100:103]
    v_mfma_f32_16x16x32_bf16 v[104:107], a[24:27], a[72:75], v[104:107]
    s_add_u32 m0, s34, 54272
    v_mfma_f32_16x16x32_bf16 v[108:111], a[24:27], a[76:79], v[108:111]
    s_add_u32 s46, s51, 46080
    buffer_load_dwordx4 v219, s[16:19], s46 offen  lds
    v_mfma_f32_16x16x32_bf16 v[112:115], a[28:31], a[64:67], v[112:115]
    v_mfma_f32_16x16x32_bf16 v[116:119], a[28:31], a[68:71], v[116:119]
    v_mfma_f32_16x16x32_bf16 v[120:123], a[28:31], a[72:75], v[120:123]
    v_mfma_f32_16x16x32_bf16 v[124:127], a[28:31], a[76:79], v[124:127]
    s_waitcnt lgkmcnt(0)
    s_waitcnt vmcnt(6)
    s_barrier
    v_mfma_f32_16x16x32_bf16 v[0:3], a[32:35], a[80:83], v[0:3]
    ds_read_b128 a[64:67], v210 offset:16384
    v_mfma_f32_16x16x32_bf16 v[4:7], a[32:35], a[84:87], v[4:7]
    s_add_u32 m0, s34, 55296
    ds_read_b64_tr_b16 a[0:1], v214 offset:0
    v_mfma_f32_16x16x32_bf16 v[8:11], a[32:35], a[88:91], v[8:11]
    s_add_u32 s46, s51, 55296
    ds_read_b64_tr_b16 a[2:3], v214 offset:1024
    buffer_load_dwordx4 v218, s[16:19], s46 offen  lds
    v_mfma_f32_16x16x32_bf16 v[12:15], a[32:35], a[92:95], v[12:15]
    ds_read_b128 a[68:71], v210 offset:18432
    v_mfma_f32_16x16x32_bf16 v[16:19], a[36:39], a[80:83], v[16:19]
    v_mfma_f32_16x16x32_bf16 v[20:23], a[36:39], a[84:87], v[20:23]
    ds_read_b128 a[72:75], v210 offset:20480
    v_mfma_f32_16x16x32_bf16 v[24:27], a[36:39], a[88:91], v[24:27]
    s_add_u32 m0, s34, 56320
    ds_read_b128 a[76:79], v210 offset:22528
    v_mfma_f32_16x16x32_bf16 v[28:31], a[36:39], a[92:95], v[28:31]
    s_add_u32 s46, s51, 64512
    ds_read_b64_tr_b16 a[4:5], v214 offset:8
    buffer_load_dwordx4 v219, s[16:19], s46 offen  lds
    v_mfma_f32_16x16x32_bf16 v[32:35], a[40:43], a[80:83], v[32:35]
    s_add_u32 s50, s50, 1
    v_mfma_f32_16x16x32_bf16 v[36:39], a[40:43], a[84:87], v[36:39]
    s_cmp_eq_u32 s50, 9
    ds_read_b64_tr_b16 a[6:7], v214 offset:1032
    v_mfma_f32_16x16x32_bf16 v[40:43], a[40:43], a[88:91], v[40:43]
    s_cselect_b32 s50, 0, s50
    ds_read_b64_tr_b16 a[8:9], v215 offset:0
    v_mfma_f32_16x16x32_bf16 v[44:47], a[40:43], a[92:95], v[44:47]
    s_add_u32 m0, s35, 131072
    ds_read_b64_tr_b16 a[10:11], v215 offset:1024
    v_mfma_f32_16x16x32_bf16 v[48:51], a[44:47], a[80:83], v[48:51]
    s_add_u32 s46, s52, 0
    buffer_load_dwordx4 v220, s[20:23], s46 offen  lds
    v_mfma_f32_16x16x32_bf16 v[52:55], a[44:47], a[84:87], v[52:55]
    ds_read_b64_tr_b16 a[12:13], v215 offset:8
    v_mfma_f32_16x16x32_bf16 v[56:59], a[44:47], a[88:91], v[56:59]
    ds_read_b64_tr_b16 a[14:15], v215 offset:1032
    v_mfma_f32_16x16x32_bf16 v[60:63], a[44:47], a[92:95], v[60:63]
    ds_read_b64_tr_b16 a[16:17], v216 offset:0
    v_mfma_f32_16x16x32_bf16 v[64:67], a[48:51], a[80:83], v[64:67]
    s_add_u32 m0, s35, 132096
    ds_read_b64_tr_b16 a[18:19], v216 offset:1024
    v_mfma_f32_16x16x32_bf16 v[68:71], a[48:51], a[84:87], v[68:71]
    s_add_u32 s46, s52, 32768
    buffer_load_dwordx4 v220, s[20:23], s46 offen  lds
    v_mfma_f32_16x16x32_bf16 v[72:75], a[48:51], a[88:91], v[72:75]
    ds_read_b64_tr_b16 a[20:21], v216 offset:8
    v_mfma_f32_16x16x32_bf16 v[76:79], a[48:51], a[92:95], v[76:79]
    ds_read_b64_tr_b16 a[22:23], v216 offset:1032
    v_mfma_f32_16x16x32_bf16 v[80:83], a[52:55], a[80:83], v[80:83]
    ds_read_b64_tr_b16 a[24:25], v217 offset:0
    v_mfma_f32_16x16x32_bf16 v[84:87], a[52:55], a[84:87], v[84:87]
    s_add_u32 m0, s35, 133120
    v_mfma_f32_16x16x32_bf16 v[88:91], a[52:55], a[88:91], v[88:91]
    s_add_u32 s46, s52, 65536
    ds_read_b64_tr_b16 a[26:27], v217 offset:1024
    buffer_load_dwordx4 v220, s[20:23], s46 offen  lds
    v_mfma_f32_16x16x32_bf16 v[92:95], a[52:55], a[92:95], v[92:95]
    ds_read_b64_tr_b16 a[28:29], v217 offset:8
    v_mfma_f32_16x16x32_bf16 v[96:99], a[56:59], a[80:83], v[96:99]
    ds_read_b64_tr_b16 a[30:31], v217 offset:1032
    v_mfma_f32_16x16x32_bf16 v[100:103], a[56:59], a[84:87], v[100:103]
    v_mfma_f32_16x16x32_bf16 v[104:107], a[56:59], a[88:91], v[104:107]
    s_add_u32 m0, s35, 134144
    v_mfma_f32_16x16x32_bf16 v[108:111], a[56:59], a[92:95], v[108:111]
    s_add_u32 s46, s52, 98304
    buffer_load_dwordx4 v220, s[20:23], s46 offen  lds
    v_mfma_f32_16x16x32_bf16 v[112:115], a[60:63], a[80:83], v[112:115]
    v_mfma_f32_16x16x32_bf16 v[116:119], a[60:63], a[84:87], v[116:119]
    v_mfma_f32_16x16x32_bf16 v[120:123], a[60:63], a[88:91], v[120:123]
    v_mfma_f32_16x16x32_bf16 v[124:127], a[60:63], a[92:95], v[124:127]
    s_waitcnt lgkmcnt(0)
    v_mfma_f32_16x16x32_bf16 v[0:3], a[0:3], a[64:67], v[0:3]
    s_lshl_b32 s51, s50, 7
    s_lshl_b32 s52, s50, 19
    ds_read_b128 a[80:83], v211 offset:16384
    v_mfma_f32_16x16x32_bf16 v[4:7], a[0:3], a[68:71], v[4:7]
    s_add_u32 m0, s34, 81920
    ds_read_b64_tr_b16 a[32:33], v214 offset:8192
    v_mfma_f32_16x16x32_bf16 v[8:11], a[0:3], a[72:75], v[8:11]
    s_add_u32 s46, s51, 0
    ds_read_b64_tr_b16 a[34:35], v214 offset:9216
    buffer_load_dwordx4 v218, s[16:19], s46 offen  lds
    v_mfma_f32_16x16x32_bf16 v[12:15], a[0:3], a[76:79], v[12:15]
    ds_read_b128 a[84:87], v211 offset:18432
    v_mfma_f32_16x16x32_bf16 v[16:19], a[4:7], a[64:67], v[16:19]
    v_mfma_f32_16x16x32_bf16 v[20:23], a[4:7], a[68:71], v[20:23]
    ds_read_b128 a[88:91], v211 offset:20480
    v_mfma_f32_16x16x32_bf16 v[24:27], a[4:7], a[72:75], v[24:27]
    s_add_u32 m0, s34, 82944
    ds_read_b128 a[92:95], v211 offset:22528
    v_mfma_f32_16x16x32_bf16 v[28:31], a[4:7], a[76:79], v[28:31]
    s_add_u32 s46, s51, 9216
    ds_read_b64_tr_b16 a[36:37], v214 offset:8200
    buffer_load_dwordx4 v219, s[16:19], s46 offen  lds
    v_mfma_f32_16x16x32_bf16 v[32:35], a[8:11], a[64:67], v[32:35]
    v_mfma_f32_16x16x32_bf16 v[36:39], a[8:11], a[68:71], v[36:39]
    ds_read_b64_tr_b16 a[38:39], v214 offset:9224
    v_mfma_f32_16x16x32_bf16 v[40:43], a[8:11], a[72:75], v[40:43]
    ds_read_b64_tr_b16 a[40:41], v215 offset:8192
    v_mfma_f32_16x16x32_bf16 v[44:47], a[8:11], a[76:79], v[44:47]
    s_add_u32 m0, s34, 83968
    ds_read_b64_tr_b16 a[42:43], v215 offset:9216
    v_mfma_f32_16x16x32_bf16 v[48:51], a[12:15], a[64:67], v[48:51]
    s_add_u32 s46, s51, 18432
    buffer_load_dwordx4 v218, s[16:19], s46 offen  lds
    v_mfma_f32_16x16x32_bf16 v[52:55], a[12:15], a[68:71], v[52:55]
    ds_read_b64_tr_b16 a[44:45], v215 offset:8200
    v_mfma_f32_16x16x32_bf16 v[56:59], a[12:15], a[72:75], v[56:59]
    ds_read_b64_tr_b16 a[46:47], v215 offset:9224
    v_mfma_f32_16x16x32_bf16 v[60:63], a[12:15], a[76:79], v[60:63]
    ds_read_b64_tr_b16 a[48:49], v216 offset:8192
    v_mfma_f32_16x16x32_bf16 v[64:67], a[16:19], a[64:67], v[64:67]
    s_add_u32 m0, s34, 84992
    ds_read_b64_tr_b16 a[50:51], v216 offset:9216
    v_mfma_f32_16x16x32_bf16 v[68:71], a[16:19], a[68:71], v[68:71]
    s_add_u32 s46, s51, 27648
    buffer_load_dwordx4 v219, s[16:19], s46 offen  lds
    v_mfma_f32_16x16x32_bf16 v[72:75], a[16:19], a[72:75], v[72:75]
    ds_read_b64_tr_b16 a[52:53], v216 offset:8200
    v_mfma_f32_16x16x32_bf16 v[76:79], a[16:19], a[76:79], v[76:79]
    ds_read_b64_tr_b16 a[54:55], v216 offset:9224
    v_mfma_f32_16x16x32_bf16 v[80:83], a[20:23], a[64:67], v[80:83]
    ds_read_b64_tr_b16 a[56:57], v217 offset:8192
    v_mfma_f32_16x16x32_bf16 v[84:87], a[20:23], a[68:71], v[84:87]
    s_add_u32 m0, s34, 86016
    v_mfma_f32_16x16x32_bf16 v[88:91], a[20:23], a[72:75], v[88:91]
    s_add_u32 s46, s51, 36864
    ds_read_b64_tr_b16 a[58:59], v217 offset:9216
    buffer_load_dwordx4 v218, s[16:19], s46 offen  lds
    v_mfma_f32_16x16x32_bf16 v[92:95], a[20:23], a[76:79], v[92:95]
    ds_read_b64_tr_b16 a[60:61], v217 offset:8200
    v_mfma_f32_16x16x32_bf16 v[96:99], a[24:27], a[64:67], v[96:99]
    ds_read_b64_tr_b16 a[62:63], v217 offset:9224
    v_mfma_f32_16x16x32_bf16 v[100:103], a[24:27], a[68:71], v[100:103]
    v_mfma_f32_16x16x32_bf16 v[104:107], a[24:27], a[72:75], v[104:107]
    s_add_u32 m0, s34, 87040
    v_mfma_f32_16x16x32_bf16 v[108:111], a[24:27], a[76:79], v[108:111]
    s_add_u32 s46, s51, 46080
    buffer_load_dwordx4 v219, s[16:19], s46 offen  lds
    v_mfma_f32_16x16x32_bf16 v[112:115], a[28:31], a[64:67], v[112:115]
    v_mfma_f32_16x16x32_bf16 v[116:119], a[28:31], a[68:71], v[116:119]
    v_mfma_f32_16x16x32_bf16 v[120:123], a[28:31], a[72:75], v[120:123]
    v_mfma_f32_16x16x32_bf16 v[124:127], a[28:31], a[76:79], v[124:127]
    s_waitcnt lgkmcnt(0)
    s_waitcnt vmcnt(6)
    s_barrier
    v_mfma_f32_16x16x32_bf16 v[0:3], a[32:35], a[80:83], v[0:3]
    ds_read_b128 a[64:67], v210 offset:49152
    v_mfma_f32_16x16x32_bf16 v[4:7], a[32:35], a[84:87], v[4:7]
    s_add_u32 m0, s34, 88064
    ds_read_b64_tr_b16 a[0:1], v214 offset:16384
    v_mfma_f32_16x16x32_bf16 v[8:11], a[32:35], a[88:91], v[8:11]
    s_add_u32 s46, s51, 55296
    ds_read_b64_tr_b16 a[2:3], v214 offset:17408
    buffer_load_dwordx4 v218, s[16:19], s46 offen  lds
    v_mfma_f32_16x16x32_bf16 v[12:15], a[32:35], a[92:95], v[12:15]
    ds_read_b128 a[68:71], v210 offset:51200
    v_mfma_f32_16x16x32_bf16 v[16:19], a[36:39], a[80:83], v[16:19]
    v_mfma_f32_16x16x32_bf16 v[20:23], a[36:39], a[84:87], v[20:23]
    ds_read_b128 a[72:75], v210 offset:53248
    v_mfma_f32_16x16x32_bf16 v[24:27], a[36:39], a[88:91], v[24:27]
    s_add_u32 m0, s34, 89088
    ds_read_b128 a[76:79], v210 offset:55296
    v_mfma_f32_16x16x32_bf16 v[28:31], a[36:39], a[92:95], v[28:31]
    s_add_u32 s46, s51, 64512
    ds_read_b64_tr_b16 a[4:5], v214 offset:16392
    buffer_load_dwordx4 v219, s[16:19], s46 offen  lds
    v_mfma_f32_16x16x32_bf16 v[32:35], a[40:43], a[80:83], v[32:35]
    s_add_u32 s50, s50, 1
    v_mfma_f32_16x16x32_bf16 v[36:39], a[40:43], a[84:87], v[36:39]
    s_cmp_eq_u32 s50, 9
    ds_read_b64_tr_b16 a[6:7], v214 offset:17416
    v_mfma_f32_16x16x32_bf16 v[40:43], a[40:43], a[88:91], v[40:43]
    s_cselect_b32 s50, 0, s50
    ds_read_b64_tr_b16 a[8:9], v215 offset:16384
    v_mfma_f32_16x16x32_bf16 v[44:47], a[40:43], a[92:95], v[44:47]
    s_add_u32 m0, s35, 147456
    ds_read_b64_tr_b16 a[10:11], v215 offset:17408
    v_mfma_f32_16x16x32_bf16 v[48:51], a[44:47], a[80:83], v[48:51]
    s_add_u32 s46, s52, 0
    buffer_load_dwordx4 v220, s[20:23], s46 offen  lds
    v_mfma_f32_16x16x32_bf16 v[52:55], a[44:47], a[84:87], v[52:55]
    ds_read_b64_tr_b16 a[12:13], v215 offset:16392
    v_mfma_f32_16x16x32_bf16 v[56:59], a[44:47], a[88:91], v[56:59]
    ds_read_b64_tr_b16 a[14:15], v215 offset:17416
    v_mfma_f32_16x16x32_bf16 v[60:63], a[44:47], a[92:95], v[60:63]
    ds_read_b64_tr_b16 a[16:17], v216 offset:16384
    v_mfma_f32_16x16x32_bf16 v[64:67], a[48:51], a[80:83], v[64:67]
    s_add_u32 m0, s35, 148480
    ds_read_b64_tr_b16 a[18:19], v216 offset:17408
    v_mfma_f32_16x16x32_bf16 v[68:71], a[48:51], a[84:87], v[68:71]
    s_add_u32 s46, s52, 32768
    buffer_load_dwordx4 v220, s[20:23], s46 offen  lds
    v_mfma_f32_16x16x32_bf16 v[72:75], a[48:51], a[88:91], v[72:75]
    ds_read_b64_tr_b16 a[20:21], v216 offset:16392
    v_mfma_f32_16x16x32_bf16 v[76:79], a[48:51], a[92:95], v[76:79]
    ds_read_b64_tr_b16 a[22:23], v216 offset:17416
    v_mfma_f32_16x16x32_bf16 v[80:83], a[52:55], a[80:83], v[80:83]
    ds_read_b64_tr_b16 a[24:25], v217 offset:16384
    v_mfma_f32_16x16x32_bf16 v[84:87], a[52:55], a[84:87], v[84:87]
    s_add_u32 m0, s35, 149504
    v_mfma_f32_16x16x32_bf16 v[88:91], a[52:55], a[88:91], v[88:91]
    s_add_u32 s46, s52, 65536
    ds_read_b64_tr_b16 a[26:27], v217 offset:17408
    buffer_load_dwordx4 v220, s[20:23], s46 offen  lds
    v_mfma_f32_16x16x32_bf16 v[92:95], a[52:55], a[92:95], v[92:95]
    ds_read_b64_tr_b16 a[28:29], v217 offset:16392
    v_mfma_f32_16x16x32_bf16 v[96:99], a[56:59], a[80:83], v[96:99]
    ds_read_b64_tr_b16 a[30:31], v217 offset:17416
    v_mfma_f32_16x16x32_bf16 v[100:103], a[56:59], a[84:87], v[100:103]
    v_mfma_f32_16x16x32_bf16 v[104:107], a[56:59], a[88:91], v[104:107]
    s_add_u32 m0, s35, 150528
    v_mfma_f32_16x16x32_bf16 v[108:111], a[56:59], a[92:95], v[108:111]
    s_add_u32 s46, s52, 98304
    buffer_load_dwordx4 v220, s[20:23], s46 offen  lds
    v_mfma_f32_16x16x32_bf16 v[112:115], a[60:63], a[80:83], v[112:115]
    v_mfma_f32_16x16x32_bf16 v[116:119], a[60:63], a[84:87], v[116:119]
    v_mfma_f32_16x16x32_bf16 v[120:123], a[60:63], a[88:91], v[120:123]
    v_mfma_f32_16x16x32_bf16 v[124:127], a[60:63], a[92:95], v[124:127]
    s_waitcnt lgkmcnt(0)
    v_mfma_f32_16x16x32_bf16 v[0:3], a[0:3], a[64:67], v[0:3]
    ds_read_b128 a[80:83], v211 offset:49152
    s_lshr_b32 s57, s2, 3
    s_min_u32 s93, s57, 29
    v_mfma_f32_16x16x32_bf16 v[4:7], a[0:3], a[68:71], v[4:7]
    ds_read_b64_tr_b16 a[32:33], v214 offset:24576
    s_mul_i32 s58, s93, 43
    s_lshr_b32 s58, s58, 8
    v_mfma_f32_16x16x32_bf16 v[8:11], a[0:3], a[72:75], v[8:11]
    ds_read_b64_tr_b16 a[34:35], v214 offset:25600
    s_mul_i32 s59, s58, 6
    s_sub_u32 s87, s93, s59
    v_mfma_f32_16x16x32_bf16 v[12:15], a[0:3], a[76:79], v[12:15]
    ds_read_b128 a[84:87], v211 offset:51200
    s_and_b32 s56, s2, 7
    s_lshr_b32 s86, s56, 1
    v_mfma_f32_16x16x32_bf16 v[16:19], a[4:7], a[64:67], v[16:19]
    s_and_b32 s56, s56, 1
    v_mfma_f32_16x16x32_bf16 v[20:23], a[4:7], a[68:71], v[20:23]
    ds_read_b128 a[88:91], v211 offset:53248
    s_mul_i32 s59, s56, 5
    s_add_u32 s59, s59, s58
    v_mfma_f32_16x16x32_bf16 v[24:27], a[4:7], a[72:75], v[24:27]
    ds_read_b128 a[92:95], v211 offset:55296
    s_mul_i32 s89, s59, 6
    s_add_u32 s89, s89, s87
    v_mfma_f32_16x16x32_bf16 v[28:31], a[4:7], a[76:79], v[28:31]
    ds_read_b64_tr_b16 a[36:37], v214 offset:24584
    s_mul_i32 s88, s59, 12
    s_add_u32 s90, s87, s58
    v_mfma_f32_16x16x32_bf16 v[32:35], a[8:11], a[64:67], v[32:35]
    s_mul_i32 s90, s90, 3
    s_and_b32 s90, s90, 15
    v_mfma_f32_16x16x32_bf16 v[36:39], a[8:11], a[68:71], v[36:39]
    ds_read_b64_tr_b16 a[38:39], v214 offset:25608
    s_mov_b32 s91, s90
    v_mfma_f32_16x16x32_bf16 v[40:43], a[8:11], a[72:75], v[40:43]
    ds_read_b64_tr_b16 a[40:41], v215 offset:24576
    s_mov_b32 s94, s58
    s_mul_i32 s56, s3, 3
    v_mfma_f32_16x16x32_bf16 v[44:47], a[8:11], a[76:79], v[44:47]
    ds_read_b64_tr_b16 a[42:43], v215 offset:25600
    s_add_u32 s56, s56, s88
    s_lshl_b32 s56, s56, 17
    v_mfma_f32_16x16x32_bf16 v[48:51], a[12:15], a[64:67], v[48:51]
    s_lshl_b32 s57, s86, 15
    s_add_u32 s56, s56, s57
    v_mfma_f32_16x16x32_bf16 v[52:55], a[12:15], a[68:71], v[52:55]
    ds_read_b64_tr_b16 a[44:45], v215 offset:24584
    s_add_u32 s16, s44, s56
    s_addc_u32 s17, s45, 0
    v_mfma_f32_16x16x32_bf16 v[56:59], a[12:15], a[72:75], v[56:59]
    ds_read_b64_tr_b16 a[46:47], v215 offset:25608
    s_sub_u32 s18, 15728640, s56
    s_mov_b32 s19, 0x20000
    v_mfma_f32_16x16x32_bf16 v[60:63], a[12:15], a[76:79], v[60:63]
    ds_read_b64_tr_b16 a[48:49], v216 offset:24576
    s_mul_i32 s56, s86, 1179648
    s_mul_i32 s57, s87, 192
    v_mfma_f32_16x16x32_bf16 v[64:67], a[16:19], a[64:67], v[64:67]
    ds_read_b64_tr_b16 a[50:51], v216 offset:25600
    s_add_u32 s56, s56, s57
    s_add_u32 s96, s80, s56
    s_addc_u32 s97, s81, 0
    v_mfma_f32_16x16x32_bf16 v[68:71], a[16:19], a[68:71], v[68:71]
    s_sub_u32 s98, 4718592, s56
    s_mov_b32 s99, 0x20000
    v_mfma_f32_16x16x32_bf16 v[72:75], a[16:19], a[72:75], v[72:75]
    ds_read_b64_tr_b16 a[52:53], v216 offset:24584
    s_mov_b32 s20, s82
    v_mfma_f32_16x16x32_bf16 v[76:79], a[16:19], a[76:79], v[76:79]
    ds_read_b64_tr_b16 a[54:55], v216 offset:25608
    s_mov_b32 s21, s83
    s_mov_b32 s22, 2211840
    v_mfma_f32_16x16x32_bf16 v[80:83], a[20:23], a[64:67], v[80:83]
    ds_read_b64_tr_b16 a[56:57], v217 offset:24576
    s_mov_b32 s23, 0x20000
    s_mul_i32 s95, s3, 3072
    v_mfma_f32_16x16x32_bf16 v[84:87], a[20:23], a[68:71], v[84:87]
    v_lshlrev_b32 v247, 4, v221
    s_mul_i32 s56, s3, 192
    v_mfma_f32_16x16x32_bf16 v[88:91], a[20:23], a[72:75], v[88:91]
    ds_read_b64_tr_b16 a[58:59], v217 offset:25600
    s_mov_b32 s57, 43691
    v_mfma_f32_16x16x32_bf16 v[92:95], a[20:23], a[76:79], v[92:95]
    ds_read_b64_tr_b16 a[60:61], v217 offset:24584
    v_add_u32 v230, s56, v221
    v_mul_lo_u32 v231, v230, s57
    v_mfma_f32_16x16x32_bf16 v[96:99], a[24:27], a[64:67], v[96:99]
    ds_read_b64_tr_b16 a[62:63], v217 offset:25608
    v_lshrrev_b32 v231, 19, v231
    v_mul_u32_u24 v232, 12, v231
    v_mfma_f32_16x16x32_bf16 v[100:103], a[24:27], a[68:71], v[100:103]
    v_sub_u32 v232, v230, v232
    v_bfe_u32 v233, v231, 2, 1
    v_mfma_f32_16x16x32_bf16 v[104:107], a[24:27], a[72:75], v[104:107]
    v_lshlrev_b32 v233, 1, v233
    v_xor_b32 v232, v232, v233
    v_mfma_f32_16x16x32_bf16 v[108:111], a[24:27], a[76:79], v[108:111]
    v_mul_u32_u24 v231, 1152, v231
    v_mfma_f32_16x16x32_bf16 v[112:115], a[28:31], a[64:67], v[112:115]
    v_lshl_add_u32 v244, v232, 4, v231
    v_add_u32 v230, s56, v221
    v_mfma_f32_16x16x32_bf16 v[116:119], a[28:31], a[68:71], v[116:119]
    v_add_u32 v230, 64, v230
    v_mul_lo_u32 v231, v230, s57
    v_mfma_f32_16x16x32_bf16 v[120:123], a[28:31], a[72:75], v[120:123]
    v_lshrrev_b32 v231, 19, v231
    v_mul_u32_u24 v232, 12, v231
    v_mfma_f32_16x16x32_bf16 v[124:127], a[28:31], a[76:79], v[124:127]
    v_sub_u32 v232, v230, v232
    s_waitcnt lgkmcnt(0)
    s_waitcnt vmcnt(0)
    s_barrier
    v_mfma_f32_16x16x32_bf16 v[0:3], a[32:35], a[80:83], v[0:3]
    ds_read_b128 a[64:67], v212 offset:16384
    ds_read_b64_tr_b16 a[0:1], v214 offset:32768
    v_bfe_u32 v233, v231, 2, 1
    v_mfma_f32_16x16x32_bf16 v[4:7], a[32:35], a[84:87], v[4:7]
    ds_read_b64_tr_b16 a[2:3], v214 offset:33792
    v_mfma_f32_16x16x32_bf16 v[8:11], a[32:35], a[88:91], v[8:11]
    ds_read_b128 a[68:71], v212 offset:18432
    ds_read_b128 a[72:75], v212 offset:20480
    v_lshlrev_b32 v233, 1, v233
    v_mfma_f32_16x16x32_bf16 v[12:15], a[32:35], a[92:95], v[12:15]
    ds_read_b128 a[76:79], v212 offset:22528
    v_mfma_f32_16x16x32_bf16 v[16:19], a[36:39], a[80:83], v[16:19]
    ds_read_b64_tr_b16 a[4:5], v214 offset:32776
    v_xor_b32 v232, v232, v233
    v_mfma_f32_16x16x32_bf16 v[20:23], a[36:39], a[84:87], v[20:23]
    ds_read_b64_tr_b16 a[6:7], v214 offset:33800
    ds_read_b64_tr_b16 a[8:9], v215 offset:32768
    v_mfma_f32_16x16x32_bf16 v[24:27], a[36:39], a[88:91], v[24:27]
    ds_read_b64_tr_b16 a[10:11], v215 offset:33792
    v_mfma_f32_16x16x32_bf16 v[28:31], a[36:39], a[92:95], v[28:31]
    ds_read_b64_tr_b16 a[12:13], v215 offset:32776
    ds_read_b64_tr_b16 a[14:15], v215 offset:33800
    v_mul_u32_u24 v231, 1152, v231
    v_mfma_f32_16x16x32_bf16 v[32:35], a[40:43], a[80:83], v[32:35]
    ds_read_b64_tr_b16 a[16:17], v216 offset:32768
    v_mfma_f32_16x16x32_bf16 v[36:39], a[40:43], a[84:87], v[36:39]
    ds_read_b64_tr_b16 a[18:19], v216 offset:33792
    v_lshl_add_u32 v245, v232, 4, v231
    v_mfma_f32_16x16x32_bf16 v[40:43], a[40:43], a[88:91], v[40:43]
    ds_read_b64_tr_b16 a[20:21], v216 offset:32776
    ds_read_b64_tr_b16 a[22:23], v216 offset:33800
    v_mfma_f32_16x16x32_bf16 v[44:47], a[40:43], a[92:95], v[44:47]
    ds_read_b64_tr_b16 a[24:25], v217 offset:32768
    v_mfma_f32_16x16x32_bf16 v[48:51], a[44:47], a[80:83], v[48:51]
    ds_read_b64_tr_b16 a[26:27], v217 offset:33792
    v_add_u32 v230, s56, v221
    v_mfma_f32_16x16x32_bf16 v[52:55], a[44:47], a[84:87], v[52:55]
    ds_read_b64_tr_b16 a[28:29], v217 offset:32776
    ds_read_b64_tr_b16 a[30:31], v217 offset:33800
    v_mfma_f32_16x16x32_bf16 v[56:59], a[44:47], a[88:91], v[56:59]
    ds_read_b128 a[212:215], v213 offset:16384
    v_add_u32 v230, 128, v230
    v_mfma_f32_16x16x32_bf16 v[60:63], a[44:47], a[92:95], v[60:63]
    ds_read_b64_tr_b16 a[96:97], v214 offset:40960
    ds_read_b64_tr_b16 a[98:99], v214 offset:41984
    v_mfma_f32_16x16x32_bf16 v[64:67], a[48:51], a[80:83], v[64:67]
    ds_read_b128 a[216:219], v213 offset:18432
    v_mfma_f32_16x16x32_bf16 v[68:71], a[48:51], a[84:87], v[68:71]
    ds_read_b128 a[220:223], v213 offset:20480
    v_mul_lo_u32 v231, v230, s57
    v_mfma_f32_16x16x32_bf16 v[72:75], a[48:51], a[88:91], v[72:75]
    ds_read_b128 a[224:227], v213 offset:22528
    ds_read_b64_tr_b16 a[100:101], v214 offset:40968
    v_mfma_f32_16x16x32_bf16 v[76:79], a[48:51], a[92:95], v[76:79]
    ds_read_b64_tr_b16 a[102:103], v214 offset:41992
    v_lshrrev_b32 v231, 19, v231
    v_mfma_f32_16x16x32_bf16 v[80:83], a[52:55], a[80:83], v[80:83]
    ds_read_b64_tr_b16 a[104:105], v215 offset:40960
    v_mfma_f32_16x16x32_bf16 v[84:87], a[52:55], a[84:87], v[84:87]
    ds_read_b64_tr_b16 a[106:107], v215 offset:41984
    ds_read_b64_tr_b16 a[108:109], v215 offset:40968
    v_mfma_f32_16x16x32_bf16 v[88:91], a[52:55], a[88:91], v[88:91]
    ds_read_b64_tr_b16 a[110:111], v215 offset:41992
    v_mul_u32_u24 v232, 12, v231
    v_mfma_f32_16x16x32_bf16 v[92:95], a[52:55], a[92:95], v[92:95]
    ds_read_b64_tr_b16 a[112:113], v216 offset:40960
    ds_read_b64_tr_b16 a[114:115], v216 offset:41984
    v_mfma_f32_16x16x32_bf16 v[96:99], a[56:59], a[80:83], v[96:99]
    ds_read_b64_tr_b16 a[116:117], v216 offset:40968
    v_sub_u32 v232, v230, v232
    v_mfma_f32_16x16x32_bf16 v[100:103], a[56:59], a[84:87], v[100:103]
    ds_read_b64_tr_b16 a[118:119], v216 offset:41992
    v_mfma_f32_16x16x32_bf16 v[104:107], a[56:59], a[88:91], v[104:107]
    ds_read_b64_tr_b16 a[120:121], v217 offset:40960
    ds_read_b64_tr_b16 a[122:123], v217 offset:41984
    v_mfma_f32_16x16x32_bf16 v[108:111], a[56:59], a[92:95], v[108:111]
    ds_read_b64_tr_b16 a[124:125], v217 offset:40968
    v_bfe_u32 v233, v231, 2, 1
    v_mfma_f32_16x16x32_bf16 v[112:115], a[60:63], a[80:83], v[112:115]
    ds_read_b64_tr_b16 a[126:127], v217 offset:41992
    v_mfma_f32_16x16x32_bf16 v[116:119], a[60:63], a[84:87], v[116:119]
    v_lshlrev_b32 v233, 1, v233
    v_mfma_f32_16x16x32_bf16 v[120:123], a[60:63], a[88:91], v[120:123]
    v_mfma_f32_16x16x32_bf16 v[124:127], a[60:63], a[92:95], v[124:127]
    s_waitcnt lgkmcnt(0)
    s_mov_b32 s53, 0x3e0293ee
    s_barrier
    v_mfma_f32_16x16x32_bf16 v[0:3], a[0:3], a[64:67], v[0:3]
    ds_read_b128 a[128:131], v192 offset:0
    v_xor_b32 v232, v232, v233
    v_mul_u32_u24 v231, 1152, v231
    v_lshl_add_u32 v246, v232, 4, v231
    v_mfma_f32_16x16x32_bf16 v[0:3], a[96:99], a[212:215], v[0:3]
    ds_read_b128 a[132:135], v193 offset:0
    v_lshrrev_b32 v230, 4, v221
    v_bfe_u32 v231, v221, 2, 2
    v_mfma_f32_16x16x32_bf16 v[16:19], a[4:7], a[64:67], v[16:19]
    ds_read_b128 a[136:139], v194 offset:0
    v_lshl_add_u32 v231, v230, 2, v231
    v_mul_u32_u24 v231, 192, v231
    v_mfma_f32_16x16x32_bf16 v[16:19], a[100:103], a[212:215], v[16:19]
    ds_read_b128 a[140:143], v195 offset:0
    v_and_b32 v232, 1, v221
    v_lshl_add_u32 v231, v232, 3, v231
    v_mfma_f32_16x16x32_bf16 v[32:35], a[8:11], a[64:67], v[32:35]
    ds_read_b128 a[144:147], v192 offset:4096
    v_bfe_u32 v232, v221, 1, 1
    v_lshl_add_u32 v231, v232, 4, v231
    v_mfma_f32_16x16x32_bf16 v[32:35], a[104:107], a[212:215], v[32:35]
    ds_read_b128 a[148:151], v193 offset:4096
    v_and_b32 v230, 1, v230
    v_xor_b32 v232, 0, v230
    v_mfma_f32_16x16x32_bf16 v[48:51], a[12:15], a[64:67], v[48:51]
    ds_read_b128 a[152:155], v194 offset:4096
    v_lshl_add_u32 v248, v232, 5, v231
    v_add_u32 v250, 65536, v248
    v_xor_b32 v232, 1, v230
    v_mfma_f32_16x16x32_bf16 v[48:51], a[108:111], a[212:215], v[48:51]
    ds_read_b128 a[156:159], v195 offset:4096
    v_lshl_add_u32 v249, v232, 5, v231
    v_add_u32 v251, 65536, v249
    v_mfma_f32_16x16x32_bf16 v[64:67], a[16:19], a[64:67], v[64:67]
    s_mov_b32 s76, s84
    s_mov_b32 s77, s85
    v_mfma_f32_16x16x32_bf16 v[64:67], a[112:115], a[212:215], v[64:67]
    s_mov_b32 s78, 256
    s_mov_b32 s79, 0x20000
    v_mfma_f32_16x16x32_bf16 v[80:83], a[20:23], a[64:67], v[80:83]
    v_mov_b32 v230, 0
    s_nop 0
    v_mfma_f32_16x16x32_bf16 v[80:83], a[116:119], a[212:215], v[80:83]
    s_nop 0
    buffer_load_dword v243, v230, s[76:79], 0 offen sc1
    v_mfma_f32_16x16x32_bf16 v[96:99], a[24:27], a[64:67], v[96:99]
    v_mul_f32 v0, s53, v0
    v_mul_f32 v1, s53, v1
    v_mul_f32 v2, s53, v2
    v_mfma_f32_16x16x32_bf16 v[96:99], a[120:123], a[212:215], v[96:99]
    v_mul_f32 v3, s53, v3
    v_mul_f32 v16, s53, v16
    v_mul_f32 v17, s53, v17
    v_mfma_f32_16x16x32_bf16 v[112:115], a[28:31], a[64:67], v[112:115]
    v_mul_f32 v18, s53, v18
    v_mul_f32 v19, s53, v19
    v_cvt_pk_bf16_f32 v128, v0, v1
    v_mfma_f32_16x16x32_bf16 v[112:115], a[124:127], a[212:215], v[112:115]
    v_cvt_pk_bf16_f32 v129, v2, v3
    v_cvt_pk_bf16_f32 v130, v16, v17
    v_cvt_pk_bf16_f32 v131, v18, v19
    v_mfma_f32_16x16x32_bf16 v[4:7], a[0:3], a[68:71], v[4:7]
    v_mul_f32 v32, s53, v32
    v_mul_f32 v33, s53, v33
    v_mul_f32 v34, s53, v34
    v_mfma_f32_16x16x32_bf16 v[4:7], a[96:99], a[216:219], v[4:7]
    v_mul_f32 v35, s53, v35
    v_mul_f32 v48, s53, v48
    v_mul_f32 v49, s53, v49
    v_mfma_f32_16x16x32_bf16 v[20:23], a[4:7], a[68:71], v[20:23]
    v_mul_f32 v50, s53, v50
    v_mul_f32 v51, s53, v51
    v_cvt_pk_bf16_f32 v132, v32, v33
    v_mfma_f32_16x16x32_bf16 v[20:23], a[100:103], a[216:219], v[20:23]
    v_cvt_pk_bf16_f32 v133, v34, v35
    v_cvt_pk_bf16_f32 v134, v48, v49
    v_cvt_pk_bf16_f32 v135, v50, v51
    v_mfma_f32_16x16x32_bf16 v[36:39], a[8:11], a[68:71], v[36:39]
    v_mul_f32 v64, s53, v64
    v_mul_f32 v65, s53, v65
    v_mul_f32 v66, s53, v66
    v_mfma_f32_16x16x32_bf16 v[36:39], a[104:107], a[216:219], v[36:39]
    v_mul_f32 v67, s53, v67
    v_mul_f32 v80, s53, v80
    v_mul_f32 v81, s53, v81
    v_mfma_f32_16x16x32_bf16 v[52:55], a[12:15], a[68:71], v[52:55]
    v_mul_f32 v82, s53, v82
    v_mul_f32 v83, s53, v83
    v_cvt_pk_bf16_f32 v136, v64, v65
    v_mfma_f32_16x16x32_bf16 v[52:55], a[108:111], a[216:219], v[52:55]
    v_cvt_pk_bf16_f32 v137, v66, v67
    v_cvt_pk_bf16_f32 v138, v80, v81
    v_cvt_pk_bf16_f32 v139, v82, v83
    v_mfma_f32_16x16x32_bf16 v[68:71], a[16:19], a[68:71], v[68:71]
    v_mul_f32 v96, s53, v96
    v_mul_f32 v97, s53, v97
    v_mul_f32 v98, s53, v98
    v_mfma_f32_16x16x32_bf16 v[68:71], a[112:115], a[216:219], v[68:71]
    v_mul_f32 v99, s53, v99
    v_mul_f32 v112, s53, v112
    v_mul_f32 v113, s53, v113
    v_mfma_f32_16x16x32_bf16 v[84:87], a[20:23], a[68:71], v[84:87]
    v_mul_f32 v114, s53, v114
    v_mul_f32 v115, s53, v115
    v_cvt_pk_bf16_f32 v140, v96, v97
    v_mfma_f32_16x16x32_bf16 v[84:87], a[116:119], a[216:219], v[84:87]
    v_cvt_pk_bf16_f32 v141, v98, v99
    v_cvt_pk_bf16_f32 v142, v112, v113
    v_cvt_pk_bf16_f32 v143, v114, v115
    v_mfma_f32_16x16x32_bf16 v[100:103], a[24:27], a[68:71], v[100:103]
    v_mul_f32 v4, s53, v4
    v_mul_f32 v5, s53, v5
    v_mul_f32 v6, s53, v6
    v_mfma_f32_16x16x32_bf16 v[100:103], a[120:123], a[216:219], v[100:103]
    v_mul_f32 v7, s53, v7
    v_mul_f32 v20, s53, v20
    v_mul_f32 v21, s53, v21
    v_mfma_f32_16x16x32_bf16 v[116:119], a[28:31], a[68:71], v[116:119]
    v_mul_f32 v22, s53, v22
    v_mul_f32 v23, s53, v23
    v_cvt_pk_bf16_f32 v144, v4, v5
    v_mfma_f32_16x16x32_bf16 v[116:119], a[124:127], a[216:219], v[116:119]
    v_cvt_pk_bf16_f32 v145, v6, v7
    v_cvt_pk_bf16_f32 v146, v20, v21
    v_cvt_pk_bf16_f32 v147, v22, v23
    v_mfma_f32_16x16x32_bf16 v[8:11], a[0:3], a[72:75], v[8:11]
    v_mul_f32 v36, s53, v36
    v_mul_f32 v37, s53, v37
    v_mul_f32 v38, s53, v38
    v_mfma_f32_16x16x32_bf16 v[8:11], a[96:99], a[220:223], v[8:11]
    v_mul_f32 v39, s53, v39
    v_mul_f32 v52, s53, v52
    v_mul_f32 v53, s53, v53
    v_mfma_f32_16x16x32_bf16 v[24:27], a[4:7], a[72:75], v[24:27]
    v_mul_f32 v54, s53, v54
    v_mul_f32 v55, s53, v55
    v_cvt_pk_bf16_f32 v148, v36, v37
    v_mfma_f32_16x16x32_bf16 v[24:27], a[100:103], a[220:223], v[24:27]
    v_cvt_pk_bf16_f32 v149, v38, v39
    v_cvt_pk_bf16_f32 v150, v52, v53
    v_cvt_pk_bf16_f32 v151, v54, v55
    v_mfma_f32_16x16x32_bf16 v[40:43], a[8:11], a[72:75], v[40:43]
    v_mul_f32 v68, s53, v68
    v_mul_f32 v69, s53, v69
    v_mul_f32 v70, s53, v70
    v_mfma_f32_16x16x32_bf16 v[40:43], a[104:107], a[220:223], v[40:43]
    v_mul_f32 v71, s53, v71
    v_mul_f32 v84, s53, v84
    v_mul_f32 v85, s53, v85
    v_mfma_f32_16x16x32_bf16 v[56:59], a[12:15], a[72:75], v[56:59]
    v_mul_f32 v86, s53, v86
    v_mul_f32 v87, s53, v87
    v_cvt_pk_bf16_f32 v152, v68, v69
    v_mfma_f32_16x16x32_bf16 v[56:59], a[108:111], a[220:223], v[56:59]
    v_cvt_pk_bf16_f32 v153, v70, v71
    v_cvt_pk_bf16_f32 v154, v84, v85
    v_cvt_pk_bf16_f32 v155, v86, v87
    v_mfma_f32_16x16x32_bf16 v[72:75], a[16:19], a[72:75], v[72:75]
    v_mul_f32 v100, s53, v100
    v_mul_f32 v101, s53, v101
    v_mul_f32 v102, s53, v102
    v_mfma_f32_16x16x32_bf16 v[72:75], a[112:115], a[220:223], v[72:75]
    v_mul_f32 v103, s53, v103
    v_mul_f32 v116, s53, v116
    v_mul_f32 v117, s53, v117
    v_mfma_f32_16x16x32_bf16 v[88:91], a[20:23], a[72:75], v[88:91]
    v_mul_f32 v118, s53, v118
    v_mul_f32 v119, s53, v119
    v_cvt_pk_bf16_f32 v156, v100, v101
    v_mfma_f32_16x16x32_bf16 v[88:91], a[116:119], a[220:223], v[88:91]
    v_cvt_pk_bf16_f32 v157, v102, v103
    v_cvt_pk_bf16_f32 v158, v116, v117
    v_cvt_pk_bf16_f32 v159, v118, v119
    v_mfma_f32_16x16x32_bf16 v[104:107], a[24:27], a[72:75], v[104:107]
    v_mul_f32 v8, s53, v8
    v_mul_f32 v9, s53, v9
    v_mul_f32 v10, s53, v10
    v_mfma_f32_16x16x32_bf16 v[104:107], a[120:123], a[220:223], v[104:107]
    v_mul_f32 v11, s53, v11
    v_mul_f32 v24, s53, v24
    v_mul_f32 v25, s53, v25
    v_mfma_f32_16x16x32_bf16 v[120:123], a[28:31], a[72:75], v[120:123]
    v_mul_f32 v26, s53, v26
    v_mul_f32 v27, s53, v27
    v_cvt_pk_bf16_f32 v160, v8, v9
    v_mfma_f32_16x16x32_bf16 v[120:123], a[124:127], a[220:223], v[120:123]
    v_cvt_pk_bf16_f32 v161, v10, v11
    v_cvt_pk_bf16_f32 v162, v24, v25
    v_cvt_pk_bf16_f32 v163, v26, v27
    v_mfma_f32_16x16x32_bf16 v[12:15], a[0:3], a[76:79], v[12:15]
    v_mul_f32 v40, s53, v40
    v_mul_f32 v41, s53, v41
    v_mul_f32 v42, s53, v42
    v_mfma_f32_16x16x32_bf16 v[12:15], a[96:99], a[224:227], v[12:15]
    v_mul_f32 v43, s53, v43
    v_mul_f32 v56, s53, v56
    v_mul_f32 v57, s53, v57
    v_mfma_f32_16x16x32_bf16 v[28:31], a[4:7], a[76:79], v[28:31]
    v_mul_f32 v58, s53, v58
    v_mul_f32 v59, s53, v59
    v_cvt_pk_bf16_f32 v164, v40, v41
    v_mfma_f32_16x16x32_bf16 v[28:31], a[100:103], a[224:227], v[28:31]
    v_cvt_pk_bf16_f32 v165, v42, v43
    v_cvt_pk_bf16_f32 v166, v56, v57
    v_cvt_pk_bf16_f32 v167, v58, v59
    v_mfma_f32_16x16x32_bf16 v[44:47], a[8:11], a[76:79], v[44:47]
    v_mul_f32 v72, s53, v72
    v_mul_f32 v73, s53, v73
    v_mul_f32 v74, s53, v74
    v_mfma_f32_16x16x32_bf16 v[44:47], a[104:107], a[224:227], v[44:47]
    v_mul_f32 v75, s53, v75
    v_mul_f32 v88, s53, v88
    v_mul_f32 v89, s53, v89
    v_mfma_f32_16x16x32_bf16 v[60:63], a[12:15], a[76:79], v[60:63]
    v_mul_f32 v90, s53, v90
    v_mul_f32 v91, s53, v91
    v_cvt_pk_bf16_f32 v168, v72, v73
    v_mfma_f32_16x16x32_bf16 v[60:63], a[108:111], a[224:227], v[60:63]
    v_cvt_pk_bf16_f32 v169, v74, v75
    v_cvt_pk_bf16_f32 v170, v88, v89
    v_cvt_pk_bf16_f32 v171, v90, v91
    v_mfma_f32_16x16x32_bf16 v[76:79], a[16:19], a[76:79], v[76:79]
    v_mul_f32 v104, s53, v104
    v_mul_f32 v105, s53, v105
    v_mul_f32 v106, s53, v106
    v_mfma_f32_16x16x32_bf16 v[76:79], a[112:115], a[224:227], v[76:79]
    v_mul_f32 v107, s53, v107
    v_mul_f32 v120, s53, v120
    v_mul_f32 v121, s53, v121
    v_mfma_f32_16x16x32_bf16 v[92:95], a[20:23], a[76:79], v[92:95]
    v_mul_f32 v122, s53, v122
    v_mul_f32 v123, s53, v123
    v_cvt_pk_bf16_f32 v172, v104, v105
    v_mfma_f32_16x16x32_bf16 v[92:95], a[116:119], a[224:227], v[92:95]
    v_cvt_pk_bf16_f32 v173, v106, v107
    v_cvt_pk_bf16_f32 v174, v120, v121
    v_cvt_pk_bf16_f32 v175, v122, v123
    v_mfma_f32_16x16x32_bf16 v[108:111], a[24:27], a[76:79], v[108:111]
    v_mul_f32 v12, s53, v12
    v_mul_f32 v13, s53, v13
    v_mul_f32 v14, s53, v14
    v_mfma_f32_16x16x32_bf16 v[108:111], a[120:123], a[224:227], v[108:111]
    v_mul_f32 v15, s53, v15
    v_mul_f32 v28, s53, v28
    v_mul_f32 v29, s53, v29
    v_mfma_f32_16x16x32_bf16 v[124:127], a[28:31], a[76:79], v[124:127]
    v_mul_f32 v30, s53, v30
    v_mul_f32 v31, s53, v31
    v_cvt_pk_bf16_f32 v176, v12, v13
    v_mfma_f32_16x16x32_bf16 v[124:127], a[124:127], a[224:227], v[124:127]
    v_cvt_pk_bf16_f32 v177, v14, v15
    v_cvt_pk_bf16_f32 v178, v28, v29
    v_cvt_pk_bf16_f32 v179, v30, v31
    s_waitcnt lgkmcnt(0)
    v_mov_b32 v222, 0x3f803f80
    s_nop 7
    s_nop 1
    v_mfma_f32_16x16x32_bf16 v[0:3], a[128:131], v[128:131], 0
    v_mul_f32 v44, s53, v44
    v_mul_f32 v45, s53, v45
    v_mfma_f32_16x16x32_bf16 v[0:3], a[132:135], v[132:135], v[0:3]
    v_mul_f32 v46, s53, v46
    v_mul_f32 v47, s53, v47
    v_mfma_f32_16x16x32_bf16 v[0:3], a[136:139], v[136:139], v[0:3]
    v_mul_f32 v60, s53, v60
    v_mul_f32 v61, s53, v61
    v_mfma_f32_16x16x32_bf16 v[0:3], a[140:143], v[140:143], v[0:3]
    v_mul_f32 v62, s53, v62
    v_mul_f32 v63, s53, v63
    v_mfma_f32_16x16x32_bf16 v[4:7], a[144:147], v[128:131], 0
    v_cvt_pk_bf16_f32 v180, v44, v45
    v_cvt_pk_bf16_f32 v181, v46, v47
    v_mfma_f32_16x16x32_bf16 v[4:7], a[148:151], v[132:135], v[4:7]
    v_cvt_pk_bf16_f32 v182, v60, v61
    v_cvt_pk_bf16_f32 v183, v62, v63
    v_mfma_f32_16x16x32_bf16 v[4:7], a[152:155], v[136:139], v[4:7]
    v_mul_f32 v76, s53, v76
    v_mul_f32 v77, s53, v77
    v_mfma_f32_16x16x32_bf16 v[4:7], a[156:159], v[140:143], v[4:7]
    v_mul_f32 v78, s53, v78
    v_mul_f32 v79, s53, v79
    v_mfma_f32_16x16x32_bf16 v[8:11], a[128:131], v[144:147], 0
    v_mul_f32 v92, s53, v92
    v_mul_f32 v93, s53, v93
    v_mfma_f32_16x16x32_bf16 v[8:11], a[132:135], v[148:151], v[8:11]
    v_mul_f32 v94, s53, v94
    v_mul_f32 v95, s53, v95
    v_mfma_f32_16x16x32_bf16 v[8:11], a[136:139], v[152:155], v[8:11]
    v_cvt_pk_bf16_f32 v184, v76, v77
    v_cvt_pk_bf16_f32 v185, v78, v79
    v_mfma_f32_16x16x32_bf16 v[8:11], a[140:143], v[156:159], v[8:11]
    v_cvt_pk_bf16_f32 v186, v92, v93
    v_cvt_pk_bf16_f32 v187, v94, v95
    v_mfma_f32_16x16x32_bf16 v[12:15], a[144:147], v[144:147], 0
    v_mul_f32 v108, s53, v108
    v_mul_f32 v109, s53, v109
    v_mfma_f32_16x16x32_bf16 v[12:15], a[148:151], v[148:151], v[12:15]
    v_mul_f32 v110, s53, v110
    v_mul_f32 v111, s53, v111
    v_mfma_f32_16x16x32_bf16 v[12:15], a[152:155], v[152:155], v[12:15]
    v_mul_f32 v124, s53, v124
    v_mul_f32 v125, s53, v125
    v_mfma_f32_16x16x32_bf16 v[12:15], a[156:159], v[156:159], v[12:15]
    v_mul_f32 v126, s53, v126
    v_mul_f32 v127, s53, v127
    v_mfma_f32_16x16x32_bf16 v[16:19], a[128:131], v[160:163], 0
    v_cvt_pk_bf16_f32 v188, v108, v109
    v_cvt_pk_bf16_f32 v189, v110, v111
    v_mfma_f32_16x16x32_bf16 v[16:19], a[132:135], v[164:167], v[16:19]
    v_cvt_pk_bf16_f32 v190, v124, v125
    v_cvt_pk_bf16_f32 v191, v126, v127
    v_mfma_f32_16x16x32_bf16 v[16:19], a[136:139], v[168:171], v[16:19]
    v_accvgpr_write_b32 a208, v222
    v_mfma_f32_16x16x32_bf16 v[16:19], a[140:143], v[172:175], v[16:19]
    v_accvgpr_write_b32 a209, v222
    v_mfma_f32_16x16x32_bf16 v[20:23], a[144:147], v[160:163], 0
    v_accvgpr_write_b32 a210, v222
    v_mfma_f32_16x16x32_bf16 v[20:23], a[148:151], v[164:167], v[20:23]
    v_accvgpr_write_b32 a211, v222
    v_mfma_f32_16x16x32_bf16 v[20:23], a[152:155], v[168:171], v[20:23]
    v_mfma_f32_16x16x32_bf16 v[20:23], a[156:159], v[172:175], v[20:23]
    v_mfma_f32_16x16x32_bf16 v[24:27], a[128:131], v[176:179], 0
    v_mfma_f32_16x16x32_bf16 v[24:27], a[132:135], v[180:183], v[24:27]
    v_mfma_f32_16x16x32_bf16 v[24:27], a[136:139], v[184:187], v[24:27]
    v_mfma_f32_16x16x32_bf16 v[24:27], a[140:143], v[188:191], v[24:27]
    v_mfma_f32_16x16x32_bf16 v[28:31], a[144:147], v[176:179], 0
    v_mfma_f32_16x16x32_bf16 v[28:31], a[148:151], v[180:183], v[28:31]
    v_mfma_f32_16x16x32_bf16 v[28:31], a[152:155], v[184:187], v[28:31]
    v_mfma_f32_16x16x32_bf16 v[28:31], a[156:159], v[188:191], v[28:31]
    ds_read_b128 a[128:131], v192 offset:8192
    ds_read_b128 a[132:135], v193 offset:8192
    ds_read_b128 a[136:139], v194 offset:8192
    ds_read_b128 a[140:143], v195 offset:8192
    ds_read_b128 a[144:147], v192 offset:12288
    ds_read_b128 a[148:151], v193 offset:12288
    ds_read_b128 a[152:155], v194 offset:12288
    ds_read_b128 a[156:159], v195 offset:12288
    s_nop 3
    v_max3_f32 v222, v0, v1, v2
    v_max3_f32 v222, v222, v3, v4
    v_max3_f32 v222, v222, v5, v6
    v_max_f32 v222, v222, v7
    v_max3_f32 v223, v8, v9, v10
    v_max3_f32 v223, v223, v11, v12
    v_max3_f32 v223, v223, v13, v14
    v_max_f32 v223, v223, v15
    v_max3_f32 v224, v16, v17, v18
    v_max3_f32 v224, v224, v19, v20
    v_max3_f32 v224, v224, v21, v22
    v_max_f32 v224, v224, v23
    v_max3_f32 v225, v24, v25, v26
    v_max3_f32 v225, v225, v27, v28
    v_max3_f32 v225, v225, v29, v30
    v_max_f32 v225, v225, v31
    v_mov_b32 v226, v222
    v_mov_b32 v227, v223
    v_mov_b32 v228, v224
    v_mov_b32 v229, v225
    s_nop 1
    v_permlane16_swap_b32 v222, v226
    v_permlane16_swap_b32 v223, v227
    v_permlane16_swap_b32 v224, v228
    v_permlane16_swap_b32 v225, v229
    s_nop 1
    v_max_f32 v222, v222, v226
    v_max_f32 v223, v223, v227
    v_max_f32 v224, v224, v228
    v_max_f32 v225, v225, v229
    v_mov_b32 v226, v222
    v_mov_b32 v227, v223
    v_mov_b32 v228, v224
    v_mov_b32 v229, v225
    s_nop 1
    v_permlane32_swap_b32 v222, v226
    v_permlane32_swap_b32 v223, v227
    v_permlane32_swap_b32 v224, v228
    v_permlane32_swap_b32 v225, v229
    s_nop 1
    v_max_f32 v222, v222, v226
    v_max_f32 v223, v223, v227
    v_max_f32 v224, v224, v228
    v_max_f32 v225, v225, v229
    v_sub_f32 v222, 0, v222
    v_sub_f32 v223, 0, v223
    v_sub_f32 v224, 0, v224
    v_sub_f32 v225, 0, v225
    v_mov_b32 v96, v222
    v_mov_b32 v97, v222
    v_mov_b32 v98, v222
    v_mov_b32 v99, v222
    v_add_f32 v0, v0, v222
    v_add_f32 v1, v1, v222
    v_add_f32 v2, v2, v222
    v_add_f32 v3, v3, v222
    v_add_f32 v4, v4, v222
    v_add_f32 v5, v5, v222
    v_add_f32 v6, v6, v222
    v_add_f32 v7, v7, v222
    v_mov_b32 v100, v223
    v_mov_b32 v101, v223
    v_mov_b32 v102, v223
    v_mov_b32 v103, v223
    v_add_f32 v8, v8, v223
    v_add_f32 v9, v9, v223
    v_add_f32 v10, v10, v223
    v_add_f32 v11, v11, v223
    v_add_f32 v12, v12, v223
    v_add_f32 v13, v13, v223
    v_add_f32 v14, v14, v223
    v_add_f32 v15, v15, v223
    v_mov_b32 v104, v224
    v_mov_b32 v105, v224
    v_mov_b32 v106, v224
    v_mov_b32 v107, v224
    v_add_f32 v16, v16, v224
    v_add_f32 v17, v17, v224
    v_add_f32 v18, v18, v224
    v_add_f32 v19, v19, v224
    v_add_f32 v20, v20, v224
    v_add_f32 v21, v21, v224
    v_add_f32 v22, v22, v224
    v_add_f32 v23, v23, v224
    v_mov_b32 v108, v225
    v_mov_b32 v109, v225
    v_mov_b32 v110, v225
    v_mov_b32 v111, v225
    v_add_f32 v24, v24, v225
    v_add_f32 v25, v25, v225
    v_add_f32 v26, v26, v225
    v_add_f32 v27, v27, v225
    v_add_f32 v28, v28, v225
    v_add_f32 v29, v29, v225
    v_add_f32 v30, v30, v225
    v_add_f32 v31, v31, v225
    s_waitcnt lgkmcnt(0)
    s_barrier
    s_mul_i32 s46, s2, 18432
    s_mul_i32 s47, s3, 6144
    s_add_u32 s46, s46, s47
    v_mul_u32_u24 v234, 96, v221
    s_mov_b32 s56, s80
    s_mov_b32 s57, s81
    s_mov_b32 s58, 4718592
    s_mov_b32 s59, 0x20000
    buffer_load_dword v235, v234, s[56:59], s46 offen
    v_mfma_f32_16x16x32_bf16 v[32:35], a[128:131], v[128:131], v[96:99]
    v_exp_f32 v0, v0
    v_mfma_f32_16x16x32_bf16 v[32:35], a[132:135], v[132:135], v[32:35]
    v_exp_f32 v1, v1
    v_mfma_f32_16x16x32_bf16 v[32:35], a[136:139], v[136:139], v[32:35]
    v_cvt_pk_bf16_f32 v64, v0, v1
    v_mfma_f32_16x16x32_bf16 v[32:35], a[140:143], v[140:143], v[32:35]
    v_exp_f32 v2, v2
    v_mfma_f32_16x16x32_bf16 v[40:43], a[128:131], v[144:147], v[100:103]
    v_exp_f32 v3, v3
    v_mfma_f32_16x16x32_bf16 v[40:43], a[132:135], v[148:151], v[40:43]
    v_cvt_pk_bf16_f32 v65, v2, v3
    v_mfma_f32_16x16x32_bf16 v[40:43], a[136:139], v[152:155], v[40:43]
    v_exp_f32 v4, v4
    v_mfma_f32_16x16x32_bf16 v[40:43], a[140:143], v[156:159], v[40:43]
    v_exp_f32 v5, v5
    v_mfma_f32_16x16x32_bf16 v[48:51], a[128:131], v[160:163], v[104:107]
    v_cvt_pk_bf16_f32 v66, v4, v5
    v_mfma_f32_16x16x32_bf16 v[48:51], a[132:135], v[164:167], v[48:51]
    v_exp_f32 v6, v6
    v_mfma_f32_16x16x32_bf16 v[48:51], a[136:139], v[168:171], v[48:51]
    v_exp_f32 v7, v7
    v_mfma_f32_16x16x32_bf16 v[48:51], a[140:143], v[172:175], v[48:51]
    v_cvt_pk_bf16_f32 v67, v6, v7
    v_mfma_f32_16x16x32_bf16 v[56:59], a[128:131], v[176:179], v[108:111]
    v_exp_f32 v8, v8
    v_mfma_f32_16x16x32_bf16 v[56:59], a[132:135], v[180:183], v[56:59]
    v_exp_f32 v9, v9
    v_mfma_f32_16x16x32_bf16 v[56:59], a[136:139], v[184:187], v[56:59]
    v_cvt_pk_bf16_f32 v68, v8, v9
    v_mfma_f32_16x16x32_bf16 v[56:59], a[140:143], v[188:191], v[56:59]
    v_exp_f32 v10, v10
    v_mfma_f32_16x16x32_bf16 v[36:39], a[144:147], v[128:131], v[96:99]
    v_exp_f32 v11, v11
    v_mfma_f32_16x16x32_bf16 v[36:39], a[148:151], v[132:135], v[36:39]
    ds_read_b128 a[128:131], v192 offset:16384
    ds_read_b128 a[132:135], v193 offset:16384
    v_cvt_pk_bf16_f32 v69, v10, v11
    v_mfma_f32_16x16x32_bf16 v[36:39], a[152:155], v[136:139], v[36:39]
    v_exp_f32 v12, v12
    v_mfma_f32_16x16x32_bf16 v[36:39], a[156:159], v[140:143], v[36:39]
    v_exp_f32 v13, v13
    v_mfma_f32_16x16x32_bf16 v[44:47], a[144:147], v[144:147], v[100:103]
    ds_read_b128 a[136:139], v194 offset:16384
    ds_read_b128 a[140:143], v195 offset:16384
    v_cvt_pk_bf16_f32 v70, v12, v13
    v_mfma_f32_16x16x32_bf16 v[44:47], a[148:151], v[148:151], v[44:47]
    v_exp_f32 v14, v14
    v_mfma_f32_16x16x32_bf16 v[44:47], a[152:155], v[152:155], v[44:47]
    v_exp_f32 v15, v15
    v_mfma_f32_16x16x32_bf16 v[44:47], a[156:159], v[156:159], v[44:47]
    v_cvt_pk_bf16_f32 v71, v14, v15
    v_mfma_f32_16x16x32_bf16 v[52:55], a[144:147], v[160:163], v[104:107]
    v_exp_f32 v16, v16
    v_mfma_f32_16x16x32_bf16 v[52:55], a[148:151], v[164:167], v[52:55]
    v_exp_f32 v17, v17
    v_mfma_f32_16x16x32_bf16 v[52:55], a[152:155], v[168:171], v[52:55]
    v_cvt_pk_bf16_f32 v72, v16, v17
    v_mfma_f32_16x16x32_bf16 v[52:55], a[156:159], v[172:175], v[52:55]
    v_exp_f32 v18, v18
    v_mfma_f32_16x16x32_bf16 v[60:63], a[144:147], v[176:179], v[108:111]
    v_exp_f32 v19, v19
    v_mfma_f32_16x16x32_bf16 v[60:63], a[148:151], v[180:183], v[60:63]
    v_cvt_pk_bf16_f32 v73, v18, v19
    v_mfma_f32_16x16x32_bf16 v[60:63], a[152:155], v[184:187], v[60:63]
    v_exp_f32 v20, v20
    v_mfma_f32_16x16x32_bf16 v[60:63], a[156:159], v[188:191], v[60:63]
    v_exp_f32 v21, v21
    s_nop 0
    v_cvt_pk_bf16_f32 v74, v20, v21
    v_exp_f32 v22, v22
    v_exp_f32 v23, v23
    s_nop 0
    v_cvt_pk_bf16_f32 v75, v22, v23
    v_exp_f32 v24, v24
    v_exp_f32 v25, v25
    s_nop 0
    v_cvt_pk_bf16_f32 v76, v24, v25
    v_exp_f32 v26, v26
    v_exp_f32 v27, v27
    s_nop 0
    v_cvt_pk_bf16_f32 v77, v26, v27
    v_exp_f32 v28, v28
    v_exp_f32 v29, v29
    s_nop 0
    v_cvt_pk_bf16_f32 v78, v28, v29
    v_exp_f32 v30, v30
    v_exp_f32 v31, v31
    s_nop 0
    v_cvt_pk_bf16_f32 v79, v30, v31
    ds_read_b128 a[144:147], v192 offset:20480
    ds_read_b128 a[148:151], v193 offset:20480
    ds_read_b128 a[152:155], v194 offset:20480
    ds_read_b128 a[156:159], v195 offset:20480
    s_waitcnt lgkmcnt(0)
    s_barrier
    v_mfma_f32_16x16x32_bf16 v[0:3], a[128:131], v[128:131], v[96:99]
    v_exp_f32 v32, v32
    v_mfma_f32_16x16x32_bf16 v[0:3], a[132:135], v[132:135], v[0:3]
    ds_read_b64_tr_b16 a[160:161], v196 offset:0
    ds_read_b64_tr_b16 a[162:163], v196 offset:4096
    v_mfma_f32_16x16x32_bf16 v[0:3], a[136:139], v[136:139], v[0:3]
    v_exp_f32 v33, v33
    v_mfma_f32_16x16x32_bf16 v[0:3], a[140:143], v[140:143], v[0:3]
    ds_read_b64_tr_b16 a[164:165], v197 offset:0
    ds_read_b64_tr_b16 a[166:167], v197 offset:4096
    v_mfma_f32_16x16x32_bf16 v[8:11], a[128:131], v[144:147], v[100:103]
    v_exp_f32 v34, v34
    v_mfma_f32_16x16x32_bf16 v[8:11], a[132:135], v[148:151], v[8:11]
    ds_read_b64_tr_b16 a[168:169], v198 offset:0
    v_cvt_pk_bf16_f32 v80, v32, v33
    v_mfma_f32_16x16x32_bf16 v[8:11], a[136:139], v[152:155], v[8:11]
    v_exp_f32 v35, v35
    v_mfma_f32_16x16x32_bf16 v[8:11], a[140:143], v[156:159], v[8:11]
    ds_read_b64_tr_b16 a[170:171], v198 offset:4096
    ds_read_b64_tr_b16 a[172:173], v199 offset:0
    v_mfma_f32_16x16x32_bf16 v[16:19], a[128:131], v[160:163], v[104:107]
    v_exp_f32 v36, v36
    v_mfma_f32_16x16x32_bf16 v[16:19], a[132:135], v[164:167], v[16:19]
    ds_read_b64_tr_b16 a[174:175], v199 offset:4096
    v_cvt_pk_bf16_f32 v81, v34, v35
    v_mfma_f32_16x16x32_bf16 v[16:19], a[136:139], v[168:171], v[16:19]
    v_exp_f32 v37, v37
    v_mfma_f32_16x16x32_bf16 v[16:19], a[140:143], v[172:175], v[16:19]
    ds_read_b64_tr_b16 a[176:177], v200 offset:0
    ds_read_b64_tr_b16 a[178:179], v200 offset:4096
    v_mfma_f32_16x16x32_bf16 v[24:27], a[128:131], v[176:179], v[108:111]
    v_exp_f32 v38, v38
    v_mfma_f32_16x16x32_bf16 v[24:27], a[132:135], v[180:183], v[24:27]
    ds_read_b64_tr_b16 a[180:181], v201 offset:0
    v_cvt_pk_bf16_f32 v82, v36, v37
    v_mfma_f32_16x16x32_bf16 v[24:27], a[136:139], v[184:187], v[24:27]
    v_exp_f32 v39, v39
    v_mfma_f32_16x16x32_bf16 v[24:27], a[140:143], v[188:191], v[24:27]
    ds_read_b64_tr_b16 a[182:183], v201 offset:4096
    ds_read_b64_tr_b16 a[184:185], v202 offset:0
    v_mfma_f32_16x16x32_bf16 v[4:7], a[144:147], v[128:131], v[96:99]
    v_exp_f32 v40, v40
    v_mfma_f32_16x16x32_bf16 v[4:7], a[148:151], v[132:135], v[4:7]
    ds_read_b64_tr_b16 a[186:187], v202 offset:4096
    v_cvt_pk_bf16_f32 v83, v38, v39
    v_mfma_f32_16x16x32_bf16 v[4:7], a[152:155], v[136:139], v[4:7]
    v_exp_f32 v41, v41
    v_mfma_f32_16x16x32_bf16 v[4:7], a[156:159], v[140:143], v[4:7]
    ds_read_b64_tr_b16 a[188:189], v203 offset:0
    ds_read_b64_tr_b16 a[190:191], v203 offset:4096
    v_mfma_f32_16x16x32_bf16 v[12:15], a[144:147], v[144:147], v[100:103]
    v_exp_f32 v42, v42
    v_mfma_f32_16x16x32_bf16 v[12:15], a[148:151], v[148:151], v[12:15]
    ds_read_b128 a[128:131], v192 offset:24576
    v_cvt_pk_bf16_f32 v84, v40, v41
    v_mfma_f32_16x16x32_bf16 v[12:15], a[152:155], v[152:155], v[12:15]
    v_exp_f32 v43, v43
    v_mfma_f32_16x16x32_bf16 v[12:15], a[156:159], v[156:159], v[12:15]
    ds_read_b128 a[132:135], v193 offset:24576
    ds_read_b128 a[136:139], v194 offset:24576
    v_mfma_f32_16x16x32_bf16 v[20:23], a[144:147], v[160:163], v[104:107]
    v_exp_f32 v44, v44
    v_mfma_f32_16x16x32_bf16 v[20:23], a[148:151], v[164:167], v[20:23]
    ds_read_b128 a[140:143], v195 offset:24576
    v_cvt_pk_bf16_f32 v85, v42, v43
    v_mfma_f32_16x16x32_bf16 v[20:23], a[152:155], v[168:171], v[20:23]
    v_exp_f32 v45, v45
    v_mfma_f32_16x16x32_bf16 v[20:23], a[156:159], v[172:175], v[20:23]
    v_mfma_f32_16x16x32_bf16 v[28:31], a[144:147], v[176:179], v[108:111]
    v_exp_f32 v46, v46
    v_mfma_f32_16x16x32_bf16 v[28:31], a[148:151], v[180:183], v[28:31]
    v_cvt_pk_bf16_f32 v86, v44, v45
    v_mfma_f32_16x16x32_bf16 v[28:31], a[152:155], v[184:187], v[28:31]
    v_exp_f32 v47, v47
    v_mfma_f32_16x16x32_bf16 v[28:31], a[156:159], v[188:191], v[28:31]
    s_waitcnt lgkmcnt(4)
    v_mfma_f32_16x16x32_bf16 a[0:3], a[160:163], v[64:67], 0
    v_exp_f32 v48, v48
    v_mfma_f32_16x16x32_bf16 a[16:19], a[164:167], v[64:67], 0
    ds_read_b128 a[144:147], v192 offset:28672
    v_cvt_pk_bf16_f32 v87, v46, v47
    v_mfma_f32_16x16x32_bf16 a[4:7], a[160:163], v[68:71], 0
    v_exp_f32 v49, v49
    v_mfma_f32_16x16x32_bf16 a[20:23], a[164:167], v[68:71], 0
    ds_read_b128 a[148:151], v193 offset:28672
    ds_read_b128 a[152:155], v194 offset:28672
    v_mfma_f32_16x16x32_bf16 a[8:11], a[160:163], v[72:75], 0
    v_exp_f32 v50, v50
    v_mfma_f32_16x16x32_bf16 a[24:27], a[164:167], v[72:75], 0
    ds_read_b128 a[156:159], v195 offset:28672
    v_cvt_pk_bf16_f32 v88, v48, v49
    v_mfma_f32_16x16x32_bf16 a[12:15], a[160:163], v[76:79], 0
    v_exp_f32 v51, v51
    v_mfma_f32_16x16x32_bf16 a[28:31], a[164:167], v[76:79], 0
    v_mfma_f32_16x16x32_bf16 a[192:195], a[208:211], v[64:67], 0
    v_exp_f32 v52, v52
    v_mfma_f32_16x16x32_bf16 a[32:35], a[168:171], v[64:67], 0
    v_cvt_pk_bf16_f32 v89, v50, v51
    v_mfma_f32_16x16x32_bf16 a[48:51], a[172:175], v[64:67], 0
    v_exp_f32 v53, v53
    v_mfma_f32_16x16x32_bf16 a[36:39], a[168:171], v[68:71], 0
    v_mfma_f32_16x16x32_bf16 a[52:55], a[172:175], v[68:71], 0
    v_exp_f32 v54, v54
    v_mfma_f32_16x16x32_bf16 a[40:43], a[168:171], v[72:75], 0
    v_cvt_pk_bf16_f32 v90, v52, v53
    v_mfma_f32_16x16x32_bf16 a[56:59], a[172:175], v[72:75], 0
    v_exp_f32 v55, v55
    v_mfma_f32_16x16x32_bf16 a[44:47], a[168:171], v[76:79], 0
    v_mfma_f32_16x16x32_bf16 a[60:63], a[172:175], v[76:79], 0
    v_exp_f32 v56, v56
    v_mfma_f32_16x16x32_bf16 a[196:199], a[208:211], v[68:71], 0
    v_cvt_pk_bf16_f32 v91, v54, v55
    v_mfma_f32_16x16x32_bf16 a[64:67], a[176:179], v[64:67], 0
    v_exp_f32 v57, v57
    v_mfma_f32_16x16x32_bf16 a[80:83], a[180:183], v[64:67], 0
    v_mfma_f32_16x16x32_bf16 a[68:71], a[176:179], v[68:71], 0
    v_exp_f32 v58, v58
    v_mfma_f32_16x16x32_bf16 a[84:87], a[180:183], v[68:71], 0
    v_cvt_pk_bf16_f32 v92, v56, v57
    v_mfma_f32_16x16x32_bf16 a[72:75], a[176:179], v[72:75], 0
    v_exp_f32 v59, v59
    v_mfma_f32_16x16x32_bf16 a[88:91], a[180:183], v[72:75], 0
    v_mfma_f32_16x16x32_bf16 a[76:79], a[176:179], v[76:79], 0
    v_exp_f32 v60, v60
    v_mfma_f32_16x16x32_bf16 a[92:95], a[180:183], v[76:79], 0
    v_cvt_pk_bf16_f32 v93, v58, v59
    v_mfma_f32_16x16x32_bf16 a[200:203], a[208:211], v[72:75], 0
    v_exp_f32 v61, v61
    v_mfma_f32_16x16x32_bf16 a[96:99], a[184:187], v[64:67], 0
    v_mfma_f32_16x16x32_bf16 a[112:115], a[188:191], v[64:67], 0
    v_exp_f32 v62, v62
    v_mfma_f32_16x16x32_bf16 a[100:103], a[184:187], v[68:71], 0
    v_cvt_pk_bf16_f32 v94, v60, v61
    v_mfma_f32_16x16x32_bf16 a[116:119], a[188:191], v[68:71], 0
    v_exp_f32 v63, v63
    v_mfma_f32_16x16x32_bf16 a[104:107], a[184:187], v[72:75], 0
    v_mfma_f32_16x16x32_bf16 a[120:123], a[188:191], v[72:75], 0
    v_mfma_f32_16x16x32_bf16 a[108:111], a[184:187], v[76:79], 0
    v_cvt_pk_bf16_f32 v95, v62, v63
    v_mfma_f32_16x16x32_bf16 a[124:127], a[188:191], v[76:79], 0
    v_mfma_f32_16x16x32_bf16 a[204:207], a[208:211], v[76:79], 0
    s_waitcnt lgkmcnt(0)
    s_barrier
    s_mov_b32 s30, 0
    s_branch L1_pos2a
    .p2align 6
L1_pos0a:
    v_mfma_f32_16x16x32_bf16 v[32:35], a[128:131], v[128:131], v[96:99]
    v_exp_f32 v0, v0
    v_mfma_f32_16x16x32_bf16 v[32:35], a[132:135], v[132:135], v[32:35]
    ds_read_b64_tr_b16 a[160:161], v196 offset:57344
    ds_read_b64_tr_b16 a[162:163], v196 offset:61440
    v_mfma_f32_16x16x32_bf16 v[32:35], a[136:139], v[136:139], v[32:35]
    v_exp_f32 v1, v1
    v_mfma_f32_16x16x32_bf16 v[32:35], a[140:143], v[140:143], v[32:35]
    ds_read_b64_tr_b16 a[164:165], v197 offset:57344
    ds_read_b64_tr_b16 a[166:167], v197 offset:61440
    v_mfma_f32_16x16x32_bf16 v[40:43], a[128:131], v[144:147], v[100:103]
    v_exp_f32 v2, v2
    v_mfma_f32_16x16x32_bf16 v[40:43], a[132:135], v[148:151], v[40:43]
    ds_read_b64_tr_b16 a[168:169], v198 offset:57344
    v_cvt_pk_bf16_f32 v64, v0, v1
    v_mfma_f32_16x16x32_bf16 v[40:43], a[136:139], v[152:155], v[40:43]
    v_exp_f32 v3, v3
    v_mfma_f32_16x16x32_bf16 v[40:43], a[140:143], v[156:159], v[40:43]
    ds_read_b64_tr_b16 a[170:171], v198 offset:61440
    ds_read_b64_tr_b16 a[172:173], v199 offset:57344
    v_mfma_f32_16x16x32_bf16 v[48:51], a[128:131], v[160:163], v[104:107]
    v_exp_f32 v4, v4
    v_mfma_f32_16x16x32_bf16 v[48:51], a[132:135], v[164:167], v[48:51]
    ds_read_b64_tr_b16 a[174:175], v199 offset:61440
    v_cvt_pk_bf16_f32 v65, v2, v3
    v_mfma_f32_16x16x32_bf16 v[48:51], a[136:139], v[168:171], v[48:51]
    v_exp_f32 v5, v5
    v_mfma_f32_16x16x32_bf16 v[48:51], a[140:143], v[172:175], v[48:51]
    ds_read_b64_tr_b16 a[176:177], v200 offset:57344
    ds_read_b64_tr_b16 a[178:179], v200 offset:61440
    v_mfma_f32_16x16x32_bf16 v[56:59], a[128:131], v[176:179], v[108:111]
    v_exp_f32 v6, v6
    v_mfma_f32_16x16x32_bf16 v[56:59], a[132:135], v[180:183], v[56:59]
    ds_read_b64_tr_b16 a[180:181], v201 offset:57344
    v_cvt_pk_bf16_f32 v66, v4, v5
    v_mfma_f32_16x16x32_bf16 v[56:59], a[136:139], v[184:187], v[56:59]
    v_exp_f32 v7, v7
    v_mfma_f32_16x16x32_bf16 v[56:59], a[140:143], v[188:191], v[56:59]
    ds_read_b64_tr_b16 a[182:183], v201 offset:61440
    ds_read_b64_tr_b16 a[184:185], v202 offset:57344
    v_mfma_f32_16x16x32_bf16 v[36:39], a[144:147], v[128:131], v[96:99]
    v_exp_f32 v8, v8
    v_mfma_f32_16x16x32_bf16 v[36:39], a[148:151], v[132:135], v[36:39]
    ds_read_b64_tr_b16 a[186:187], v202 offset:61440
    v_cvt_pk_bf16_f32 v67, v6, v7
    v_mfma_f32_16x16x32_bf16 v[36:39], a[152:155], v[136:139], v[36:39]
    v_exp_f32 v9, v9
    v_mfma_f32_16x16x32_bf16 v[36:39], a[156:159], v[140:143], v[36:39]
    ds_read_b64_tr_b16 a[188:189], v203 offset:57344
    ds_read_b64_tr_b16 a[190:191], v203 offset:61440
    v_mfma_f32_16x16x32_bf16 v[44:47], a[144:147], v[144:147], v[100:103]
    v_exp_f32 v10, v10
    v_mfma_f32_16x16x32_bf16 v[44:47], a[148:151], v[148:151], v[44:47]
    ds_read_b128 a[128:131], v192 offset:16384
    v_cvt_pk_bf16_f32 v68, v8, v9
    v_mfma_f32_16x16x32_bf16 v[44:47], a[152:155], v[152:155], v[44:47]
    v_exp_f32 v11, v11
    v_mfma_f32_16x16x32_bf16 v[44:47], a[156:159], v[156:159], v[44:47]
    ds_read_b128 a[132:135], v193 offset:16384
    ds_read_b128 a[136:139], v194 offset:16384
    v_mfma_f32_16x16x32_bf16 v[52:55], a[144:147], v[160:163], v[104:107]
    v_exp_f32 v12, v12
    v_mfma_f32_16x16x32_bf16 v[52:55], a[148:151], v[164:167], v[52:55]
    ds_read_b128 a[140:143], v195 offset:16384
    v_cvt_pk_bf16_f32 v69, v10, v11
    v_mfma_f32_16x16x32_bf16 v[52:55], a[152:155], v[168:171], v[52:55]
    v_exp_f32 v13, v13
    v_mfma_f32_16x16x32_bf16 v[52:55], a[156:159], v[172:175], v[52:55]
    v_mfma_f32_16x16x32_bf16 v[60:63], a[144:147], v[176:179], v[108:111]
    v_exp_f32 v14, v14
    v_mfma_f32_16x16x32_bf16 v[60:63], a[148:151], v[180:183], v[60:63]
    v_cvt_pk_bf16_f32 v70, v12, v13
    v_mfma_f32_16x16x32_bf16 v[60:63], a[152:155], v[184:187], v[60:63]
    v_exp_f32 v15, v15
    v_mfma_f32_16x16x32_bf16 v[60:63], a[156:159], v[188:191], v[60:63]
    s_waitcnt lgkmcnt(4)
    v_mfma_f32_16x16x32_bf16 a[0:3], a[160:163], v[80:83], a[0:3]
    v_exp_f32 v16, v16
    v_mfma_f32_16x16x32_bf16 a[16:19], a[164:167], v[80:83], a[16:19]
    ds_read_b128 a[144:147], v192 offset:20480
    v_cvt_pk_bf16_f32 v71, v14, v15
    v_mfma_f32_16x16x32_bf16 a[4:7], a[160:163], v[84:87], a[4:7]
    v_exp_f32 v17, v17
    v_mfma_f32_16x16x32_bf16 a[20:23], a[164:167], v[84:87], a[20:23]
    ds_read_b128 a[148:151], v193 offset:20480
    ds_read_b128 a[152:155], v194 offset:20480
    v_mfma_f32_16x16x32_bf16 a[8:11], a[160:163], v[88:91], a[8:11]
    v_exp_f32 v18, v18
    v_mfma_f32_16x16x32_bf16 a[24:27], a[164:167], v[88:91], a[24:27]
    ds_read_b128 a[156:159], v195 offset:20480
    v_cvt_pk_bf16_f32 v72, v16, v17
    v_mfma_f32_16x16x32_bf16 a[12:15], a[160:163], v[92:95], a[12:15]
    v_exp_f32 v19, v19
    v_mfma_f32_16x16x32_bf16 a[28:31], a[164:167], v[92:95], a[28:31]
    v_mfma_f32_16x16x32_bf16 a[192:195], a[208:211], v[80:83], a[192:195]
    v_exp_f32 v20, v20
    v_mfma_f32_16x16x32_bf16 a[32:35], a[168:171], v[80:83], a[32:35]
    v_cvt_pk_bf16_f32 v73, v18, v19
    v_mfma_f32_16x16x32_bf16 a[48:51], a[172:175], v[80:83], a[48:51]
    v_exp_f32 v21, v21
    v_mfma_f32_16x16x32_bf16 a[36:39], a[168:171], v[84:87], a[36:39]
    v_mfma_f32_16x16x32_bf16 a[52:55], a[172:175], v[84:87], a[52:55]
    v_exp_f32 v22, v22
    v_mfma_f32_16x16x32_bf16 a[40:43], a[168:171], v[88:91], a[40:43]
    v_cvt_pk_bf16_f32 v74, v20, v21
    v_mfma_f32_16x16x32_bf16 a[56:59], a[172:175], v[88:91], a[56:59]
    v_exp_f32 v23, v23
    v_mfma_f32_16x16x32_bf16 a[44:47], a[168:171], v[92:95], a[44:47]
    v_mfma_f32_16x16x32_bf16 a[60:63], a[172:175], v[92:95], a[60:63]
    v_exp_f32 v24, v24
    v_mfma_f32_16x16x32_bf16 a[196:199], a[208:211], v[84:87], a[196:199]
    v_cvt_pk_bf16_f32 v75, v22, v23
    v_mfma_f32_16x16x32_bf16 a[64:67], a[176:179], v[80:83], a[64:67]
    v_exp_f32 v25, v25
    v_mfma_f32_16x16x32_bf16 a[80:83], a[180:183], v[80:83], a[80:83]
    v_mfma_f32_16x16x32_bf16 a[68:71], a[176:179], v[84:87], a[68:71]
    v_exp_f32 v26, v26
    v_mfma_f32_16x16x32_bf16 a[84:87], a[180:183], v[84:87], a[84:87]
    v_cvt_pk_bf16_f32 v76, v24, v25
    v_mfma_f32_16x16x32_bf16 a[72:75], a[176:179], v[88:91], a[72:75]
    v_exp_f32 v27, v27
    v_mfma_f32_16x16x32_bf16 a[88:91], a[180:183], v[88:91], a[88:91]
    v_mfma_f32_16x16x32_bf16 a[76:79], a[176:179], v[92:95], a[76:79]
    v_exp_f32 v28, v28
    v_mfma_f32_16x16x32_bf16 a[92:95], a[180:183], v[92:95], a[92:95]
    v_cvt_pk_bf16_f32 v77, v26, v27
    v_mfma_f32_16x16x32_bf16 a[200:203], a[208:211], v[88:91], a[200:203]
    v_exp_f32 v29, v29
    v_mfma_f32_16x16x32_bf16 a[96:99], a[184:187], v[80:83], a[96:99]
    v_mfma_f32_16x16x32_bf16 a[112:115], a[188:191], v[80:83], a[112:115]
    v_exp_f32 v30, v30
    v_mfma_f32_16x16x32_bf16 a[100:103], a[184:187], v[84:87], a[100:103]
    v_cvt_pk_bf16_f32 v78, v28, v29
    v_mfma_f32_16x16x32_bf16 a[116:119], a[188:191], v[84:87], a[116:119]
    v_exp_f32 v31, v31
    v_mfma_f32_16x16x32_bf16 a[104:107], a[184:187], v[88:91], a[104:107]
    v_mfma_f32_16x16x32_bf16 a[120:123], a[188:191], v[88:91], a[120:123]
    v_mfma_f32_16x16x32_bf16 a[108:111], a[184:187], v[92:95], a[108:111]
    v_cvt_pk_bf16_f32 v79, v30, v31
    v_mfma_f32_16x16x32_bf16 a[124:127], a[188:191], v[92:95], a[124:127]
    v_mfma_f32_16x16x32_bf16 a[204:207], a[208:211], v[92:95], a[204:207]
    s_waitcnt lgkmcnt(0)
    s_barrier
L1_pos1a:
    v_mfma_f32_16x16x32_bf16 v[0:3], a[128:131], v[128:131], v[96:99]
    v_exp_f32 v32, v32
    v_mfma_f32_16x16x32_bf16 v[0:3], a[132:135], v[132:135], v[0:3]
    ds_read_b64_tr_b16 a[160:161], v196 offset:0
    ds_read_b64_tr_b16 a[162:163], v196 offset:4096
    v_mfma_f32_16x16x32_bf16 v[0:3], a[136:139], v[136:139], v[0:3]
    v_exp_f32 v33, v33
    v_mfma_f32_16x16x32_bf16 v[0:3], a[140:143], v[140:143], v[0:3]
    ds_read_b64_tr_b16 a[164:165], v197 offset:0
    ds_read_b64_tr_b16 a[166:167], v197 offset:4096
    v_mfma_f32_16x16x32_bf16 v[8:11], a[128:131], v[144:147], v[100:103]
    v_exp_f32 v34, v34
    v_mfma_f32_16x16x32_bf16 v[8:11], a[132:135], v[148:151], v[8:11]
    ds_read_b64_tr_b16 a[168:169], v198 offset:0
    v_cvt_pk_bf16_f32 v80, v32, v33
    v_mfma_f32_16x16x32_bf16 v[8:11], a[136:139], v[152:155], v[8:11]
    v_exp_f32 v35, v35
    v_mfma_f32_16x16x32_bf16 v[8:11], a[140:143], v[156:159], v[8:11]
    ds_read_b64_tr_b16 a[170:171], v198 offset:4096
    ds_read_b64_tr_b16 a[172:173], v199 offset:0
    v_mfma_f32_16x16x32_bf16 v[16:19], a[128:131], v[160:163], v[104:107]
    v_exp_f32 v36, v36
    v_mfma_f32_16x16x32_bf16 v[16:19], a[132:135], v[164:167], v[16:19]
    ds_read_b64_tr_b16 a[174:175], v199 offset:4096
    v_cvt_pk_bf16_f32 v81, v34, v35
    v_mfma_f32_16x16x32_bf16 v[16:19], a[136:139], v[168:171], v[16:19]
    v_exp_f32 v37, v37
    v_mfma_f32_16x16x32_bf16 v[16:19], a[140:143], v[172:175], v[16:19]
    ds_read_b64_tr_b16 a[176:177], v200 offset:0
    ds_read_b64_tr_b16 a[178:179], v200 offset:4096
    v_mfma_f32_16x16x32_bf16 v[24:27], a[128:131], v[176:179], v[108:111]
    v_exp_f32 v38, v38
    v_mfma_f32_16x16x32_bf16 v[24:27], a[132:135], v[180:183], v[24:27]
    ds_read_b64_tr_b16 a[180:181], v201 offset:0
    v_cvt_pk_bf16_f32 v82, v36, v37
    v_mfma_f32_16x16x32_bf16 v[24:27], a[136:139], v[184:187], v[24:27]
    v_exp_f32 v39, v39
    v_mfma_f32_16x16x32_bf16 v[24:27], a[140:143], v[188:191], v[24:27]
    ds_read_b64_tr_b16 a[182:183], v201 offset:4096
    ds_read_b64_tr_b16 a[184:185], v202 offset:0
    v_mfma_f32_16x16x32_bf16 v[4:7], a[144:147], v[128:131], v[96:99]
    v_exp_f32 v40, v40
    v_mfma_f32_16x16x32_bf16 v[4:7], a[148:151], v[132:135], v[4:7]
    ds_read_b64_tr_b16 a[186:187], v202 offset:4096
    v_cvt_pk_bf16_f32 v83, v38, v39
    v_mfma_f32_16x16x32_bf16 v[4:7], a[152:155], v[136:139], v[4:7]
    v_exp_f32 v41, v41
    v_mfma_f32_16x16x32_bf16 v[4:7], a[156:159], v[140:143], v[4:7]
    ds_read_b64_tr_b16 a[188:189], v203 offset:0
    ds_read_b64_tr_b16 a[190:191], v203 offset:4096
    v_mfma_f32_16x16x32_bf16 v[12:15], a[144:147], v[144:147], v[100:103]
    v_exp_f32 v42, v42
    v_mfma_f32_16x16x32_bf16 v[12:15], a[148:151], v[148:151], v[12:15]
    ds_read_b128 a[128:131], v192 offset:24576
    v_cvt_pk_bf16_f32 v84, v40, v41
    v_mfma_f32_16x16x32_bf16 v[12:15], a[152:155], v[152:155], v[12:15]
    v_exp_f32 v43, v43
    v_mfma_f32_16x16x32_bf16 v[12:15], a[156:159], v[156:159], v[12:15]
    ds_read_b128 a[132:135], v193 offset:24576
    ds_read_b128 a[136:139], v194 offset:24576
    v_mfma_f32_16x16x32_bf16 v[20:23], a[144:147], v[160:163], v[104:107]
    v_exp_f32 v44, v44
    v_mfma_f32_16x16x32_bf16 v[20:23], a[148:151], v[164:167], v[20:23]
    ds_read_b128 a[140:143], v195 offset:24576
    v_cvt_pk_bf16_f32 v85, v42, v43
    v_mfma_f32_16x16x32_bf16 v[20:23], a[152:155], v[168:171], v[20:23]
    v_exp_f32 v45, v45
    v_mfma_f32_16x16x32_bf16 v[20:23], a[156:159], v[172:175], v[20:23]
    v_mfma_f32_16x16x32_bf16 v[28:31], a[144:147], v[176:179], v[108:111]
    v_exp_f32 v46, v46
    v_mfma_f32_16x16x32_bf16 v[28:31], a[148:151], v[180:183], v[28:31]
    v_cvt_pk_bf16_f32 v86, v44, v45
    v_mfma_f32_16x16x32_bf16 v[28:31], a[152:155], v[184:187], v[28:31]
    v_exp_f32 v47, v47
    v_mfma_f32_16x16x32_bf16 v[28:31], a[156:159], v[188:191], v[28:31]
    s_waitcnt lgkmcnt(4)
    v_mfma_f32_16x16x32_bf16 a[0:3], a[160:163], v[64:67], a[0:3]
    v_exp_f32 v48, v48
    v_mfma_f32_16x16x32_bf16 a[16:19], a[164:167], v[64:67], a[16:19]
    ds_read_b128 a[144:147], v192 offset:28672
    v_cvt_pk_bf16_f32 v87, v46, v47
    v_mfma_f32_16x16x32_bf16 a[4:7], a[160:163], v[68:71], a[4:7]
    v_exp_f32 v49, v49
    v_mfma_f32_16x16x32_bf16 a[20:23], a[164:167], v[68:71], a[20:23]
    ds_read_b128 a[148:151], v193 offset:28672
    ds_read_b128 a[152:155], v194 offset:28672
    v_mfma_f32_16x16x32_bf16 a[8:11], a[160:163], v[72:75], a[8:11]
    v_exp_f32 v50, v50
    v_mfma_f32_16x16x32_bf16 a[24:27], a[164:167], v[72:75], a[24:27]
    ds_read_b128 a[156:159], v195 offset:28672
    v_cvt_pk_bf16_f32 v88, v48, v49
    v_mfma_f32_16x16x32_bf16 a[12:15], a[160:163], v[76:79], a[12:15]
    v_exp_f32 v51, v51
    v_mfma_f32_16x16x32_bf16 a[28:31], a[164:167], v[76:79], a[28:31]
    v_mfma_f32_16x16x32_bf16 a[192:195], a[208:211], v[64:67], a[192:195]
    v_exp_f32 v52, v52
    v_mfma_f32_16x16x32_bf16 a[32:35], a[168:171], v[64:67], a[32:35]
    v_cvt_pk_bf16_f32 v89, v50, v51
    v_mfma_f32_16x16x32_bf16 a[48:51], a[172:175], v[64:67], a[48:51]
    v_exp_f32 v53, v53
    v_mfma_f32_16x16x32_bf16 a[36:39], a[168:171], v[68:71], a[36:39]
    v_mfma_f32_16x16x32_bf16 a[52:55], a[172:175], v[68:71], a[52:55]
    v_exp_f32 v54, v54
    v_mfma_f32_16x16x32_bf16 a[40:43], a[168:171], v[72:75], a[40:43]
    v_cvt_pk_bf16_f32 v90, v52, v53
    v_mfma_f32_16x16x32_bf16 a[56:59], a[172:175], v[72:75], a[56:59]
    v_exp_f32 v55, v55
    v_mfma_f32_16x16x32_bf16 a[44:47], a[168:171], v[76:79], a[44:47]
    v_mfma_f32_16x16x32_bf16 a[60:63], a[172:175], v[76:79], a[60:63]
    v_exp_f32 v56, v56
    v_mfma_f32_16x16x32_bf16 a[196:199], a[208:211], v[68:71], a[196:199]
    v_cvt_pk_bf16_f32 v91, v54, v55
    v_mfma_f32_16x16x32_bf16 a[64:67], a[176:179], v[64:67], a[64:67]
    v_exp_f32 v57, v57
    v_mfma_f32_16x16x32_bf16 a[80:83], a[180:183], v[64:67], a[80:83]
    v_mfma_f32_16x16x32_bf16 a[68:71], a[176:179], v[68:71], a[68:71]
    v_exp_f32 v58, v58
    v_mfma_f32_16x16x32_bf16 a[84:87], a[180:183], v[68:71], a[84:87]
    v_cvt_pk_bf16_f32 v92, v56, v57
    v_mfma_f32_16x16x32_bf16 a[72:75], a[176:179], v[72:75], a[72:75]
    v_exp_f32 v59, v59
    v_mfma_f32_16x16x32_bf16 a[88:91], a[180:183], v[72:75], a[88:91]
    v_mfma_f32_16x16x32_bf16 a[76:79], a[176:179], v[76:79], a[76:79]
    v_exp_f32 v60, v60
    v_mfma_f32_16x16x32_bf16 a[92:95], a[180:183], v[76:79], a[92:95]
    v_cvt_pk_bf16_f32 v93, v58, v59
    v_mfma_f32_16x16x32_bf16 a[200:203], a[208:211], v[72:75], a[200:203]
    v_exp_f32 v61, v61
    v_mfma_f32_16x16x32_bf16 a[96:99], a[184:187], v[64:67], a[96:99]
    v_mfma_f32_16x16x32_bf16 a[112:115], a[188:191], v[64:67], a[112:115]
    v_exp_f32 v62, v62
    v_mfma_f32_16x16x32_bf16 a[100:103], a[184:187], v[68:71], a[100:103]
    v_cvt_pk_bf16_f32 v94, v60, v61
    v_mfma_f32_16x16x32_bf16 a[116:119], a[188:191], v[68:71], a[116:119]
    v_exp_f32 v63, v63
    v_mfma_f32_16x16x32_bf16 a[104:107], a[184:187], v[72:75], a[104:107]
    v_mfma_f32_16x16x32_bf16 a[120:123], a[188:191], v[72:75], a[120:123]
    v_mfma_f32_16x16x32_bf16 a[108:111], a[184:187], v[76:79], a[108:111]
    v_cvt_pk_bf16_f32 v95, v62, v63
    v_mfma_f32_16x16x32_bf16 a[124:127], a[188:191], v[76:79], a[124:127]
    v_mfma_f32_16x16x32_bf16 a[204:207], a[208:211], v[76:79], a[204:207]
    s_waitcnt lgkmcnt(0)
    s_barrier
L1_pos2a:
    v_mfma_f32_16x16x32_bf16 v[32:35], a[128:131], v[128:131], v[96:99]
    v_exp_f32 v0, v0
    v_mfma_f32_16x16x32_bf16 v[32:35], a[132:135], v[132:135], v[32:35]
    ds_read_b64_tr_b16 a[160:161], v196 offset:8192
    ds_read_b64_tr_b16 a[162:163], v196 offset:12288
    v_mfma_f32_16x16x32_bf16 v[32:35], a[136:139], v[136:139], v[32:35]
    v_exp_f32 v1, v1
    v_mfma_f32_16x16x32_bf16 v[32:35], a[140:143], v[140:143], v[32:35]
    ds_read_b64_tr_b16 a[164:165], v197 offset:8192
    ds_read_b64_tr_b16 a[166:167], v197 offset:12288
    v_mfma_f32_16x16x32_bf16 v[40:43], a[128:131], v[144:147], v[100:103]
    v_exp_f32 v2, v2
    v_mfma_f32_16x16x32_bf16 v[40:43], a[132:135], v[148:151], v[40:43]
    ds_read_b64_tr_b16 a[168:169], v198 offset:8192
    v_cvt_pk_bf16_f32 v64, v0, v1
    v_mfma_f32_16x16x32_bf16 v[40:43], a[136:139], v[152:155], v[40:43]
    v_exp_f32 v3, v3
    v_mfma_f32_16x16x32_bf16 v[40:43], a[140:143], v[156:159], v[40:43]
    ds_read_b64_tr_b16 a[170:171], v198 offset:12288
    ds_read_b64_tr_b16 a[172:173], v199 offset:8192
    v_mfma_f32_16x16x32_bf16 v[48:51], a[128:131], v[160:163], v[104:107]
    v_exp_f32 v4, v4
    v_mfma_f32_16x16x32_bf16 v[48:51], a[132:135], v[164:167], v[48:51]
    ds_read_b64_tr_b16 a[174:175], v199 offset:12288
    v_cvt_pk_bf16_f32 v65, v2, v3
    v_mfma_f32_16x16x32_bf16 v[48:51], a[136:139], v[168:171], v[48:51]
    v_exp_f32 v5, v5
    v_mfma_f32_16x16x32_bf16 v[48:51], a[140:143], v[172:175], v[48:51]
    ds_read_b64_tr_b16 a[176:177], v200 offset:8192
    ds_read_b64_tr_b16 a[178:179], v200 offset:12288
    v_mfma_f32_16x16x32_bf16 v[56:59], a[128:131], v[176:179], v[108:111]
    v_exp_f32 v6, v6
    v_mfma_f32_16x16x32_bf16 v[56:59], a[132:135], v[180:183], v[56:59]
    ds_read_b64_tr_b16 a[180:181], v201 offset:8192
    v_cvt_pk_bf16_f32 v66, v4, v5
    v_mfma_f32_16x16x32_bf16 v[56:59], a[136:139], v[184:187], v[56:59]
    v_exp_f32 v7, v7
    v_mfma_f32_16x16x32_bf16 v[56:59], a[140:143], v[188:191], v[56:59]
    ds_read_b64_tr_b16 a[182:183], v201 offset:12288
    ds_read_b64_tr_b16 a[184:185], v202 offset:8192
    v_mfma_f32_16x16x32_bf16 v[36:39], a[144:147], v[128:131], v[96:99]
    v_exp_f32 v8, v8
    v_mfma_f32_16x16x32_bf16 v[36:39], a[148:151], v[132:135], v[36:39]
    ds_read_b64_tr_b16 a[186:187], v202 offset:12288
    v_cvt_pk_bf16_f32 v67, v6, v7
    v_mfma_f32_16x16x32_bf16 v[36:39], a[152:155], v[136:139], v[36:39]
    v_exp_f32 v9, v9
    v_mfma_f32_16x16x32_bf16 v[36:39], a[156:159], v[140:143], v[36:39]
    ds_read_b64_tr_b16 a[188:189], v203 offset:8192
    ds_read_b64_tr_b16 a[190:191], v203 offset:12288
    v_mfma_f32_16x16x32_bf16 v[44:47], a[144:147], v[144:147], v[100:103]
    v_exp_f32 v10, v10
    v_mfma_f32_16x16x32_bf16 v[44:47], a[148:151], v[148:151], v[44:47]
    ds_read_b128 a[128:131], v192 offset:32768
    v_cvt_pk_bf16_f32 v68, v8, v9
    v_mfma_f32_16x16x32_bf16 v[44:47], a[152:155], v[152:155], v[44:47]
    v_exp_f32 v11, v11
    v_mfma_f32_16x16x32_bf16 v[44:47], a[156:159], v[156:159], v[44:47]
    ds_read_b128 a[132:135], v193 offset:32768
    ds_read_b128 a[136:139], v194 offset:32768
    v_mfma_f32_16x16x32_bf16 v[52:55], a[144:147], v[160:163], v[104:107]
    v_exp_f32 v12, v12
    v_mfma_f32_16x16x32_bf16 v[52:55], a[148:151], v[164:167], v[52:55]
    ds_read_b128 a[140:143], v195 offset:32768
    v_cvt_pk_bf16_f32 v69, v10, v11
    v_mfma_f32_16x16x32_bf16 v[52:55], a[152:155], v[168:171], v[52:55]
    v_exp_f32 v13, v13
    v_mfma_f32_16x16x32_bf16 v[52:55], a[156:159], v[172:175], v[52:55]
    v_mfma_f32_16x16x32_bf16 v[60:63], a[144:147], v[176:179], v[108:111]
    v_exp_f32 v14, v14
    v_mfma_f32_16x16x32_bf16 v[60:63], a[148:151], v[180:183], v[60:63]
    v_cvt_pk_bf16_f32 v70, v12, v13
    v_mfma_f32_16x16x32_bf16 v[60:63], a[152:155], v[184:187], v[60:63]
    v_exp_f32 v15, v15
    v_mfma_f32_16x16x32_bf16 v[60:63], a[156:159], v[188:191], v[60:63]
    s_waitcnt lgkmcnt(4)
    v_mfma_f32_16x16x32_bf16 a[0:3], a[160:163], v[80:83], a[0:3]
    v_exp_f32 v16, v16
    v_mfma_f32_16x16x32_bf16 a[16:19], a[164:167], v[80:83], a[16:19]
    ds_read_b128 a[144:147], v192 offset:36864
    v_cvt_pk_bf16_f32 v71, v14, v15
    v_mfma_f32_16x16x32_bf16 a[4:7], a[160:163], v[84:87], a[4:7]
    v_exp_f32 v17, v17
    v_mfma_f32_16x16x32_bf16 a[20:23], a[164:167], v[84:87], a[20:23]
    ds_read_b128 a[148:151], v193 offset:36864
    ds_read_b128 a[152:155], v194 offset:36864
    v_mfma_f32_16x16x32_bf16 a[8:11], a[160:163], v[88:91], a[8:11]
    v_exp_f32 v18, v18
    v_mfma_f32_16x16x32_bf16 a[24:27], a[164:167], v[88:91], a[24:27]
    ds_read_b128 a[156:159], v195 offset:36864
    v_cvt_pk_bf16_f32 v72, v16, v17
    v_mfma_f32_16x16x32_bf16 a[12:15], a[160:163], v[92:95], a[12:15]
    v_exp_f32 v19, v19
    v_mfma_f32_16x16x32_bf16 a[28:31], a[164:167], v[92:95], a[28:31]
    v_mfma_f32_16x16x32_bf16 a[192:195], a[208:211], v[80:83], a[192:195]
    v_exp_f32 v20, v20
    v_mfma_f32_16x16x32_bf16 a[32:35], a[168:171], v[80:83], a[32:35]
    v_cvt_pk_bf16_f32 v73, v18, v19
    v_mfma_f32_16x16x32_bf16 a[48:51], a[172:175], v[80:83], a[48:51]
    v_exp_f32 v21, v21
    v_mfma_f32_16x16x32_bf16 a[36:39], a[168:171], v[84:87], a[36:39]
    v_mfma_f32_16x16x32_bf16 a[52:55], a[172:175], v[84:87], a[52:55]
    v_exp_f32 v22, v22
    v_mfma_f32_16x16x32_bf16 a[40:43], a[168:171], v[88:91], a[40:43]
    v_cvt_pk_bf16_f32 v74, v20, v21
    v_mfma_f32_16x16x32_bf16 a[56:59], a[172:175], v[88:91], a[56:59]
    v_exp_f32 v23, v23
    v_mfma_f32_16x16x32_bf16 a[44:47], a[168:171], v[92:95], a[44:47]
    v_mfma_f32_16x16x32_bf16 a[60:63], a[172:175], v[92:95], a[60:63]
    v_exp_f32 v24, v24
    v_mfma_f32_16x16x32_bf16 a[196:199], a[208:211], v[84:87], a[196:199]
    v_cvt_pk_bf16_f32 v75, v22, v23
    v_mfma_f32_16x16x32_bf16 a[64:67], a[176:179], v[80:83], a[64:67]
    v_exp_f32 v25, v25
    v_mfma_f32_16x16x32_bf16 a[80:83], a[180:183], v[80:83], a[80:83]
    v_mfma_f32_16x16x32_bf16 a[68:71], a[176:179], v[84:87], a[68:71]
    v_exp_f32 v26, v26
    v_mfma_f32_16x16x32_bf16 a[84:87], a[180:183], v[84:87], a[84:87]
    v_cvt_pk_bf16_f32 v76, v24, v25
    v_mfma_f32_16x16x32_bf16 a[72:75], a[176:179], v[88:91], a[72:75]
    v_exp_f32 v27, v27
    v_mfma_f32_16x16x32_bf16 a[88:91], a[180:183], v[88:91], a[88:91]
    v_mfma_f32_16x16x32_bf16 a[76:79], a[176:179], v[92:95], a[76:79]
    v_exp_f32 v28, v28
    v_mfma_f32_16x16x32_bf16 a[92:95], a[180:183], v[92:95], a[92:95]
    v_cvt_pk_bf16_f32 v77, v26, v27
    v_mfma_f32_16x16x32_bf16 a[200:203], a[208:211], v[88:91], a[200:203]
    v_exp_f32 v29, v29
    v_mfma_f32_16x16x32_bf16 a[96:99], a[184:187], v[80:83], a[96:99]
    v_mfma_f32_16x16x32_bf16 a[112:115], a[188:191], v[80:83], a[112:115]
    v_exp_f32 v30, v30
    v_mfma_f32_16x16x32_bf16 a[100:103], a[184:187], v[84:87], a[100:103]
    v_cvt_pk_bf16_f32 v78, v28, v29
    v_mfma_f32_16x16x32_bf16 a[116:119], a[188:191], v[84:87], a[116:119]
    v_exp_f32 v31, v31
    v_mfma_f32_16x16x32_bf16 a[104:107], a[184:187], v[88:91], a[104:107]
    v_mfma_f32_16x16x32_bf16 a[120:123], a[188:191], v[88:91], a[120:123]
    v_mfma_f32_16x16x32_bf16 a[108:111], a[184:187], v[92:95], a[108:111]
    v_cvt_pk_bf16_f32 v79, v30, v31
    v_mfma_f32_16x16x32_bf16 a[124:127], a[188:191], v[92:95], a[124:127]
    v_mfma_f32_16x16x32_bf16 a[204:207], a[208:211], v[92:95], a[204:207]
    s_waitcnt lgkmcnt(0)
    s_barrier
L1_pos3a:
    v_mfma_f32_16x16x32_bf16 v[0:3], a[128:131], v[128:131], v[96:99]
    v_exp_f32 v32, v32
    v_mfma_f32_16x16x32_bf16 v[0:3], a[132:135], v[132:135], v[0:3]
    ds_read_b64_tr_b16 a[160:161], v196 offset:16384
    ds_read_b64_tr_b16 a[162:163], v196 offset:20480
    v_mfma_f32_16x16x32_bf16 v[0:3], a[136:139], v[136:139], v[0:3]
    v_exp_f32 v33, v33
    v_mfma_f32_16x16x32_bf16 v[0:3], a[140:143], v[140:143], v[0:3]
    ds_read_b64_tr_b16 a[164:165], v197 offset:16384
    ds_read_b64_tr_b16 a[166:167], v197 offset:20480
    v_mfma_f32_16x16x32_bf16 v[8:11], a[128:131], v[144:147], v[100:103]
    v_exp_f32 v34, v34
    v_mfma_f32_16x16x32_bf16 v[8:11], a[132:135], v[148:151], v[8:11]
    ds_read_b64_tr_b16 a[168:169], v198 offset:16384
    v_cvt_pk_bf16_f32 v80, v32, v33
    v_mfma_f32_16x16x32_bf16 v[8:11], a[136:139], v[152:155], v[8:11]
    v_exp_f32 v35, v35
    v_mfma_f32_16x16x32_bf16 v[8:11], a[140:143], v[156:159], v[8:11]
    ds_read_b64_tr_b16 a[170:171], v198 offset:20480
    ds_read_b64_tr_b16 a[172:173], v199 offset:16384
    v_mfma_f32_16x16x32_bf16 v[16:19], a[128:131], v[160:163], v[104:107]
    v_exp_f32 v36, v36
    v_mfma_f32_16x16x32_bf16 v[16:19], a[132:135], v[164:167], v[16:19]
    ds_read_b64_tr_b16 a[174:175], v199 offset:20480
    v_cvt_pk_bf16_f32 v81, v34, v35
    v_mfma_f32_16x16x32_bf16 v[16:19], a[136:139], v[168:171], v[16:19]
    v_exp_f32 v37, v37
    v_mfma_f32_16x16x32_bf16 v[16:19], a[140:143], v[172:175], v[16:19]
    ds_read_b64_tr_b16 a[176:177], v200 offset:16384
    ds_read_b64_tr_b16 a[178:179], v200 offset:20480
    v_mfma_f32_16x16x32_bf16 v[24:27], a[128:131], v[176:179], v[108:111]
    v_exp_f32 v38, v38
    v_mfma_f32_16x16x32_bf16 v[24:27], a[132:135], v[180:183], v[24:27]
    ds_read_b64_tr_b16 a[180:181], v201 offset:16384
    v_cvt_pk_bf16_f32 v82, v36, v37
    v_mfma_f32_16x16x32_bf16 v[24:27], a[136:139], v[184:187], v[24:27]
    v_exp_f32 v39, v39
    v_mfma_f32_16x16x32_bf16 v[24:27], a[140:143], v[188:191], v[24:27]
    ds_read_b64_tr_b16 a[182:183], v201 offset:20480
    ds_read_b64_tr_b16 a[184:185], v202 offset:16384
    v_mfma_f32_16x16x32_bf16 v[4:7], a[144:147], v[128:131], v[96:99]
    v_exp_f32 v40, v40
    v_mfma_f32_16x16x32_bf16 v[4:7], a[148:151], v[132:135], v[4:7]
    ds_read_b64_tr_b16 a[186:187], v202 offset:20480
    v_cvt_pk_bf16_f32 v83, v38, v39
    v_mfma_f32_16x16x32_bf16 v[4:7], a[152:155], v[136:139], v[4:7]
    v_exp_f32 v41, v41
    v_mfma_f32_16x16x32_bf16 v[4:7], a[156:159], v[140:143], v[4:7]
    ds_read_b64_tr_b16 a[188:189], v203 offset:16384
    ds_read_b64_tr_b16 a[190:191], v203 offset:20480
    v_mfma_f32_16x16x32_bf16 v[12:15], a[144:147], v[144:147], v[100:103]
    v_exp_f32 v42, v42
    v_mfma_f32_16x16x32_bf16 v[12:15], a[148:151], v[148:151], v[12:15]
    ds_read_b128 a[128:131], v192 offset:40960
    v_cvt_pk_bf16_f32 v84, v40, v41
    v_mfma_f32_16x16x32_bf16 v[12:15], a[152:155], v[152:155], v[12:15]
    v_exp_f32 v43, v43
    v_mfma_f32_16x16x32_bf16 v[12:15], a[156:159], v[156:159], v[12:15]
    ds_read_b128 a[132:135], v193 offset:40960
    ds_read_b128 a[136:139], v194 offset:40960
    v_mfma_f32_16x16x32_bf16 v[20:23], a[144:147], v[160:163], v[104:107]
    v_exp_f32 v44, v44
    v_mfma_f32_16x16x32_bf16 v[20:23], a[148:151], v[164:167], v[20:23]
    ds_read_b128 a[140:143], v195 offset:40960
    v_cvt_pk_bf16_f32 v85, v42, v43
    v_mfma_f32_16x16x32_bf16 v[20:23], a[152:155], v[168:171], v[20:23]
    v_exp_f32 v45, v45
    v_mfma_f32_16x16x32_bf16 v[20:23], a[156:159], v[172:175], v[20:23]
    v_mfma_f32_16x16x32_bf16 v[28:31], a[144:147], v[176:179], v[108:111]
    v_exp_f32 v46, v46
    v_mfma_f32_16x16x32_bf16 v[28:31], a[148:151], v[180:183], v[28:31]
    v_cvt_pk_bf16_f32 v86, v44, v45
    v_mfma_f32_16x16x32_bf16 v[28:31], a[152:155], v[184:187], v[28:31]
    v_exp_f32 v47, v47
    v_mfma_f32_16x16x32_bf16 v[28:31], a[156:159], v[188:191], v[28:31]
    s_waitcnt lgkmcnt(4)
    v_mfma_f32_16x16x32_bf16 a[0:3], a[160:163], v[64:67], a[0:3]
    v_exp_f32 v48, v48
    v_mfma_f32_16x16x32_bf16 a[16:19], a[164:167], v[64:67], a[16:19]
    ds_read_b128 a[144:147], v192 offset:45056
    v_cvt_pk_bf16_f32 v87, v46, v47
    v_mfma_f32_16x16x32_bf16 a[4:7], a[160:163], v[68:71], a[4:7]
    v_exp_f32 v49, v49
    v_mfma_f32_16x16x32_bf16 a[20:23], a[164:167], v[68:71], a[20:23]
    ds_read_b128 a[148:151], v193 offset:45056
    ds_read_b128 a[152:155], v194 offset:45056
    v_mfma_f32_16x16x32_bf16 a[8:11], a[160:163], v[72:75], a[8:11]
    v_exp_f32 v50, v50
    v_mfma_f32_16x16x32_bf16 a[24:27], a[164:167], v[72:75], a[24:27]
    ds_read_b128 a[156:159], v195 offset:45056
    v_cvt_pk_bf16_f32 v88, v48, v49
    v_mfma_f32_16x16x32_bf16 a[12:15], a[160:163], v[76:79], a[12:15]
    v_exp_f32 v51, v51
    v_mfma_f32_16x16x32_bf16 a[28:31], a[164:167], v[76:79], a[28:31]
    v_mfma_f32_16x16x32_bf16 a[192:195], a[208:211], v[64:67], a[192:195]
    v_exp_f32 v52, v52
    v_mfma_f32_16x16x32_bf16 a[32:35], a[168:171], v[64:67], a[32:35]
    v_cvt_pk_bf16_f32 v89, v50, v51
    v_mfma_f32_16x16x32_bf16 a[48:51], a[172:175], v[64:67], a[48:51]
    v_exp_f32 v53, v53
    v_mfma_f32_16x16x32_bf16 a[36:39], a[168:171], v[68:71], a[36:39]
    v_mfma_f32_16x16x32_bf16 a[52:55], a[172:175], v[68:71], a[52:55]
    v_exp_f32 v54, v54
    v_mfma_f32_16x16x32_bf16 a[40:43], a[168:171], v[72:75], a[40:43]
    v_cvt_pk_bf16_f32 v90, v52, v53
    v_mfma_f32_16x16x32_bf16 a[56:59], a[172:175], v[72:75], a[56:59]
    v_exp_f32 v55, v55
    v_mfma_f32_16x16x32_bf16 a[44:47], a[168:171], v[76:79], a[44:47]
    v_mfma_f32_16x16x32_bf16 a[60:63], a[172:175], v[76:79], a[60:63]
    v_exp_f32 v56, v56
    v_mfma_f32_16x16x32_bf16 a[196:199], a[208:211], v[68:71], a[196:199]
    v_cvt_pk_bf16_f32 v91, v54, v55
    v_mfma_f32_16x16x32_bf16 a[64:67], a[176:179], v[64:67], a[64:67]
    v_exp_f32 v57, v57
    v_mfma_f32_16x16x32_bf16 a[80:83], a[180:183], v[64:67], a[80:83]
    v_mfma_f32_16x16x32_bf16 a[68:71], a[176:179], v[68:71], a[68:71]
    v_exp_f32 v58, v58
    v_mfma_f32_16x16x32_bf16 a[84:87], a[180:183], v[68:71], a[84:87]
    v_cvt_pk_bf16_f32 v92, v56, v57
    v_mfma_f32_16x16x32_bf16 a[72:75], a[176:179], v[72:75], a[72:75]
    v_exp_f32 v59, v59
    v_mfma_f32_16x16x32_bf16 a[88:91], a[180:183], v[72:75], a[88:91]
    v_mfma_f32_16x16x32_bf16 a[76:79], a[176:179], v[76:79], a[76:79]
    v_exp_f32 v60, v60
    v_mfma_f32_16x16x32_bf16 a[92:95], a[180:183], v[76:79], a[92:95]
    v_cvt_pk_bf16_f32 v93, v58, v59
    v_mfma_f32_16x16x32_bf16 a[200:203], a[208:211], v[72:75], a[200:203]
    v_exp_f32 v61, v61
    v_mfma_f32_16x16x32_bf16 a[96:99], a[184:187], v[64:67], a[96:99]
    v_mfma_f32_16x16x32_bf16 a[112:115], a[188:191], v[64:67], a[112:115]
    v_exp_f32 v62, v62
    v_mfma_f32_16x16x32_bf16 a[100:103], a[184:187], v[68:71], a[100:103]
    v_cvt_pk_bf16_f32 v94, v60, v61
    v_mfma_f32_16x16x32_bf16 a[116:119], a[188:191], v[68:71], a[116:119]
    v_exp_f32 v63, v63
    v_mfma_f32_16x16x32_bf16 a[104:107], a[184:187], v[72:75], a[104:107]
    v_mfma_f32_16x16x32_bf16 a[120:123], a[188:191], v[72:75], a[120:123]
    v_mfma_f32_16x16x32_bf16 a[108:111], a[184:187], v[76:79], a[108:111]
    v_cvt_pk_bf16_f32 v95, v62, v63
    v_mfma_f32_16x16x32_bf16 a[124:127], a[188:191], v[76:79], a[124:127]
    v_mfma_f32_16x16x32_bf16 a[204:207], a[208:211], v[76:79], a[204:207]
    s_waitcnt lgkmcnt(0)
    s_barrier
L1_pos4a:
    v_mfma_f32_16x16x32_bf16 v[32:35], a[128:131], v[128:131], v[96:99]
    v_exp_f32 v0, v0
    v_mfma_f32_16x16x32_bf16 v[32:35], a[132:135], v[132:135], v[32:35]
    ds_read_b64_tr_b16 a[160:161], v196 offset:24576
    ds_read_b64_tr_b16 a[162:163], v196 offset:28672
    v_mfma_f32_16x16x32_bf16 v[32:35], a[136:139], v[136:139], v[32:35]
    v_exp_f32 v1, v1
    v_mfma_f32_16x16x32_bf16 v[32:35], a[140:143], v[140:143], v[32:35]
    ds_read_b64_tr_b16 a[164:165], v197 offset:24576
    ds_read_b64_tr_b16 a[166:167], v197 offset:28672
    v_mfma_f32_16x16x32_bf16 v[40:43], a[128:131], v[144:147], v[100:103]
    v_exp_f32 v2, v2
    v_mfma_f32_16x16x32_bf16 v[40:43], a[132:135], v[148:151], v[40:43]
    ds_read_b64_tr_b16 a[168:169], v198 offset:24576
    v_cvt_pk_bf16_f32 v64, v0, v1
    v_mfma_f32_16x16x32_bf16 v[40:43], a[136:139], v[152:155], v[40:43]
    v_exp_f32 v3, v3
    v_mfma_f32_16x16x32_bf16 v[40:43], a[140:143], v[156:159], v[40:43]
    ds_read_b64_tr_b16 a[170:171], v198 offset:28672
    ds_read_b64_tr_b16 a[172:173], v199 offset:24576
    v_mfma_f32_16x16x32_bf16 v[48:51], a[128:131], v[160:163], v[104:107]
    v_exp_f32 v4, v4
    v_mfma_f32_16x16x32_bf16 v[48:51], a[132:135], v[164:167], v[48:51]
    ds_read_b64_tr_b16 a[174:175], v199 offset:28672
    v_cvt_pk_bf16_f32 v65, v2, v3
    v_mfma_f32_16x16x32_bf16 v[48:51], a[136:139], v[168:171], v[48:51]
    v_exp_f32 v5, v5
    v_mfma_f32_16x16x32_bf16 v[48:51], a[140:143], v[172:175], v[48:51]
    ds_read_b64_tr_b16 a[176:177], v200 offset:24576
    ds_read_b64_tr_b16 a[178:179], v200 offset:28672
    v_mfma_f32_16x16x32_bf16 v[56:59], a[128:131], v[176:179], v[108:111]
    v_exp_f32 v6, v6
    v_mfma_f32_16x16x32_bf16 v[56:59], a[132:135], v[180:183], v[56:59]
    ds_read_b64_tr_b16 a[180:181], v201 offset:24576
    v_cvt_pk_bf16_f32 v66, v4, v5
    v_mfma_f32_16x16x32_bf16 v[56:59], a[136:139], v[184:187], v[56:59]
    v_exp_f32 v7, v7
    v_mfma_f32_16x16x32_bf16 v[56:59], a[140:143], v[188:191], v[56:59]
    ds_read_b64_tr_b16 a[182:183], v201 offset:28672
    ds_read_b64_tr_b16 a[184:185], v202 offset:24576
    v_mfma_f32_16x16x32_bf16 v[36:39], a[144:147], v[128:131], v[96:99]
    v_exp_f32 v8, v8
    v_mfma_f32_16x16x32_bf16 v[36:39], a[148:151], v[132:135], v[36:39]
    ds_read_b64_tr_b16 a[186:187], v202 offset:28672
    v_cvt_pk_bf16_f32 v67, v6, v7
    v_mfma_f32_16x16x32_bf16 v[36:39], a[152:155], v[136:139], v[36:39]
    v_exp_f32 v9, v9
    v_mfma_f32_16x16x32_bf16 v[36:39], a[156:159], v[140:143], v[36:39]
    ds_read_b64_tr_b16 a[188:189], v203 offset:24576
    ds_read_b64_tr_b16 a[190:191], v203 offset:28672
    v_mfma_f32_16x16x32_bf16 v[44:47], a[144:147], v[144:147], v[100:103]
    v_exp_f32 v10, v10
    v_mfma_f32_16x16x32_bf16 v[44:47], a[148:151], v[148:151], v[44:47]
    ds_read_b128 a[128:131], v192 offset:49152
    v_cvt_pk_bf16_f32 v68, v8, v9
    v_mfma_f32_16x16x32_bf16 v[44:47], a[152:155], v[152:155], v[44:47]
    v_exp_f32 v11, v11
    v_mfma_f32_16x16x32_bf16 v[44:47], a[156:159], v[156:159], v[44:47]
    ds_read_b128 a[132:135], v193 offset:49152
    ds_read_b128 a[136:139], v194 offset:49152
    v_mfma_f32_16x16x32_bf16 v[52:55], a[144:147], v[160:163], v[104:107]
    v_exp_f32 v12, v12
    v_mfma_f32_16x16x32_bf16 v[52:55], a[148:151], v[164:167], v[52:55]
    ds_read_b128 a[140:143], v195 offset:49152
    v_cvt_pk_bf16_f32 v69, v10, v11
    v_mfma_f32_16x16x32_bf16 v[52:55], a[152:155], v[168:171], v[52:55]
    v_exp_f32 v13, v13
    v_mfma_f32_16x16x32_bf16 v[52:55], a[156:159], v[172:175], v[52:55]
    v_mfma_f32_16x16x32_bf16 v[60:63], a[144:147], v[176:179], v[108:111]
    v_exp_f32 v14, v14
    v_mfma_f32_16x16x32_bf16 v[60:63], a[148:151], v[180:183], v[60:63]
    v_cvt_pk_bf16_f32 v70, v12, v13
    v_mfma_f32_16x16x32_bf16 v[60:63], a[152:155], v[184:187], v[60:63]
    v_exp_f32 v15, v15
    v_mfma_f32_16x16x32_bf16 v[60:63], a[156:159], v[188:191], v[60:63]
    s_waitcnt lgkmcnt(4)
    v_mfma_f32_16x16x32_bf16 a[0:3], a[160:163], v[80:83], a[0:3]
    v_exp_f32 v16, v16
    v_mfma_f32_16x16x32_bf16 a[16:19], a[164:167], v[80:83], a[16:19]
    ds_read_b128 a[144:147], v192 offset:53248
    v_cvt_pk_bf16_f32 v71, v14, v15
    v_mfma_f32_16x16x32_bf16 a[4:7], a[160:163], v[84:87], a[4:7]
    v_exp_f32 v17, v17
    v_mfma_f32_16x16x32_bf16 a[20:23], a[164:167], v[84:87], a[20:23]
    ds_read_b128 a[148:151], v193 offset:53248
    ds_read_b128 a[152:155], v194 offset:53248
    v_mfma_f32_16x16x32_bf16 a[8:11], a[160:163], v[88:91], a[8:11]
    v_exp_f32 v18, v18
    v_mfma_f32_16x16x32_bf16 a[24:27], a[164:167], v[88:91], a[24:27]
    ds_read_b128 a[156:159], v195 offset:53248
    v_cvt_pk_bf16_f32 v72, v16, v17
    v_mfma_f32_16x16x32_bf16 a[12:15], a[160:163], v[92:95], a[12:15]
    v_exp_f32 v19, v19
    v_mfma_f32_16x16x32_bf16 a[28:31], a[164:167], v[92:95], a[28:31]
    v_mfma_f32_16x16x32_bf16 a[192:195], a[208:211], v[80:83], a[192:195]
    v_exp_f32 v20, v20
    v_mfma_f32_16x16x32_bf16 a[32:35], a[168:171], v[80:83], a[32:35]
    v_cvt_pk_bf16_f32 v73, v18, v19
    v_mfma_f32_16x16x32_bf16 a[48:51], a[172:175], v[80:83], a[48:51]
    v_exp_f32 v21, v21
    v_mfma_f32_16x16x32_bf16 a[36:39], a[168:171], v[84:87], a[36:39]
    v_mfma_f32_16x16x32_bf16 a[52:55], a[172:175], v[84:87], a[52:55]
    v_exp_f32 v22, v22
    v_mfma_f32_16x16x32_bf16 a[40:43], a[168:171], v[88:91], a[40:43]
    v_cvt_pk_bf16_f32 v74, v20, v21
    v_mfma_f32_16x16x32_bf16 a[56:59], a[172:175], v[88:91], a[56:59]
    v_exp_f32 v23, v23
    v_mfma_f32_16x16x32_bf16 a[44:47], a[168:171], v[92:95], a[44:47]
    v_mfma_f32_16x16x32_bf16 a[60:63], a[172:175], v[92:95], a[60:63]
    v_exp_f32 v24, v24
    v_mfma_f32_16x16x32_bf16 a[196:199], a[208:211], v[84:87], a[196:199]
    v_cvt_pk_bf16_f32 v75, v22, v23
    v_mfma_f32_16x16x32_bf16 a[64:67], a[176:179], v[80:83], a[64:67]
    v_exp_f32 v25, v25
    v_mfma_f32_16x16x32_bf16 a[80:83], a[180:183], v[80:83], a[80:83]
    v_mfma_f32_16x16x32_bf16 a[68:71], a[176:179], v[84:87], a[68:71]
    v_exp_f32 v26, v26
    v_mfma_f32_16x16x32_bf16 a[84:87], a[180:183], v[84:87], a[84:87]
    v_cvt_pk_bf16_f32 v76, v24, v25
    v_mfma_f32_16x16x32_bf16 a[72:75], a[176:179], v[88:91], a[72:75]
    v_exp_f32 v27, v27
    v_mfma_f32_16x16x32_bf16 a[88:91], a[180:183], v[88:91], a[88:91]
    v_mfma_f32_16x16x32_bf16 a[76:79], a[176:179], v[92:95], a[76:79]
    v_exp_f32 v28, v28
    v_mfma_f32_16x16x32_bf16 a[92:95], a[180:183], v[92:95], a[92:95]
    v_cvt_pk_bf16_f32 v77, v26, v27
    v_mfma_f32_16x16x32_bf16 a[200:203], a[208:211], v[88:91], a[200:203]
    v_exp_f32 v29, v29
    v_mfma_f32_16x16x32_bf16 a[96:99], a[184:187], v[80:83], a[96:99]
    v_mfma_f32_16x16x32_bf16 a[112:115], a[188:191], v[80:83], a[112:115]
    v_exp_f32 v30, v30
    v_mfma_f32_16x16x32_bf16 a[100:103], a[184:187], v[84:87], a[100:103]
    v_cvt_pk_bf16_f32 v78, v28, v29
    v_mfma_f32_16x16x32_bf16 a[116:119], a[188:191], v[84:87], a[116:119]
    v_exp_f32 v31, v31
    v_mfma_f32_16x16x32_bf16 a[104:107], a[184:187], v[88:91], a[104:107]
    v_mfma_f32_16x16x32_bf16 a[120:123], a[188:191], v[88:91], a[120:123]
    v_mfma_f32_16x16x32_bf16 a[108:111], a[184:187], v[92:95], a[108:111]
    v_cvt_pk_bf16_f32 v79, v30, v31
    v_mfma_f32_16x16x32_bf16 a[124:127], a[188:191], v[92:95], a[124:127]
    v_mfma_f32_16x16x32_bf16 a[204:207], a[208:211], v[92:95], a[204:207]
    s_waitcnt lgkmcnt(0)
    s_barrier
L1_pos5a:
    v_mfma_f32_16x16x32_bf16 v[0:3], a[128:131], v[128:131], v[96:99]
    v_exp_f32 v32, v32
    v_mfma_f32_16x16x32_bf16 v[0:3], a[132:135], v[132:135], v[0:3]
    ds_read_b64_tr_b16 a[160:161], v196 offset:32768
    ds_read_b64_tr_b16 a[162:163], v196 offset:36864
    v_mfma_f32_16x16x32_bf16 v[0:3], a[136:139], v[136:139], v[0:3]
    v_exp_f32 v33, v33
    v_mfma_f32_16x16x32_bf16 v[0:3], a[140:143], v[140:143], v[0:3]
    ds_read_b64_tr_b16 a[164:165], v197 offset:32768
    ds_read_b64_tr_b16 a[166:167], v197 offset:36864
    v_mfma_f32_16x16x32_bf16 v[8:11], a[128:131], v[144:147], v[100:103]
    v_exp_f32 v34, v34
    v_mfma_f32_16x16x32_bf16 v[8:11], a[132:135], v[148:151], v[8:11]
    ds_read_b64_tr_b16 a[168:169], v198 offset:32768
    v_cvt_pk_bf16_f32 v80, v32, v33
    v_mfma_f32_16x16x32_bf16 v[8:11], a[136:139], v[152:155], v[8:11]
    v_exp_f32 v35, v35
    v_mfma_f32_16x16x32_bf16 v[8:11], a[140:143], v[156:159], v[8:11]
    ds_read_b64_tr_b16 a[170:171], v198 offset:36864
    ds_read_b64_tr_b16 a[172:173], v199 offset:32768
    v_mfma_f32_16x16x32_bf16 v[16:19], a[128:131], v[160:163], v[104:107]
    v_exp_f32 v36, v36
    v_mfma_f32_16x16x32_bf16 v[16:19], a[132:135], v[164:167], v[16:19]
    ds_read_b64_tr_b16 a[174:175], v199 offset:36864
    v_cvt_pk_bf16_f32 v81, v34, v35
    v_mfma_f32_16x16x32_bf16 v[16:19], a[136:139], v[168:171], v[16:19]
    v_exp_f32 v37, v37
    v_mfma_f32_16x16x32_bf16 v[16:19], a[140:143], v[172:175], v[16:19]
    ds_read_b64_tr_b16 a[176:177], v200 offset:32768
    ds_read_b64_tr_b16 a[178:179], v200 offset:36864
    v_mfma_f32_16x16x32_bf16 v[24:27], a[128:131], v[176:179], v[108:111]
    v_exp_f32 v38, v38
    v_mfma_f32_16x16x32_bf16 v[24:27], a[132:135], v[180:183], v[24:27]
    ds_read_b64_tr_b16 a[180:181], v201 offset:32768
    v_cvt_pk_bf16_f32 v82, v36, v37
    v_mfma_f32_16x16x32_bf16 v[24:27], a[136:139], v[184:187], v[24:27]
    v_exp_f32 v39, v39
    v_mfma_f32_16x16x32_bf16 v[24:27], a[140:143], v[188:191], v[24:27]
    ds_read_b64_tr_b16 a[182:183], v201 offset:36864
    ds_read_b64_tr_b16 a[184:185], v202 offset:32768
    v_mfma_f32_16x16x32_bf16 v[4:7], a[144:147], v[128:131], v[96:99]
    v_exp_f32 v40, v40
    v_mfma_f32_16x16x32_bf16 v[4:7], a[148:151], v[132:135], v[4:7]
    ds_read_b64_tr_b16 a[186:187], v202 offset:36864
    v_cvt_pk_bf16_f32 v83, v38, v39
    v_mfma_f32_16x16x32_bf16 v[4:7], a[152:155], v[136:139], v[4:7]
    v_exp_f32 v41, v41
    v_mfma_f32_16x16x32_bf16 v[4:7], a[156:159], v[140:143], v[4:7]
    ds_read_b64_tr_b16 a[188:189], v203 offset:32768
    ds_read_b64_tr_b16 a[190:191], v203 offset:36864
    v_mfma_f32_16x16x32_bf16 v[12:15], a[144:147], v[144:147], v[100:103]
    v_exp_f32 v42, v42
    v_mfma_f32_16x16x32_bf16 v[12:15], a[148:151], v[148:151], v[12:15]
    ds_read_b128 a[128:131], v192 offset:57344
    v_cvt_pk_bf16_f32 v84, v40, v41
    v_mfma_f32_16x16x32_bf16 v[12:15], a[152:155], v[152:155], v[12:15]
    v_exp_f32 v43, v43
    v_mfma_f32_16x16x32_bf16 v[12:15], a[156:159], v[156:159], v[12:15]
    ds_read_b128 a[132:135], v193 offset:57344
    ds_read_b128 a[136:139], v194 offset:57344
    v_mfma_f32_16x16x32_bf16 v[20:23], a[144:147], v[160:163], v[104:107]
    v_exp_f32 v44, v44
    v_mfma_f32_16x16x32_bf16 v[20:23], a[148:151], v[164:167], v[20:23]
    ds_read_b128 a[140:143], v195 offset:57344
    v_cvt_pk_bf16_f32 v85, v42, v43
    v_mfma_f32_16x16x32_bf16 v[20:23], a[152:155], v[168:171], v[20:23]
    v_exp_f32 v45, v45
    v_mfma_f32_16x16x32_bf16 v[20:23], a[156:159], v[172:175], v[20:23]
    v_mfma_f32_16x16x32_bf16 v[28:31], a[144:147], v[176:179], v[108:111]
    v_exp_f32 v46, v46
    v_mfma_f32_16x16x32_bf16 v[28:31], a[148:151], v[180:183], v[28:31]
    v_cvt_pk_bf16_f32 v86, v44, v45
    v_mfma_f32_16x16x32_bf16 v[28:31], a[152:155], v[184:187], v[28:31]
    v_exp_f32 v47, v47
    v_mfma_f32_16x16x32_bf16 v[28:31], a[156:159], v[188:191], v[28:31]
    s_waitcnt lgkmcnt(4)
    v_mfma_f32_16x16x32_bf16 a[0:3], a[160:163], v[64:67], a[0:3]
    v_exp_f32 v48, v48
    v_mfma_f32_16x16x32_bf16 a[16:19], a[164:167], v[64:67], a[16:19]
    ds_read_b128 a[144:147], v192 offset:61440
    v_cvt_pk_bf16_f32 v87, v46, v47
    v_mfma_f32_16x16x32_bf16 a[4:7], a[160:163], v[68:71], a[4:7]
    v_exp_f32 v49, v49
    v_mfma_f32_16x16x32_bf16 a[20:23], a[164:167], v[68:71], a[20:23]
    ds_read_b128 a[148:151], v193 offset:61440
    ds_read_b128 a[152:155], v194 offset:61440
    v_mfma_f32_16x16x32_bf16 a[8:11], a[160:163], v[72:75], a[8:11]
    v_exp_f32 v50, v50
    v_mfma_f32_16x16x32_bf16 a[24:27], a[164:167], v[72:75], a[24:27]
    ds_read_b128 a[156:159], v195 offset:61440
    v_cvt_pk_bf16_f32 v88, v48, v49
    v_mfma_f32_16x16x32_bf16 a[12:15], a[160:163], v[76:79], a[12:15]
    v_exp_f32 v51, v51
    v_mfma_f32_16x16x32_bf16 a[28:31], a[164:167], v[76:79], a[28:31]
    v_mfma_f32_16x16x32_bf16 a[192:195], a[208:211], v[64:67], a[192:195]
    v_exp_f32 v52, v52
    v_mfma_f32_16x16x32_bf16 a[32:35], a[168:171], v[64:67], a[32:35]
    v_cvt_pk_bf16_f32 v89, v50, v51
    v_mfma_f32_16x16x32_bf16 a[48:51], a[172:175], v[64:67], a[48:51]
    v_exp_f32 v53, v53
    v_mfma_f32_16x16x32_bf16 a[36:39], a[168:171], v[68:71], a[36:39]
    v_mfma_f32_16x16x32_bf16 a[52:55], a[172:175], v[68:71], a[52:55]
    v_exp_f32 v54, v54
    v_mfma_f32_16x16x32_bf16 a[40:43], a[168:171], v[72:75], a[40:43]
    v_cvt_pk_bf16_f32 v90, v52, v53
    v_mfma_f32_16x16x32_bf16 a[56:59], a[172:175], v[72:75], a[56:59]
    v_exp_f32 v55, v55
    v_mfma_f32_16x16x32_bf16 a[44:47], a[168:171], v[76:79], a[44:47]
    v_mfma_f32_16x16x32_bf16 a[60:63], a[172:175], v[76:79], a[60:63]
    v_exp_f32 v56, v56
    v_mfma_f32_16x16x32_bf16 a[196:199], a[208:211], v[68:71], a[196:199]
    v_cvt_pk_bf16_f32 v91, v54, v55
    v_mfma_f32_16x16x32_bf16 a[64:67], a[176:179], v[64:67], a[64:67]
    v_exp_f32 v57, v57
    v_mfma_f32_16x16x32_bf16 a[80:83], a[180:183], v[64:67], a[80:83]
    v_mfma_f32_16x16x32_bf16 a[68:71], a[176:179], v[68:71], a[68:71]
    v_exp_f32 v58, v58
    v_mfma_f32_16x16x32_bf16 a[84:87], a[180:183], v[68:71], a[84:87]
    v_cvt_pk_bf16_f32 v92, v56, v57
    v_mfma_f32_16x16x32_bf16 a[72:75], a[176:179], v[72:75], a[72:75]
    v_exp_f32 v59, v59
    v_mfma_f32_16x16x32_bf16 a[88:91], a[180:183], v[72:75], a[88:91]
    v_mfma_f32_16x16x32_bf16 a[76:79], a[176:179], v[76:79], a[76:79]
    v_exp_f32 v60, v60
    v_mfma_f32_16x16x32_bf16 a[92:95], a[180:183], v[76:79], a[92:95]
    v_cvt_pk_bf16_f32 v93, v58, v59
    v_mfma_f32_16x16x32_bf16 a[200:203], a[208:211], v[72:75], a[200:203]
    v_exp_f32 v61, v61
    v_mfma_f32_16x16x32_bf16 a[96:99], a[184:187], v[64:67], a[96:99]
    v_mfma_f32_16x16x32_bf16 a[112:115], a[188:191], v[64:67], a[112:115]
    v_exp_f32 v62, v62
    v_mfma_f32_16x16x32_bf16 a[100:103], a[184:187], v[68:71], a[100:103]
    v_cvt_pk_bf16_f32 v94, v60, v61
    v_mfma_f32_16x16x32_bf16 a[116:119], a[188:191], v[68:71], a[116:119]
    v_exp_f32 v63, v63
    v_mfma_f32_16x16x32_bf16 a[104:107], a[184:187], v[72:75], a[104:107]
    v_mfma_f32_16x16x32_bf16 a[120:123], a[188:191], v[72:75], a[120:123]
    v_mfma_f32_16x16x32_bf16 a[108:111], a[184:187], v[76:79], a[108:111]
    v_cvt_pk_bf16_f32 v95, v62, v63
    v_mfma_f32_16x16x32_bf16 a[124:127], a[188:191], v[76:79], a[124:127]
    v_mfma_f32_16x16x32_bf16 a[204:207], a[208:211], v[76:79], a[204:207]
    s_waitcnt lgkmcnt(0)
    s_barrier
L1_pos6a:
    v_mfma_f32_16x16x32_bf16 v[32:35], a[128:131], v[128:131], v[96:99]
    v_exp_f32 v0, v0
    v_mfma_f32_16x16x32_bf16 v[32:35], a[132:135], v[132:135], v[32:35]
    ds_read_b64_tr_b16 a[160:161], v196 offset:40960
    ds_read_b64_tr_b16 a[162:163], v196 offset:45056
    v_mfma_f32_16x16x32_bf16 v[32:35], a[136:139], v[136:139], v[32:35]
    v_exp_f32 v1, v1
    v_mfma_f32_16x16x32_bf16 v[32:35], a[140:143], v[140:143], v[32:35]
    ds_read_b64_tr_b16 a[164:165], v197 offset:40960
    ds_read_b64_tr_b16 a[166:167], v197 offset:45056
    v_mfma_f32_16x16x32_bf16 v[40:43], a[128:131], v[144:147], v[100:103]
    v_exp_f32 v2, v2
    v_mfma_f32_16x16x32_bf16 v[40:43], a[132:135], v[148:151], v[40:43]
    ds_read_b64_tr_b16 a[168:169], v198 offset:40960
    v_cvt_pk_bf16_f32 v64, v0, v1
    v_mfma_f32_16x16x32_bf16 v[40:43], a[136:139], v[152:155], v[40:43]
    v_exp_f32 v3, v3
    v_mfma_f32_16x16x32_bf16 v[40:43], a[140:143], v[156:159], v[40:43]
    ds_read_b64_tr_b16 a[170:171], v198 offset:45056
    ds_read_b64_tr_b16 a[172:173], v199 offset:40960
    v_mfma_f32_16x16x32_bf16 v[48:51], a[128:131], v[160:163], v[104:107]
    v_exp_f32 v4, v4
    v_mfma_f32_16x16x32_bf16 v[48:51], a[132:135], v[164:167], v[48:51]
    ds_read_b64_tr_b16 a[174:175], v199 offset:45056
    v_cvt_pk_bf16_f32 v65, v2, v3
    v_mfma_f32_16x16x32_bf16 v[48:51], a[136:139], v[168:171], v[48:51]
    v_exp_f32 v5, v5
    v_mfma_f32_16x16x32_bf16 v[48:51], a[140:143], v[172:175], v[48:51]
    ds_read_b64_tr_b16 a[176:177], v200 offset:40960
    ds_read_b64_tr_b16 a[178:179], v200 offset:45056
    v_mfma_f32_16x16x32_bf16 v[56:59], a[128:131], v[176:179], v[108:111]
    v_exp_f32 v6, v6
    v_mfma_f32_16x16x32_bf16 v[56:59], a[132:135], v[180:183], v[56:59]
    ds_read_b64_tr_b16 a[180:181], v201 offset:40960
    v_cvt_pk_bf16_f32 v66, v4, v5
    v_mfma_f32_16x16x32_bf16 v[56:59], a[136:139], v[184:187], v[56:59]
    v_exp_f32 v7, v7
    v_mfma_f32_16x16x32_bf16 v[56:59], a[140:143], v[188:191], v[56:59]
    ds_read_b64_tr_b16 a[182:183], v201 offset:45056
    ds_read_b64_tr_b16 a[184:185], v202 offset:40960
    v_mfma_f32_16x16x32_bf16 v[36:39], a[144:147], v[128:131], v[96:99]
    v_exp_f32 v8, v8
    v_mfma_f32_16x16x32_bf16 v[36:39], a[148:151], v[132:135], v[36:39]
    ds_read_b64_tr_b16 a[186:187], v202 offset:45056
    v_cvt_pk_bf16_f32 v67, v6, v7
    v_mfma_f32_16x16x32_bf16 v[36:39], a[152:155], v[136:139], v[36:39]
    v_exp_f32 v9, v9
    v_mfma_f32_16x16x32_bf16 v[36:39], a[156:159], v[140:143], v[36:39]
    ds_read_b64_tr_b16 a[188:189], v203 offset:40960
    ds_read_b64_tr_b16 a[190:191], v203 offset:45056
    v_mfma_f32_16x16x32_bf16 v[44:47], a[144:147], v[144:147], v[100:103]
    v_exp_f32 v10, v10
    v_mfma_f32_16x16x32_bf16 v[44:47], a[148:151], v[148:151], v[44:47]
    ds_read_b128 a[128:131], v192 offset:0
    v_cvt_pk_bf16_f32 v68, v8, v9
    v_mfma_f32_16x16x32_bf16 v[44:47], a[152:155], v[152:155], v[44:47]
    v_exp_f32 v11, v11
    v_mfma_f32_16x16x32_bf16 v[44:47], a[156:159], v[156:159], v[44:47]
    ds_read_b128 a[132:135], v193 offset:0
    ds_read_b128 a[136:139], v194 offset:0
    v_mfma_f32_16x16x32_bf16 v[52:55], a[144:147], v[160:163], v[104:107]
    v_exp_f32 v12, v12
    v_mfma_f32_16x16x32_bf16 v[52:55], a[148:151], v[164:167], v[52:55]
    ds_read_b128 a[140:143], v195 offset:0
    v_cvt_pk_bf16_f32 v69, v10, v11
    v_mfma_f32_16x16x32_bf16 v[52:55], a[152:155], v[168:171], v[52:55]
    v_exp_f32 v13, v13
    v_mfma_f32_16x16x32_bf16 v[52:55], a[156:159], v[172:175], v[52:55]
    v_mfma_f32_16x16x32_bf16 v[60:63], a[144:147], v[176:179], v[108:111]
    v_exp_f32 v14, v14
    v_mfma_f32_16x16x32_bf16 v[60:63], a[148:151], v[180:183], v[60:63]
    v_cvt_pk_bf16_f32 v70, v12, v13
    v_mfma_f32_16x16x32_bf16 v[60:63], a[152:155], v[184:187], v[60:63]
    v_exp_f32 v15, v15
    v_mfma_f32_16x16x32_bf16 v[60:63], a[156:159], v[188:191], v[60:63]
    s_waitcnt lgkmcnt(4)
    v_mfma_f32_16x16x32_bf16 a[0:3], a[160:163], v[80:83], a[0:3]
    v_exp_f32 v16, v16
    v_mfma_f32_16x16x32_bf16 a[16:19], a[164:167], v[80:83], a[16:19]
    ds_read_b128 a[144:147], v192 offset:4096
    v_cvt_pk_bf16_f32 v71, v14, v15
    v_mfma_f32_16x16x32_bf16 a[4:7], a[160:163], v[84:87], a[4:7]
    v_exp_f32 v17, v17
    v_mfma_f32_16x16x32_bf16 a[20:23], a[164:167], v[84:87], a[20:23]
    ds_read_b128 a[148:151], v193 offset:4096
    ds_read_b128 a[152:155], v194 offset:4096
    v_mfma_f32_16x16x32_bf16 a[8:11], a[160:163], v[88:91], a[8:11]
    v_exp_f32 v18, v18
    v_mfma_f32_16x16x32_bf16 a[24:27], a[164:167], v[88:91], a[24:27]
    ds_read_b128 a[156:159], v195 offset:4096
    v_cvt_pk_bf16_f32 v72, v16, v17
    v_mfma_f32_16x16x32_bf16 a[12:15], a[160:163], v[92:95], a[12:15]
    v_exp_f32 v19, v19
    v_mfma_f32_16x16x32_bf16 a[28:31], a[164:167], v[92:95], a[28:31]
    v_mfma_f32_16x16x32_bf16 a[192:195], a[208:211], v[80:83], a[192:195]
    v_exp_f32 v20, v20
    v_mfma_f32_16x16x32_bf16 a[32:35], a[168:171], v[80:83], a[32:35]
    v_cvt_pk_bf16_f32 v73, v18, v19
    v_mfma_f32_16x16x32_bf16 a[48:51], a[172:175], v[80:83], a[48:51]
    v_exp_f32 v21, v21
    v_mfma_f32_16x16x32_bf16 a[36:39], a[168:171], v[84:87], a[36:39]
    v_mfma_f32_16x16x32_bf16 a[52:55], a[172:175], v[84:87], a[52:55]
    v_exp_f32 v22, v22
    v_mfma_f32_16x16x32_bf16 a[40:43], a[168:171], v[88:91], a[40:43]
    v_cvt_pk_bf16_f32 v74, v20, v21
    v_mfma_f32_16x16x32_bf16 a[56:59], a[172:175], v[88:91], a[56:59]
    v_exp_f32 v23, v23
    v_mfma_f32_16x16x32_bf16 a[44:47], a[168:171], v[92:95], a[44:47]
    v_mfma_f32_16x16x32_bf16 a[60:63], a[172:175], v[92:95], a[60:63]
    v_exp_f32 v24, v24
    v_mfma_f32_16x16x32_bf16 a[196:199], a[208:211], v[84:87], a[196:199]
    v_cvt_pk_bf16_f32 v75, v22, v23
    v_mfma_f32_16x16x32_bf16 a[64:67], a[176:179], v[80:83], a[64:67]
    v_exp_f32 v25, v25
    v_mfma_f32_16x16x32_bf16 a[80:83], a[180:183], v[80:83], a[80:83]
    v_mfma_f32_16x16x32_bf16 a[68:71], a[176:179], v[84:87], a[68:71]
    v_exp_f32 v26, v26
    v_mfma_f32_16x16x32_bf16 a[84:87], a[180:183], v[84:87], a[84:87]
    v_cvt_pk_bf16_f32 v76, v24, v25
    v_mfma_f32_16x16x32_bf16 a[72:75], a[176:179], v[88:91], a[72:75]
    v_exp_f32 v27, v27
    v_mfma_f32_16x16x32_bf16 a[88:91], a[180:183], v[88:91], a[88:91]
    v_mfma_f32_16x16x32_bf16 a[76:79], a[176:179], v[92:95], a[76:79]
    v_exp_f32 v28, v28
    v_mfma_f32_16x16x32_bf16 a[92:95], a[180:183], v[92:95], a[92:95]
    v_cvt_pk_bf16_f32 v77, v26, v27
    v_mfma_f32_16x16x32_bf16 a[200:203], a[208:211], v[88:91], a[200:203]
    v_exp_f32 v29, v29
    v_mfma_f32_16x16x32_bf16 a[96:99], a[184:187], v[80:83], a[96:99]
    v_mfma_f32_16x16x32_bf16 a[112:115], a[188:191], v[80:83], a[112:115]
    v_exp_f32 v30, v30
    v_mfma_f32_16x16x32_bf16 a[100:103], a[184:187], v[84:87], a[100:103]
    v_cvt_pk_bf16_f32 v78, v28, v29
    v_mfma_f32_16x16x32_bf16 a[116:119], a[188:191], v[84:87], a[116:119]
    v_exp_f32 v31, v31
    v_mfma_f32_16x16x32_bf16 a[104:107], a[184:187], v[88:91], a[104:107]
    v_mfma_f32_16x16x32_bf16 a[120:123], a[188:191], v[88:91], a[120:123]
    v_mfma_f32_16x16x32_bf16 a[108:111], a[184:187], v[92:95], a[108:111]
    v_cvt_pk_bf16_f32 v79, v30, v31
    v_mfma_f32_16x16x32_bf16 a[124:127], a[188:191], v[92:95], a[124:127]
    v_mfma_f32_16x16x32_bf16 a[204:207], a[208:211], v[92:95], a[204:207]
    s_waitcnt lgkmcnt(0)
    s_cmp_eq_u32 s30, 7
    s_barrier
    s_cbranch_scc1 L1_taila
L1_pos7a:
    v_mfma_f32_16x16x32_bf16 v[0:3], a[128:131], v[128:131], v[96:99]
    v_exp_f32 v32, v32
    v_mfma_f32_16x16x32_bf16 v[0:3], a[132:135], v[132:135], v[0:3]
    ds_read_b64_tr_b16 a[160:161], v196 offset:49152
    ds_read_b64_tr_b16 a[162:163], v196 offset:53248
    v_mfma_f32_16x16x32_bf16 v[0:3], a[136:139], v[136:139], v[0:3]
    v_exp_f32 v33, v33
    v_mfma_f32_16x16x32_bf16 v[0:3], a[140:143], v[140:143], v[0:3]
    ds_read_b64_tr_b16 a[164:165], v197 offset:49152
    ds_read_b64_tr_b16 a[166:167], v197 offset:53248
    v_mfma_f32_16x16x32_bf16 v[8:11], a[128:131], v[144:147], v[100:103]
    v_exp_f32 v34, v34
    v_mfma_f32_16x16x32_bf16 v[8:11], a[132:135], v[148:151], v[8:11]
    ds_read_b64_tr_b16 a[168:169], v198 offset:49152
    v_cvt_pk_bf16_f32 v80, v32, v33
    v_mfma_f32_16x16x32_bf16 v[8:11], a[136:139], v[152:155], v[8:11]
    v_exp_f32 v35, v35
    v_mfma_f32_16x16x32_bf16 v[8:11], a[140:143], v[156:159], v[8:11]
    ds_read_b64_tr_b16 a[170:171], v198 offset:53248
    ds_read_b64_tr_b16 a[172:173], v199 offset:49152
    v_mfma_f32_16x16x32_bf16 v[16:19], a[128:131], v[160:163], v[104:107]
    v_exp_f32 v36, v36
    v_mfma_f32_16x16x32_bf16 v[16:19], a[132:135], v[164:167], v[16:19]
    ds_read_b64_tr_b16 a[174:175], v199 offset:53248
    v_cvt_pk_bf16_f32 v81, v34, v35
    v_mfma_f32_16x16x32_bf16 v[16:19], a[136:139], v[168:171], v[16:19]
    v_exp_f32 v37, v37
    v_mfma_f32_16x16x32_bf16 v[16:19], a[140:143], v[172:175], v[16:19]
    ds_read_b64_tr_b16 a[176:177], v200 offset:49152
    ds_read_b64_tr_b16 a[178:179], v200 offset:53248
    v_mfma_f32_16x16x32_bf16 v[24:27], a[128:131], v[176:179], v[108:111]
    v_exp_f32 v38, v38
    v_mfma_f32_16x16x32_bf16 v[24:27], a[132:135], v[180:183], v[24:27]
    ds_read_b64_tr_b16 a[180:181], v201 offset:49152
    v_cvt_pk_bf16_f32 v82, v36, v37
    v_mfma_f32_16x16x32_bf16 v[24:27], a[136:139], v[184:187], v[24:27]
    v_exp_f32 v39, v39
    v_mfma_f32_16x16x32_bf16 v[24:27], a[140:143], v[188:191], v[24:27]
    ds_read_b64_tr_b16 a[182:183], v201 offset:53248
    ds_read_b64_tr_b16 a[184:185], v202 offset:49152
    v_mfma_f32_16x16x32_bf16 v[4:7], a[144:147], v[128:131], v[96:99]
    v_exp_f32 v40, v40
    v_mfma_f32_16x16x32_bf16 v[4:7], a[148:151], v[132:135], v[4:7]
    ds_read_b64_tr_b16 a[186:187], v202 offset:53248
    v_cvt_pk_bf16_f32 v83, v38, v39
    v_mfma_f32_16x16x32_bf16 v[4:7], a[152:155], v[136:139], v[4:7]
    v_exp_f32 v41, v41
    v_mfma_f32_16x16x32_bf16 v[4:7], a[156:159], v[140:143], v[4:7]
    ds_read_b64_tr_b16 a[188:189], v203 offset:49152
    ds_read_b64_tr_b16 a[190:191], v203 offset:53248
    v_mfma_f32_16x16x32_bf16 v[12:15], a[144:147], v[144:147], v[100:103]
    v_exp_f32 v42, v42
    v_mfma_f32_16x16x32_bf16 v[12:15], a[148:151], v[148:151], v[12:15]
    ds_read_b128 a[128:131], v192 offset:8192
    v_cvt_pk_bf16_f32 v84, v40, v41
    v_mfma_f32_16x16x32_bf16 v[12:15], a[152:155], v[152:155], v[12:15]
    v_exp_f32 v43, v43
    v_mfma_f32_16x16x32_bf16 v[12:15], a[156:159], v[156:159], v[12:15]
    ds_read_b128 a[132:135], v193 offset:8192
    ds_read_b128 a[136:139], v194 offset:8192
    v_mfma_f32_16x16x32_bf16 v[20:23], a[144:147], v[160:163], v[104:107]
    v_exp_f32 v44, v44
    v_mfma_f32_16x16x32_bf16 v[20:23], a[148:151], v[164:167], v[20:23]
    ds_read_b128 a[140:143], v195 offset:8192
    v_cvt_pk_bf16_f32 v85, v42, v43
    v_mfma_f32_16x16x32_bf16 v[20:23], a[152:155], v[168:171], v[20:23]
    v_exp_f32 v45, v45
    v_mfma_f32_16x16x32_bf16 v[20:23], a[156:159], v[172:175], v[20:23]
    v_mfma_f32_16x16x32_bf16 v[28:31], a[144:147], v[176:179], v[108:111]
    v_exp_f32 v46, v46
    v_mfma_f32_16x16x32_bf16 v[28:31], a[148:151], v[180:183], v[28:31]
    v_cvt_pk_bf16_f32 v86, v44, v45
    v_mfma_f32_16x16x32_bf16 v[28:31], a[152:155], v[184:187], v[28:31]
    v_exp_f32 v47, v47
    v_mfma_f32_16x16x32_bf16 v[28:31], a[156:159], v[188:191], v[28:31]
    s_waitcnt lgkmcnt(4)
    v_mfma_f32_16x16x32_bf16 a[0:3], a[160:163], v[64:67], a[0:3]
    v_exp_f32 v48, v48
    v_mfma_f32_16x16x32_bf16 a[16:19], a[164:167], v[64:67], a[16:19]
    ds_read_b128 a[144:147], v192 offset:12288
    v_cvt_pk_bf16_f32 v87, v46, v47
    v_mfma_f32_16x16x32_bf16 a[4:7], a[160:163], v[68:71], a[4:7]
    v_exp_f32 v49, v49
    v_mfma_f32_16x16x32_bf16 a[20:23], a[164:167], v[68:71], a[20:23]
    ds_read_b128 a[148:151], v193 offset:12288
    ds_read_b128 a[152:155], v194 offset:12288
    v_mfma_f32_16x16x32_bf16 a[8:11], a[160:163], v[72:75], a[8:11]
    v_exp_f32 v50, v50
    v_mfma_f32_16x16x32_bf16 a[24:27], a[164:167], v[72:75], a[24:27]
    ds_read_b128 a[156:159], v195 offset:12288
    v_cvt_pk_bf16_f32 v88, v48, v49
    v_mfma_f32_16x16x32_bf16 a[12:15], a[160:163], v[76:79], a[12:15]
    v_exp_f32 v51, v51
    v_mfma_f32_16x16x32_bf16 a[28:31], a[164:167], v[76:79], a[28:31]
    v_mfma_f32_16x16x32_bf16 a[192:195], a[208:211], v[64:67], a[192:195]
    v_exp_f32 v52, v52
    v_mfma_f32_16x16x32_bf16 a[32:35], a[168:171], v[64:67], a[32:35]
    v_cvt_pk_bf16_f32 v89, v50, v51
    v_mfma_f32_16x16x32_bf16 a[48:51], a[172:175], v[64:67], a[48:51]
    v_exp_f32 v53, v53
    v_mfma_f32_16x16x32_bf16 a[36:39], a[168:171], v[68:71], a[36:39]
    v_mfma_f32_16x16x32_bf16 a[52:55], a[172:175], v[68:71], a[52:55]
    v_exp_f32 v54, v54
    v_mfma_f32_16x16x32_bf16 a[40:43], a[168:171], v[72:75], a[40:43]
    v_cvt_pk_bf16_f32 v90, v52, v53
    v_mfma_f32_16x16x32_bf16 a[56:59], a[172:175], v[72:75], a[56:59]
    v_exp_f32 v55, v55
    v_mfma_f32_16x16x32_bf16 a[44:47], a[168:171], v[76:79], a[44:47]
    v_mfma_f32_16x16x32_bf16 a[60:63], a[172:175], v[76:79], a[60:63]
    v_exp_f32 v56, v56
    v_mfma_f32_16x16x32_bf16 a[196:199], a[208:211], v[68:71], a[196:199]
    v_cvt_pk_bf16_f32 v91, v54, v55
    v_mfma_f32_16x16x32_bf16 a[64:67], a[176:179], v[64:67], a[64:67]
    v_exp_f32 v57, v57
    v_mfma_f32_16x16x32_bf16 a[80:83], a[180:183], v[64:67], a[80:83]
    v_mfma_f32_16x16x32_bf16 a[68:71], a[176:179], v[68:71], a[68:71]
    v_exp_f32 v58, v58
    v_mfma_f32_16x16x32_bf16 a[84:87], a[180:183], v[68:71], a[84:87]
    v_cvt_pk_bf16_f32 v92, v56, v57
    v_mfma_f32_16x16x32_bf16 a[72:75], a[176:179], v[72:75], a[72:75]
    v_exp_f32 v59, v59
    v_mfma_f32_16x16x32_bf16 a[88:91], a[180:183], v[72:75], a[88:91]
    v_mfma_f32_16x16x32_bf16 a[76:79], a[176:179], v[76:79], a[76:79]
    v_exp_f32 v60, v60
    v_mfma_f32_16x16x32_bf16 a[92:95], a[180:183], v[76:79], a[92:95]
    v_cvt_pk_bf16_f32 v93, v58, v59
    v_mfma_f32_16x16x32_bf16 a[200:203], a[208:211], v[72:75], a[200:203]
    v_exp_f32 v61, v61
    v_mfma_f32_16x16x32_bf16 a[96:99], a[184:187], v[64:67], a[96:99]
    v_mfma_f32_16x16x32_bf16 a[112:115], a[188:191], v[64:67], a[112:115]
    v_exp_f32 v62, v62
    v_mfma_f32_16x16x32_bf16 a[100:103], a[184:187], v[68:71], a[100:103]
    v_cvt_pk_bf16_f32 v94, v60, v61
    v_mfma_f32_16x16x32_bf16 a[116:119], a[188:191], v[68:71], a[116:119]
    v_exp_f32 v63, v63
    v_mfma_f32_16x16x32_bf16 a[104:107], a[184:187], v[72:75], a[104:107]
    v_mfma_f32_16x16x32_bf16 a[120:123], a[188:191], v[72:75], a[120:123]
    v_mfma_f32_16x16x32_bf16 a[108:111], a[184:187], v[76:79], a[108:111]
    v_cvt_pk_bf16_f32 v95, v62, v63
    v_mfma_f32_16x16x32_bf16 a[124:127], a[188:191], v[76:79], a[124:127]
    v_mfma_f32_16x16x32_bf16 a[204:207], a[208:211], v[76:79], a[204:207]
    s_waitcnt lgkmcnt(0)
    s_add_u32 s30, s30, 1
    s_barrier
    s_branch L1_pos0a
L1_taila:
    ds_read_b64_tr_b16 a[160:161], v196 offset:49152
    ds_read_b64_tr_b16 a[162:163], v196 offset:53248
    ds_read_b64_tr_b16 a[164:165], v197 offset:49152
    ds_read_b64_tr_b16 a[166:167], v197 offset:53248
    ds_read_b64_tr_b16 a[168:169], v198 offset:49152
    ds_read_b64_tr_b16 a[170:171], v198 offset:53248
    ds_read_b64_tr_b16 a[172:173], v199 offset:49152
    ds_read_b64_tr_b16 a[174:175], v199 offset:53248
    ds_read_b64_tr_b16 a[176:177], v200 offset:49152
    ds_read_b64_tr_b16 a[178:179], v200 offset:53248
    ds_read_b64_tr_b16 a[180:181], v201 offset:49152
    ds_read_b64_tr_b16 a[182:183], v201 offset:53248
    ds_read_b64_tr_b16 a[184:185], v202 offset:49152
    ds_read_b64_tr_b16 a[186:187], v202 offset:53248
    ds_read_b64_tr_b16 a[188:189], v203 offset:49152
    ds_read_b64_tr_b16 a[190:191], v203 offset:53248
    v_exp_f32 v32, v32
    v_exp_f32 v33, v33
    s_nop 0
    v_cvt_pk_bf16_f32 v80, v32, v33
    v_exp_f32 v34, v34
    v_exp_f32 v35, v35
    s_nop 0
    v_cvt_pk_bf16_f32 v81, v34, v35
    s_waitcnt lgkmcnt(0)
    v_mfma_f32_16x16x32_bf16 a[0:3], a[160:163], v[64:67], a[0:3]
    v_exp_f32 v36, v36
    s_barrier
    v_mfma_f32_16x16x32_bf16 a[16:19], a[164:167], v[64:67], a[16:19]
    v_exp_f32 v37, v37
    v_mfma_f32_16x16x32_bf16 a[4:7], a[160:163], v[68:71], a[4:7]
    v_cvt_pk_bf16_f32 v82, v36, v37
    v_mfma_f32_16x16x32_bf16 a[20:23], a[164:167], v[68:71], a[20:23]
    v_exp_f32 v38, v38
    v_mfma_f32_16x16x32_bf16 a[8:11], a[160:163], v[72:75], a[8:11]
    v_exp_f32 v39, v39
    v_mfma_f32_16x16x32_bf16 a[24:27], a[164:167], v[72:75], a[24:27]
    v_cvt_pk_bf16_f32 v83, v38, v39
    v_mfma_f32_16x16x32_bf16 a[12:15], a[160:163], v[76:79], a[12:15]
    v_exp_f32 v40, v40
    v_mfma_f32_16x16x32_bf16 a[28:31], a[164:167], v[76:79], a[28:31]
    ds_read_b64_tr_b16 a[160:161], v196 offset:57344
    ds_read_b64_tr_b16 a[162:163], v196 offset:61440
    v_mfma_f32_16x16x32_bf16 a[192:195], a[208:211], v[64:67], a[192:195]
    v_exp_f32 v41, v41
    v_mfma_f32_16x16x32_bf16 a[32:35], a[168:171], v[64:67], a[32:35]
    ds_read_b64_tr_b16 a[164:165], v197 offset:57344
    ds_read_b64_tr_b16 a[166:167], v197 offset:61440
    v_cvt_pk_bf16_f32 v84, v40, v41
    v_mfma_f32_16x16x32_bf16 a[48:51], a[172:175], v[64:67], a[48:51]
    v_exp_f32 v42, v42
    v_mfma_f32_16x16x32_bf16 a[36:39], a[168:171], v[68:71], a[36:39]
    v_exp_f32 v43, v43
    v_mfma_f32_16x16x32_bf16 a[52:55], a[172:175], v[68:71], a[52:55]
    v_cvt_pk_bf16_f32 v85, v42, v43
    v_mfma_f32_16x16x32_bf16 a[40:43], a[168:171], v[72:75], a[40:43]
    v_exp_f32 v44, v44
    v_mfma_f32_16x16x32_bf16 a[56:59], a[172:175], v[72:75], a[56:59]
    v_exp_f32 v45, v45
    v_mfma_f32_16x16x32_bf16 a[44:47], a[168:171], v[76:79], a[44:47]
    v_cvt_pk_bf16_f32 v86, v44, v45
    v_mfma_f32_16x16x32_bf16 a[60:63], a[172:175], v[76:79], a[60:63]
    v_exp_f32 v46, v46
    v_mfma_f32_16x16x32_bf16 a[196:199], a[208:211], v[68:71], a[196:199]
    ds_read_b64_tr_b16 a[168:169], v198 offset:57344
    ds_read_b64_tr_b16 a[170:171], v198 offset:61440
    ds_read_b64_tr_b16 a[172:173], v199 offset:57344
    v_mfma_f32_16x16x32_bf16 a[64:67], a[176:179], v[64:67], a[64:67]
    v_exp_f32 v47, v47
    v_mfma_f32_16x16x32_bf16 a[80:83], a[180:183], v[64:67], a[80:83]
    ds_read_b64_tr_b16 a[174:175], v199 offset:61440
    v_cvt_pk_bf16_f32 v87, v46, v47
    v_mfma_f32_16x16x32_bf16 a[68:71], a[176:179], v[68:71], a[68:71]
    v_exp_f32 v48, v48
    v_mfma_f32_16x16x32_bf16 a[84:87], a[180:183], v[68:71], a[84:87]
    v_exp_f32 v49, v49
    v_mfma_f32_16x16x32_bf16 a[72:75], a[176:179], v[72:75], a[72:75]
    v_cvt_pk_bf16_f32 v88, v48, v49
    v_mfma_f32_16x16x32_bf16 a[88:91], a[180:183], v[72:75], a[88:91]
    v_exp_f32 v50, v50
    v_mfma_f32_16x16x32_bf16 a[76:79], a[176:179], v[76:79], a[76:79]
    v_exp_f32 v51, v51
    v_mfma_f32_16x16x32_bf16 a[92:95], a[180:183], v[76:79], a[92:95]
    ds_read_b64_tr_b16 a[176:177], v200 offset:57344
    ds_read_b64_tr_b16 a[178:179], v200 offset:61440
    v_cvt_pk_bf16_f32 v89, v50, v51
    v_mfma_f32_16x16x32_bf16 a[200:203], a[208:211], v[72:75], a[200:203]
    v_exp_f32 v52, v52
    v_mfma_f32_16x16x32_bf16 a[96:99], a[184:187], v[64:67], a[96:99]
    v_exp_f32 v53, v53
    v_mfma_f32_16x16x32_bf16 a[112:115], a[188:191], v[64:67], a[112:115]
    ds_read_b64_tr_b16 a[180:181], v201 offset:57344
    ds_read_b64_tr_b16 a[182:183], v201 offset:61440
    v_cvt_pk_bf16_f32 v90, v52, v53
    v_mfma_f32_16x16x32_bf16 a[100:103], a[184:187], v[68:71], a[100:103]
    v_exp_f32 v54, v54
    v_mfma_f32_16x16x32_bf16 a[116:119], a[188:191], v[68:71], a[116:119]
    v_exp_f32 v55, v55
    v_mfma_f32_16x16x32_bf16 a[104:107], a[184:187], v[72:75], a[104:107]
    v_cvt_pk_bf16_f32 v91, v54, v55
    v_mfma_f32_16x16x32_bf16 a[120:123], a[188:191], v[72:75], a[120:123]
    v_exp_f32 v56, v56
    v_mfma_f32_16x16x32_bf16 a[108:111], a[184:187], v[76:79], a[108:111]
    v_exp_f32 v57, v57
    v_mfma_f32_16x16x32_bf16 a[124:127], a[188:191], v[76:79], a[124:127]
    ds_read_b64_tr_b16 a[184:185], v202 offset:57344
    ds_read_b64_tr_b16 a[186:187], v202 offset:61440
    v_cvt_pk_bf16_f32 v92, v56, v57
    v_mfma_f32_16x16x32_bf16 a[204:207], a[208:211], v[76:79], a[204:207]
    v_exp_f32 v58, v58
    s_nop 0
    v_exp_f32 v59, v59
    s_nop 0
    v_cvt_pk_bf16_f32 v93, v58, v59
    v_exp_f32 v60, v60
    v_exp_f32 v61, v61
    s_nop 0
    v_cvt_pk_bf16_f32 v94, v60, v61
    v_exp_f32 v62, v62
    v_exp_f32 v63, v63
    s_nop 0
    v_cvt_pk_bf16_f32 v95, v62, v63
    ds_read_b64_tr_b16 a[188:189], v203 offset:57344
    ds_read_b64_tr_b16 a[190:191], v203 offset:61440
    s_waitcnt lgkmcnt(0)
    s_barrier
    v_mfma_f32_16x16x32_bf16 a[192:195], a[208:211], v[80:83], a[192:195]
    s_mul_i32 s46, s32, 15
    v_mfma_f32_16x16x32_bf16 a[196:199], a[208:211], v[84:87], a[196:199]
    s_lshl_b32 s47, s3, 2
    v_lshlrev_b32 v230, 4, v221
    v_mfma_f32_16x16x32_bf16 a[200:203], a[208:211], v[88:91], a[200:203]
    s_add_u32 s46, s46, s47
    v_mfma_f32_16x16x32_bf16 a[204:207], a[208:211], v[92:95], a[204:207]
    s_lshl_b32 s46, s46, 17
    v_mfma_f32_16x16x32_bf16 a[0:3], a[160:163], v[80:83], a[0:3]
    s_lshl_b32 s47, s33, 12
    v_mfma_f32_16x16x32_bf16 a[4:7], a[160:163], v[84:87], a[4:7]
    s_add_u32 s46, s46, s47
    v_mfma_f32_16x16x32_bf16 a[8:11], a[160:163], v[88:91], a[8:11]
    s_mov_b32 s55, 0x53800000
    v_mfma_f32_16x16x32_bf16 a[12:15], a[160:163], v[92:95], a[12:15]
    v_mfma_f32_16x16x32_bf16 a[16:19], a[164:167], v[80:83], a[16:19]
    v_mfma_f32_16x16x32_bf16 a[20:23], a[164:167], v[84:87], a[20:23]
    v_mfma_f32_16x16x32_bf16 a[24:27], a[164:167], v[88:91], a[24:27]
    v_mfma_f32_16x16x32_bf16 a[28:31], a[164:167], v[92:95], a[28:31]
    v_mfma_f32_16x16x32_bf16 a[32:35], a[168:171], v[80:83], a[32:35]
    v_mfma_f32_16x16x32_bf16 a[36:39], a[168:171], v[84:87], a[36:39]
    v_accvgpr_read_b32 v222, a192
    v_accvgpr_read_b32 v223, a196
    v_mfma_f32_16x16x32_bf16 a[40:43], a[168:171], v[88:91], a[40:43]
    v_accvgpr_read_b32 v224, a200
    v_accvgpr_read_b32 v225, a204
    v_mfma_f32_16x16x32_bf16 a[44:47], a[168:171], v[92:95], a[44:47]
    v_mfma_f32_16x16x32_bf16 a[48:51], a[172:175], v[80:83], a[48:51]
    v_cmp_ngt_f32 s[48:49], s55, v222
    v_cmp_ngt_f32 s[50:51], s55, v223
    v_mfma_f32_16x16x32_bf16 a[52:55], a[172:175], v[84:87], a[52:55]
    v_cmp_ngt_f32 s[52:53], s55, v224
    v_cmp_ngt_f32 s[56:57], s55, v225
    v_mfma_f32_16x16x32_bf16 a[56:59], a[172:175], v[88:91], a[56:59]
    v_mfma_f32_16x16x32_bf16 a[60:63], a[172:175], v[92:95], a[60:63]
    v_rcp_f32 v226, v222
    v_mfma_f32_16x16x32_bf16 a[64:67], a[176:179], v[80:83], a[64:67]
    v_rcp_f32 v227, v223
    v_mfma_f32_16x16x32_bf16 a[68:71], a[176:179], v[84:87], a[68:71]
    v_rcp_f32 v228, v224
    v_mfma_f32_16x16x32_bf16 a[72:75], a[176:179], v[88:91], a[72:75]
    v_rcp_f32 v229, v225
    v_mfma_f32_16x16x32_bf16 a[76:79], a[176:179], v[92:95], a[76:79]
    v_mfma_f32_16x16x32_bf16 a[80:83], a[180:183], v[80:83], a[80:83]
    v_mfma_f32_16x16x32_bf16 a[84:87], a[180:183], v[84:87], a[84:87]
    v_mfma_f32_16x16x32_bf16 a[88:91], a[180:183], v[88:91], a[88:91]
    v_mfma_f32_16x16x32_bf16 a[92:95], a[180:183], v[92:95], a[92:95]
    v_mfma_f32_16x16x32_bf16 a[96:99], a[184:187], v[80:83], a[96:99]
    v_mfma_f32_16x16x32_bf16 a[100:103], a[184:187], v[84:87], a[100:103]
    v_mfma_f32_16x16x32_bf16 a[104:107], a[184:187], v[88:91], a[104:107]
    v_mfma_f32_16x16x32_bf16 a[108:111], a[184:187], v[92:95], a[108:111]
    v_mfma_f32_16x16x32_bf16 a[112:115], a[188:191], v[80:83], a[112:115]
    v_mfma_f32_16x16x32_bf16 a[116:119], a[188:191], v[84:87], a[116:119]
    v_mfma_f32_16x16x32_bf16 a[120:123], a[188:191], v[88:91], a[120:123]
    v_mfma_f32_16x16x32_bf16 a[124:127], a[188:191], v[92:95], a[124:127]
    s_or_b64 s[48:49], s[48:49], s[50:51]
    s_or_b64 s[48:49], s[48:49], s[52:53]
    s_or_b64 s[48:49], s[48:49], s[56:57]
    s_cmp_eq_u64 s[48:49], 0
    s_cbranch_scc0 L1_slowa
L1_norma:
    s_nop 3
    s_add_u32 s47, s46, 0
    v_accvgpr_read_b32 v0, a0
    v_accvgpr_read_b32 v1, a1
    v_accvgpr_read_b32 v2, a2
    v_accvgpr_read_b32 v3, a3
    v_accvgpr_read_b32 v4, a16
    v_accvgpr_read_b32 v5, a17
    v_accvgpr_read_b32 v6, a18
    v_accvgpr_read_b32 v7, a19
    v_pk_mul_f32 v[0:1], v[0:1], v[226:227] op_sel:[0,0] op_sel_hi:[1,0]
    v_pk_mul_f32 v[2:3], v[2:3], v[226:227] op_sel:[0,0] op_sel_hi:[1,0]
    v_pk_mul_f32 v[4:5], v[4:5], v[226:227] op_sel:[0,0] op_sel_hi:[1,0]
    v_pk_mul_f32 v[6:7], v[6:7], v[226:227] op_sel:[0,0] op_sel_hi:[1,0]
    v_cvt_pk_bf16_f32 v8, v0, v1
    v_cvt_pk_bf16_f32 v9, v2, v3
    v_cvt_pk_bf16_f32 v10, v4, v5
    v_cvt_pk_bf16_f32 v11, v6, v7
    buffer_store_dwordx4 v[8:11], v230, s[24:27], s47 offen offset:0 sc1
    v_accvgpr_read_b32 v12, a32
    v_accvgpr_read_b32 v13, a33
    v_accvgpr_read_b32 v14, a34
    v_accvgpr_read_b32 v15, a35
    v_accvgpr_read_b32 v16, a48
    v_accvgpr_read_b32 v17, a49
    v_accvgpr_read_b32 v18, a50
    v_accvgpr_read_b32 v19, a51
    v_pk_mul_f32 v[12:13], v[12:13], v[226:227] op_sel:[0,0] op_sel_hi:[1,0]
    v_pk_mul_f32 v[14:15], v[14:15], v[226:227] op_sel:[0,0] op_sel_hi:[1,0]
    v_pk_mul_f32 v[16:17], v[16:17], v[226:227] op_sel:[0,0] op_sel_hi:[1,0]
    v_pk_mul_f32 v[18:19], v[18:19], v[226:227] op_sel:[0,0] op_sel_hi:[1,0]
    v_cvt_pk_bf16_f32 v20, v12, v13
    v_cvt_pk_bf16_f32 v21, v14, v15
    v_cvt_pk_bf16_f32 v22, v16, v17
    v_cvt_pk_bf16_f32 v23, v18, v19
    buffer_store_dwordx4 v[20:23], v230, s[24:27], s47 offen offset:1024 sc1
    v_accvgpr_read_b32 v24, a64
    v_accvgpr_read_b32 v25, a65
    v_accvgpr_read_b32 v26, a66
    v_accvgpr_read_b32 v27, a67
    v_accvgpr_read_b32 v28, a80
    v_accvgpr_read_b32 v29, a81
    v_accvgpr_read_b32 v30, a82
    v_accvgpr_read_b32 v31, a83
    v_pk_mul_f32 v[24:25], v[24:25], v[226:227] op_sel:[0,0] op_sel_hi:[1,0]
    v_pk_mul_f32 v[26:27], v[26:27], v[226:227] op_sel:[0,0] op_sel_hi:[1,0]
    v_pk_mul_f32 v[28:29], v[28:29], v[226:227] op_sel:[0,0] op_sel_hi:[1,0]
    v_pk_mul_f32 v[30:31], v[30:31], v[226:227] op_sel:[0,0] op_sel_hi:[1,0]
    v_cvt_pk_bf16_f32 v32, v24, v25
    v_cvt_pk_bf16_f32 v33, v26, v27
    v_cvt_pk_bf16_f32 v34, v28, v29
    v_cvt_pk_bf16_f32 v35, v30, v31
    buffer_store_dwordx4 v[32:35], v230, s[24:27], s47 offen offset:2048 sc1
    v_accvgpr_read_b32 v36, a96
    v_accvgpr_read_b32 v37, a97
    v_accvgpr_read_b32 v38, a98
    v_accvgpr_read_b32 v39, a99
    v_accvgpr_read_b32 v40, a112
    v_accvgpr_read_b32 v41, a113
    v_accvgpr_read_b32 v42, a114
    v_accvgpr_read_b32 v43, a115
    v_pk_mul_f32 v[36:37], v[36:37], v[226:227] op_sel:[0,0] op_sel_hi:[1,0]
    v_pk_mul_f32 v[38:39], v[38:39], v[226:227] op_sel:[0,0] op_sel_hi:[1,0]
    v_pk_mul_f32 v[40:41], v[40:41], v[226:227] op_sel:[0,0] op_sel_hi:[1,0]
    v_pk_mul_f32 v[42:43], v[42:43], v[226:227] op_sel:[0,0] op_sel_hi:[1,0]
    v_cvt_pk_bf16_f32 v44, v36, v37
    v_cvt_pk_bf16_f32 v45, v38, v39
    v_cvt_pk_bf16_f32 v46, v40, v41
    v_cvt_pk_bf16_f32 v47, v42, v43
    buffer_store_dwordx4 v[44:47], v230, s[24:27], s47 offen offset:3072 sc1
    s_add_u32 s47, s46, 131072
    v_accvgpr_read_b32 v48, a4
    v_accvgpr_read_b32 v49, a5
    v_accvgpr_read_b32 v50, a6
    v_accvgpr_read_b32 v51, a7
    v_accvgpr_read_b32 v52, a20
    v_accvgpr_read_b32 v53, a21
    v_accvgpr_read_b32 v54, a22
    v_accvgpr_read_b32 v55, a23
    v_pk_mul_f32 v[48:49], v[48:49], v[226:227] op_sel:[0,1] op_sel_hi:[1,1]
    v_pk_mul_f32 v[50:51], v[50:51], v[226:227] op_sel:[0,1] op_sel_hi:[1,1]
    v_pk_mul_f32 v[52:53], v[52:53], v[226:227] op_sel:[0,1] op_sel_hi:[1,1]
    v_pk_mul_f32 v[54:55], v[54:55], v[226:227] op_sel:[0,1] op_sel_hi:[1,1]
    v_cvt_pk_bf16_f32 v56, v48, v49
    v_cvt_pk_bf16_f32 v57, v50, v51
    v_cvt_pk_bf16_f32 v58, v52, v53
    v_cvt_pk_bf16_f32 v59, v54, v55
    buffer_store_dwordx4 v[56:59], v230, s[24:27], s47 offen offset:0 sc1
    v_accvgpr_read_b32 v60, a36
    v_accvgpr_read_b32 v61, a37
    v_accvgpr_read_b32 v62, a38
    v_accvgpr_read_b32 v63, a39
    v_accvgpr_read_b32 v64, a52
    v_accvgpr_read_b32 v65, a53
    v_accvgpr_read_b32 v66, a54
    v_accvgpr_read_b32 v67, a55
    v_pk_mul_f32 v[60:61], v[60:61], v[226:227] op_sel:[0,1] op_sel_hi:[1,1]
    v_pk_mul_f32 v[62:63], v[62:63], v[226:227] op_sel:[0,1] op_sel_hi:[1,1]
    v_pk_mul_f32 v[64:65], v[64:65], v[226:227] op_sel:[0,1] op_sel_hi:[1,1]
    v_pk_mul_f32 v[66:67], v[66:67], v[226:227] op_sel:[0,1] op_sel_hi:[1,1]
    v_cvt_pk_bf16_f32 v68, v60, v61
    v_cvt_pk_bf16_f32 v69, v62, v63
    v_cvt_pk_bf16_f32 v70, v64, v65
    v_cvt_pk_bf16_f32 v71, v66, v67
    buffer_store_dwordx4 v[68:71], v230, s[24:27], s47 offen offset:1024 sc1
    v_accvgpr_read_b32 v0, a68
    v_accvgpr_read_b32 v1, a69
    v_accvgpr_read_b32 v2, a70
    v_accvgpr_read_b32 v3, a71
    v_accvgpr_read_b32 v4, a84
    v_accvgpr_read_b32 v5, a85
    v_accvgpr_read_b32 v6, a86
    v_accvgpr_read_b32 v7, a87
    v_pk_mul_f32 v[0:1], v[0:1], v[226:227] op_sel:[0,1] op_sel_hi:[1,1]
    v_pk_mul_f32 v[2:3], v[2:3], v[226:227] op_sel:[0,1] op_sel_hi:[1,1]
    v_pk_mul_f32 v[4:5], v[4:5], v[226:227] op_sel:[0,1] op_sel_hi:[1,1]
    v_pk_mul_f32 v[6:7], v[6:7], v[226:227] op_sel:[0,1] op_sel_hi:[1,1]
    v_cvt_pk_bf16_f32 v8, v0, v1
    v_cvt_pk_bf16_f32 v9, v2, v3
    v_cvt_pk_bf16_f32 v10, v4, v5
    v_cvt_pk_bf16_f32 v11, v6, v7
    buffer_store_dwordx4 v[8:11], v230, s[24:27], s47 offen offset:2048 sc1
    v_accvgpr_read_b32 v12, a100
    v_accvgpr_read_b32 v13, a101
    v_accvgpr_read_b32 v14, a102
    v_accvgpr_read_b32 v15, a103
    v_accvgpr_read_b32 v16, a116
    v_accvgpr_read_b32 v17, a117
    v_accvgpr_read_b32 v18, a118
    v_accvgpr_read_b32 v19, a119
    v_pk_mul_f32 v[12:13], v[12:13], v[226:227] op_sel:[0,1] op_sel_hi:[1,1]
    v_pk_mul_f32 v[14:15], v[14:15], v[226:227] op_sel:[0,1] op_sel_hi:[1,1]
    v_pk_mul_f32 v[16:17], v[16:17], v[226:227] op_sel:[0,1] op_sel_hi:[1,1]
    v_pk_mul_f32 v[18:19], v[18:19], v[226:227] op_sel:[0,1] op_sel_hi:[1,1]
    v_cvt_pk_bf16_f32 v20, v12, v13
    v_cvt_pk_bf16_f32 v21, v14, v15
    v_cvt_pk_bf16_f32 v22, v16, v17
    v_cvt_pk_bf16_f32 v23, v18, v19
    buffer_store_dwordx4 v[20:23], v230, s[24:27], s47 offen offset:3072 sc1
    s_add_u32 s47, s46, 262144
    v_accvgpr_read_b32 v24, a8
    v_accvgpr_read_b32 v25, a9
    v_accvgpr_read_b32 v26, a10
    v_accvgpr_read_b32 v27, a11
    v_accvgpr_read_b32 v28, a24
    v_accvgpr_read_b32 v29, a25
    v_accvgpr_read_b32 v30, a26
    v_accvgpr_read_b32 v31, a27
    v_pk_mul_f32 v[24:25], v[24:25], v[228:229] op_sel:[0,0] op_sel_hi:[1,0]
    v_pk_mul_f32 v[26:27], v[26:27], v[228:229] op_sel:[0,0] op_sel_hi:[1,0]
    v_pk_mul_f32 v[28:29], v[28:29], v[228:229] op_sel:[0,0] op_sel_hi:[1,0]
    v_pk_mul_f32 v[30:31], v[30:31], v[228:229] op_sel:[0,0] op_sel_hi:[1,0]
    v_cvt_pk_bf16_f32 v32, v24, v25
    v_cvt_pk_bf16_f32 v33, v26, v27
    v_cvt_pk_bf16_f32 v34, v28, v29
    v_cvt_pk_bf16_f32 v35, v30, v31
    buffer_store_dwordx4 v[32:35], v230, s[24:27], s47 offen offset:0 sc1
    v_accvgpr_read_b32 v36, a40
    v_accvgpr_read_b32 v37, a41
    v_accvgpr_read_b32 v38, a42
    v_accvgpr_read_b32 v39, a43
    v_accvgpr_read_b32 v40, a56
    v_accvgpr_read_b32 v41, a57
    v_accvgpr_read_b32 v42, a58
    v_accvgpr_read_b32 v43, a59
    v_pk_mul_f32 v[36:37], v[36:37], v[228:229] op_sel:[0,0] op_sel_hi:[1,0]
    v_pk_mul_f32 v[38:39], v[38:39], v[228:229] op_sel:[0,0] op_sel_hi:[1,0]
    v_pk_mul_f32 v[40:41], v[40:41], v[228:229] op_sel:[0,0] op_sel_hi:[1,0]
    v_pk_mul_f32 v[42:43], v[42:43], v[228:229] op_sel:[0,0] op_sel_hi:[1,0]
    v_cvt_pk_bf16_f32 v44, v36, v37
    v_cvt_pk_bf16_f32 v45, v38, v39
    v_cvt_pk_bf16_f32 v46, v40, v41
    v_cvt_pk_bf16_f32 v47, v42, v43
    buffer_store_dwordx4 v[44:47], v230, s[24:27], s47 offen offset:1024 sc1
    v_accvgpr_read_b32 v48, a72
    v_accvgpr_read_b32 v49, a73
    v_accvgpr_read_b32 v50, a74
    v_accvgpr_read_b32 v51, a75
    v_accvgpr_read_b32 v52, a88
    v_accvgpr_read_b32 v53, a89
    v_accvgpr_read_b32 v54, a90
    v_accvgpr_read_b32 v55, a91
    v_pk_mul_f32 v[48:49], v[48:49], v[228:229] op_sel:[0,0] op_sel_hi:[1,0]
    v_pk_mul_f32 v[50:51], v[50:51], v[228:229] op_sel:[0,0] op_sel_hi:[1,0]
    v_pk_mul_f32 v[52:53], v[52:53], v[228:229] op_sel:[0,0] op_sel_hi:[1,0]
    v_pk_mul_f32 v[54:55], v[54:55], v[228:229] op_sel:[0,0] op_sel_hi:[1,0]
    v_cvt_pk_bf16_f32 v56, v48, v49
    v_cvt_pk_bf16_f32 v57, v50, v51
    v_cvt_pk_bf16_f32 v58, v52, v53
    v_cvt_pk_bf16_f32 v59, v54, v55
    buffer_store_dwordx4 v[56:59], v230, s[24:27], s47 offen offset:2048 sc1
    v_accvgpr_read_b32 v60, a104
    v_accvgpr_read_b32 v61, a105
    v_accvgpr_read_b32 v62, a106
    v_accvgpr_read_b32 v63, a107
    v_accvgpr_read_b32 v64, a120
    v_accvgpr_read_b32 v65, a121
    v_accvgpr_read_b32 v66, a122
    v_accvgpr_read_b32 v67, a123
    v_pk_mul_f32 v[60:61], v[60:61], v[228:229] op_sel:[0,0] op_sel_hi:[1,0]
    v_pk_mul_f32 v[62:63], v[62:63], v[228:229] op_sel:[0,0] op_sel_hi:[1,0]
    v_pk_mul_f32 v[64:65], v[64:65], v[228:229] op_sel:[0,0] op_sel_hi:[1,0]
    v_pk_mul_f32 v[66:67], v[66:67], v[228:229] op_sel:[0,0] op_sel_hi:[1,0]
    v_cvt_pk_bf16_f32 v68, v60, v61
    v_cvt_pk_bf16_f32 v69, v62, v63
    v_cvt_pk_bf16_f32 v70, v64, v65
    v_cvt_pk_bf16_f32 v71, v66, v67
    buffer_store_dwordx4 v[68:71], v230, s[24:27], s47 offen offset:3072 sc1
    s_add_u32 s47, s46, 393216
    v_accvgpr_read_b32 v0, a12
    v_accvgpr_read_b32 v1, a13
    v_accvgpr_read_b32 v2, a14
    v_accvgpr_read_b32 v3, a15
    v_accvgpr_read_b32 v4, a28
    v_accvgpr_read_b32 v5, a29
    v_accvgpr_read_b32 v6, a30
    v_accvgpr_read_b32 v7, a31
    v_pk_mul_f32 v[0:1], v[0:1], v[228:229] op_sel:[0,1] op_sel_hi:[1,1]
    v_pk_mul_f32 v[2:3], v[2:3], v[228:229] op_sel:[0,1] op_sel_hi:[1,1]
    v_pk_mul_f32 v[4:5], v[4:5], v[228:229] op_sel:[0,1] op_sel_hi:[1,1]
    v_pk_mul_f32 v[6:7], v[6:7], v[228:229] op_sel:[0,1] op_sel_hi:[1,1]
    v_cvt_pk_bf16_f32 v8, v0, v1
    v_cvt_pk_bf16_f32 v9, v2, v3
    v_cvt_pk_bf16_f32 v10, v4, v5
    v_cvt_pk_bf16_f32 v11, v6, v7
    buffer_store_dwordx4 v[8:11], v230, s[24:27], s47 offen offset:0 sc1
    v_accvgpr_read_b32 v12, a44
    v_accvgpr_read_b32 v13, a45
    v_accvgpr_read_b32 v14, a46
    v_accvgpr_read_b32 v15, a47
    v_accvgpr_read_b32 v16, a60
    v_accvgpr_read_b32 v17, a61
    v_accvgpr_read_b32 v18, a62
    v_accvgpr_read_b32 v19, a63
    v_pk_mul_f32 v[12:13], v[12:13], v[228:229] op_sel:[0,1] op_sel_hi:[1,1]
    v_pk_mul_f32 v[14:15], v[14:15], v[228:229] op_sel:[0,1] op_sel_hi:[1,1]
    v_pk_mul_f32 v[16:17], v[16:17], v[228:229] op_sel:[0,1] op_sel_hi:[1,1]
    v_pk_mul_f32 v[18:19], v[18:19], v[228:229] op_sel:[0,1] op_sel_hi:[1,1]
    v_cvt_pk_bf16_f32 v20, v12, v13
    v_cvt_pk_bf16_f32 v21, v14, v15
    v_cvt_pk_bf16_f32 v22, v16, v17
    v_cvt_pk_bf16_f32 v23, v18, v19
    buffer_store_dwordx4 v[20:23], v230, s[24:27], s47 offen offset:1024 sc1
    v_accvgpr_read_b32 v24, a76
    v_accvgpr_read_b32 v25, a77
    v_accvgpr_read_b32 v26, a78
    v_accvgpr_read_b32 v27, a79
    v_accvgpr_read_b32 v28, a92
    v_accvgpr_read_b32 v29, a93
    v_accvgpr_read_b32 v30, a94
    v_accvgpr_read_b32 v31, a95
    v_pk_mul_f32 v[24:25], v[24:25], v[228:229] op_sel:[0,1] op_sel_hi:[1,1]
    v_pk_mul_f32 v[26:27], v[26:27], v[228:229] op_sel:[0,1] op_sel_hi:[1,1]
    v_pk_mul_f32 v[28:29], v[28:29], v[228:229] op_sel:[0,1] op_sel_hi:[1,1]
    v_pk_mul_f32 v[30:31], v[30:31], v[228:229] op_sel:[0,1] op_sel_hi:[1,1]
    v_cvt_pk_bf16_f32 v32, v24, v25
    v_cvt_pk_bf16_f32 v33, v26, v27
    v_cvt_pk_bf16_f32 v34, v28, v29
    v_cvt_pk_bf16_f32 v35, v30, v31
    buffer_store_dwordx4 v[32:35], v230, s[24:27], s47 offen offset:2048 sc1
    v_accvgpr_read_b32 v36, a108
    v_accvgpr_read_b32 v37, a109
    v_accvgpr_read_b32 v38, a110
    v_accvgpr_read_b32 v39, a111
    v_accvgpr_read_b32 v40, a124
    v_accvgpr_read_b32 v41, a125
    v_accvgpr_read_b32 v42, a126
    v_accvgpr_read_b32 v43, a127
    v_pk_mul_f32 v[36:37], v[36:37], v[228:229] op_sel:[0,1] op_sel_hi:[1,1]
    v_pk_mul_f32 v[38:39], v[38:39], v[228:229] op_sel:[0,1] op_sel_hi:[1,1]
    v_pk_mul_f32 v[40:41], v[40:41], v[228:229] op_sel:[0,1] op_sel_hi:[1,1]
    v_pk_mul_f32 v[42:43], v[42:43], v[228:229] op_sel:[0,1] op_sel_hi:[1,1]
    v_cvt_pk_bf16_f32 v44, v36, v37
    v_cvt_pk_bf16_f32 v45, v38, v39
    v_cvt_pk_bf16_f32 v46, v40, v41
    v_cvt_pk_bf16_f32 v47, v42, v43
    buffer_store_dwordx4 v[44:47], v230, s[24:27], s47 offen offset:3072 sc1
    s_branch L2_entry
L1_slowa:
    s_lshl_b32 s52, s3, 14
    s_add_u32 s52, s52, 98304
    v_add_u32 v192, s52, v192
    v_add_u32 v193, s52, v193
    v_add_u32 v194, s52, v194
    v_add_u32 v195, s52, v195
    s_sub_u32 s55, s52, 57344
    v_add_u32 v196, s55, v196
    v_add_u32 v197, s55, v197
    v_add_u32 v198, s55, v198
    v_add_u32 v199, s55, v199
    v_add_u32 v200, s55, v200
    v_add_u32 v201, s55, v201
    v_add_u32 v202, s55, v202
    v_add_u32 v203, s55, v203
    v_mov_b32 v222, 0xff800000
    v_mov_b32 v223, 0xff800000
    v_mov_b32 v224, 0xff800000
    v_mov_b32 v225, 0xff800000
    s_mov_b32 s53, 0
L1_slow_maxa:
    s_add_u32 s54, s53, 0
    s_add_u32 m0, s52, 0
    s_nop 0
    buffer_load_dwordx4 v204, s[8:11], s54 offen lds
    buffer_load_dwordx4 v205, s[8:11], s54 offen offset:1024 lds
    buffer_load_dwordx4 v206, s[8:11], s54 offen offset:2048 lds
    buffer_load_dwordx4 v207, s[8:11], s54 offen offset:3072 lds
    s_add_u32 s54, s53, 4096
    s_add_u32 m0, s52, 4096
    s_nop 0
    buffer_load_dwordx4 v204, s[8:11], s54 offen lds
    buffer_load_dwordx4 v205, s[8:11], s54 offen offset:1024 lds
    buffer_load_dwordx4 v206, s[8:11], s54 offen offset:2048 lds
    buffer_load_dwordx4 v207, s[8:11], s54 offen offset:3072 lds
    s_waitcnt vmcnt(0)
    ds_read_b128 a[128:131], v192 offset:0
    ds_read_b128 a[132:135], v193 offset:0
    ds_read_b128 a[136:139], v194 offset:0
    ds_read_b128 a[140:143], v195 offset:0
    ds_read_b128 a[144:147], v192 offset:4096
    ds_read_b128 a[148:151], v193 offset:4096
    ds_read_b128 a[152:155], v194 offset:4096
    ds_read_b128 a[156:159], v195 offset:4096
    s_waitcnt lgkmcnt(0)
    v_mfma_f32_16x16x32_bf16 v[0:3], a[128:131], v[128:131], 0
    v_mfma_f32_16x16x32_bf16 v[0:3], a[132:135], v[132:135], v[0:3]
    v_mfma_f32_16x16x32_bf16 v[0:3], a[136:139], v[136:139], v[0:3]
    v_mfma_f32_16x16x32_bf16 v[0:3], a[140:143], v[140:143], v[0:3]
    v_mfma_f32_16x16x32_bf16 v[8:11], a[128:131], v[144:147], 0
    v_mfma_f32_16x16x32_bf16 v[8:11], a[132:135], v[148:151], v[8:11]
    v_mfma_f32_16x16x32_bf16 v[8:11], a[136:139], v[152:155], v[8:11]
    v_mfma_f32_16x16x32_bf16 v[8:11], a[140:143], v[156:159], v[8:11]
    v_mfma_f32_16x16x32_bf16 v[16:19], a[128:131], v[160:163], 0
    v_mfma_f32_16x16x32_bf16 v[16:19], a[132:135], v[164:167], v[16:19]
    v_mfma_f32_16x16x32_bf16 v[16:19], a[136:139], v[168:171], v[16:19]
    v_mfma_f32_16x16x32_bf16 v[16:19], a[140:143], v[172:175], v[16:19]
    v_mfma_f32_16x16x32_bf16 v[24:27], a[128:131], v[176:179], 0
    v_mfma_f32_16x16x32_bf16 v[24:27], a[132:135], v[180:183], v[24:27]
    v_mfma_f32_16x16x32_bf16 v[24:27], a[136:139], v[184:187], v[24:27]
    v_mfma_f32_16x16x32_bf16 v[24:27], a[140:143], v[188:191], v[24:27]
    v_mfma_f32_16x16x32_bf16 v[4:7], a[144:147], v[128:131], 0
    v_mfma_f32_16x16x32_bf16 v[4:7], a[148:151], v[132:135], v[4:7]
    v_mfma_f32_16x16x32_bf16 v[4:7], a[152:155], v[136:139], v[4:7]
    v_mfma_f32_16x16x32_bf16 v[4:7], a[156:159], v[140:143], v[4:7]
    v_mfma_f32_16x16x32_bf16 v[12:15], a[144:147], v[144:147], 0
    v_mfma_f32_16x16x32_bf16 v[12:15], a[148:151], v[148:151], v[12:15]
    v_mfma_f32_16x16x32_bf16 v[12:15], a[152:155], v[152:155], v[12:15]
    v_mfma_f32_16x16x32_bf16 v[12:15], a[156:159], v[156:159], v[12:15]
    v_mfma_f32_16x16x32_bf16 v[20:23], a[144:147], v[160:163], 0
    v_mfma_f32_16x16x32_bf16 v[20:23], a[148:151], v[164:167], v[20:23]
    v_mfma_f32_16x16x32_bf16 v[20:23], a[152:155], v[168:171], v[20:23]
    v_mfma_f32_16x16x32_bf16 v[20:23], a[156:159], v[172:175], v[20:23]
    v_mfma_f32_16x16x32_bf16 v[28:31], a[144:147], v[176:179], 0
    v_mfma_f32_16x16x32_bf16 v[28:31], a[148:151], v[180:183], v[28:31]
    v_mfma_f32_16x16x32_bf16 v[28:31], a[152:155], v[184:187], v[28:31]
    v_mfma_f32_16x16x32_bf16 v[28:31], a[156:159], v[188:191], v[28:31]
    s_nop 7
    s_nop 7
    v_max3_f32 v222, v222, v0, v1
    v_max3_f32 v222, v222, v2, v3
    v_max3_f32 v222, v222, v4, v5
    v_max3_f32 v222, v222, v6, v7
    v_max3_f32 v223, v223, v8, v9
    v_max3_f32 v223, v223, v10, v11
    v_max3_f32 v223, v223, v12, v13
    v_max3_f32 v223, v223, v14, v15
    v_max3_f32 v224, v224, v16, v17
    v_max3_f32 v224, v224, v18, v19
    v_max3_f32 v224, v224, v20, v21
    v_max3_f32 v224, v224, v22, v23
    v_max3_f32 v225, v225, v24, v25
    v_max3_f32 v225, v225, v26, v27
    v_max3_f32 v225, v225, v28, v29
    v_max3_f32 v225, v225, v30, v31
    s_add_u32 s53, s53, 8192
    s_cmp_lt_u32 s53, 524288
    s_cbranch_scc1 L1_slow_maxa
    v_mov_b32 v226, v222
    v_mov_b32 v227, v223
    v_mov_b32 v228, v224
    v_mov_b32 v229, v225
    s_nop 1
    v_permlane16_swap_b32 v222, v226
    v_permlane16_swap_b32 v223, v227
    v_permlane16_swap_b32 v224, v228
    v_permlane16_swap_b32 v225, v229
    s_nop 1
    v_max_f32 v222, v222, v226
    v_max_f32 v223, v223, v227
    v_max_f32 v224, v224, v228
    v_max_f32 v225, v225, v229
    v_mov_b32 v226, v222
    v_mov_b32 v227, v223
    v_mov_b32 v228, v224
    v_mov_b32 v229, v225
    s_nop 1
    v_permlane32_swap_b32 v222, v226
    v_permlane32_swap_b32 v223, v227
    v_permlane32_swap_b32 v224, v228
    v_permlane32_swap_b32 v225, v229
    s_nop 1
    v_max_f32 v222, v222, v226
    v_max_f32 v223, v223, v227
    v_max_f32 v224, v224, v228
    v_max_f32 v225, v225, v229
    v_sub_f32 v222, 0, v222
    v_sub_f32 v223, 0, v223
    v_sub_f32 v224, 0, v224
    v_sub_f32 v225, 0, v225
    v_mov_b32 v96, v222
    v_mov_b32 v97, v222
    v_mov_b32 v98, v222
    v_mov_b32 v99, v222
    v_mov_b32 v100, v223
    v_mov_b32 v101, v223
    v_mov_b32 v102, v223
    v_mov_b32 v103, v223
    v_mov_b32 v104, v224
    v_mov_b32 v105, v224
    v_mov_b32 v106, v224
    v_mov_b32 v107, v224
    v_mov_b32 v108, v225
    v_mov_b32 v109, v225
    v_mov_b32 v110, v225
    v_mov_b32 v111, v225
    v_accvgpr_write_b32 a0, 0
    v_accvgpr_write_b32 a1, 0
    v_accvgpr_write_b32 a2, 0
    v_accvgpr_write_b32 a3, 0
    v_accvgpr_write_b32 a4, 0
    v_accvgpr_write_b32 a5, 0
    v_accvgpr_write_b32 a6, 0
    v_accvgpr_write_b32 a7, 0
    v_accvgpr_write_b32 a8, 0
    v_accvgpr_write_b32 a9, 0
    v_accvgpr_write_b32 a10, 0
    v_accvgpr_write_b32 a11, 0
    v_accvgpr_write_b32 a12, 0
    v_accvgpr_write_b32 a13, 0
    v_accvgpr_write_b32 a14, 0
    v_accvgpr_write_b32 a15, 0
    v_accvgpr_write_b32 a16, 0
    v_accvgpr_write_b32 a17, 0
    v_accvgpr_write_b32 a18, 0
    v_accvgpr_write_b32 a19, 0
    v_accvgpr_write_b32 a20, 0
    v_accvgpr_write_b32 a21, 0
    v_accvgpr_write_b32 a22, 0
    v_accvgpr_write_b32 a23, 0
    v_accvgpr_write_b32 a24, 0
    v_accvgpr_write_b32 a25, 0
    v_accvgpr_write_b32 a26, 0
    v_accvgpr_write_b32 a27, 0
    v_accvgpr_write_b32 a28, 0
    v_accvgpr_write_b32 a29, 0
    v_accvgpr_write_b32 a30, 0
    v_accvgpr_write_b32 a31, 0
    v_accvgpr_write_b32 a32, 0
    v_accvgpr_write_b32 a33, 0
    v_accvgpr_write_b32 a34, 0
    v_accvgpr_write_b32 a35, 0
    v_accvgpr_write_b32 a36, 0
    v_accvgpr_write_b32 a37, 0
    v_accvgpr_write_b32 a38, 0
    v_accvgpr_write_b32 a39, 0
    v_accvgpr_write_b32 a40, 0
    v_accvgpr_write_b32 a41, 0
    v_accvgpr_write_b32 a42, 0
    v_accvgpr_write_b32 a43, 0
    v_accvgpr_write_b32 a44, 0
    v_accvgpr_write_b32 a45, 0
    v_accvgpr_write_b32 a46, 0
    v_accvgpr_write_b32 a47, 0
    v_accvgpr_write_b32 a48, 0
    v_accvgpr_write_b32 a49, 0
    v_accvgpr_write_b32 a50, 0
    v_accvgpr_write_b32 a51, 0
    v_accvgpr_write_b32 a52, 0
    v_accvgpr_write_b32 a53, 0
    v_accvgpr_write_b32 a54, 0
    v_accvgpr_write_b32 a55, 0
    v_accvgpr_write_b32 a56, 0
    v_accvgpr_write_b32 a57, 0
    v_accvgpr_write_b32 a58, 0
    v_accvgpr_write_b32 a59, 0
    v_accvgpr_write_b32 a60, 0
    v_accvgpr_write_b32 a61, 0
    v_accvgpr_write_b32 a62, 0
    v_accvgpr_write_b32 a63, 0
    v_accvgpr_write_b32 a64, 0
    v_accvgpr_write_b32 a65, 0
    v_accvgpr_write_b32 a66, 0
    v_accvgpr_write_b32 a67, 0
    v_accvgpr_write_b32 a68, 0
    v_accvgpr_write_b32 a69, 0
    v_accvgpr_write_b32 a70, 0
    v_accvgpr_write_b32 a71, 0
    v_accvgpr_write_b32 a72, 0
    v_accvgpr_write_b32 a73, 0
    v_accvgpr_write_b32 a74, 0
    v_accvgpr_write_b32 a75, 0
    v_accvgpr_write_b32 a76, 0
    v_accvgpr_write_b32 a77, 0
    v_accvgpr_write_b32 a78, 0
    v_accvgpr_write_b32 a79, 0
    v_accvgpr_write_b32 a80, 0
    v_accvgpr_write_b32 a81, 0
    v_accvgpr_write_b32 a82, 0
    v_accvgpr_write_b32 a83, 0
    v_accvgpr_write_b32 a84, 0
    v_accvgpr_write_b32 a85, 0
    v_accvgpr_write_b32 a86, 0
    v_accvgpr_write_b32 a87, 0
    v_accvgpr_write_b32 a88, 0
    v_accvgpr_write_b32 a89, 0
    v_accvgpr_write_b32 a90, 0
    v_accvgpr_write_b32 a91, 0
    v_accvgpr_write_b32 a92, 0
    v_accvgpr_write_b32 a93, 0
    v_accvgpr_write_b32 a94, 0
    v_accvgpr_write_b32 a95, 0
    v_accvgpr_write_b32 a96, 0
    v_accvgpr_write_b32 a97, 0
    v_accvgpr_write_b32 a98, 0
    v_accvgpr_write_b32 a99, 0
    v_accvgpr_write_b32 a100, 0
    v_accvgpr_write_b32 a101, 0
    v_accvgpr_write_b32 a102, 0
    v_accvgpr_write_b32 a103, 0
    v_accvgpr_write_b32 a104, 0
    v_accvgpr_write_b32 a105, 0
    v_accvgpr_write_b32 a106, 0
    v_accvgpr_write_b32 a107, 0
    v_accvgpr_write_b32 a108, 0
    v_accvgpr_write_b32 a109, 0
    v_accvgpr_write_b32 a110, 0
    v_accvgpr_write_b32 a111, 0
    v_accvgpr_write_b32 a112, 0
    v_accvgpr_write_b32 a113, 0
    v_accvgpr_write_b32 a114, 0
    v_accvgpr_write_b32 a115, 0
    v_accvgpr_write_b32 a116, 0
    v_accvgpr_write_b32 a117, 0
    v_accvgpr_write_b32 a118, 0
    v_accvgpr_write_b32 a119, 0
    v_accvgpr_write_b32 a120, 0
    v_accvgpr_write_b32 a121, 0
    v_accvgpr_write_b32 a122, 0
    v_accvgpr_write_b32 a123, 0
    v_accvgpr_write_b32 a124, 0
    v_accvgpr_write_b32 a125, 0
    v_accvgpr_write_b32 a126, 0
    v_accvgpr_write_b32 a127, 0
    v_accvgpr_write_b32 a192, 0
    v_accvgpr_write_b32 a193, 0
    v_accvgpr_write_b32 a194, 0
    v_accvgpr_write_b32 a195, 0
    v_accvgpr_write_b32 a196, 0
    v_accvgpr_write_b32 a197, 0
    v_accvgpr_write_b32 a198, 0
    v_accvgpr_write_b32 a199, 0
    v_accvgpr_write_b32 a200, 0
    v_accvgpr_write_b32 a201, 0
    v_accvgpr_write_b32 a202, 0
    v_accvgpr_write_b32 a203, 0
    v_accvgpr_write_b32 a204, 0
    v_accvgpr_write_b32 a205, 0
    v_accvgpr_write_b32 a206, 0
    v_accvgpr_write_b32 a207, 0
    s_mov_b32 s53, 0
L1_slow_maina:
    s_add_u32 s54, s53, 0
    s_add_u32 m0, s52, 0
    s_nop 0
    buffer_load_dwordx4 v204, s[8:11], s54 offen lds
    buffer_load_dwordx4 v205, s[8:11], s54 offen offset:1024 lds
    buffer_load_dwordx4 v206, s[8:11], s54 offen offset:2048 lds
    buffer_load_dwordx4 v207, s[8:11], s54 offen offset:3072 lds
    s_add_u32 s54, s53, 4096
    s_add_u32 m0, s52, 4096
    s_nop 0
    buffer_load_dwordx4 v204, s[8:11], s54 offen lds
    buffer_load_dwordx4 v205, s[8:11], s54 offen offset:1024 lds
    buffer_load_dwordx4 v206, s[8:11], s54 offen offset:2048 lds
    buffer_load_dwordx4 v207, s[8:11], s54 offen offset:3072 lds
    s_add_u32 s54, s53, 0
    s_add_u32 m0, s52, 8192
    s_nop 0
    buffer_load_dwordx4 v208, s[12:15], s54 offen lds
    buffer_load_dwordx4 v209, s[12:15], s54 offen offset:1024 lds
    buffer_load_dwordx4 v208, s[12:15], s54 offen offset:2048 lds
    buffer_load_dwordx4 v209, s[12:15], s54 offen offset:3072 lds
    s_add_u32 s54, s53, 4096
    s_add_u32 m0, s52, 12288
    s_nop 0
    buffer_load_dwordx4 v208, s[12:15], s54 offen lds
    buffer_load_dwordx4 v209, s[12:15], s54 offen offset:1024 lds
    buffer_load_dwordx4 v208, s[12:15], s54 offen offset:2048 lds
    buffer_load_dwordx4 v209, s[12:15], s54 offen offset:3072 lds
    s_waitcnt vmcnt(0)
    ds_read_b128 a[128:131], v192 offset:0
    ds_read_b128 a[132:135], v193 offset:0
    ds_read_b128 a[136:139], v194 offset:0
    ds_read_b128 a[140:143], v195 offset:0
    ds_read_b128 a[144:147], v192 offset:4096
    ds_read_b128 a[148:151], v193 offset:4096
    ds_read_b128 a[152:155], v194 offset:4096
    ds_read_b128 a[156:159], v195 offset:4096
    ds_read_b64_tr_b16 a[160:161], v196 offset:0
    ds_read_b64_tr_b16 a[162:163], v196 offset:4096
    ds_read_b64_tr_b16 a[164:165], v197 offset:0
    ds_read_b64_tr_b16 a[166:167], v197 offset:4096
    ds_read_b64_tr_b16 a[168:169], v198 offset:0
    ds_read_b64_tr_b16 a[170:171], v198 offset:4096
    ds_read_b64_tr_b16 a[172:173], v199 offset:0
    ds_read_b64_tr_b16 a[174:175], v199 offset:4096
    ds_read_b64_tr_b16 a[176:177], v200 offset:0
    ds_read_b64_tr_b16 a[178:179], v200 offset:4096
    ds_read_b64_tr_b16 a[180:181], v201 offset:0
    ds_read_b64_tr_b16 a[182:183], v201 offset:4096
    ds_read_b64_tr_b16 a[184:185], v202 offset:0
    ds_read_b64_tr_b16 a[186:187], v202 offset:4096
    ds_read_b64_tr_b16 a[188:189], v203 offset:0
    ds_read_b64_tr_b16 a[190:191], v203 offset:4096
    s_waitcnt lgkmcnt(0)
    v_mfma_f32_16x16x32_bf16 v[0:3], a[128:131], v[128:131], v[96:99]
    v_mfma_f32_16x16x32_bf16 v[0:3], a[132:135], v[132:135], v[0:3]
    v_mfma_f32_16x16x32_bf16 v[0:3], a[136:139], v[136:139], v[0:3]
    v_mfma_f32_16x16x32_bf16 v[0:3], a[140:143], v[140:143], v[0:3]
    v_mfma_f32_16x16x32_bf16 v[8:11], a[128:131], v[144:147], v[100:103]
    v_mfma_f32_16x16x32_bf16 v[8:11], a[132:135], v[148:151], v[8:11]
    v_mfma_f32_16x16x32_bf16 v[8:11], a[136:139], v[152:155], v[8:11]
    v_mfma_f32_16x16x32_bf16 v[8:11], a[140:143], v[156:159], v[8:11]
    v_mfma_f32_16x16x32_bf16 v[16:19], a[128:131], v[160:163], v[104:107]
    v_mfma_f32_16x16x32_bf16 v[16:19], a[132:135], v[164:167], v[16:19]
    v_mfma_f32_16x16x32_bf16 v[16:19], a[136:139], v[168:171], v[16:19]
    v_mfma_f32_16x16x32_bf16 v[16:19], a[140:143], v[172:175], v[16:19]
    v_mfma_f32_16x16x32_bf16 v[24:27], a[128:131], v[176:179], v[108:111]
    v_mfma_f32_16x16x32_bf16 v[24:27], a[132:135], v[180:183], v[24:27]
    v_mfma_f32_16x16x32_bf16 v[24:27], a[136:139], v[184:187], v[24:27]
    v_mfma_f32_16x16x32_bf16 v[24:27], a[140:143], v[188:191], v[24:27]
    v_mfma_f32_16x16x32_bf16 v[4:7], a[144:147], v[128:131], v[96:99]
    v_mfma_f32_16x16x32_bf16 v[4:7], a[148:151], v[132:135], v[4:7]
    v_mfma_f32_16x16x32_bf16 v[4:7], a[152:155], v[136:139], v[4:7]
    v_mfma_f32_16x16x32_bf16 v[4:7], a[156:159], v[140:143], v[4:7]
    v_mfma_f32_16x16x32_bf16 v[12:15], a[144:147], v[144:147], v[100:103]
    v_mfma_f32_16x16x32_bf16 v[12:15], a[148:151], v[148:151], v[12:15]
    v_mfma_f32_16x16x32_bf16 v[12:15], a[152:155], v[152:155], v[12:15]
    v_mfma_f32_16x16x32_bf16 v[12:15], a[156:159], v[156:159], v[12:15]
    v_mfma_f32_16x16x32_bf16 v[20:23], a[144:147], v[160:163], v[104:107]
    v_mfma_f32_16x16x32_bf16 v[20:23], a[148:151], v[164:167], v[20:23]
    v_mfma_f32_16x16x32_bf16 v[20:23], a[152:155], v[168:171], v[20:23]
    v_mfma_f32_16x16x32_bf16 v[20:23], a[156:159], v[172:175], v[20:23]
    v_mfma_f32_16x16x32_bf16 v[28:31], a[144:147], v[176:179], v[108:111]
    v_mfma_f32_16x16x32_bf16 v[28:31], a[148:151], v[180:183], v[28:31]
    v_mfma_f32_16x16x32_bf16 v[28:31], a[152:155], v[184:187], v[28:31]
    v_mfma_f32_16x16x32_bf16 v[28:31], a[156:159], v[188:191], v[28:31]
    s_nop 7
    s_nop 7
    v_exp_f32 v0, v0
    v_exp_f32 v1, v1
    v_exp_f32 v2, v2
    v_exp_f32 v3, v3
    v_exp_f32 v4, v4
    v_exp_f32 v5, v5
    v_exp_f32 v6, v6
    v_exp_f32 v7, v7
    v_exp_f32 v8, v8
    v_exp_f32 v9, v9
    v_exp_f32 v10, v10
    v_exp_f32 v11, v11
    v_exp_f32 v12, v12
    v_exp_f32 v13, v13
    v_exp_f32 v14, v14
    v_exp_f32 v15, v15
    v_exp_f32 v16, v16
    v_exp_f32 v17, v17
    v_exp_f32 v18, v18
    v_exp_f32 v19, v19
    v_exp_f32 v20, v20
    v_exp_f32 v21, v21
    v_exp_f32 v22, v22
    v_exp_f32 v23, v23
    v_exp_f32 v24, v24
    v_exp_f32 v25, v25
    v_exp_f32 v26, v26
    v_exp_f32 v27, v27
    v_exp_f32 v28, v28
    v_exp_f32 v29, v29
    v_exp_f32 v30, v30
    v_exp_f32 v31, v31
    s_nop 0
    v_cvt_pk_bf16_f32 v64, v0, v1
    v_cvt_pk_bf16_f32 v65, v2, v3
    v_cvt_pk_bf16_f32 v66, v4, v5
    v_cvt_pk_bf16_f32 v67, v6, v7
    v_cvt_pk_bf16_f32 v68, v8, v9
    v_cvt_pk_bf16_f32 v69, v10, v11
    v_cvt_pk_bf16_f32 v70, v12, v13
    v_cvt_pk_bf16_f32 v71, v14, v15
    v_cvt_pk_bf16_f32 v72, v16, v17
    v_cvt_pk_bf16_f32 v73, v18, v19
    v_cvt_pk_bf16_f32 v74, v20, v21
    v_cvt_pk_bf16_f32 v75, v22, v23
    v_cvt_pk_bf16_f32 v76, v24, v25
    v_cvt_pk_bf16_f32 v77, v26, v27
    v_cvt_pk_bf16_f32 v78, v28, v29
    v_cvt_pk_bf16_f32 v79, v30, v31
    s_nop 1
    v_mfma_f32_16x16x32_bf16 a[0:3], a[160:163], v[64:67], a[0:3]
    v_mfma_f32_16x16x32_bf16 a[16:19], a[164:167], v[64:67], a[16:19]
    v_mfma_f32_16x16x32_bf16 a[4:7], a[160:163], v[68:71], a[4:7]
    v_mfma_f32_16x16x32_bf16 a[20:23], a[164:167], v[68:71], a[20:23]
    v_mfma_f32_16x16x32_bf16 a[8:11], a[160:163], v[72:75], a[8:11]
    v_mfma_f32_16x16x32_bf16 a[24:27], a[164:167], v[72:75], a[24:27]
    v_mfma_f32_16x16x32_bf16 a[12:15], a[160:163], v[76:79], a[12:15]
    v_mfma_f32_16x16x32_bf16 a[28:31], a[164:167], v[76:79], a[28:31]
    v_mfma_f32_16x16x32_bf16 a[192:195], a[208:211], v[64:67], a[192:195]
    v_mfma_f32_16x16x32_bf16 a[32:35], a[168:171], v[64:67], a[32:35]
    v_mfma_f32_16x16x32_bf16 a[48:51], a[172:175], v[64:67], a[48:51]
    v_mfma_f32_16x16x32_bf16 a[36:39], a[168:171], v[68:71], a[36:39]
    v_mfma_f32_16x16x32_bf16 a[52:55], a[172:175], v[68:71], a[52:55]
    v_mfma_f32_16x16x32_bf16 a[40:43], a[168:171], v[72:75], a[40:43]
    v_mfma_f32_16x16x32_bf16 a[56:59], a[172:175], v[72:75], a[56:59]
    v_mfma_f32_16x16x32_bf16 a[44:47], a[168:171], v[76:79], a[44:47]
    v_mfma_f32_16x16x32_bf16 a[60:63], a[172:175], v[76:79], a[60:63]
    v_mfma_f32_16x16x32_bf16 a[196:199], a[208:211], v[68:71], a[196:199]
    v_mfma_f32_16x16x32_bf16 a[64:67], a[176:179], v[64:67], a[64:67]
    v_mfma_f32_16x16x32_bf16 a[80:83], a[180:183], v[64:67], a[80:83]
    v_mfma_f32_16x16x32_bf16 a[68:71], a[176:179], v[68:71], a[68:71]
    v_mfma_f32_16x16x32_bf16 a[84:87], a[180:183], v[68:71], a[84:87]
    v_mfma_f32_16x16x32_bf16 a[72:75], a[176:179], v[72:75], a[72:75]
    v_mfma_f32_16x16x32_bf16 a[88:91], a[180:183], v[72:75], a[88:91]
    v_mfma_f32_16x16x32_bf16 a[76:79], a[176:179], v[76:79], a[76:79]
    v_mfma_f32_16x16x32_bf16 a[92:95], a[180:183], v[76:79], a[92:95]
    v_mfma_f32_16x16x32_bf16 a[200:203], a[208:211], v[72:75], a[200:203]
    v_mfma_f32_16x16x32_bf16 a[96:99], a[184:187], v[64:67], a[96:99]
    v_mfma_f32_16x16x32_bf16 a[112:115], a[188:191], v[64:67], a[112:115]
    v_mfma_f32_16x16x32_bf16 a[100:103], a[184:187], v[68:71], a[100:103]
    v_mfma_f32_16x16x32_bf16 a[116:119], a[188:191], v[68:71], a[116:119]
    v_mfma_f32_16x16x32_bf16 a[104:107], a[184:187], v[72:75], a[104:107]
    v_mfma_f32_16x16x32_bf16 a[120:123], a[188:191], v[72:75], a[120:123]
    v_mfma_f32_16x16x32_bf16 a[108:111], a[184:187], v[76:79], a[108:111]
    v_mfma_f32_16x16x32_bf16 a[124:127], a[188:191], v[76:79], a[124:127]
    v_mfma_f32_16x16x32_bf16 a[204:207], a[208:211], v[76:79], a[204:207]
    s_add_u32 s53, s53, 8192
    s_cmp_lt_u32 s53, 524288
    s_cbranch_scc1 L1_slow_maina
    s_nop 7
    s_nop 7
    v_accvgpr_read_b32 v222, a192
    v_accvgpr_read_b32 v223, a196
    v_accvgpr_read_b32 v224, a200
    v_accvgpr_read_b32 v225, a204
    s_nop 0
    v_rcp_f32 v226, v222
    v_rcp_f32 v227, v223
    v_rcp_f32 v228, v224
    v_rcp_f32 v229, v225
    s_mul_i32 s46, s32, 15
    s_lshl_b32 s47, s3, 2
    s_add_u32 s46, s46, s47
    s_lshl_b32 s46, s46, 17
    s_lshl_b32 s47, s33, 12
    s_add_u32 s46, s46, s47
    v_lshlrev_b32 v230, 4, v221
    s_branch L1_norma
    .p2align 6
L1_w3:
    s_lshl_b32 s51, s50, 7
    s_lshl_b32 s52, s50, 19
    s_add_u32 m0, s34, 16384
    s_add_u32 s46, s51, 0
    buffer_load_dwordx4 v218, s[16:19], s46 offen  lds
    s_add_u32 m0, s34, 17408
    s_add_u32 s46, s51, 9216
    buffer_load_dwordx4 v219, s[16:19], s46 offen  lds
    s_add_u32 m0, s34, 18432
    s_add_u32 s46, s51, 18432
    buffer_load_dwordx4 v218, s[16:19], s46 offen  lds
    s_add_u32 m0, s34, 19456
    s_add_u32 s46, s51, 27648
    buffer_load_dwordx4 v219, s[16:19], s46 offen  lds
    s_add_u32 m0, s34, 20480
    s_add_u32 s46, s51, 36864
    buffer_load_dwordx4 v218, s[16:19], s46 offen  lds
    s_add_u32 m0, s34, 21504
    s_add_u32 s46, s51, 46080
    buffer_load_dwordx4 v219, s[16:19], s46 offen  lds
    s_add_u32 s50, s50, 1
    s_cmp_eq_u32 s50, 9
    s_cselect_b32 s50, 0, s50
    s_add_u32 m0, s35, 114688
    s_add_u32 s46, s52, 0
    buffer_load_dwordx4 v220, s[20:23], s46 offen  lds
    s_add_u32 m0, s35, 115712
    s_add_u32 s46, s52, 32768
    buffer_load_dwordx4 v220, s[20:23], s46 offen  lds
    s_add_u32 m0, s35, 116736
    s_add_u32 s46, s52, 65536
    buffer_load_dwordx4 v220, s[20:23], s46 offen  lds
    s_add_u32 m0, s35, 117760
    s_add_u32 s46, s52, 98304
    buffer_load_dwordx4 v220, s[20:23], s46 offen  lds
    s_lshl_b32 s46, s32, 5
    s_add_u32 s46, s46, s33
    s_lshl_b32 s46, s46, 19
    s_add_u32 s8, s38, s46
    s_addc_u32 s9, s39, 0
    s_mov_b32 s10, 524288
    s_mov_b32 s11, 0x20000
    s_add_u32 s12, s40, s46
    s_addc_u32 s13, s41, 0
    s_mov_b32 s14, 524288
    s_mov_b32 s15, 0x20000
    s_mov_b32 s24, s44
    s_mov_b32 s25, s45
    s_mov_b32 s26, 0x2A00000
    s_mov_b32 s27, 0x20000
    v_and_b32 v222, 15, v221
    v_lshrrev_b32 v223, 4, v221
    v_bfe_u32 v224, v221, 2, 2
    v_and_b32 v225, 3, v221
    v_add_u32 v226, 0, v223
    v_xor_b32 v226, v226, v222
    v_lshlrev_b32 v226, 4, v226
    v_lshl_add_u32 v192, v222, 8, v226
    v_add_u32 v226, 4, v223
    v_xor_b32 v226, v226, v222
    v_lshlrev_b32 v226, 4, v226
    v_lshl_add_u32 v193, v222, 8, v226
    v_add_u32 v226, 8, v223
    v_xor_b32 v226, v226, v222
    v_lshlrev_b32 v226, 4, v226
    v_lshl_add_u32 v194, v222, 8, v226
    v_add_u32 v226, 12, v223
    v_xor_b32 v226, v226, v222
    v_lshlrev_b32 v226, 4, v226
    v_lshl_add_u32 v195, v222, 8, v226
    v_lshl_add_u32 v227, v223, 2, v224
    v_and_b32 v228, 7, v227
    v_lshrrev_b32 v229, 1, v225
    v_and_b32 v230, 1, v225
    v_lshlrev_b32 v230, 3, v230
    v_lshl_add_u32 v230, v227, 8, v230
    v_add_u32 v230, 65536, v230
    v_xor_b32 v226, 0, v228
    v_lshl_add_u32 v226, v226, 1, v229
    v_lshl_add_u32 v196, v226, 4, v230
    v_xor_b32 v226, 1, v228
    v_lshl_add_u32 v226, v226, 1, v229
    v_lshl_add_u32 v197, v226, 4, v230
    v_xor_b32 v226, 2, v228
    v_lshl_add_u32 v226, v226, 1, v229
    v_lshl_add_u32 v198, v226, 4, v230
    v_xor_b32 v226, 3, v228
    v_lshl_add_u32 v226, v226, 1, v229
    v_lshl_add_u32 v199, v226, 4, v230
    v_xor_b32 v226, 4, v228
    v_lshl_add_u32 v226, v226, 1, v229
    v_lshl_add_u32 v200, v226, 4, v230
    v_xor_b32 v226, 5, v228
    v_lshl_add_u32 v226, v226, 1, v229
    v_lshl_add_u32 v201, v226, 4, v230
    v_xor_b32 v226, 6, v228
    v_lshl_add_u32 v226, v226, 1, v229
    v_lshl_add_u32 v202, v226, 4, v230
    v_xor_b32 v226, 7, v228
    v_lshl_add_u32 v226, v226, 1, v229
    v_lshl_add_u32 v203, v226, 4, v230
    v_bfe_u32 v227, v222, 1, 3
    v_lshlrev_b32 v228, 7, v222
    v_add_u32 v228, s34, v228
    v_add_u32 v226, 0, v223
    v_xor_b32 v226, v226, v227
    v_lshl_add_u32 v210, v226, 4, v228
    v_add_u32 v212, 65536, v210
    v_add_u32 v226, 4, v223
    v_xor_b32 v226, v226, v227
    v_lshl_add_u32 v211, v226, 4, v228
    v_add_u32 v213, 65536, v211
    v_lshl_add_u32 v227, v223, 3, v224
    v_lshlrev_b32 v227, 8, v227
    v_add_u32 v227, 114688, v227
    v_xor_b32 v226, 0, v224
    v_lshl_add_u32 v226, v226, 2, v225
    v_lshl_add_u32 v214, v226, 4, v227
    v_xor_b32 v226, 1, v224
    v_lshl_add_u32 v226, v226, 2, v225
    v_lshl_add_u32 v215, v226, 4, v227
    v_xor_b32 v226, 2, v224
    v_lshl_add_u32 v226, v226, 2, v225
    v_lshl_add_u32 v216, v226, 4, v227
    v_xor_b32 v226, 3, v224
    v_lshl_add_u32 v226, v226, 2, v225
    v_lshl_add_u32 v217, v226, 4, v227
    v_add_u32 v226, 0, v223
    v_xor_b32 v226, v226, v222
    v_lshlrev_b32 v226, 4, v226
    v_lshl_add_u32 v204, v223, 8, v226
    v_add_u32 v226, 4, v223
    v_xor_b32 v226, v226, v222
    v_lshlrev_b32 v226, 4, v226
    v_lshl_add_u32 v205, v223, 8, v226
    v_add_u32 v226, 8, v223
    v_xor_b32 v226, v226, v222
    v_lshlrev_b32 v226, 4, v226
    v_lshl_add_u32 v206, v223, 8, v226
    v_add_u32 v226, 12, v223
    v_xor_b32 v226, v226, v222
    v_lshlrev_b32 v226, 4, v226
    v_lshl_add_u32 v207, v223, 8, v226
    v_add_u32 v226, 0, v223
    v_lshlrev_b32 v226, 1, v226
    v_xor_b32 v226, v226, v222
    v_lshlrev_b32 v226, 4, v226
    v_lshl_add_u32 v208, v223, 8, v226
    v_add_u32 v226, 4, v223
    v_lshlrev_b32 v226, 1, v226
    v_xor_b32 v226, v226, v222
    v_lshlrev_b32 v226, 4, v226
    v_lshl_add_u32 v209, v223, 8, v226
    s_lshl_b32 s51, s50, 7
    s_lshl_b32 s52, s50, 19
    s_add_u32 m0, s34, 49152
    s_add_u32 s46, s51, 0
    buffer_load_dwordx4 v218, s[16:19], s46 offen  lds
    s_add_u32 m0, s34, 50176
    s_add_u32 s46, s51, 9216
    buffer_load_dwordx4 v219, s[16:19], s46 offen  lds
    s_add_u32 m0, s34, 51200
    s_add_u32 s46, s51, 18432
    buffer_load_dwordx4 v218, s[16:19], s46 offen  lds
    s_add_u32 m0, s34, 52224
    s_add_u32 s46, s51, 27648
    buffer_load_dwordx4 v219, s[16:19], s46 offen  lds
    s_add_u32 m0, s34, 53248
    s_add_u32 s46, s51, 36864
    buffer_load_dwordx4 v218, s[16:19], s46 offen  lds
    s_add_u32 m0, s34, 54272
    s_add_u32 s46, s51, 46080
    buffer_load_dwordx4 v219, s[16:19], s46 offen  lds
    s_add_u32 s50, s50, 1
    s_cmp_eq_u32 s50, 9
    s_cselect_b32 s50, 0, s50
    s_add_u32 m0, s35, 131072
    s_add_u32 s46, s52, 0
    buffer_load_dwordx4 v220, s[20:23], s46 offen  lds
    s_add_u32 m0, s35, 132096
    s_add_u32 s46, s52, 32768
    buffer_load_dwordx4 v220, s[20:23], s46 offen  lds
    s_add_u32 m0, s35, 133120
    s_add_u32 s46, s52, 65536
    buffer_load_dwordx4 v220, s[20:23], s46 offen  lds
    s_add_u32 m0, s35, 134144
    s_add_u32 s46, s52, 98304
    buffer_load_dwordx4 v220, s[20:23], s46 offen  lds
    s_lshr_b32 s46, s2, 3
    s_lshl_b32 s46, s46, 2
    s_add_u32 s46, s46, s3
    s_mul_i32 s46, s46, 640
    v_lshlrev_b32 v234, 7, v221
    v_add_u32 v234, s46, v234
    v_min_u32 v234, L1_done-L1_pc, v234
    v_mov_b32 v237, s59
    v_add_co_u32 v236, vcc, s58, v234
    s_nop 1
    v_addc_co_u32 v237, vcc, 0, v237, vcc
    v_cmp_gt_u32 vcc, 5, v221
    s_and_saveexec_b64 s[48:49], vcc
    global_load_dword v235, v[236:237], off
    s_mov_b64 exec, s[48:49]
    s_waitcnt vmcnt(11)
    s_barrier
    ds_read_b128 a[64:67], v210 offset:16384
    ds_read_b64_tr_b16 a[0:1], v214 offset:0
    ds_read_b64_tr_b16 a[2:3], v214 offset:1024
    ds_read_b128 a[68:71], v210 offset:18432
    ds_read_b128 a[72:75], v210 offset:20480
    ds_read_b64_tr_b16 a[4:5], v214 offset:8
    ds_read_b64_tr_b16 a[6:7], v214 offset:1032
    ds_read_b64_tr_b16 a[8:9], v215 offset:0
    ds_read_b64_tr_b16 a[10:11], v215 offset:1024
    ds_read_b64_tr_b16 a[12:13], v215 offset:8
    ds_read_b64_tr_b16 a[14:15], v215 offset:1032
    ds_read_b64_tr_b16 a[16:17], v216 offset:0
    ds_read_b64_tr_b16 a[18:19], v216 offset:1024
    ds_read_b64_tr_b16 a[20:21], v216 offset:8
    ds_read_b64_tr_b16 a[22:23], v216 offset:1032
    ds_read_b64_tr_b16 a[24:25], v217 offset:0
    ds_read_b64_tr_b16 a[26:27], v217 offset:1024
    ds_read_b64_tr_b16 a[28:29], v217 offset:8
    ds_read_b64_tr_b16 a[30:31], v217 offset:1032
    s_waitcnt lgkmcnt(0)
    v_mfma_f32_16x16x32_bf16 v[0:3], a[0:3], a[64:67], 0
    s_lshl_b32 s51, s50, 7
    s_lshl_b32 s52, s50, 19
    ds_read_b128 a[80:83], v211 offset:16384
    ds_read_b64_tr_b16 a[32:33], v214 offset:8192
    v_mfma_f32_16x16x32_bf16 v[4:7], a[0:3], a[68:71], 0
    s_add_u32 m0, s34, 81920
    ds_read_b64_tr_b16 a[34:35], v214 offset:9216
    v_mfma_f32_16x16x32_bf16 v[8:11], a[0:3], a[72:75], 0
    s_add_u32 s46, s51, 0
    ds_read_b128 a[84:87], v211 offset:18432
    buffer_load_dwordx4 v218, s[16:19], s46 offen  lds
    v_mfma_f32_16x16x32_bf16 v[16:19], a[4:7], a[64:67], 0
    s_add_u32 m0, s34, 82944
    ds_read_b128 a[88:91], v211 offset:20480
    v_mfma_f32_16x16x32_bf16 v[20:23], a[4:7], a[68:71], 0
    s_add_u32 s46, s51, 9216
    ds_read_b64_tr_b16 a[36:37], v214 offset:8200
    buffer_load_dwordx4 v219, s[16:19], s46 offen  lds
    v_mfma_f32_16x16x32_bf16 v[24:27], a[4:7], a[72:75], 0
    s_add_u32 m0, s34, 83968
    ds_read_b64_tr_b16 a[38:39], v214 offset:9224
    v_mfma_f32_16x16x32_bf16 v[32:35], a[8:11], a[64:67], 0
    s_add_u32 s46, s51, 18432
    ds_read_b64_tr_b16 a[40:41], v215 offset:8192
    buffer_load_dwordx4 v218, s[16:19], s46 offen  lds
    v_mfma_f32_16x16x32_bf16 v[36:39], a[8:11], a[68:71], 0
    s_add_u32 m0, s34, 84992
    ds_read_b64_tr_b16 a[42:43], v215 offset:9216
    v_mfma_f32_16x16x32_bf16 v[40:43], a[8:11], a[72:75], 0
    s_add_u32 s46, s51, 27648
    ds_read_b64_tr_b16 a[44:45], v215 offset:8200
    buffer_load_dwordx4 v219, s[16:19], s46 offen  lds
    v_mfma_f32_16x16x32_bf16 v[48:51], a[12:15], a[64:67], 0
    s_add_u32 m0, s34, 86016
    ds_read_b64_tr_b16 a[46:47], v215 offset:9224
    v_mfma_f32_16x16x32_bf16 v[52:55], a[12:15], a[68:71], 0
    s_add_u32 s46, s51, 36864
    ds_read_b64_tr_b16 a[48:49], v216 offset:8192
    buffer_load_dwordx4 v218, s[16:19], s46 offen  lds
    v_mfma_f32_16x16x32_bf16 v[56:59], a[12:15], a[72:75], 0
    ds_read_b64_tr_b16 a[50:51], v216 offset:9216
    v_mfma_f32_16x16x32_bf16 v[64:67], a[16:19], a[64:67], 0
    s_add_u32 m0, s34, 87040
    ds_read_b64_tr_b16 a[52:53], v216 offset:8200
    v_mfma_f32_16x16x32_bf16 v[68:71], a[16:19], a[68:71], 0
    s_add_u32 s46, s51, 46080
    ds_read_b64_tr_b16 a[54:55], v216 offset:9224
    buffer_load_dwordx4 v219, s[16:19], s46 offen  lds
    v_mfma_f32_16x16x32_bf16 v[72:75], a[16:19], a[72:75], 0
    s_add_u32 s50, s50, 1
    s_cmp_eq_u32 s50, 9
    s_cselect_b32 s50, 0, s50
    s_add_u32 m0, s35, 147456
    ds_read_b64_tr_b16 a[56:57], v217 offset:8192
    v_mfma_f32_16x16x32_bf16 v[80:83], a[20:23], a[64:67], 0
    s_add_u32 s46, s52, 0
    ds_read_b64_tr_b16 a[58:59], v217 offset:9216
    buffer_load_dwordx4 v220, s[20:23], s46 offen  lds
    v_mfma_f32_16x16x32_bf16 v[84:87], a[20:23], a[68:71], 0
    s_add_u32 m0, s35, 148480
    ds_read_b64_tr_b16 a[60:61], v217 offset:8200
    v_mfma_f32_16x16x32_bf16 v[88:91], a[20:23], a[72:75], 0
    s_add_u32 s46, s52, 32768
    ds_read_b64_tr_b16 a[62:63], v217 offset:9224
    buffer_load_dwordx4 v220, s[20:23], s46 offen  lds
    v_mfma_f32_16x16x32_bf16 v[96:99], a[24:27], a[64:67], 0
    s_add_u32 m0, s35, 149504
    v_mfma_f32_16x16x32_bf16 v[100:103], a[24:27], a[68:71], 0
    s_add_u32 s46, s52, 65536
    buffer_load_dwordx4 v220, s[20:23], s46 offen  lds
    v_mfma_f32_16x16x32_bf16 v[104:107], a[24:27], a[72:75], 0
    s_add_u32 m0, s35, 150528
    v_mfma_f32_16x16x32_bf16 v[112:115], a[28:31], a[64:67], 0
    s_add_u32 s46, s52, 98304
    buffer_load_dwordx4 v220, s[20:23], s46 offen  lds
    v_mfma_f32_16x16x32_bf16 v[116:119], a[28:31], a[68:71], 0
    v_mfma_f32_16x16x32_bf16 v[120:123], a[28:31], a[72:75], 0
    s_waitcnt lgkmcnt(0)
    s_waitcnt vmcnt(11)
    s_barrier
    v_mfma_f32_16x16x32_bf16 v[0:3], a[32:35], a[80:83], v[0:3]
    ds_read_b128 a[64:67], v210 offset:49152
    ds_read_b64_tr_b16 a[0:1], v214 offset:16384
    v_mfma_f32_16x16x32_bf16 v[4:7], a[32:35], a[84:87], v[4:7]
    s_mov_b32 s47, 0
    ds_read_b64_tr_b16 a[2:3], v214 offset:17408
    v_mfma_f32_16x16x32_bf16 v[8:11], a[32:35], a[88:91], v[8:11]
    s_mov_b32 m0, 0
    s_nop 0
    ds_read_b128 a[68:71], v210 offset:51200
    buffer_load_dwordx4 v204, s[8:11], s47 offen nt lds
    v_mfma_f32_16x16x32_bf16 v[16:19], a[36:39], a[80:83], v[16:19]
    ds_read_b128 a[72:75], v210 offset:53248
    v_mfma_f32_16x16x32_bf16 v[20:23], a[36:39], a[84:87], v[20:23]
    ds_read_b64_tr_b16 a[4:5], v214 offset:16392
    buffer_load_dwordx4 v205, s[8:11], s47 offen offset:1024 nt lds
    v_mfma_f32_16x16x32_bf16 v[24:27], a[36:39], a[88:91], v[24:27]
    ds_read_b64_tr_b16 a[6:7], v214 offset:17416
    v_mfma_f32_16x16x32_bf16 v[32:35], a[40:43], a[80:83], v[32:35]
    ds_read_b64_tr_b16 a[8:9], v215 offset:16384
    buffer_load_dwordx4 v206, s[8:11], s47 offen offset:2048 nt lds
    v_mfma_f32_16x16x32_bf16 v[36:39], a[40:43], a[84:87], v[36:39]
    ds_read_b64_tr_b16 a[10:11], v215 offset:17408
    v_mfma_f32_16x16x32_bf16 v[40:43], a[40:43], a[88:91], v[40:43]
    ds_read_b64_tr_b16 a[12:13], v215 offset:16392
    buffer_load_dwordx4 v207, s[8:11], s47 offen offset:3072 nt lds
    v_mfma_f32_16x16x32_bf16 v[48:51], a[44:47], a[80:83], v[48:51]
    s_mov_b32 s47, 4096
    ds_read_b64_tr_b16 a[14:15], v215 offset:17416
    v_mfma_f32_16x16x32_bf16 v[52:55], a[44:47], a[84:87], v[52:55]
    s_mov_b32 m0, 4096
    s_nop 0
    ds_read_b64_tr_b16 a[16:17], v216 offset:16384
    buffer_load_dwordx4 v204, s[8:11], s47 offen nt lds
    v_mfma_f32_16x16x32_bf16 v[56:59], a[44:47], a[88:91], v[56:59]
    ds_read_b64_tr_b16 a[18:19], v216 offset:17408
    v_mfma_f32_16x16x32_bf16 v[64:67], a[48:51], a[80:83], v[64:67]
    ds_read_b64_tr_b16 a[20:21], v216 offset:16392
    v_mfma_f32_16x16x32_bf16 v[68:71], a[48:51], a[84:87], v[68:71]
    ds_read_b64_tr_b16 a[22:23], v216 offset:17416
    buffer_load_dwordx4 v205, s[8:11], s47 offen offset:1024 nt lds
    v_mfma_f32_16x16x32_bf16 v[72:75], a[48:51], a[88:91], v[72:75]
    ds_read_b64_tr_b16 a[24:25], v217 offset:16384
    v_mfma_f32_16x16x32_bf16 v[80:83], a[52:55], a[80:83], v[80:83]
    ds_read_b64_tr_b16 a[26:27], v217 offset:17408
    buffer_load_dwordx4 v206, s[8:11], s47 offen offset:2048 nt lds
    v_mfma_f32_16x16x32_bf16 v[84:87], a[52:55], a[84:87], v[84:87]
    ds_read_b64_tr_b16 a[28:29], v217 offset:16392
    v_mfma_f32_16x16x32_bf16 v[88:91], a[52:55], a[88:91], v[88:91]
    ds_read_b64_tr_b16 a[30:31], v217 offset:17416
    buffer_load_dwordx4 v207, s[8:11], s47 offen offset:3072 nt lds
    v_mfma_f32_16x16x32_bf16 v[96:99], a[56:59], a[80:83], v[96:99]
    s_mov_b32 s47, 8192
    v_mfma_f32_16x16x32_bf16 v[100:103], a[56:59], a[84:87], v[100:103]
    s_mov_b32 m0, 8192
    s_nop 0
    buffer_load_dwordx4 v204, s[8:11], s47 offen nt lds
    v_mfma_f32_16x16x32_bf16 v[104:107], a[56:59], a[88:91], v[104:107]
    v_mfma_f32_16x16x32_bf16 v[112:115], a[60:63], a[80:83], v[112:115]
    buffer_load_dwordx4 v205, s[8:11], s47 offen offset:1024 nt lds
    v_mfma_f32_16x16x32_bf16 v[116:119], a[60:63], a[84:87], v[116:119]
    v_mfma_f32_16x16x32_bf16 v[120:123], a[60:63], a[88:91], v[120:123]
    s_waitcnt lgkmcnt(0)
    v_mfma_f32_16x16x32_bf16 v[0:3], a[0:3], a[64:67], v[0:3]
    ds_read_b128 a[80:83], v211 offset:49152
    ds_read_b64_tr_b16 a[32:33], v214 offset:24576
    v_mfma_f32_16x16x32_bf16 v[4:7], a[0:3], a[68:71], v[4:7]
    ds_read_b64_tr_b16 a[34:35], v214 offset:25600
    v_mfma_f32_16x16x32_bf16 v[8:11], a[0:3], a[72:75], v[8:11]
    ds_read_b128 a[84:87], v211 offset:51200
    buffer_load_dwordx4 v206, s[8:11], s47 offen offset:2048 nt lds
    v_mfma_f32_16x16x32_bf16 v[16:19], a[4:7], a[64:67], v[16:19]
    ds_read_b128 a[88:91], v211 offset:53248
    v_mfma_f32_16x16x32_bf16 v[20:23], a[4:7], a[68:71], v[20:23]
    ds_read_b64_tr_b16 a[36:37], v214 offset:24584
    buffer_load_dwordx4 v207, s[8:11], s47 offen offset:3072 nt lds
    v_mfma_f32_16x16x32_bf16 v[24:27], a[4:7], a[72:75], v[24:27]
    s_mov_b32 s47, 12288
    ds_read_b64_tr_b16 a[38:39], v214 offset:25608
    v_mfma_f32_16x16x32_bf16 v[32:35], a[8:11], a[64:67], v[32:35]
    s_mov_b32 m0, 12288
    s_nop 0
    ds_read_b64_tr_b16 a[40:41], v215 offset:24576
    buffer_load_dwordx4 v204, s[8:11], s47 offen nt lds
    v_mfma_f32_16x16x32_bf16 v[36:39], a[8:11], a[68:71], v[36:39]
    ds_read_b64_tr_b16 a[42:43], v215 offset:25600
    v_mfma_f32_16x16x32_bf16 v[40:43], a[8:11], a[72:75], v[40:43]
    ds_read_b64_tr_b16 a[44:45], v215 offset:24584
    buffer_load_dwordx4 v205, s[8:11], s47 offen offset:1024 nt lds
    v_mfma_f32_16x16x32_bf16 v[48:51], a[12:15], a[64:67], v[48:51]
    ds_read_b64_tr_b16 a[46:47], v215 offset:25608
    v_mfma_f32_16x16x32_bf16 v[52:55], a[12:15], a[68:71], v[52:55]
    ds_read_b64_tr_b16 a[48:49], v216 offset:24576
    buffer_load_dwordx4 v206, s[8:11], s47 offen offset:2048 nt lds
    v_mfma_f32_16x16x32_bf16 v[56:59], a[12:15], a[72:75], v[56:59]
    ds_read_b64_tr_b16 a[50:51], v216 offset:25600
    v_mfma_f32_16x16x32_bf16 v[64:67], a[16:19], a[64:67], v[64:67]
    ds_read_b64_tr_b16 a[52:53], v216 offset:24584
    v_mfma_f32_16x16x32_bf16 v[68:71], a[16:19], a[68:71], v[68:71]
    ds_read_b64_tr_b16 a[54:55], v216 offset:25608
    buffer_load_dwordx4 v207, s[8:11], s47 offen offset:3072 nt lds
    v_mfma_f32_16x16x32_bf16 v[72:75], a[16:19], a[72:75], v[72:75]
    s_lshl_b32 s51, s50, 7
    s_lshl_b32 s52, s50, 19
    s_add_u32 m0, s34, 16384
    ds_read_b64_tr_b16 a[56:57], v217 offset:24576
    v_mfma_f32_16x16x32_bf16 v[80:83], a[20:23], a[64:67], v[80:83]
    s_add_u32 s46, s51, 0
    ds_read_b64_tr_b16 a[58:59], v217 offset:25600
    buffer_load_dwordx4 v218, s[16:19], s46 offen  lds
    v_mfma_f32_16x16x32_bf16 v[84:87], a[20:23], a[68:71], v[84:87]
    s_add_u32 m0, s34, 17408
    ds_read_b64_tr_b16 a[60:61], v217 offset:24584
    v_mfma_f32_16x16x32_bf16 v[88:91], a[20:23], a[72:75], v[88:91]
    s_add_u32 s46, s51, 9216
    ds_read_b64_tr_b16 a[62:63], v217 offset:25608
    buffer_load_dwordx4 v219, s[16:19], s46 offen  lds
    v_mfma_f32_16x16x32_bf16 v[96:99], a[24:27], a[64:67], v[96:99]
    s_add_u32 m0, s34, 18432
    v_mfma_f32_16x16x32_bf16 v[100:103], a[24:27], a[68:71], v[100:103]
    s_add_u32 s46, s51, 18432
    buffer_load_dwordx4 v218, s[16:19], s46 offen  lds
    v_mfma_f32_16x16x32_bf16 v[104:107], a[24:27], a[72:75], v[104:107]
    s_add_u32 m0, s34, 19456
    v_mfma_f32_16x16x32_bf16 v[112:115], a[28:31], a[64:67], v[112:115]
    s_add_u32 s46, s51, 27648
    buffer_load_dwordx4 v219, s[16:19], s46 offen  lds
    v_mfma_f32_16x16x32_bf16 v[116:119], a[28:31], a[68:71], v[116:119]
    v_mfma_f32_16x16x32_bf16 v[120:123], a[28:31], a[72:75], v[120:123]
    s_waitcnt lgkmcnt(0)
    s_waitcnt vmcnt(20)
    s_barrier
    v_mfma_f32_16x16x32_bf16 v[0:3], a[32:35], a[80:83], v[0:3]
    ds_read_b128 a[64:67], v212 offset:16384
    ds_read_b64_tr_b16 a[0:1], v214 offset:32768
    v_mfma_f32_16x16x32_bf16 v[4:7], a[32:35], a[84:87], v[4:7]
    s_add_u32 m0, s34, 20480
    ds_read_b64_tr_b16 a[2:3], v214 offset:33792
    v_mfma_f32_16x16x32_bf16 v[8:11], a[32:35], a[88:91], v[8:11]
    s_add_u32 s46, s51, 36864
    ds_read_b128 a[68:71], v212 offset:18432
    buffer_load_dwordx4 v218, s[16:19], s46 offen  lds
    v_mfma_f32_16x16x32_bf16 v[16:19], a[36:39], a[80:83], v[16:19]
    s_add_u32 m0, s34, 21504
    ds_read_b128 a[72:75], v212 offset:20480
    v_mfma_f32_16x16x32_bf16 v[20:23], a[36:39], a[84:87], v[20:23]
    s_add_u32 s46, s51, 46080
    ds_read_b64_tr_b16 a[4:5], v214 offset:32776
    buffer_load_dwordx4 v219, s[16:19], s46 offen  lds
    v_mfma_f32_16x16x32_bf16 v[24:27], a[36:39], a[88:91], v[24:27]
    s_add_u32 s50, s50, 1
    s_cmp_eq_u32 s50, 9
    s_cselect_b32 s50, 0, s50
    s_add_u32 m0, s35, 114688
    ds_read_b64_tr_b16 a[6:7], v214 offset:33800
    v_mfma_f32_16x16x32_bf16 v[32:35], a[40:43], a[80:83], v[32:35]
    s_add_u32 s46, s52, 0
    ds_read_b64_tr_b16 a[8:9], v215 offset:32768
    buffer_load_dwordx4 v220, s[20:23], s46 offen  lds
    v_mfma_f32_16x16x32_bf16 v[36:39], a[40:43], a[84:87], v[36:39]
    s_add_u32 m0, s35, 115712
    ds_read_b64_tr_b16 a[10:11], v215 offset:33792
    v_mfma_f32_16x16x32_bf16 v[40:43], a[40:43], a[88:91], v[40:43]
    s_add_u32 s46, s52, 32768
    ds_read_b64_tr_b16 a[12:13], v215 offset:32776
    buffer_load_dwordx4 v220, s[20:23], s46 offen  lds
    v_mfma_f32_16x16x32_bf16 v[48:51], a[44:47], a[80:83], v[48:51]
    s_add_u32 m0, s35, 116736
    ds_read_b64_tr_b16 a[14:15], v215 offset:33800
    v_mfma_f32_16x16x32_bf16 v[52:55], a[44:47], a[84:87], v[52:55]
    s_add_u32 s46, s52, 65536
    ds_read_b64_tr_b16 a[16:17], v216 offset:32768
    buffer_load_dwordx4 v220, s[20:23], s46 offen  lds
    v_mfma_f32_16x16x32_bf16 v[56:59], a[44:47], a[88:91], v[56:59]
    ds_read_b64_tr_b16 a[18:19], v216 offset:33792
    v_mfma_f32_16x16x32_bf16 v[64:67], a[48:51], a[80:83], v[64:67]
    s_add_u32 m0, s35, 117760
    ds_read_b64_tr_b16 a[20:21], v216 offset:32776
    v_mfma_f32_16x16x32_bf16 v[68:71], a[48:51], a[84:87], v[68:71]
    s_add_u32 s46, s52, 98304
    ds_read_b64_tr_b16 a[22:23], v216 offset:33800
    buffer_load_dwordx4 v220, s[20:23], s46 offen  lds
    v_mfma_f32_16x16x32_bf16 v[72:75], a[48:51], a[88:91], v[72:75]
    s_lshl_b32 s51, s50, 7
    s_lshl_b32 s52, s50, 19
    s_add_u32 m0, s34, 49152
    ds_read_b64_tr_b16 a[24:25], v217 offset:32768
    v_mfma_f32_16x16x32_bf16 v[80:83], a[52:55], a[80:83], v[80:83]
    s_add_u32 s46, s51, 0
    ds_read_b64_tr_b16 a[26:27], v217 offset:33792
    buffer_load_dwordx4 v218, s[16:19], s46 offen  lds
    v_mfma_f32_16x16x32_bf16 v[84:87], a[52:55], a[84:87], v[84:87]
    s_add_u32 m0, s34, 50176
    ds_read_b64_tr_b16 a[28:29], v217 offset:32776
    v_mfma_f32_16x16x32_bf16 v[88:91], a[52:55], a[88:91], v[88:91]
    s_add_u32 s46, s51, 9216
    ds_read_b64_tr_b16 a[30:31], v217 offset:33800
    buffer_load_dwordx4 v219, s[16:19], s46 offen  lds
    v_mfma_f32_16x16x32_bf16 v[96:99], a[56:59], a[80:83], v[96:99]
    s_add_u32 m0, s34, 51200
    v_mfma_f32_16x16x32_bf16 v[100:103], a[56:59], a[84:87], v[100:103]
    s_add_u32 s46, s51, 18432
    buffer_load_dwordx4 v218, s[16:19], s46 offen  lds
    v_mfma_f32_16x16x32_bf16 v[104:107], a[56:59], a[88:91], v[104:107]
    s_add_u32 m0, s34, 52224
    v_mfma_f32_16x16x32_bf16 v[112:115], a[60:63], a[80:83], v[112:115]
    s_add_u32 s46, s51, 27648
    buffer_load_dwordx4 v219, s[16:19], s46 offen  lds
    v_mfma_f32_16x16x32_bf16 v[116:119], a[60:63], a[84:87], v[116:119]
    v_mfma_f32_16x16x32_bf16 v[120:123], a[60:63], a[88:91], v[120:123]
    s_waitcnt lgkmcnt(0)
    v_mfma_f32_16x16x32_bf16 v[0:3], a[0:3], a[64:67], v[0:3]
    ds_read_b128 a[80:83], v213 offset:16384
    ds_read_b64_tr_b16 a[32:33], v214 offset:40960
    v_mfma_f32_16x16x32_bf16 v[4:7], a[0:3], a[68:71], v[4:7]
    s_add_u32 m0, s34, 53248
    ds_read_b64_tr_b16 a[34:35], v214 offset:41984
    v_mfma_f32_16x16x32_bf16 v[8:11], a[0:3], a[72:75], v[8:11]
    s_add_u32 s46, s51, 36864
    ds_read_b128 a[84:87], v213 offset:18432
    buffer_load_dwordx4 v218, s[16:19], s46 offen  lds
    v_mfma_f32_16x16x32_bf16 v[16:19], a[4:7], a[64:67], v[16:19]
    s_add_u32 m0, s34, 54272
    ds_read_b128 a[88:91], v213 offset:20480
    v_mfma_f32_16x16x32_bf16 v[20:23], a[4:7], a[68:71], v[20:23]
    s_add_u32 s46, s51, 46080
    ds_read_b64_tr_b16 a[36:37], v214 offset:40968
    buffer_load_dwordx4 v219, s[16:19], s46 offen  lds
    v_mfma_f32_16x16x32_bf16 v[24:27], a[4:7], a[72:75], v[24:27]
    s_add_u32 s50, s50, 1
    s_cmp_eq_u32 s50, 9
    s_cselect_b32 s50, 0, s50
    s_add_u32 m0, s35, 131072
    ds_read_b64_tr_b16 a[38:39], v214 offset:41992
    v_mfma_f32_16x16x32_bf16 v[32:35], a[8:11], a[64:67], v[32:35]
    s_add_u32 s46, s52, 0
    ds_read_b64_tr_b16 a[40:41], v215 offset:40960
    buffer_load_dwordx4 v220, s[20:23], s46 offen  lds
    v_mfma_f32_16x16x32_bf16 v[36:39], a[8:11], a[68:71], v[36:39]
    s_add_u32 m0, s35, 132096
    ds_read_b64_tr_b16 a[42:43], v215 offset:41984
    v_mfma_f32_16x16x32_bf16 v[40:43], a[8:11], a[72:75], v[40:43]
    s_add_u32 s46, s52, 32768
    ds_read_b64_tr_b16 a[44:45], v215 offset:40968
    buffer_load_dwordx4 v220, s[20:23], s46 offen  lds
    v_mfma_f32_16x16x32_bf16 v[48:51], a[12:15], a[64:67], v[48:51]
    s_add_u32 m0, s35, 133120
    ds_read_b64_tr_b16 a[46:47], v215 offset:41992
    v_mfma_f32_16x16x32_bf16 v[52:55], a[12:15], a[68:71], v[52:55]
    s_add_u32 s46, s52, 65536
    ds_read_b64_tr_b16 a[48:49], v216 offset:40960
    buffer_load_dwordx4 v220, s[20:23], s46 offen  lds
    v_mfma_f32_16x16x32_bf16 v[56:59], a[12:15], a[72:75], v[56:59]
    ds_read_b64_tr_b16 a[50:51], v216 offset:41984
    v_mfma_f32_16x16x32_bf16 v[64:67], a[16:19], a[64:67], v[64:67]
    s_add_u32 m0, s35, 134144
    ds_read_b64_tr_b16 a[52:53], v216 offset:40968
    v_mfma_f32_16x16x32_bf16 v[68:71], a[16:19], a[68:71], v[68:71]
    s_add_u32 s46, s52, 98304
    ds_read_b64_tr_b16 a[54:55], v216 offset:41992
    buffer_load_dwordx4 v220, s[20:23], s46 offen  lds
    v_mfma_f32_16x16x32_bf16 v[72:75], a[16:19], a[72:75], v[72:75]
    ds_read_b64_tr_b16 a[56:57], v217 offset:40960
    v_mfma_f32_16x16x32_bf16 v[80:83], a[20:23], a[64:67], v[80:83]
    ds_read_b64_tr_b16 a[58:59], v217 offset:41984
    v_mfma_f32_16x16x32_bf16 v[84:87], a[20:23], a[68:71], v[84:87]
    ds_read_b64_tr_b16 a[60:61], v217 offset:40968
    v_mfma_f32_16x16x32_bf16 v[88:91], a[20:23], a[72:75], v[88:91]
    ds_read_b64_tr_b16 a[62:63], v217 offset:41992
    v_mfma_f32_16x16x32_bf16 v[96:99], a[24:27], a[64:67], v[96:99]
    v_mfma_f32_16x16x32_bf16 v[100:103], a[24:27], a[68:71], v[100:103]
    v_mfma_f32_16x16x32_bf16 v[104:107], a[24:27], a[72:75], v[104:107]
    v_mfma_f32_16x16x32_bf16 v[112:115], a[28:31], a[64:67], v[112:115]
    v_mfma_f32_16x16x32_bf16 v[116:119], a[28:31], a[68:71], v[116:119]
    v_mfma_f32_16x16x32_bf16 v[120:123], a[28:31], a[72:75], v[120:123]
    s_waitcnt lgkmcnt(0)
    s_waitcnt vmcnt(10)
    s_barrier
    v_mfma_f32_16x16x32_bf16 v[0:3], a[32:35], a[80:83], v[0:3]
    s_lshl_b32 s51, s50, 7
    s_lshl_b32 s52, s50, 19
    ds_read_b128 a[64:67], v210 offset:16384
    ds_read_b64_tr_b16 a[0:1], v214 offset:0
    v_mfma_f32_16x16x32_bf16 v[4:7], a[32:35], a[84:87], v[4:7]
    s_add_u32 m0, s34, 81920
    ds_read_b64_tr_b16 a[2:3], v214 offset:1024
    v_mfma_f32_16x16x32_bf16 v[8:11], a[32:35], a[88:91], v[8:11]
    s_add_u32 s46, s51, 0
    ds_read_b128 a[68:71], v210 offset:18432
    buffer_load_dwordx4 v218, s[16:19], s46 offen  lds
    v_mfma_f32_16x16x32_bf16 v[16:19], a[36:39], a[80:83], v[16:19]
    s_add_u32 m0, s34, 82944
    ds_read_b128 a[72:75], v210 offset:20480
    v_mfma_f32_16x16x32_bf16 v[20:23], a[36:39], a[84:87], v[20:23]
    s_add_u32 s46, s51, 9216
    ds_read_b64_tr_b16 a[4:5], v214 offset:8
    buffer_load_dwordx4 v219, s[16:19], s46 offen  lds
    v_mfma_f32_16x16x32_bf16 v[24:27], a[36:39], a[88:91], v[24:27]
    s_add_u32 m0, s34, 83968
    ds_read_b64_tr_b16 a[6:7], v214 offset:1032
    v_mfma_f32_16x16x32_bf16 v[32:35], a[40:43], a[80:83], v[32:35]
    s_add_u32 s46, s51, 18432
    ds_read_b64_tr_b16 a[8:9], v215 offset:0
    buffer_load_dwordx4 v218, s[16:19], s46 offen  lds
    v_mfma_f32_16x16x32_bf16 v[36:39], a[40:43], a[84:87], v[36:39]
    s_add_u32 m0, s34, 84992
    ds_read_b64_tr_b16 a[10:11], v215 offset:1024
    v_mfma_f32_16x16x32_bf16 v[40:43], a[40:43], a[88:91], v[40:43]
    s_add_u32 s46, s51, 27648
    ds_read_b64_tr_b16 a[12:13], v215 offset:8
    buffer_load_dwordx4 v219, s[16:19], s46 offen  lds
    v_mfma_f32_16x16x32_bf16 v[48:51], a[44:47], a[80:83], v[48:51]
    s_add_u32 m0, s34, 86016
    ds_read_b64_tr_b16 a[14:15], v215 offset:1032
    v_mfma_f32_16x16x32_bf16 v[52:55], a[44:47], a[84:87], v[52:55]
    s_add_u32 s46, s51, 36864
    ds_read_b64_tr_b16 a[16:17], v216 offset:0
    buffer_load_dwordx4 v218, s[16:19], s46 offen  lds
    v_mfma_f32_16x16x32_bf16 v[56:59], a[44:47], a[88:91], v[56:59]
    ds_read_b64_tr_b16 a[18:19], v216 offset:1024
    v_mfma_f32_16x16x32_bf16 v[64:67], a[48:51], a[80:83], v[64:67]
    s_add_u32 m0, s34, 87040
    ds_read_b64_tr_b16 a[20:21], v216 offset:8
    v_mfma_f32_16x16x32_bf16 v[68:71], a[48:51], a[84:87], v[68:71]
    s_add_u32 s46, s51, 46080
    ds_read_b64_tr_b16 a[22:23], v216 offset:1032
    buffer_load_dwordx4 v219, s[16:19], s46 offen  lds
    v_mfma_f32_16x16x32_bf16 v[72:75], a[48:51], a[88:91], v[72:75]
    s_add_u32 s50, s50, 1
    s_cmp_eq_u32 s50, 9
    s_cselect_b32 s50, 0, s50
    s_add_u32 m0, s35, 147456
    ds_read_b64_tr_b16 a[24:25], v217 offset:0
    v_mfma_f32_16x16x32_bf16 v[80:83], a[52:55], a[80:83], v[80:83]
    s_add_u32 s46, s52, 0
    ds_read_b64_tr_b16 a[26:27], v217 offset:1024
    buffer_load_dwordx4 v220, s[20:23], s46 offen  lds
    v_mfma_f32_16x16x32_bf16 v[84:87], a[52:55], a[84:87], v[84:87]
    s_add_u32 m0, s35, 148480
    ds_read_b64_tr_b16 a[28:29], v217 offset:8
    v_mfma_f32_16x16x32_bf16 v[88:91], a[52:55], a[88:91], v[88:91]
    s_add_u32 s46, s52, 32768
    ds_read_b64_tr_b16 a[30:31], v217 offset:1032
    buffer_load_dwordx4 v220, s[20:23], s46 offen  lds
    v_mfma_f32_16x16x32_bf16 v[96:99], a[56:59], a[80:83], v[96:99]
    s_add_u32 m0, s35, 149504
    v_mfma_f32_16x16x32_bf16 v[100:103], a[56:59], a[84:87], v[100:103]
    s_add_u32 s46, s52, 65536
    buffer_load_dwordx4 v220, s[20:23], s46 offen  lds
    v_mfma_f32_16x16x32_bf16 v[104:107], a[56:59], a[88:91], v[104:107]
    s_add_u32 m0, s35, 150528
    v_mfma_f32_16x16x32_bf16 v[112:115], a[60:63], a[80:83], v[112:115]
    s_add_u32 s46, s52, 98304
    buffer_load_dwordx4 v220, s[20:23], s46 offen  lds
    v_mfma_f32_16x16x32_bf16 v[116:119], a[60:63], a[84:87], v[116:119]
    v_mfma_f32_16x16x32_bf16 v[120:123], a[60:63], a[88:91], v[120:123]
    s_waitcnt lgkmcnt(0)
    v_mfma_f32_16x16x32_bf16 v[0:3], a[0:3], a[64:67], v[0:3]
    ds_read_b128 a[80:83], v211 offset:16384
    ds_read_b64_tr_b16 a[32:33], v214 offset:8192
    v_mfma_f32_16x16x32_bf16 v[4:7], a[0:3], a[68:71], v[4:7]
    ds_read_b64_tr_b16 a[34:35], v214 offset:9216
    v_mfma_f32_16x16x32_bf16 v[8:11], a[0:3], a[72:75], v[8:11]
    ds_read_b128 a[84:87], v211 offset:18432
    v_mfma_f32_16x16x32_bf16 v[16:19], a[4:7], a[64:67], v[16:19]
    ds_read_b128 a[88:91], v211 offset:20480
    v_mfma_f32_16x16x32_bf16 v[20:23], a[4:7], a[68:71], v[20:23]
    ds_read_b64_tr_b16 a[36:37], v214 offset:8200
    v_mfma_f32_16x16x32_bf16 v[24:27], a[4:7], a[72:75], v[24:27]
    ds_read_b64_tr_b16 a[38:39], v214 offset:9224
    v_mfma_f32_16x16x32_bf16 v[32:35], a[8:11], a[64:67], v[32:35]
    ds_read_b64_tr_b16 a[40:41], v215 offset:8192
    v_mfma_f32_16x16x32_bf16 v[36:39], a[8:11], a[68:71], v[36:39]
    ds_read_b64_tr_b16 a[42:43], v215 offset:9216
    v_mfma_f32_16x16x32_bf16 v[40:43], a[8:11], a[72:75], v[40:43]
    ds_read_b64_tr_b16 a[44:45], v215 offset:8200
    v_mfma_f32_16x16x32_bf16 v[48:51], a[12:15], a[64:67], v[48:51]
    ds_read_b64_tr_b16 a[46:47], v215 offset:9224
    v_mfma_f32_16x16x32_bf16 v[52:55], a[12:15], a[68:71], v[52:55]
    ds_read_b64_tr_b16 a[48:49], v216 offset:8192
    v_mfma_f32_16x16x32_bf16 v[56:59], a[12:15], a[72:75], v[56:59]
    ds_read_b64_tr_b16 a[50:51], v216 offset:9216
    v_mfma_f32_16x16x32_bf16 v[64:67], a[16:19], a[64:67], v[64:67]
    ds_read_b64_tr_b16 a[52:53], v216 offset:8200
    v_mfma_f32_16x16x32_bf16 v[68:71], a[16:19], a[68:71], v[68:71]
    ds_read_b64_tr_b16 a[54:55], v216 offset:9224
    v_mfma_f32_16x16x32_bf16 v[72:75], a[16:19], a[72:75], v[72:75]
    ds_read_b64_tr_b16 a[56:57], v217 offset:8192
    v_mfma_f32_16x16x32_bf16 v[80:83], a[20:23], a[64:67], v[80:83]
    ds_read_b64_tr_b16 a[58:59], v217 offset:9216
    v_mfma_f32_16x16x32_bf16 v[84:87], a[20:23], a[68:71], v[84:87]
    ds_read_b64_tr_b16 a[60:61], v217 offset:8200
    v_mfma_f32_16x16x32_bf16 v[88:91], a[20:23], a[72:75], v[88:91]
    ds_read_b64_tr_b16 a[62:63], v217 offset:9224
    v_mfma_f32_16x16x32_bf16 v[96:99], a[24:27], a[64:67], v[96:99]
    v_mfma_f32_16x16x32_bf16 v[100:103], a[24:27], a[68:71], v[100:103]
    v_mfma_f32_16x16x32_bf16 v[104:107], a[24:27], a[72:75], v[104:107]
    v_mfma_f32_16x16x32_bf16 v[112:115], a[28:31], a[64:67], v[112:115]
    v_mfma_f32_16x16x32_bf16 v[116:119], a[28:31], a[68:71], v[116:119]
    v_mfma_f32_16x16x32_bf16 v[120:123], a[28:31], a[72:75], v[120:123]
    s_waitcnt lgkmcnt(0)
    s_waitcnt vmcnt(10)
    s_barrier
    v_mfma_f32_16x16x32_bf16 v[0:3], a[32:35], a[80:83], v[0:3]
    s_lshl_b32 s51, s50, 7
    s_lshl_b32 s52, s50, 19
    ds_read_b128 a[64:67], v210 offset:49152
    ds_read_b64_tr_b16 a[0:1], v214 offset:16384
    v_mfma_f32_16x16x32_bf16 v[4:7], a[32:35], a[84:87], v[4:7]
    s_add_u32 m0, s34, 16384
    ds_read_b64_tr_b16 a[2:3], v214 offset:17408
    v_mfma_f32_16x16x32_bf16 v[8:11], a[32:35], a[88:91], v[8:11]
    s_add_u32 s46, s51, 0
    ds_read_b128 a[68:71], v210 offset:51200
    buffer_load_dwordx4 v218, s[16:19], s46 offen  lds
    v_mfma_f32_16x16x32_bf16 v[16:19], a[36:39], a[80:83], v[16:19]
    s_add_u32 m0, s34, 17408
    ds_read_b128 a[72:75], v210 offset:53248
    v_mfma_f32_16x16x32_bf16 v[20:23], a[36:39], a[84:87], v[20:23]
    s_add_u32 s46, s51, 9216
    ds_read_b64_tr_b16 a[4:5], v214 offset:16392
    buffer_load_dwordx4 v219, s[16:19], s46 offen  lds
    v_mfma_f32_16x16x32_bf16 v[24:27], a[36:39], a[88:91], v[24:27]
    s_add_u32 m0, s34, 18432
    ds_read_b64_tr_b16 a[6:7], v214 offset:17416
    v_mfma_f32_16x16x32_bf16 v[32:35], a[40:43], a[80:83], v[32:35]
    s_add_u32 s46, s51, 18432
    ds_read_b64_tr_b16 a[8:9], v215 offset:16384
    buffer_load_dwordx4 v218, s[16:19], s46 offen  lds
    v_mfma_f32_16x16x32_bf16 v[36:39], a[40:43], a[84:87], v[36:39]
    s_add_u32 m0, s34, 19456
    ds_read_b64_tr_b16 a[10:11], v215 offset:17408
    v_mfma_f32_16x16x32_bf16 v[40:43], a[40:43], a[88:91], v[40:43]
    s_add_u32 s46, s51, 27648
    ds_read_b64_tr_b16 a[12:13], v215 offset:16392
    buffer_load_dwordx4 v219, s[16:19], s46 offen  lds
    v_mfma_f32_16x16x32_bf16 v[48:51], a[44:47], a[80:83], v[48:51]
    s_add_u32 m0, s34, 20480
    ds_read_b64_tr_b16 a[14:15], v215 offset:17416
    v_mfma_f32_16x16x32_bf16 v[52:55], a[44:47], a[84:87], v[52:55]
    s_add_u32 s46, s51, 36864
    ds_read_b64_tr_b16 a[16:17], v216 offset:16384
    buffer_load_dwordx4 v218, s[16:19], s46 offen  lds
    v_mfma_f32_16x16x32_bf16 v[56:59], a[44:47], a[88:91], v[56:59]
    ds_read_b64_tr_b16 a[18:19], v216 offset:17408
    v_mfma_f32_16x16x32_bf16 v[64:67], a[48:51], a[80:83], v[64:67]
    s_add_u32 m0, s34, 21504
    ds_read_b64_tr_b16 a[20:21], v216 offset:16392
    v_mfma_f32_16x16x32_bf16 v[68:71], a[48:51], a[84:87], v[68:71]
    s_add_u32 s46, s51, 46080
    ds_read_b64_tr_b16 a[22:23], v216 offset:17416
    buffer_load_dwordx4 v219, s[16:19], s46 offen  lds
    v_mfma_f32_16x16x32_bf16 v[72:75], a[48:51], a[88:91], v[72:75]
    s_add_u32 s50, s50, 1
    s_cmp_eq_u32 s50, 9
    s_cselect_b32 s50, 0, s50
    s_add_u32 m0, s35, 114688
    ds_read_b64_tr_b16 a[24:25], v217 offset:16384
    v_mfma_f32_16x16x32_bf16 v[80:83], a[52:55], a[80:83], v[80:83]
    s_add_u32 s46, s52, 0
    ds_read_b64_tr_b16 a[26:27], v217 offset:17408
    buffer_load_dwordx4 v220, s[20:23], s46 offen  lds
    v_mfma_f32_16x16x32_bf16 v[84:87], a[52:55], a[84:87], v[84:87]
    s_add_u32 m0, s35, 115712
    ds_read_b64_tr_b16 a[28:29], v217 offset:16392
    v_mfma_f32_16x16x32_bf16 v[88:91], a[52:55], a[88:91], v[88:91]
    s_add_u32 s46, s52, 32768
    ds_read_b64_tr_b16 a[30:31], v217 offset:17416
    buffer_load_dwordx4 v220, s[20:23], s46 offen  lds
    v_mfma_f32_16x16x32_bf16 v[96:99], a[56:59], a[80:83], v[96:99]
    s_add_u32 m0, s35, 116736
    v_mfma_f32_16x16x32_bf16 v[100:103], a[56:59], a[84:87], v[100:103]
    s_add_u32 s46, s52, 65536
    buffer_load_dwordx4 v220, s[20:23], s46 offen  lds
    v_mfma_f32_16x16x32_bf16 v[104:107], a[56:59], a[88:91], v[104:107]
    s_add_u32 m0, s35, 117760
    v_mfma_f32_16x16x32_bf16 v[112:115], a[60:63], a[80:83], v[112:115]
    s_add_u32 s46, s52, 98304
    buffer_load_dwordx4 v220, s[20:23], s46 offen  lds
    v_mfma_f32_16x16x32_bf16 v[116:119], a[60:63], a[84:87], v[116:119]
    v_mfma_f32_16x16x32_bf16 v[120:123], a[60:63], a[88:91], v[120:123]
    s_waitcnt lgkmcnt(0)
    v_mfma_f32_16x16x32_bf16 v[0:3], a[0:3], a[64:67], v[0:3]
    ds_read_b128 a[80:83], v211 offset:49152
    ds_read_b64_tr_b16 a[32:33], v214 offset:24576
    v_mfma_f32_16x16x32_bf16 v[4:7], a[0:3], a[68:71], v[4:7]
    ds_read_b64_tr_b16 a[34:35], v214 offset:25600
    v_mfma_f32_16x16x32_bf16 v[8:11], a[0:3], a[72:75], v[8:11]
    ds_read_b128 a[84:87], v211 offset:51200
    v_mfma_f32_16x16x32_bf16 v[16:19], a[4:7], a[64:67], v[16:19]
    ds_read_b128 a[88:91], v211 offset:53248
    v_mfma_f32_16x16x32_bf16 v[20:23], a[4:7], a[68:71], v[20:23]
    ds_read_b64_tr_b16 a[36:37], v214 offset:24584
    v_mfma_f32_16x16x32_bf16 v[24:27], a[4:7], a[72:75], v[24:27]
    ds_read_b64_tr_b16 a[38:39], v214 offset:25608
    v_mfma_f32_16x16x32_bf16 v[32:35], a[8:11], a[64:67], v[32:35]
    ds_read_b64_tr_b16 a[40:41], v215 offset:24576
    v_mfma_f32_16x16x32_bf16 v[36:39], a[8:11], a[68:71], v[36:39]
    ds_read_b64_tr_b16 a[42:43], v215 offset:25600
    v_mfma_f32_16x16x32_bf16 v[40:43], a[8:11], a[72:75], v[40:43]
    ds_read_b64_tr_b16 a[44:45], v215 offset:24584
    v_mfma_f32_16x16x32_bf16 v[48:51], a[12:15], a[64:67], v[48:51]
    ds_read_b64_tr_b16 a[46:47], v215 offset:25608
    v_mfma_f32_16x16x32_bf16 v[52:55], a[12:15], a[68:71], v[52:55]
    ds_read_b64_tr_b16 a[48:49], v216 offset:24576
    v_mfma_f32_16x16x32_bf16 v[56:59], a[12:15], a[72:75], v[56:59]
    ds_read_b64_tr_b16 a[50:51], v216 offset:25600
    v_mfma_f32_16x16x32_bf16 v[64:67], a[16:19], a[64:67], v[64:67]
    ds_read_b64_tr_b16 a[52:53], v216 offset:24584
    v_mfma_f32_16x16x32_bf16 v[68:71], a[16:19], a[68:71], v[68:71]
    ds_read_b64_tr_b16 a[54:55], v216 offset:25608
    v_mfma_f32_16x16x32_bf16 v[72:75], a[16:19], a[72:75], v[72:75]
    ds_read_b64_tr_b16 a[56:57], v217 offset:24576
    v_mfma_f32_16x16x32_bf16 v[80:83], a[20:23], a[64:67], v[80:83]
    ds_read_b64_tr_b16 a[58:59], v217 offset:25600
    v_mfma_f32_16x16x32_bf16 v[84:87], a[20:23], a[68:71], v[84:87]
    ds_read_b64_tr_b16 a[60:61], v217 offset:24584
    v_mfma_f32_16x16x32_bf16 v[88:91], a[20:23], a[72:75], v[88:91]
    ds_read_b64_tr_b16 a[62:63], v217 offset:25608
    v_mfma_f32_16x16x32_bf16 v[96:99], a[24:27], a[64:67], v[96:99]
    v_mfma_f32_16x16x32_bf16 v[100:103], a[24:27], a[68:71], v[100:103]
    v_mfma_f32_16x16x32_bf16 v[104:107], a[24:27], a[72:75], v[104:107]
    v_mfma_f32_16x16x32_bf16 v[112:115], a[28:31], a[64:67], v[112:115]
    v_mfma_f32_16x16x32_bf16 v[116:119], a[28:31], a[68:71], v[116:119]
    v_mfma_f32_16x16x32_bf16 v[120:123], a[28:31], a[72:75], v[120:123]
    s_waitcnt lgkmcnt(0)
    s_waitcnt vmcnt(10)
    s_barrier
    v_mfma_f32_16x16x32_bf16 v[0:3], a[32:35], a[80:83], v[0:3]
    s_lshl_b32 s51, s50, 7
    s_lshl_b32 s52, s50, 19
    ds_read_b128 a[64:67], v212 offset:16384
    ds_read_b64_tr_b16 a[0:1], v214 offset:32768
    v_mfma_f32_16x16x32_bf16 v[4:7], a[32:35], a[84:87], v[4:7]
    s_add_u32 m0, s34, 49152
    ds_read_b64_tr_b16 a[2:3], v214 offset:33792
    v_mfma_f32_16x16x32_bf16 v[8:11], a[32:35], a[88:91], v[8:11]
    s_add_u32 s46, s51, 0
    ds_read_b128 a[68:71], v212 offset:18432
    buffer_load_dwordx4 v218, s[16:19], s46 offen  lds
    v_mfma_f32_16x16x32_bf16 v[16:19], a[36:39], a[80:83], v[16:19]
    s_add_u32 m0, s34, 50176
    ds_read_b128 a[72:75], v212 offset:20480
    v_mfma_f32_16x16x32_bf16 v[20:23], a[36:39], a[84:87], v[20:23]
    s_add_u32 s46, s51, 9216
    ds_read_b64_tr_b16 a[4:5], v214 offset:32776
    buffer_load_dwordx4 v219, s[16:19], s46 offen  lds
    v_mfma_f32_16x16x32_bf16 v[24:27], a[36:39], a[88:91], v[24:27]
    s_add_u32 m0, s34, 51200
    ds_read_b64_tr_b16 a[6:7], v214 offset:33800
    v_mfma_f32_16x16x32_bf16 v[32:35], a[40:43], a[80:83], v[32:35]
    s_add_u32 s46, s51, 18432
    ds_read_b64_tr_b16 a[8:9], v215 offset:32768
    buffer_load_dwordx4 v218, s[16:19], s46 offen  lds
    v_mfma_f32_16x16x32_bf16 v[36:39], a[40:43], a[84:87], v[36:39]
    s_add_u32 m0, s34, 52224
    ds_read_b64_tr_b16 a[10:11], v215 offset:33792
    v_mfma_f32_16x16x32_bf16 v[40:43], a[40:43], a[88:91], v[40:43]
    s_add_u32 s46, s51, 27648
    ds_read_b64_tr_b16 a[12:13], v215 offset:32776
    buffer_load_dwordx4 v219, s[16:19], s46 offen  lds
    v_mfma_f32_16x16x32_bf16 v[48:51], a[44:47], a[80:83], v[48:51]
    s_add_u32 m0, s34, 53248
    ds_read_b64_tr_b16 a[14:15], v215 offset:33800
    v_mfma_f32_16x16x32_bf16 v[52:55], a[44:47], a[84:87], v[52:55]
    s_add_u32 s46, s51, 36864
    ds_read_b64_tr_b16 a[16:17], v216 offset:32768
    buffer_load_dwordx4 v218, s[16:19], s46 offen  lds
    v_mfma_f32_16x16x32_bf16 v[56:59], a[44:47], a[88:91], v[56:59]
    ds_read_b64_tr_b16 a[18:19], v216 offset:33792
    v_mfma_f32_16x16x32_bf16 v[64:67], a[48:51], a[80:83], v[64:67]
    s_add_u32 m0, s34, 54272
    ds_read_b64_tr_b16 a[20:21], v216 offset:32776
    v_mfma_f32_16x16x32_bf16 v[68:71], a[48:51], a[84:87], v[68:71]
    s_add_u32 s46, s51, 46080
    ds_read_b64_tr_b16 a[22:23], v216 offset:33800
    buffer_load_dwordx4 v219, s[16:19], s46 offen  lds
    v_mfma_f32_16x16x32_bf16 v[72:75], a[48:51], a[88:91], v[72:75]
    s_add_u32 s50, s50, 1
    s_cmp_eq_u32 s50, 9
    s_cselect_b32 s50, 0, s50
    s_add_u32 m0, s35, 131072
    ds_read_b64_tr_b16 a[24:25], v217 offset:32768
    v_mfma_f32_16x16x32_bf16 v[80:83], a[52:55], a[80:83], v[80:83]
    s_add_u32 s46, s52, 0
    ds_read_b64_tr_b16 a[26:27], v217 offset:33792
    buffer_load_dwordx4 v220, s[20:23], s46 offen  lds
    v_mfma_f32_16x16x32_bf16 v[84:87], a[52:55], a[84:87], v[84:87]
    s_add_u32 m0, s35, 132096
    ds_read_b64_tr_b16 a[28:29], v217 offset:32776
    v_mfma_f32_16x16x32_bf16 v[88:91], a[52:55], a[88:91], v[88:91]
    s_add_u32 s46, s52, 32768
    ds_read_b64_tr_b16 a[30:31], v217 offset:33800
    buffer_load_dwordx4 v220, s[20:23], s46 offen  lds
    v_mfma_f32_16x16x32_bf16 v[96:99], a[56:59], a[80:83], v[96:99]
    s_add_u32 m0, s35, 133120
    v_mfma_f32_16x16x32_bf16 v[100:103], a[56:59], a[84:87], v[100:103]
    s_add_u32 s46, s52, 65536
    buffer_load_dwordx4 v220, s[20:23], s46 offen  lds
    v_mfma_f32_16x16x32_bf16 v[104:107], a[56:59], a[88:91], v[104:107]
    s_add_u32 m0, s35, 134144
    v_mfma_f32_16x16x32_bf16 v[112:115], a[60:63], a[80:83], v[112:115]
    s_add_u32 s46, s52, 98304
    buffer_load_dwordx4 v220, s[20:23], s46 offen  lds
    v_mfma_f32_16x16x32_bf16 v[116:119], a[60:63], a[84:87], v[116:119]
    v_mfma_f32_16x16x32_bf16 v[120:123], a[60:63], a[88:91], v[120:123]
    s_waitcnt lgkmcnt(0)
    v_mfma_f32_16x16x32_bf16 v[0:3], a[0:3], a[64:67], v[0:3]
    ds_read_b128 a[80:83], v213 offset:16384
    ds_read_b64_tr_b16 a[32:33], v214 offset:40960
    v_mfma_f32_16x16x32_bf16 v[4:7], a[0:3], a[68:71], v[4:7]
    ds_read_b64_tr_b16 a[34:35], v214 offset:41984
    v_mfma_f32_16x16x32_bf16 v[8:11], a[0:3], a[72:75], v[8:11]
    ds_read_b128 a[84:87], v213 offset:18432
    v_mfma_f32_16x16x32_bf16 v[16:19], a[4:7], a[64:67], v[16:19]
    ds_read_b128 a[88:91], v213 offset:20480
    v_mfma_f32_16x16x32_bf16 v[20:23], a[4:7], a[68:71], v[20:23]
    ds_read_b64_tr_b16 a[36:37], v214 offset:40968
    v_mfma_f32_16x16x32_bf16 v[24:27], a[4:7], a[72:75], v[24:27]
    ds_read_b64_tr_b16 a[38:39], v214 offset:41992
    v_mfma_f32_16x16x32_bf16 v[32:35], a[8:11], a[64:67], v[32:35]
    ds_read_b64_tr_b16 a[40:41], v215 offset:40960
    v_mfma_f32_16x16x32_bf16 v[36:39], a[8:11], a[68:71], v[36:39]
    ds_read_b64_tr_b16 a[42:43], v215 offset:41984
    v_mfma_f32_16x16x32_bf16 v[40:43], a[8:11], a[72:75], v[40:43]
    ds_read_b64_tr_b16 a[44:45], v215 offset:40968
    v_mfma_f32_16x16x32_bf16 v[48:51], a[12:15], a[64:67], v[48:51]
    ds_read_b64_tr_b16 a[46:47], v215 offset:41992
    v_mfma_f32_16x16x32_bf16 v[52:55], a[12:15], a[68:71], v[52:55]
    ds_read_b64_tr_b16 a[48:49], v216 offset:40960
    v_mfma_f32_16x16x32_bf16 v[56:59], a[12:15], a[72:75], v[56:59]
    ds_read_b64_tr_b16 a[50:51], v216 offset:41984
    v_mfma_f32_16x16x32_bf16 v[64:67], a[16:19], a[64:67], v[64:67]
    ds_read_b64_tr_b16 a[52:53], v216 offset:40968
    v_mfma_f32_16x16x32_bf16 v[68:71], a[16:19], a[68:71], v[68:71]
    ds_read_b64_tr_b16 a[54:55], v216 offset:41992
    v_mfma_f32_16x16x32_bf16 v[72:75], a[16:19], a[72:75], v[72:75]
    ds_read_b64_tr_b16 a[56:57], v217 offset:40960
    v_mfma_f32_16x16x32_bf16 v[80:83], a[20:23], a[64:67], v[80:83]
    ds_read_b64_tr_b16 a[58:59], v217 offset:41984
    v_mfma_f32_16x16x32_bf16 v[84:87], a[20:23], a[68:71], v[84:87]
    ds_read_b64_tr_b16 a[60:61], v217 offset:40968
    v_mfma_f32_16x16x32_bf16 v[88:91], a[20:23], a[72:75], v[88:91]
    ds_read_b64_tr_b16 a[62:63], v217 offset:41992
    v_mfma_f32_16x16x32_bf16 v[96:99], a[24:27], a[64:67], v[96:99]
    v_mfma_f32_16x16x32_bf16 v[100:103], a[24:27], a[68:71], v[100:103]
    v_mfma_f32_16x16x32_bf16 v[104:107], a[24:27], a[72:75], v[104:107]
    v_mfma_f32_16x16x32_bf16 v[112:115], a[28:31], a[64:67], v[112:115]
    v_mfma_f32_16x16x32_bf16 v[116:119], a[28:31], a[68:71], v[116:119]
    v_mfma_f32_16x16x32_bf16 v[120:123], a[28:31], a[72:75], v[120:123]
    s_waitcnt lgkmcnt(0)
    s_waitcnt vmcnt(10)
    s_barrier
    v_mfma_f32_16x16x32_bf16 v[0:3], a[32:35], a[80:83], v[0:3]
    s_lshl_b32 s51, s50, 7
    s_lshl_b32 s52, s50, 19
    ds_read_b128 a[64:67], v210 offset:16384
    ds_read_b64_tr_b16 a[0:1], v214 offset:0
    v_mfma_f32_16x16x32_bf16 v[4:7], a[32:35], a[84:87], v[4:7]
    s_add_u32 m0, s34, 81920
    ds_read_b64_tr_b16 a[2:3], v214 offset:1024
    v_mfma_f32_16x16x32_bf16 v[8:11], a[32:35], a[88:91], v[8:11]
    s_add_u32 s46, s51, 0
    ds_read_b128 a[68:71], v210 offset:18432
    buffer_load_dwordx4 v218, s[16:19], s46 offen  lds
    v_mfma_f32_16x16x32_bf16 v[16:19], a[36:39], a[80:83], v[16:19]
    s_add_u32 m0, s34, 82944
    ds_read_b128 a[72:75], v210 offset:20480
    v_mfma_f32_16x16x32_bf16 v[20:23], a[36:39], a[84:87], v[20:23]
    s_add_u32 s46, s51, 9216
    ds_read_b64_tr_b16 a[4:5], v214 offset:8
    buffer_load_dwordx4 v219, s[16:19], s46 offen  lds
    v_mfma_f32_16x16x32_bf16 v[24:27], a[36:39], a[88:91], v[24:27]
    s_add_u32 m0, s34, 83968
    ds_read_b64_tr_b16 a[6:7], v214 offset:1032
    v_mfma_f32_16x16x32_bf16 v[32:35], a[40:43], a[80:83], v[32:35]
    s_add_u32 s46, s51, 18432
    ds_read_b64_tr_b16 a[8:9], v215 offset:0
    buffer_load_dwordx4 v218, s[16:19], s46 offen  lds
    v_mfma_f32_16x16x32_bf16 v[36:39], a[40:43], a[84:87], v[36:39]
    s_add_u32 m0, s34, 84992
    ds_read_b64_tr_b16 a[10:11], v215 offset:1024
    v_mfma_f32_16x16x32_bf16 v[40:43], a[40:43], a[88:91], v[40:43]
    s_add_u32 s46, s51, 27648
    ds_read_b64_tr_b16 a[12:13], v215 offset:8
    buffer_load_dwordx4 v219, s[16:19], s46 offen  lds
    v_mfma_f32_16x16x32_bf16 v[48:51], a[44:47], a[80:83], v[48:51]
    s_add_u32 m0, s34, 86016
    ds_read_b64_tr_b16 a[14:15], v215 offset:1032
    v_mfma_f32_16x16x32_bf16 v[52:55], a[44:47], a[84:87], v[52:55]
    s_add_u32 s46, s51, 36864
    ds_read_b64_tr_b16 a[16:17], v216 offset:0
    buffer_load_dwordx4 v218, s[16:19], s46 offen  lds
    v_mfma_f32_16x16x32_bf16 v[56:59], a[44:47], a[88:91], v[56:59]
    ds_read_b64_tr_b16 a[18:19], v216 offset:1024
    v_mfma_f32_16x16x32_bf16 v[64:67], a[48:51], a[80:83], v[64:67]
    s_add_u32 m0, s34, 87040
    ds_read_b64_tr_b16 a[20:21], v216 offset:8
    v_mfma_f32_16x16x32_bf16 v[68:71], a[48:51], a[84:87], v[68:71]
    s_add_u32 s46, s51, 46080
    ds_read_b64_tr_b16 a[22:23], v216 offset:1032
    buffer_load_dwordx4 v219, s[16:19], s46 offen  lds
    v_mfma_f32_16x16x32_bf16 v[72:75], a[48:51], a[88:91], v[72:75]
    s_add_u32 s50, s50, 1
    s_cmp_eq_u32 s50, 9
    s_cselect_b32 s50, 0, s50
    s_add_u32 m0, s35, 147456
    ds_read_b64_tr_b16 a[24:25], v217 offset:0
    v_mfma_f32_16x16x32_bf16 v[80:83], a[52:55], a[80:83], v[80:83]
    s_add_u32 s46, s52, 0
    ds_read_b64_tr_b16 a[26:27], v217 offset:1024
    buffer_load_dwordx4 v220, s[20:23], s46 offen  lds
    v_mfma_f32_16x16x32_bf16 v[84:87], a[52:55], a[84:87], v[84:87]
    s_add_u32 m0, s35, 148480
    ds_read_b64_tr_b16 a[28:29], v217 offset:8
    v_mfma_f32_16x16x32_bf16 v[88:91], a[52:55], a[88:91], v[88:91]
    s_add_u32 s46, s52, 32768
    ds_read_b64_tr_b16 a[30:31], v217 offset:1032
    buffer_load_dwordx4 v220, s[20:23], s46 offen  lds
    v_mfma_f32_16x16x32_bf16 v[96:99], a[56:59], a[80:83], v[96:99]
    s_add_u32 m0, s35, 149504
    v_mfma_f32_16x16x32_bf16 v[100:103], a[56:59], a[84:87], v[100:103]
    s_add_u32 s46, s52, 65536
    buffer_load_dwordx4 v220, s[20:23], s46 offen  lds
    v_mfma_f32_16x16x32_bf16 v[104:107], a[56:59], a[88:91], v[104:107]
    s_add_u32 m0, s35, 150528
    v_mfma_f32_16x16x32_bf16 v[112:115], a[60:63], a[80:83], v[112:115]
    s_add_u32 s46, s52, 98304
    buffer_load_dwordx4 v220, s[20:23], s46 offen  lds
    v_mfma_f32_16x16x32_bf16 v[116:119], a[60:63], a[84:87], v[116:119]
    v_mfma_f32_16x16x32_bf16 v[120:123], a[60:63], a[88:91], v[120:123]
    s_waitcnt lgkmcnt(0)
    v_mfma_f32_16x16x32_bf16 v[0:3], a[0:3], a[64:67], v[0:3]
    ds_read_b128 a[80:83], v211 offset:16384
    ds_read_b64_tr_b16 a[32:33], v214 offset:8192
    v_mfma_f32_16x16x32_bf16 v[4:7], a[0:3], a[68:71], v[4:7]
    ds_read_b64_tr_b16 a[34:35], v214 offset:9216
    v_mfma_f32_16x16x32_bf16 v[8:11], a[0:3], a[72:75], v[8:11]
    ds_read_b128 a[84:87], v211 offset:18432
    v_mfma_f32_16x16x32_bf16 v[16:19], a[4:7], a[64:67], v[16:19]
    ds_read_b128 a[88:91], v211 offset:20480
    v_mfma_f32_16x16x32_bf16 v[20:23], a[4:7], a[68:71], v[20:23]
    ds_read_b64_tr_b16 a[36:37], v214 offset:8200
    v_mfma_f32_16x16x32_bf16 v[24:27], a[4:7], a[72:75], v[24:27]
    ds_read_b64_tr_b16 a[38:39], v214 offset:9224
    v_mfma_f32_16x16x32_bf16 v[32:35], a[8:11], a[64:67], v[32:35]
    ds_read_b64_tr_b16 a[40:41], v215 offset:8192
    v_mfma_f32_16x16x32_bf16 v[36:39], a[8:11], a[68:71], v[36:39]
    ds_read_b64_tr_b16 a[42:43], v215 offset:9216
    v_mfma_f32_16x16x32_bf16 v[40:43], a[8:11], a[72:75], v[40:43]
    ds_read_b64_tr_b16 a[44:45], v215 offset:8200
    v_mfma_f32_16x16x32_bf16 v[48:51], a[12:15], a[64:67], v[48:51]
    ds_read_b64_tr_b16 a[46:47], v215 offset:9224
    v_mfma_f32_16x16x32_bf16 v[52:55], a[12:15], a[68:71], v[52:55]
    ds_read_b64_tr_b16 a[48:49], v216 offset:8192
    v_mfma_f32_16x16x32_bf16 v[56:59], a[12:15], a[72:75], v[56:59]
    ds_read_b64_tr_b16 a[50:51], v216 offset:9216
    v_mfma_f32_16x16x32_bf16 v[64:67], a[16:19], a[64:67], v[64:67]
    ds_read_b64_tr_b16 a[52:53], v216 offset:8200
    v_mfma_f32_16x16x32_bf16 v[68:71], a[16:19], a[68:71], v[68:71]
    ds_read_b64_tr_b16 a[54:55], v216 offset:9224
    v_mfma_f32_16x16x32_bf16 v[72:75], a[16:19], a[72:75], v[72:75]
    ds_read_b64_tr_b16 a[56:57], v217 offset:8192
    v_mfma_f32_16x16x32_bf16 v[80:83], a[20:23], a[64:67], v[80:83]
    ds_read_b64_tr_b16 a[58:59], v217 offset:9216
    v_mfma_f32_16x16x32_bf16 v[84:87], a[20:23], a[68:71], v[84:87]
    ds_read_b64_tr_b16 a[60:61], v217 offset:8200
    v_mfma_f32_16x16x32_bf16 v[88:91], a[20:23], a[72:75], v[88:91]
    ds_read_b64_tr_b16 a[62:63], v217 offset:9224
    v_mfma_f32_16x16x32_bf16 v[96:99], a[24:27], a[64:67], v[96:99]
    v_mfma_f32_16x16x32_bf16 v[100:103], a[24:27], a[68:71], v[100:103]
    v_mfma_f32_16x16x32_bf16 v[104:107], a[24:27], a[72:75], v[104:107]
    v_mfma_f32_16x16x32_bf16 v[112:115], a[28:31], a[64:67], v[112:115]
    v_mfma_f32_16x16x32_bf16 v[116:119], a[28:31], a[68:71], v[116:119]
    v_mfma_f32_16x16x32_bf16 v[120:123], a[28:31], a[72:75], v[120:123]
    s_waitcnt lgkmcnt(0)
    s_waitcnt vmcnt(10)
    s_barrier
    v_mfma_f32_16x16x32_bf16 v[0:3], a[32:35], a[80:83], v[0:3]
    ds_read_b128 a[64:67], v210 offset:49152
    ds_read_b64_tr_b16 a[0:1], v214 offset:16384
    v_mfma_f32_16x16x32_bf16 v[4:7], a[32:35], a[84:87], v[4:7]
    s_mov_b32 s47, 16384
    ds_read_b64_tr_b16 a[2:3], v214 offset:17408
    v_mfma_f32_16x16x32_bf16 v[8:11], a[32:35], a[88:91], v[8:11]
    s_mov_b32 m0, 16384
    s_nop 0
    ds_read_b128 a[68:71], v210 offset:51200
    buffer_load_dwordx4 v204, s[8:11], s47 offen nt lds
    v_mfma_f32_16x16x32_bf16 v[16:19], a[36:39], a[80:83], v[16:19]
    ds_read_b128 a[72:75], v210 offset:53248
    v_mfma_f32_16x16x32_bf16 v[20:23], a[36:39], a[84:87], v[20:23]
    ds_read_b64_tr_b16 a[4:5], v214 offset:16392
    buffer_load_dwordx4 v205, s[8:11], s47 offen offset:1024 nt lds
    v_mfma_f32_16x16x32_bf16 v[24:27], a[36:39], a[88:91], v[24:27]
    ds_read_b64_tr_b16 a[6:7], v214 offset:17416
    v_mfma_f32_16x16x32_bf16 v[32:35], a[40:43], a[80:83], v[32:35]
    ds_read_b64_tr_b16 a[8:9], v215 offset:16384
    buffer_load_dwordx4 v206, s[8:11], s47 offen offset:2048 nt lds
    v_mfma_f32_16x16x32_bf16 v[36:39], a[40:43], a[84:87], v[36:39]
    ds_read_b64_tr_b16 a[10:11], v215 offset:17408
    v_mfma_f32_16x16x32_bf16 v[40:43], a[40:43], a[88:91], v[40:43]
    ds_read_b64_tr_b16 a[12:13], v215 offset:16392
    buffer_load_dwordx4 v207, s[8:11], s47 offen offset:3072 nt lds
    v_mfma_f32_16x16x32_bf16 v[48:51], a[44:47], a[80:83], v[48:51]
    s_mov_b32 s47, 20480
    ds_read_b64_tr_b16 a[14:15], v215 offset:17416
    v_mfma_f32_16x16x32_bf16 v[52:55], a[44:47], a[84:87], v[52:55]
    s_mov_b32 m0, 20480
    s_nop 0
    ds_read_b64_tr_b16 a[16:17], v216 offset:16384
    buffer_load_dwordx4 v204, s[8:11], s47 offen nt lds
    v_mfma_f32_16x16x32_bf16 v[56:59], a[44:47], a[88:91], v[56:59]
    ds_read_b64_tr_b16 a[18:19], v216 offset:17408
    v_mfma_f32_16x16x32_bf16 v[64:67], a[48:51], a[80:83], v[64:67]
    ds_read_b64_tr_b16 a[20:21], v216 offset:16392
    v_mfma_f32_16x16x32_bf16 v[68:71], a[48:51], a[84:87], v[68:71]
    ds_read_b64_tr_b16 a[22:23], v216 offset:17416
    buffer_load_dwordx4 v205, s[8:11], s47 offen offset:1024 nt lds
    v_mfma_f32_16x16x32_bf16 v[72:75], a[48:51], a[88:91], v[72:75]
    ds_read_b64_tr_b16 a[24:25], v217 offset:16384
    v_mfma_f32_16x16x32_bf16 v[80:83], a[52:55], a[80:83], v[80:83]
    ds_read_b64_tr_b16 a[26:27], v217 offset:17408
    buffer_load_dwordx4 v206, s[8:11], s47 offen offset:2048 nt lds
    v_mfma_f32_16x16x32_bf16 v[84:87], a[52:55], a[84:87], v[84:87]
    ds_read_b64_tr_b16 a[28:29], v217 offset:16392
    v_mfma_f32_16x16x32_bf16 v[88:91], a[52:55], a[88:91], v[88:91]
    ds_read_b64_tr_b16 a[30:31], v217 offset:17416
    buffer_load_dwordx4 v207, s[8:11], s47 offen offset:3072 nt lds
    v_mfma_f32_16x16x32_bf16 v[96:99], a[56:59], a[80:83], v[96:99]
    s_mov_b32 s47, 24576
    v_mfma_f32_16x16x32_bf16 v[100:103], a[56:59], a[84:87], v[100:103]
    s_mov_b32 m0, 24576
    s_nop 0
    buffer_load_dwordx4 v204, s[8:11], s47 offen nt lds
    v_mfma_f32_16x16x32_bf16 v[104:107], a[56:59], a[88:91], v[104:107]
    v_mfma_f32_16x16x32_bf16 v[112:115], a[60:63], a[80:83], v[112:115]
    buffer_load_dwordx4 v205, s[8:11], s47 offen offset:1024 nt lds
    v_mfma_f32_16x16x32_bf16 v[116:119], a[60:63], a[84:87], v[116:119]
    v_mfma_f32_16x16x32_bf16 v[120:123], a[60:63], a[88:91], v[120:123]
    s_waitcnt lgkmcnt(0)
    v_mfma_f32_16x16x32_bf16 v[0:3], a[0:3], a[64:67], v[0:3]
    ds_read_b128 a[80:83], v211 offset:49152
    ds_read_b64_tr_b16 a[32:33], v214 offset:24576
    s_lshr_b32 s57, s2, 3
    s_min_u32 s93, s57, 29
    s_mul_i32 s58, s93, 43
    v_mfma_f32_16x16x32_bf16 v[4:7], a[0:3], a[68:71], v[4:7]
    ds_read_b64_tr_b16 a[34:35], v214 offset:25600
    s_lshr_b32 s58, s58, 8
    s_mul_i32 s59, s58, 6
    v_mfma_f32_16x16x32_bf16 v[8:11], a[0:3], a[72:75], v[8:11]
    ds_read_b128 a[84:87], v211 offset:51200
    buffer_load_dwordx4 v206, s[8:11], s47 offen offset:2048 nt lds
    s_sub_u32 s87, s93, s59
    s_and_b32 s56, s2, 7
    s_lshr_b32 s86, s56, 1
    v_mfma_f32_16x16x32_bf16 v[16:19], a[4:7], a[64:67], v[16:19]
    ds_read_b128 a[88:91], v211 offset:53248
    s_and_b32 s56, s56, 1
    s_mul_i32 s59, s56, 5
    v_mfma_f32_16x16x32_bf16 v[20:23], a[4:7], a[68:71], v[20:23]
    ds_read_b64_tr_b16 a[36:37], v214 offset:24584
    buffer_load_dwordx4 v207, s[8:11], s47 offen offset:3072 nt lds
    s_add_u32 s59, s59, s58
    s_mul_i32 s89, s59, 6
    v_mfma_f32_16x16x32_bf16 v[24:27], a[4:7], a[72:75], v[24:27]
    s_mov_b32 s47, 28672
    ds_read_b64_tr_b16 a[38:39], v214 offset:25608
    s_add_u32 s89, s89, s87
    s_mul_i32 s88, s59, 12
    s_add_u32 s90, s87, s58
    v_mfma_f32_16x16x32_bf16 v[32:35], a[8:11], a[64:67], v[32:35]
    s_mov_b32 m0, 28672
    s_nop 0
    ds_read_b64_tr_b16 a[40:41], v215 offset:24576
    buffer_load_dwordx4 v204, s[8:11], s47 offen nt lds
    s_mul_i32 s90, s90, 3
    s_and_b32 s90, s90, 15
    v_mfma_f32_16x16x32_bf16 v[36:39], a[8:11], a[68:71], v[36:39]
    ds_read_b64_tr_b16 a[42:43], v215 offset:25600
    s_mov_b32 s91, s90
    s_mov_b32 s94, s58
    v_mfma_f32_16x16x32_bf16 v[40:43], a[8:11], a[72:75], v[40:43]
    ds_read_b64_tr_b16 a[44:45], v215 offset:24584
    buffer_load_dwordx4 v205, s[8:11], s47 offen offset:1024 nt lds
    s_mul_i32 s56, s3, 3
    s_add_u32 s56, s56, s88
    s_lshl_b32 s56, s56, 17
    v_mfma_f32_16x16x32_bf16 v[48:51], a[12:15], a[64:67], v[48:51]
    ds_read_b64_tr_b16 a[46:47], v215 offset:25608
    s_lshl_b32 s57, s86, 15
    s_add_u32 s56, s56, s57
    v_mfma_f32_16x16x32_bf16 v[52:55], a[12:15], a[68:71], v[52:55]
    ds_read_b64_tr_b16 a[48:49], v216 offset:24576
    buffer_load_dwordx4 v206, s[8:11], s47 offen offset:2048 nt lds
    s_add_u32 s16, s44, s56
    s_addc_u32 s17, s45, 0
    s_sub_u32 s18, 15728640, s56
    s_mov_b32 s19, 0x20000
    v_mfma_f32_16x16x32_bf16 v[56:59], a[12:15], a[72:75], v[56:59]
    ds_read_b64_tr_b16 a[50:51], v216 offset:25600
    s_mul_i32 s56, s86, 1179648
    s_mul_i32 s57, s87, 192
    v_mfma_f32_16x16x32_bf16 v[64:67], a[16:19], a[64:67], v[64:67]
    ds_read_b64_tr_b16 a[52:53], v216 offset:24584
    s_add_u32 s56, s56, s57
    s_add_u32 s96, s80, s56
    s_addc_u32 s97, s81, 0
    v_mfma_f32_16x16x32_bf16 v[68:71], a[16:19], a[68:71], v[68:71]
    ds_read_b64_tr_b16 a[54:55], v216 offset:25608
    buffer_load_dwordx4 v207, s[8:11], s47 offen offset:3072 nt lds
    s_sub_u32 s98, 4718592, s56
    s_mov_b32 s99, 0x20000
    s_mov_b32 s20, s82
    v_mfma_f32_16x16x32_bf16 v[72:75], a[16:19], a[72:75], v[72:75]
    s_mov_b32 s47, 32768
    ds_read_b64_tr_b16 a[56:57], v217 offset:24576
    s_mov_b32 s21, s83
    s_mov_b32 s22, 2211840
    v_mfma_f32_16x16x32_bf16 v[80:83], a[20:23], a[64:67], v[80:83]
    s_mov_b32 m0, 32768
    s_nop 0
    ds_read_b64_tr_b16 a[58:59], v217 offset:25600
    buffer_load_dwordx4 v204, s[8:11], s47 offen nt lds
    s_mov_b32 s23, 0x20000
    s_mul_i32 s95, s3, 3072
    v_mfma_f32_16x16x32_bf16 v[84:87], a[20:23], a[68:71], v[84:87]
    ds_read_b64_tr_b16 a[60:61], v217 offset:24584
    v_lshlrev_b32 v247, 4, v221
    s_mul_i32 s56, s3, 192
    s_mov_b32 s57, 43691
    v_mfma_f32_16x16x32_bf16 v[88:91], a[20:23], a[72:75], v[88:91]
    ds_read_b64_tr_b16 a[62:63], v217 offset:25608
    buffer_load_dwordx4 v205, s[8:11], s47 offen offset:1024 nt lds
    v_add_u32 v230, s56, v221
    v_mul_lo_u32 v231, v230, s57
    v_mfma_f32_16x16x32_bf16 v[96:99], a[24:27], a[64:67], v[96:99]
    v_lshrrev_b32 v231, 19, v231
    v_mul_u32_u24 v232, 12, v231
    v_sub_u32 v232, v230, v232
    v_mfma_f32_16x16x32_bf16 v[100:103], a[24:27], a[68:71], v[100:103]
    buffer_load_dwordx4 v206, s[8:11], s47 offen offset:2048 nt lds
    v_bfe_u32 v233, v231, 2, 1
    v_lshlrev_b32 v233, 1, v233
    v_mfma_f32_16x16x32_bf16 v[104:107], a[24:27], a[72:75], v[104:107]
    v_xor_b32 v232, v232, v233
    v_mul_u32_u24 v231, 1152, v231
    v_mfma_f32_16x16x32_bf16 v[112:115], a[28:31], a[64:67], v[112:115]
    buffer_load_dwordx4 v207, s[8:11], s47 offen offset:3072 nt lds
    v_lshl_add_u32 v244, v232, 4, v231
    v_add_u32 v230, s56, v221
    v_add_u32 v230, 64, v230
    v_mfma_f32_16x16x32_bf16 v[116:119], a[28:31], a[68:71], v[116:119]
    v_mul_lo_u32 v231, v230, s57
    v_lshrrev_b32 v231, 19, v231
    v_mfma_f32_16x16x32_bf16 v[120:123], a[28:31], a[72:75], v[120:123]
    v_mul_u32_u24 v232, 12, v231
    v_sub_u32 v232, v230, v232
    s_waitcnt lgkmcnt(0)
    s_waitcnt vmcnt(20)
    s_barrier
    v_mfma_f32_16x16x32_bf16 v[0:3], a[32:35], a[80:83], v[0:3]
    ds_read_b128 a[64:67], v212 offset:16384
    ds_read_b64_tr_b16 a[0:1], v214 offset:32768
    v_bfe_u32 v233, v231, 2, 1
    v_mfma_f32_16x16x32_bf16 v[4:7], a[32:35], a[84:87], v[4:7]
    s_mov_b32 s47, 36864
    ds_read_b64_tr_b16 a[2:3], v214 offset:33792
    ds_read_b128 a[68:71], v212 offset:18432
    v_lshlrev_b32 v233, 1, v233
    v_mfma_f32_16x16x32_bf16 v[8:11], a[32:35], a[88:91], v[8:11]
    s_mov_b32 m0, 36864
    s_nop 0
    ds_read_b128 a[72:75], v212 offset:20480
    ds_read_b64_tr_b16 a[4:5], v214 offset:32776
    buffer_load_dwordx4 v204, s[8:11], s47 offen nt lds
    v_mfma_f32_16x16x32_bf16 v[16:19], a[36:39], a[80:83], v[16:19]
    ds_read_b64_tr_b16 a[6:7], v214 offset:33800
    ds_read_b64_tr_b16 a[8:9], v215 offset:32768
    v_xor_b32 v232, v232, v233
    v_mfma_f32_16x16x32_bf16 v[20:23], a[36:39], a[84:87], v[20:23]
    ds_read_b64_tr_b16 a[10:11], v215 offset:33792
    ds_read_b64_tr_b16 a[12:13], v215 offset:32776
    buffer_load_dwordx4 v205, s[8:11], s47 offen offset:1024 nt lds
    v_mfma_f32_16x16x32_bf16 v[24:27], a[36:39], a[88:91], v[24:27]
    ds_read_b64_tr_b16 a[14:15], v215 offset:33800
    v_mul_u32_u24 v231, 1152, v231
    v_mfma_f32_16x16x32_bf16 v[32:35], a[40:43], a[80:83], v[32:35]
    ds_read_b64_tr_b16 a[16:17], v216 offset:32768
    ds_read_b64_tr_b16 a[18:19], v216 offset:33792
    buffer_load_dwordx4 v206, s[8:11], s47 offen offset:2048 nt lds
    v_mfma_f32_16x16x32_bf16 v[36:39], a[40:43], a[84:87], v[36:39]
    ds_read_b64_tr_b16 a[20:21], v216 offset:32776
    ds_read_b64_tr_b16 a[22:23], v216 offset:33800
    v_lshl_add_u32 v245, v232, 4, v231
    v_mfma_f32_16x16x32_bf16 v[40:43], a[40:43], a[88:91], v[40:43]
    ds_read_b64_tr_b16 a[24:25], v217 offset:32768
    ds_read_b64_tr_b16 a[26:27], v217 offset:33792
    buffer_load_dwordx4 v207, s[8:11], s47 offen offset:3072 nt lds
    v_mfma_f32_16x16x32_bf16 v[48:51], a[44:47], a[80:83], v[48:51]
    s_mov_b32 s47, 40960
    ds_read_b64_tr_b16 a[28:29], v217 offset:32776
    ds_read_b64_tr_b16 a[30:31], v217 offset:33800
    v_add_u32 v230, s56, v221
    v_mfma_f32_16x16x32_bf16 v[52:55], a[44:47], a[84:87], v[52:55]
    s_mov_b32 m0, 40960
    s_nop 0
    ds_read_b128 a[212:215], v213 offset:16384
    buffer_load_dwordx4 v204, s[8:11], s47 offen nt lds
    v_mfma_f32_16x16x32_bf16 v[56:59], a[44:47], a[88:91], v[56:59]
    ds_read_b64_tr_b16 a[96:97], v214 offset:40960
    ds_read_b64_tr_b16 a[98:99], v214 offset:41984
    v_add_u32 v230, 128, v230
    v_mfma_f32_16x16x32_bf16 v[64:67], a[48:51], a[80:83], v[64:67]
    ds_read_b128 a[216:219], v213 offset:18432
    ds_read_b128 a[220:223], v213 offset:20480
    v_mul_lo_u32 v231, v230, s57
    v_mfma_f32_16x16x32_bf16 v[68:71], a[48:51], a[84:87], v[68:71]
    ds_read_b64_tr_b16 a[100:101], v214 offset:40968
    ds_read_b64_tr_b16 a[102:103], v214 offset:41992
    buffer_load_dwordx4 v205, s[8:11], s47 offen offset:1024 nt lds
    v_mfma_f32_16x16x32_bf16 v[72:75], a[48:51], a[88:91], v[72:75]
    ds_read_b64_tr_b16 a[104:105], v215 offset:40960
    ds_read_b64_tr_b16 a[106:107], v215 offset:41984
    v_lshrrev_b32 v231, 19, v231
    v_mfma_f32_16x16x32_bf16 v[80:83], a[52:55], a[80:83], v[80:83]
    ds_read_b64_tr_b16 a[108:109], v215 offset:40968
    buffer_load_dwordx4 v206, s[8:11], s47 offen offset:2048 nt lds
    v_mfma_f32_16x16x32_bf16 v[84:87], a[52:55], a[84:87], v[84:87]
    ds_read_b64_tr_b16 a[110:111], v215 offset:41992
    ds_read_b64_tr_b16 a[112:113], v216 offset:40960
    v_mul_u32_u24 v232, 12, v231
    v_mfma_f32_16x16x32_bf16 v[88:91], a[52:55], a[88:91], v[88:91]
    ds_read_b64_tr_b16 a[114:115], v216 offset:41984
    ds_read_b64_tr_b16 a[116:117], v216 offset:40968
    buffer_load_dwordx4 v207, s[8:11], s47 offen offset:3072 nt lds
    v_mfma_f32_16x16x32_bf16 v[96:99], a[56:59], a[80:83], v[96:99]
    s_mov_b32 s47, 45056
    ds_read_b64_tr_b16 a[118:119], v216 offset:41992
    ds_read_b64_tr_b16 a[120:121], v217 offset:40960
    v_sub_u32 v232, v230, v232
    v_mfma_f32_16x16x32_bf16 v[100:103], a[56:59], a[84:87], v[100:103]
    s_mov_b32 m0, 45056
    s_nop 0
    ds_read_b64_tr_b16 a[122:123], v217 offset:41984
    ds_read_b64_tr_b16 a[124:125], v217 offset:40968
    buffer_load_dwordx4 v204, s[8:11], s47 offen nt lds
    v_mfma_f32_16x16x32_bf16 v[104:107], a[56:59], a[88:91], v[104:107]
    ds_read_b64_tr_b16 a[126:127], v217 offset:41992
    v_bfe_u32 v233, v231, 2, 1
    v_mfma_f32_16x16x32_bf16 v[112:115], a[60:63], a[80:83], v[112:115]
    buffer_load_dwordx4 v205, s[8:11], s47 offen offset:1024 nt lds
    v_mfma_f32_16x16x32_bf16 v[116:119], a[60:63], a[84:87], v[116:119]
    v_lshlrev_b32 v233, 1, v233
    v_mfma_f32_16x16x32_bf16 v[120:123], a[60:63], a[88:91], v[120:123]
    s_waitcnt lgkmcnt(0)
    s_mov_b32 s53, 0x3e0293ee
    s_waitcnt vmcnt(63)
    s_barrier
    v_mfma_f32_16x16x32_bf16 v[0:3], a[0:3], a[64:67], v[0:3]
    ds_read_b128 a[128:131], v192 offset:0
    v_xor_b32 v232, v232, v233
    v_mul_u32_u24 v231, 1152, v231
    v_lshl_add_u32 v246, v232, 4, v231
    v_mfma_f32_16x16x32_bf16 v[0:3], a[96:99], a[212:215], v[0:3]
    ds_read_b128 a[132:135], v193 offset:0
    v_lshrrev_b32 v230, 4, v221
    v_bfe_u32 v231, v221, 2, 2
    v_mfma_f32_16x16x32_bf16 v[16:19], a[4:7], a[64:67], v[16:19]
    ds_read_b128 a[136:139], v194 offset:0
    v_lshl_add_u32 v231, v230, 2, v231
    v_mul_u32_u24 v231, 192, v231
    v_mfma_f32_16x16x32_bf16 v[16:19], a[100:103], a[212:215], v[16:19]
    ds_read_b128 a[140:143], v195 offset:0
    buffer_load_dwordx4 v206, s[8:11], s47 offen offset:2048 nt lds
    v_and_b32 v232, 1, v221
    v_lshl_add_u32 v231, v232, 3, v231
    v_mfma_f32_16x16x32_bf16 v[32:35], a[8:11], a[64:67], v[32:35]
    ds_read_b128 a[144:147], v192 offset:4096
    buffer_load_dwordx4 v207, s[8:11], s47 offen offset:3072 nt lds
    v_bfe_u32 v232, v221, 1, 1
    v_lshl_add_u32 v231, v232, 4, v231
    v_mfma_f32_16x16x32_bf16 v[32:35], a[104:107], a[212:215], v[32:35]
    s_mov_b32 s47, 0
    s_mov_b32 m0, 65536
    s_nop 0
    ds_read_b128 a[148:151], v193 offset:4096
    buffer_load_dwordx4 v208, s[12:15], s47 offen nt lds
    v_and_b32 v230, 1, v230
    v_xor_b32 v232, 0, v230
    v_mfma_f32_16x16x32_bf16 v[48:51], a[12:15], a[64:67], v[48:51]
    ds_read_b128 a[152:155], v194 offset:4096
    buffer_load_dwordx4 v209, s[12:15], s47 offen offset:1024 nt lds
    v_lshl_add_u32 v248, v232, 5, v231
    v_add_u32 v250, 65536, v248
    v_xor_b32 v232, 1, v230
    v_mfma_f32_16x16x32_bf16 v[48:51], a[108:111], a[212:215], v[48:51]
    ds_read_b128 a[156:159], v195 offset:4096
    buffer_load_dwordx4 v208, s[12:15], s47 offen offset:2048 nt lds
    v_lshl_add_u32 v249, v232, 5, v231
    v_add_u32 v251, 65536, v249
    v_mfma_f32_16x16x32_bf16 v[64:67], a[16:19], a[64:67], v[64:67]
    buffer_load_dwordx4 v209, s[12:15], s47 offen offset:3072 nt lds
    s_mov_b32 s76, s84
    s_mov_b32 s77, s85
    v_mfma_f32_16x16x32_bf16 v[64:67], a[112:115], a[212:215], v[64:67]
    s_mov_b32 s47, 4096
    s_mov_b32 m0, 69632
    s_nop 0
    buffer_load_dwordx4 v208, s[12:15], s47 offen nt lds
    s_mov_b32 s78, 256
    s_mov_b32 s79, 0x20000
    v_mfma_f32_16x16x32_bf16 v[80:83], a[20:23], a[64:67], v[80:83]
    buffer_load_dwordx4 v209, s[12:15], s47 offen offset:1024 nt lds
    v_mov_b32 v230, 0
    s_nop 0
    v_mfma_f32_16x16x32_bf16 v[80:83], a[116:119], a[212:215], v[80:83]
    buffer_load_dwordx4 v208, s[12:15], s47 offen offset:2048 nt lds
    s_nop 0
    buffer_load_dword v243, v230, s[76:79], 0 offen sc1
    v_mfma_f32_16x16x32_bf16 v[96:99], a[24:27], a[64:67], v[96:99]
    buffer_load_dwordx4 v209, s[12:15], s47 offen offset:3072 nt lds
    v_mul_f32 v0, s53, v0
    v_mul_f32 v1, s53, v1
    v_mfma_f32_16x16x32_bf16 v[96:99], a[120:123], a[212:215], v[96:99]
    s_mov_b32 s47, 8192
    s_mov_b32 m0, 73728
    s_nop 0
    buffer_load_dwordx4 v208, s[12:15], s47 offen nt lds
    v_mul_f32 v2, s53, v2
    v_mul_f32 v3, s53, v3
    v_mfma_f32_16x16x32_bf16 v[112:115], a[28:31], a[64:67], v[112:115]
    buffer_load_dwordx4 v209, s[12:15], s47 offen offset:1024 nt lds
    v_mul_f32 v16, s53, v16
    v_mul_f32 v17, s53, v17
    v_mfma_f32_16x16x32_bf16 v[112:115], a[124:127], a[212:215], v[112:115]
    buffer_load_dwordx4 v208, s[12:15], s47 offen offset:2048 nt lds
    v_mul_f32 v18, s53, v18
    v_mul_f32 v19, s53, v19
    v_mfma_f32_16x16x32_bf16 v[4:7], a[0:3], a[68:71], v[4:7]
    buffer_load_dwordx4 v209, s[12:15], s47 offen offset:3072 nt lds
    v_cvt_pk_bf16_f32 v128, v0, v1
    v_cvt_pk_bf16_f32 v129, v2, v3
    v_mfma_f32_16x16x32_bf16 v[4:7], a[96:99], a[216:219], v[4:7]
    s_mov_b32 s47, 12288
    s_mov_b32 m0, 77824
    s_nop 0
    buffer_load_dwordx4 v208, s[12:15], s47 offen nt lds
    v_cvt_pk_bf16_f32 v130, v16, v17
    v_cvt_pk_bf16_f32 v131, v18, v19
    v_mfma_f32_16x16x32_bf16 v[20:23], a[4:7], a[68:71], v[20:23]
    buffer_load_dwordx4 v209, s[12:15], s47 offen offset:1024 nt lds
    v_mul_f32 v32, s53, v32
    v_mul_f32 v33, s53, v33
    v_mfma_f32_16x16x32_bf16 v[20:23], a[100:103], a[216:219], v[20:23]
    buffer_load_dwordx4 v208, s[12:15], s47 offen offset:2048 nt lds
    v_mul_f32 v34, s53, v34
    v_mul_f32 v35, s53, v35
    v_mfma_f32_16x16x32_bf16 v[36:39], a[8:11], a[68:71], v[36:39]
    buffer_load_dwordx4 v209, s[12:15], s47 offen offset:3072 nt lds
    v_mul_f32 v48, s53, v48
    v_mul_f32 v49, s53, v49
    v_mfma_f32_16x16x32_bf16 v[36:39], a[104:107], a[216:219], v[36:39]
    s_mov_b32 s47, 49152
    s_mov_b32 m0, 49152
    s_nop 0
    buffer_load_dwordx4 v204, s[8:11], s47 offen nt lds
    v_mul_f32 v50, s53, v50
    v_mul_f32 v51, s53, v51
    v_mfma_f32_16x16x32_bf16 v[52:55], a[12:15], a[68:71], v[52:55]
    buffer_load_dwordx4 v205, s[8:11], s47 offen offset:1024 nt lds
    v_cvt_pk_bf16_f32 v132, v32, v33
    v_cvt_pk_bf16_f32 v133, v34, v35
    v_mfma_f32_16x16x32_bf16 v[52:55], a[108:111], a[216:219], v[52:55]
    buffer_load_dwordx4 v206, s[8:11], s47 offen offset:2048 nt lds
    v_cvt_pk_bf16_f32 v134, v48, v49
    v_cvt_pk_bf16_f32 v135, v50, v51
    v_mfma_f32_16x16x32_bf16 v[68:71], a[16:19], a[68:71], v[68:71]
    v_mul_f32 v64, s53, v64
    v_mul_f32 v65, s53, v65
    v_mul_f32 v66, s53, v66
    v_mfma_f32_16x16x32_bf16 v[68:71], a[112:115], a[216:219], v[68:71]
    buffer_load_dwordx4 v207, s[8:11], s47 offen offset:3072 nt lds
    v_mul_f32 v67, s53, v67
    v_mul_f32 v80, s53, v80
    v_mfma_f32_16x16x32_bf16 v[84:87], a[20:23], a[68:71], v[84:87]
    s_mov_b32 s47, 53248
    s_mov_b32 m0, 53248
    s_nop 0
    buffer_load_dwordx4 v204, s[8:11], s47 offen nt lds
    v_mul_f32 v81, s53, v81
    v_mul_f32 v82, s53, v82
    v_mfma_f32_16x16x32_bf16 v[84:87], a[116:119], a[216:219], v[84:87]
    buffer_load_dwordx4 v205, s[8:11], s47 offen offset:1024 nt lds
    v_mul_f32 v83, s53, v83
    v_cvt_pk_bf16_f32 v136, v64, v65
    v_mfma_f32_16x16x32_bf16 v[100:103], a[24:27], a[68:71], v[100:103]
    buffer_load_dwordx4 v206, s[8:11], s47 offen offset:2048 nt lds
    v_cvt_pk_bf16_f32 v137, v66, v67
    v_cvt_pk_bf16_f32 v138, v80, v81
    v_mfma_f32_16x16x32_bf16 v[100:103], a[120:123], a[216:219], v[100:103]
    buffer_load_dwordx4 v207, s[8:11], s47 offen offset:3072 nt lds
    v_cvt_pk_bf16_f32 v139, v82, v83
    v_mul_f32 v96, s53, v96
    v_mfma_f32_16x16x32_bf16 v[116:119], a[28:31], a[68:71], v[116:119]
    s_mov_b32 s47, 57344
    s_mov_b32 m0, 57344
    s_nop 0
    buffer_load_dwordx4 v204, s[8:11], s47 offen nt lds
    v_mul_f32 v97, s53, v97
    v_mul_f32 v98, s53, v98
    v_mfma_f32_16x16x32_bf16 v[116:119], a[124:127], a[216:219], v[116:119]
    buffer_load_dwordx4 v205, s[8:11], s47 offen offset:1024 nt lds
    v_mul_f32 v99, s53, v99
    v_mul_f32 v112, s53, v112
    v_mfma_f32_16x16x32_bf16 v[8:11], a[0:3], a[72:75], v[8:11]
    buffer_load_dwordx4 v206, s[8:11], s47 offen offset:2048 nt lds
    v_mul_f32 v113, s53, v113
    v_mul_f32 v114, s53, v114
    v_mfma_f32_16x16x32_bf16 v[8:11], a[96:99], a[220:223], v[8:11]
    buffer_load_dwordx4 v207, s[8:11], s47 offen offset:3072 nt lds
    v_mul_f32 v115, s53, v115
    v_cvt_pk_bf16_f32 v140, v96, v97
    v_mfma_f32_16x16x32_bf16 v[24:27], a[4:7], a[72:75], v[24:27]
    s_mov_b32 s47, 61440
    s_mov_b32 m0, 61440
    s_nop 0
    buffer_load_dwordx4 v204, s[8:11], s47 offen nt lds
    v_cvt_pk_bf16_f32 v141, v98, v99
    v_cvt_pk_bf16_f32 v142, v112, v113
    v_mfma_f32_16x16x32_bf16 v[24:27], a[100:103], a[220:223], v[24:27]
    buffer_load_dwordx4 v205, s[8:11], s47 offen offset:1024 nt lds
    v_cvt_pk_bf16_f32 v143, v114, v115
    v_mul_f32 v4, s53, v4
    v_mfma_f32_16x16x32_bf16 v[40:43], a[8:11], a[72:75], v[40:43]
    buffer_load_dwordx4 v206, s[8:11], s47 offen offset:2048 nt lds
    v_mul_f32 v5, s53, v5
    v_mul_f32 v6, s53, v6
    v_mfma_f32_16x16x32_bf16 v[40:43], a[104:107], a[220:223], v[40:43]
    buffer_load_dwordx4 v207, s[8:11], s47 offen offset:3072 nt lds
    v_mul_f32 v7, s53, v7
    v_mul_f32 v20, s53, v20
    v_mfma_f32_16x16x32_bf16 v[56:59], a[12:15], a[72:75], v[56:59]
    s_mov_b32 s47, 16384
    s_mov_b32 m0, 81920
    s_nop 0
    buffer_load_dwordx4 v208, s[12:15], s47 offen nt lds
    v_mul_f32 v21, s53, v21
    v_mul_f32 v22, s53, v22
    v_mfma_f32_16x16x32_bf16 v[56:59], a[108:111], a[220:223], v[56:59]
    buffer_load_dwordx4 v209, s[12:15], s47 offen offset:1024 nt lds
    v_mul_f32 v23, s53, v23
    v_cvt_pk_bf16_f32 v144, v4, v5
    v_mfma_f32_16x16x32_bf16 v[72:75], a[16:19], a[72:75], v[72:75]
    buffer_load_dwordx4 v208, s[12:15], s47 offen offset:2048 nt lds
    v_cvt_pk_bf16_f32 v145, v6, v7
    v_cvt_pk_bf16_f32 v146, v20, v21
    v_mfma_f32_16x16x32_bf16 v[72:75], a[112:115], a[220:223], v[72:75]
    buffer_load_dwordx4 v209, s[12:15], s47 offen offset:3072 nt lds
    v_cvt_pk_bf16_f32 v147, v22, v23
    v_mul_f32 v36, s53, v36
    v_mfma_f32_16x16x32_bf16 v[88:91], a[20:23], a[72:75], v[88:91]
    s_mov_b32 s47, 20480
    s_mov_b32 m0, 86016
    s_nop 0
    buffer_load_dwordx4 v208, s[12:15], s47 offen nt lds
    v_mul_f32 v37, s53, v37
    v_mul_f32 v38, s53, v38
    v_mfma_f32_16x16x32_bf16 v[88:91], a[116:119], a[220:223], v[88:91]
    buffer_load_dwordx4 v209, s[12:15], s47 offen offset:1024 nt lds
    v_mul_f32 v39, s53, v39
    v_mul_f32 v52, s53, v52
    v_mfma_f32_16x16x32_bf16 v[104:107], a[24:27], a[72:75], v[104:107]
    buffer_load_dwordx4 v208, s[12:15], s47 offen offset:2048 nt lds
    v_mul_f32 v53, s53, v53
    v_mul_f32 v54, s53, v54
    v_mfma_f32_16x16x32_bf16 v[104:107], a[120:123], a[220:223], v[104:107]
    buffer_load_dwordx4 v209, s[12:15], s47 offen offset:3072 nt lds
    v_mul_f32 v55, s53, v55
    v_cvt_pk_bf16_f32 v148, v36, v37
    v_mfma_f32_16x16x32_bf16 v[120:123], a[28:31], a[72:75], v[120:123]
    v_cvt_pk_bf16_f32 v149, v38, v39
    v_cvt_pk_bf16_f32 v150, v52, v53
    v_cvt_pk_bf16_f32 v151, v54, v55
    v_mfma_f32_16x16x32_bf16 v[120:123], a[124:127], a[220:223], v[120:123]
    v_mul_f32 v68, s53, v68
    v_mul_f32 v69, s53, v69
    v_mul_f32 v70, s53, v70
    s_waitcnt lgkmcnt(0)
    v_mov_b32 v222, 0x3f803f80
    s_nop 7
    s_nop 1
    v_mfma_f32_16x16x32_bf16 v[0:3], a[128:131], v[128:131], 0
    v_mul_f32 v71, s53, v71
    v_mul_f32 v84, s53, v84
    v_mfma_f32_16x16x32_bf16 v[0:3], a[132:135], v[132:135], v[0:3]
    v_mul_f32 v85, s53, v85
    v_mul_f32 v86, s53, v86
    v_mfma_f32_16x16x32_bf16 v[0:3], a[136:139], v[136:139], v[0:3]
    v_mul_f32 v87, s53, v87
    v_cvt_pk_bf16_f32 v152, v68, v69
    v_mfma_f32_16x16x32_bf16 v[0:3], a[140:143], v[140:143], v[0:3]
    v_cvt_pk_bf16_f32 v153, v70, v71
    v_cvt_pk_bf16_f32 v154, v84, v85
    v_mfma_f32_16x16x32_bf16 v[4:7], a[144:147], v[128:131], 0
    v_cvt_pk_bf16_f32 v155, v86, v87
    v_mul_f32 v100, s53, v100
    v_mfma_f32_16x16x32_bf16 v[4:7], a[148:151], v[132:135], v[4:7]
    v_mul_f32 v101, s53, v101
    v_mul_f32 v102, s53, v102
    v_mul_f32 v103, s53, v103
    v_mul_f32 v116, s53, v116
    v_mul_f32 v117, s53, v117
    v_mul_f32 v118, s53, v118
    v_mul_f32 v119, s53, v119
    v_cvt_pk_bf16_f32 v156, v100, v101
    v_cvt_pk_bf16_f32 v157, v102, v103
    v_cvt_pk_bf16_f32 v158, v116, v117
    v_cvt_pk_bf16_f32 v159, v118, v119
    v_mfma_f32_16x16x32_bf16 v[4:7], a[152:155], v[136:139], v[4:7]
    v_mul_f32 v8, s53, v8
    v_mul_f32 v9, s53, v9
    v_mfma_f32_16x16x32_bf16 v[4:7], a[156:159], v[140:143], v[4:7]
    v_mul_f32 v10, s53, v10
    v_mul_f32 v11, s53, v11
    v_mul_f32 v24, s53, v24
    v_mul_f32 v25, s53, v25
    v_mul_f32 v26, s53, v26
    v_mul_f32 v27, s53, v27
    v_cvt_pk_bf16_f32 v160, v8, v9
    v_cvt_pk_bf16_f32 v161, v10, v11
    v_mfma_f32_16x16x32_bf16 v[8:11], a[128:131], v[144:147], 0
    v_cvt_pk_bf16_f32 v162, v24, v25
    v_cvt_pk_bf16_f32 v163, v26, v27
    v_mfma_f32_16x16x32_bf16 v[8:11], a[132:135], v[148:151], v[8:11]
    v_mul_f32 v40, s53, v40
    v_mul_f32 v41, s53, v41
    v_mfma_f32_16x16x32_bf16 v[8:11], a[136:139], v[152:155], v[8:11]
    v_mul_f32 v42, s53, v42
    v_mul_f32 v43, s53, v43
    v_mfma_f32_16x16x32_bf16 v[8:11], a[140:143], v[156:159], v[8:11]
    v_mul_f32 v56, s53, v56
    v_mul_f32 v57, s53, v57
    v_mfma_f32_16x16x32_bf16 v[12:15], a[144:147], v[144:147], 0
    v_mul_f32 v58, s53, v58
    v_mul_f32 v59, s53, v59
    v_mfma_f32_16x16x32_bf16 v[12:15], a[148:151], v[148:151], v[12:15]
    v_cvt_pk_bf16_f32 v164, v40, v41
    v_cvt_pk_bf16_f32 v165, v42, v43
    v_cvt_pk_bf16_f32 v166, v56, v57
    v_cvt_pk_bf16_f32 v167, v58, v59
    v_mul_f32 v72, s53, v72
    v_mul_f32 v73, s53, v73
    v_mul_f32 v74, s53, v74
    v_mul_f32 v75, s53, v75
    v_mul_f32 v88, s53, v88
    v_mul_f32 v89, s53, v89
    v_mul_f32 v90, s53, v90
    v_mul_f32 v91, s53, v91
    v_cvt_pk_bf16_f32 v168, v72, v73
    v_cvt_pk_bf16_f32 v169, v74, v75
    v_cvt_pk_bf16_f32 v170, v88, v89
    v_cvt_pk_bf16_f32 v171, v90, v91
    v_mul_f32 v104, s53, v104
    v_mul_f32 v105, s53, v105
    v_mul_f32 v106, s53, v106
    v_mul_f32 v107, s53, v107
    v_mul_f32 v120, s53, v120
    v_mul_f32 v121, s53, v121
    v_mul_f32 v122, s53, v122
    v_mul_f32 v123, s53, v123
    v_cvt_pk_bf16_f32 v172, v104, v105
    v_cvt_pk_bf16_f32 v173, v106, v107
    v_cvt_pk_bf16_f32 v174, v120, v121
    v_cvt_pk_bf16_f32 v175, v122, v123
    v_mfma_f32_16x16x32_bf16 v[12:15], a[152:155], v[152:155], v[12:15]
    v_accvgpr_write_b32 a208, v222
    v_mfma_f32_16x16x32_bf16 v[12:15], a[156:159], v[156:159], v[12:15]
    v_accvgpr_write_b32 a209, v222
    v_mfma_f32_16x16x32_bf16 v[16:19], a[128:131], v[160:163], 0
    v_accvgpr_write_b32 a210, v222
    v_mfma_f32_16x16x32_bf16 v[16:19], a[132:135], v[164:167], v[16:19]
    v_accvgpr_write_b32 a211, v222
    v_mfma_f32_16x16x32_bf16 v[16:19], a[136:139], v[168:171], v[16:19]
    v_mfma_f32_16x16x32_bf16 v[16:19], a[140:143], v[172:175], v[16:19]
    v_mfma_f32_16x16x32_bf16 v[20:23], a[144:147], v[160:163], 0
    v_mfma_f32_16x16x32_bf16 v[20:23], a[148:151], v[164:167], v[20:23]
    v_mfma_f32_16x16x32_bf16 v[20:23], a[152:155], v[168:171], v[20:23]
    v_mfma_f32_16x16x32_bf16 v[20:23], a[156:159], v[172:175], v[20:23]
    ds_read_b128 a[128:131], v192 offset:8192
    ds_read_b128 a[132:135], v193 offset:8192
    ds_read_b128 a[136:139], v194 offset:8192
    ds_read_b128 a[140:143], v195 offset:8192
    ds_read_b128 a[144:147], v192 offset:12288
    ds_read_b128 a[148:151], v193 offset:12288
    ds_read_b128 a[152:155], v194 offset:12288
    ds_read_b128 a[156:159], v195 offset:12288
    s_nop 3
    v_max3_f32 v222, v0, v1, v2
    v_max3_f32 v222, v222, v3, v4
    v_max3_f32 v222, v222, v5, v6
    v_max_f32 v222, v222, v7
    v_max3_f32 v223, v8, v9, v10
    v_max3_f32 v223, v223, v11, v12
    v_max3_f32 v223, v223, v13, v14
    v_max_f32 v223, v223, v15
    v_max3_f32 v224, v16, v17, v18
    v_max3_f32 v224, v224, v19, v20
    v_max3_f32 v224, v224, v21, v22
    v_max_f32 v224, v224, v23
    v_mov_b32 v226, v222
    v_mov_b32 v227, v223
    v_mov_b32 v228, v224
    s_nop 1
    v_permlane16_swap_b32 v222, v226
    v_permlane16_swap_b32 v223, v227
    v_permlane16_swap_b32 v224, v228
    s_nop 1
    v_max_f32 v222, v222, v226
    v_max_f32 v223, v223, v227
    v_max_f32 v224, v224, v228
    v_mov_b32 v226, v222
    v_mov_b32 v227, v223
    v_mov_b32 v228, v224
    s_nop 1
    v_permlane32_swap_b32 v222, v226
    v_permlane32_swap_b32 v223, v227
    v_permlane32_swap_b32 v224, v228
    s_nop 1
    v_max_f32 v222, v222, v226
    v_max_f32 v223, v223, v227
    v_max_f32 v224, v224, v228
    v_sub_f32 v222, 0, v222
    v_sub_f32 v223, 0, v223
    v_sub_f32 v224, 0, v224
    v_mov_b32 v96, v222
    v_mov_b32 v97, v222
    v_mov_b32 v98, v222
    v_mov_b32 v99, v222
    v_add_f32 v0, v0, v222
    v_add_f32 v1, v1, v222
    v_add_f32 v2, v2, v222
    v_add_f32 v3, v3, v222
    v_add_f32 v4, v4, v222
    v_add_f32 v5, v5, v222
    v_add_f32 v6, v6, v222
    v_add_f32 v7, v7, v222
    v_mov_b32 v100, v223
    v_mov_b32 v101, v223
    v_mov_b32 v102, v223
    v_mov_b32 v103, v223
    v_add_f32 v8, v8, v223
    v_add_f32 v9, v9, v223
    v_add_f32 v10, v10, v223
    v_add_f32 v11, v11, v223
    v_add_f32 v12, v12, v223
    v_add_f32 v13, v13, v223
    v_add_f32 v14, v14, v223
    v_add_f32 v15, v15, v223
    v_mov_b32 v104, v224
    v_mov_b32 v105, v224
    v_mov_b32 v106, v224
    v_mov_b32 v107, v224
    v_add_f32 v16, v16, v224
    v_add_f32 v17, v17, v224
    v_add_f32 v18, v18, v224
    v_add_f32 v19, v19, v224
    v_add_f32 v20, v20, v224
    v_add_f32 v21, v21, v224
    v_add_f32 v22, v22, v224
    v_add_f32 v23, v23, v224
    s_mov_b32 s28, 57344
    s_mov_b32 s29, 16384
    s_waitcnt vmcnt(63) lgkmcnt(0)
    s_barrier
    v_mfma_f32_16x16x32_bf16 v[32:35], a[128:131], v[128:131], v[96:99]
    v_exp_f32 v0, v0
    v_mfma_f32_16x16x32_bf16 v[32:35], a[132:135], v[132:135], v[32:35]
    v_exp_f32 v1, v1
    v_mfma_f32_16x16x32_bf16 v[32:35], a[136:139], v[136:139], v[32:35]
    s_add_u32 s29, s29, 8192
    s_mov_b32 s47, s29
    s_mov_b32 m0, 90112
    s_nop 0
    buffer_load_dwordx4 v208, s[12:15], s47 offen nt lds
    buffer_load_dwordx4 v209, s[12:15], s47 offen offset:1024 nt lds
    v_cvt_pk_bf16_f32 v64, v0, v1
    v_mfma_f32_16x16x32_bf16 v[32:35], a[140:143], v[140:143], v[32:35]
    v_exp_f32 v2, v2
    v_mfma_f32_16x16x32_bf16 v[40:43], a[128:131], v[144:147], v[100:103]
    v_exp_f32 v3, v3
    v_mfma_f32_16x16x32_bf16 v[40:43], a[132:135], v[148:151], v[40:43]
    buffer_load_dwordx4 v208, s[12:15], s47 offen offset:2048 nt lds
    v_cvt_pk_bf16_f32 v65, v2, v3
    v_mfma_f32_16x16x32_bf16 v[40:43], a[136:139], v[152:155], v[40:43]
    v_exp_f32 v4, v4
    v_mfma_f32_16x16x32_bf16 v[40:43], a[140:143], v[156:159], v[40:43]
    v_exp_f32 v5, v5
    v_mfma_f32_16x16x32_bf16 v[48:51], a[128:131], v[160:163], v[104:107]
    buffer_load_dwordx4 v209, s[12:15], s47 offen offset:3072 nt lds
    v_cvt_pk_bf16_f32 v66, v4, v5
    v_mfma_f32_16x16x32_bf16 v[48:51], a[132:135], v[164:167], v[48:51]
    v_exp_f32 v6, v6
    v_mfma_f32_16x16x32_bf16 v[48:51], a[136:139], v[168:171], v[48:51]
    v_exp_f32 v7, v7
    v_mfma_f32_16x16x32_bf16 v[48:51], a[140:143], v[172:175], v[48:51]
    s_add_u32 s47, s29, 4096
    s_mov_b32 m0, 94208
    s_nop 0
    buffer_load_dwordx4 v208, s[12:15], s47 offen nt lds
    v_cvt_pk_bf16_f32 v67, v6, v7
    v_mfma_f32_16x16x32_bf16 v[36:39], a[144:147], v[128:131], v[96:99]
    v_exp_f32 v8, v8
    v_mfma_f32_16x16x32_bf16 v[36:39], a[148:151], v[132:135], v[36:39]
    v_exp_f32 v9, v9
    v_mfma_f32_16x16x32_bf16 v[36:39], a[152:155], v[136:139], v[36:39]
    ds_read_b128 a[128:131], v192 offset:16384
    ds_read_b128 a[132:135], v193 offset:16384
    v_cvt_pk_bf16_f32 v68, v8, v9
    v_mfma_f32_16x16x32_bf16 v[36:39], a[156:159], v[140:143], v[36:39]
    v_exp_f32 v10, v10
    v_mfma_f32_16x16x32_bf16 v[44:47], a[144:147], v[144:147], v[100:103]
    v_exp_f32 v11, v11
    v_mfma_f32_16x16x32_bf16 v[44:47], a[148:151], v[148:151], v[44:47]
    ds_read_b128 a[136:139], v194 offset:16384
    ds_read_b128 a[140:143], v195 offset:16384
    v_cvt_pk_bf16_f32 v69, v10, v11
    v_mfma_f32_16x16x32_bf16 v[44:47], a[152:155], v[152:155], v[44:47]
    v_exp_f32 v12, v12
    v_mfma_f32_16x16x32_bf16 v[44:47], a[156:159], v[156:159], v[44:47]
    v_exp_f32 v13, v13
    v_mfma_f32_16x16x32_bf16 v[52:55], a[144:147], v[160:163], v[104:107]
    buffer_load_dwordx4 v209, s[12:15], s47 offen offset:1024 nt lds
    buffer_load_dwordx4 v208, s[12:15], s47 offen offset:2048 nt lds
    v_cvt_pk_bf16_f32 v70, v12, v13
    v_mfma_f32_16x16x32_bf16 v[52:55], a[148:151], v[164:167], v[52:55]
    v_exp_f32 v14, v14
    v_mfma_f32_16x16x32_bf16 v[52:55], a[152:155], v[168:171], v[52:55]
    v_exp_f32 v15, v15
    v_mfma_f32_16x16x32_bf16 v[52:55], a[156:159], v[172:175], v[52:55]
    buffer_load_dwordx4 v209, s[12:15], s47 offen offset:3072 nt lds
    v_cvt_pk_bf16_f32 v71, v14, v15
    s_nop 0
    v_exp_f32 v16, v16
    v_exp_f32 v17, v17
    s_nop 0
    v_cvt_pk_bf16_f32 v72, v16, v17
    v_exp_f32 v18, v18
    v_exp_f32 v19, v19
    s_nop 0
    v_cvt_pk_bf16_f32 v73, v18, v19
    v_exp_f32 v20, v20
    v_exp_f32 v21, v21
    s_nop 0
    v_cvt_pk_bf16_f32 v74, v20, v21
    v_exp_f32 v22, v22
    v_exp_f32 v23, v23
    s_nop 0
    v_cvt_pk_bf16_f32 v75, v22, v23
    ds_read_b128 a[144:147], v192 offset:20480
    ds_read_b128 a[148:151], v193 offset:20480
    ds_read_b128 a[152:155], v194 offset:20480
    ds_read_b128 a[156:159], v195 offset:20480
    s_waitcnt vmcnt(40) lgkmcnt(0)
    s_barrier
    v_mfma_f32_16x16x32_bf16 v[0:3], a[128:131], v[128:131], v[96:99]
    v_exp_f32 v32, v32
    v_mfma_f32_16x16x32_bf16 v[0:3], a[132:135], v[132:135], v[0:3]
    s_add_u32 s29, s29, 8192
    s_mov_b32 s47, s29
    s_mov_b32 m0, 98304
    s_nop 0
    ds_read_b64_tr_b16 a[160:161], v196 offset:0
    buffer_load_dwordx4 v208, s[12:15], s47 offen nt lds
    ds_read_b64_tr_b16 a[162:163], v196 offset:4096
    v_mfma_f32_16x16x32_bf16 v[0:3], a[136:139], v[136:139], v[0:3]
    v_exp_f32 v33, v33
    v_mfma_f32_16x16x32_bf16 v[0:3], a[140:143], v[140:143], v[0:3]
    ds_read_b64_tr_b16 a[164:165], v197 offset:0
    ds_read_b64_tr_b16 a[166:167], v197 offset:4096
    v_mfma_f32_16x16x32_bf16 v[8:11], a[128:131], v[144:147], v[100:103]
    v_exp_f32 v34, v34
    v_mfma_f32_16x16x32_bf16 v[8:11], a[132:135], v[148:151], v[8:11]
    ds_read_b64_tr_b16 a[168:169], v198 offset:0
    ds_read_b64_tr_b16 a[170:171], v198 offset:4096
    v_cvt_pk_bf16_f32 v80, v32, v33
    v_mfma_f32_16x16x32_bf16 v[8:11], a[136:139], v[152:155], v[8:11]
    v_exp_f32 v35, v35
    v_mfma_f32_16x16x32_bf16 v[8:11], a[140:143], v[156:159], v[8:11]
    ds_read_b64_tr_b16 a[172:173], v199 offset:0
    buffer_load_dwordx4 v209, s[12:15], s47 offen offset:1024 nt lds
    ds_read_b64_tr_b16 a[174:175], v199 offset:4096
    v_mfma_f32_16x16x32_bf16 v[16:19], a[128:131], v[160:163], v[104:107]
    v_exp_f32 v36, v36
    v_mfma_f32_16x16x32_bf16 v[16:19], a[132:135], v[164:167], v[16:19]
    ds_read_b64_tr_b16 a[176:177], v200 offset:0
    ds_read_b64_tr_b16 a[178:179], v200 offset:4096
    v_cvt_pk_bf16_f32 v81, v34, v35
    v_mfma_f32_16x16x32_bf16 v[16:19], a[136:139], v[168:171], v[16:19]
    v_exp_f32 v37, v37
    v_mfma_f32_16x16x32_bf16 v[16:19], a[140:143], v[172:175], v[16:19]
    ds_read_b64_tr_b16 a[180:181], v201 offset:0
    ds_read_b64_tr_b16 a[182:183], v201 offset:4096
    v_mfma_f32_16x16x32_bf16 v[4:7], a[144:147], v[128:131], v[96:99]
    v_exp_f32 v38, v38
    v_mfma_f32_16x16x32_bf16 v[4:7], a[148:151], v[132:135], v[4:7]
    ds_read_b64_tr_b16 a[184:185], v202 offset:0
    ds_read_b128 a[128:131], v192 offset:24576
    v_cvt_pk_bf16_f32 v82, v36, v37
    v_mfma_f32_16x16x32_bf16 v[4:7], a[152:155], v[136:139], v[4:7]
    v_exp_f32 v39, v39
    v_mfma_f32_16x16x32_bf16 v[4:7], a[156:159], v[140:143], v[4:7]
    ds_read_b128 a[132:135], v193 offset:24576
    ds_read_b128 a[136:139], v194 offset:24576
    ds_read_b128 a[140:143], v195 offset:24576
    v_mfma_f32_16x16x32_bf16 v[12:15], a[144:147], v[144:147], v[100:103]
    v_exp_f32 v40, v40
    v_mfma_f32_16x16x32_bf16 v[12:15], a[148:151], v[148:151], v[12:15]
    buffer_load_dwordx4 v208, s[12:15], s47 offen offset:2048 nt lds
    ds_read_b64_tr_b16 a[186:187], v202 offset:4096
    v_cvt_pk_bf16_f32 v83, v38, v39
    v_mfma_f32_16x16x32_bf16 v[12:15], a[152:155], v[152:155], v[12:15]
    v_exp_f32 v41, v41
    v_mfma_f32_16x16x32_bf16 v[12:15], a[156:159], v[156:159], v[12:15]
    ds_read_b64_tr_b16 a[188:189], v203 offset:0
    ds_read_b64_tr_b16 a[190:191], v203 offset:4096
    buffer_load_dwordx4 v209, s[12:15], s47 offen offset:3072 nt lds
    v_mfma_f32_16x16x32_bf16 v[20:23], a[144:147], v[160:163], v[104:107]
    v_exp_f32 v42, v42
    v_mfma_f32_16x16x32_bf16 v[20:23], a[148:151], v[164:167], v[20:23]
    v_cvt_pk_bf16_f32 v84, v40, v41
    v_mfma_f32_16x16x32_bf16 v[20:23], a[152:155], v[168:171], v[20:23]
    v_exp_f32 v43, v43
    v_mfma_f32_16x16x32_bf16 v[20:23], a[156:159], v[172:175], v[20:23]
    s_waitcnt lgkmcnt(2)
    v_mfma_f32_16x16x32_bf16 a[0:3], a[160:163], v[64:67], 0
    v_exp_f32 v44, v44
    v_mfma_f32_16x16x32_bf16 a[16:19], a[164:167], v[64:67], 0
    ds_read_b128 a[144:147], v192 offset:28672
    ds_read_b128 a[148:151], v193 offset:28672
    v_cvt_pk_bf16_f32 v85, v42, v43
    v_mfma_f32_16x16x32_bf16 a[4:7], a[160:163], v[68:71], 0
    v_exp_f32 v45, v45
    v_mfma_f32_16x16x32_bf16 a[20:23], a[164:167], v[68:71], 0
    s_add_u32 s47, s29, 4096
    s_mov_b32 m0, 102400
    s_nop 0
    ds_read_b128 a[152:155], v194 offset:28672
    ds_read_b128 a[156:159], v195 offset:28672
    buffer_load_dwordx4 v208, s[12:15], s47 offen nt lds
    v_mfma_f32_16x16x32_bf16 a[8:11], a[160:163], v[72:75], 0
    v_exp_f32 v46, v46
    v_mfma_f32_16x16x32_bf16 a[24:27], a[164:167], v[72:75], 0
    v_cvt_pk_bf16_f32 v86, v44, v45
    v_mfma_f32_16x16x32_bf16 a[192:195], a[208:211], v[64:67], 0
    v_exp_f32 v47, v47
    v_mfma_f32_16x16x32_bf16 a[32:35], a[168:171], v[64:67], 0
    buffer_load_dwordx4 v209, s[12:15], s47 offen offset:1024 nt lds
    v_mfma_f32_16x16x32_bf16 a[48:51], a[172:175], v[64:67], 0
    v_exp_f32 v48, v48
    v_mfma_f32_16x16x32_bf16 a[36:39], a[168:171], v[68:71], 0
    v_cvt_pk_bf16_f32 v87, v46, v47
    v_mfma_f32_16x16x32_bf16 a[52:55], a[172:175], v[68:71], 0
    v_exp_f32 v49, v49
    v_mfma_f32_16x16x32_bf16 a[40:43], a[168:171], v[72:75], 0
    v_mfma_f32_16x16x32_bf16 a[56:59], a[172:175], v[72:75], 0
    v_exp_f32 v50, v50
    v_mfma_f32_16x16x32_bf16 a[196:199], a[208:211], v[68:71], 0
    buffer_load_dwordx4 v208, s[12:15], s47 offen offset:2048 nt lds
    v_cvt_pk_bf16_f32 v88, v48, v49
    v_mfma_f32_16x16x32_bf16 a[64:67], a[176:179], v[64:67], 0
    v_exp_f32 v51, v51
    v_mfma_f32_16x16x32_bf16 a[80:83], a[180:183], v[64:67], 0
    v_mfma_f32_16x16x32_bf16 a[68:71], a[176:179], v[68:71], 0
    v_exp_f32 v52, v52
    v_mfma_f32_16x16x32_bf16 a[84:87], a[180:183], v[68:71], 0
    v_cvt_pk_bf16_f32 v89, v50, v51
    v_mfma_f32_16x16x32_bf16 a[72:75], a[176:179], v[72:75], 0
    v_exp_f32 v53, v53
    v_mfma_f32_16x16x32_bf16 a[88:91], a[180:183], v[72:75], 0
    buffer_load_dwordx4 v209, s[12:15], s47 offen offset:3072 nt lds
    v_mfma_f32_16x16x32_bf16 a[200:203], a[208:211], v[72:75], 0
    v_exp_f32 v54, v54
    v_mfma_f32_16x16x32_bf16 a[96:99], a[184:187], v[64:67], 0
    s_waitcnt lgkmcnt(4)
    v_cvt_pk_bf16_f32 v90, v52, v53
    v_mfma_f32_16x16x32_bf16 a[112:115], a[188:191], v[64:67], 0
    v_exp_f32 v55, v55
    v_mfma_f32_16x16x32_bf16 a[100:103], a[184:187], v[68:71], 0
    v_mfma_f32_16x16x32_bf16 a[116:119], a[188:191], v[68:71], 0
    v_mfma_f32_16x16x32_bf16 a[104:107], a[184:187], v[72:75], 0
    v_cvt_pk_bf16_f32 v91, v54, v55
    v_mfma_f32_16x16x32_bf16 a[120:123], a[188:191], v[72:75], 0
    s_waitcnt vmcnt(40) lgkmcnt(0)
    s_barrier
    s_mov_b32 s30, 0
    s_branch L1_pos2b
    .p2align 6
L1_pos0b:
    v_mfma_f32_16x16x32_bf16 v[32:35], a[128:131], v[128:131], v[96:99]
    v_exp_f32 v0, v0
    v_mfma_f32_16x16x32_bf16 v[32:35], a[132:135], v[132:135], v[32:35]
    s_add_u32 s29, s29, 8192
    s_mov_b32 s47, s29
    s_mov_b32 m0, 90112
    s_nop 0
    ds_read_b64_tr_b16 a[160:161], v196 offset:57344
    buffer_load_dwordx4 v208, s[12:15], s47 offen nt lds
    ds_read_b64_tr_b16 a[162:163], v196 offset:61440
    v_mfma_f32_16x16x32_bf16 v[32:35], a[136:139], v[136:139], v[32:35]
    v_exp_f32 v1, v1
    v_mfma_f32_16x16x32_bf16 v[32:35], a[140:143], v[140:143], v[32:35]
    ds_read_b64_tr_b16 a[164:165], v197 offset:57344
    ds_read_b64_tr_b16 a[166:167], v197 offset:61440
    buffer_load_dwordx4 v209, s[12:15], s47 offen offset:1024 nt lds
    v_mfma_f32_16x16x32_bf16 v[40:43], a[128:131], v[144:147], v[100:103]
    v_exp_f32 v2, v2
    v_mfma_f32_16x16x32_bf16 v[40:43], a[132:135], v[148:151], v[40:43]
    ds_read_b64_tr_b16 a[168:169], v198 offset:57344
    ds_read_b64_tr_b16 a[170:171], v198 offset:61440
    v_cvt_pk_bf16_f32 v64, v0, v1
    v_mfma_f32_16x16x32_bf16 v[40:43], a[136:139], v[152:155], v[40:43]
    v_exp_f32 v3, v3
    v_mfma_f32_16x16x32_bf16 v[40:43], a[140:143], v[156:159], v[40:43]
    ds_read_b64_tr_b16 a[172:173], v199 offset:57344
    buffer_load_dwordx4 v208, s[12:15], s47 offen offset:2048 nt lds
    ds_read_b64_tr_b16 a[174:175], v199 offset:61440
    v_mfma_f32_16x16x32_bf16 v[48:51], a[128:131], v[160:163], v[104:107]
    v_exp_f32 v4, v4
    v_mfma_f32_16x16x32_bf16 v[48:51], a[132:135], v[164:167], v[48:51]
    ds_read_b64_tr_b16 a[176:177], v200 offset:57344
    ds_read_b64_tr_b16 a[178:179], v200 offset:61440
    v_cvt_pk_bf16_f32 v65, v2, v3
    v_mfma_f32_16x16x32_bf16 v[48:51], a[136:139], v[168:171], v[48:51]
    v_exp_f32 v5, v5
    v_mfma_f32_16x16x32_bf16 v[48:51], a[140:143], v[172:175], v[48:51]
    buffer_load_dwordx4 v209, s[12:15], s47 offen offset:3072 nt lds
    ds_read_b64_tr_b16 a[180:181], v201 offset:57344
    ds_read_b64_tr_b16 a[182:183], v201 offset:61440
    v_mfma_f32_16x16x32_bf16 v[36:39], a[144:147], v[128:131], v[96:99]
    v_exp_f32 v6, v6
    v_mfma_f32_16x16x32_bf16 v[36:39], a[148:151], v[132:135], v[36:39]
    ds_read_b64_tr_b16 a[184:185], v202 offset:57344
    ds_read_b128 a[128:131], v192 offset:16384
    v_cvt_pk_bf16_f32 v66, v4, v5
    v_mfma_f32_16x16x32_bf16 v[36:39], a[152:155], v[136:139], v[36:39]
    v_exp_f32 v7, v7
    v_mfma_f32_16x16x32_bf16 v[36:39], a[156:159], v[140:143], v[36:39]
    ds_read_b128 a[132:135], v193 offset:16384
    ds_read_b128 a[136:139], v194 offset:16384
    ds_read_b128 a[140:143], v195 offset:16384
    v_mfma_f32_16x16x32_bf16 v[44:47], a[144:147], v[144:147], v[100:103]
    v_exp_f32 v8, v8
    v_mfma_f32_16x16x32_bf16 v[44:47], a[148:151], v[148:151], v[44:47]
    s_add_u32 s47, s29, 4096
    s_mov_b32 m0, 94208
    s_nop 0
    buffer_load_dwordx4 v208, s[12:15], s47 offen nt lds
    ds_read_b64_tr_b16 a[186:187], v202 offset:61440
    v_cvt_pk_bf16_f32 v67, v6, v7
    v_mfma_f32_16x16x32_bf16 v[44:47], a[152:155], v[152:155], v[44:47]
    v_exp_f32 v9, v9
    v_mfma_f32_16x16x32_bf16 v[44:47], a[156:159], v[156:159], v[44:47]
    ds_read_b64_tr_b16 a[188:189], v203 offset:57344
    ds_read_b64_tr_b16 a[190:191], v203 offset:61440
    buffer_load_dwordx4 v209, s[12:15], s47 offen offset:1024 nt lds
    v_mfma_f32_16x16x32_bf16 v[52:55], a[144:147], v[160:163], v[104:107]
    v_exp_f32 v10, v10
    v_mfma_f32_16x16x32_bf16 v[52:55], a[148:151], v[164:167], v[52:55]
    buffer_load_dwordx4 v208, s[12:15], s47 offen offset:2048 nt lds
    buffer_load_dwordx4 v209, s[12:15], s47 offen offset:3072 nt lds
    v_cvt_pk_bf16_f32 v68, v8, v9
    v_mfma_f32_16x16x32_bf16 v[52:55], a[152:155], v[168:171], v[52:55]
    v_exp_f32 v11, v11
    v_mfma_f32_16x16x32_bf16 v[52:55], a[156:159], v[172:175], v[52:55]
    s_waitcnt lgkmcnt(2)
    v_mfma_f32_16x16x32_bf16 a[0:3], a[160:163], v[80:83], a[0:3]
    v_exp_f32 v12, v12
    v_mfma_f32_16x16x32_bf16 a[16:19], a[164:167], v[80:83], a[16:19]
    ds_read_b128 a[144:147], v192 offset:20480
    ds_read_b128 a[148:151], v193 offset:20480
    v_cvt_pk_bf16_f32 v69, v10, v11
    v_mfma_f32_16x16x32_bf16 a[4:7], a[160:163], v[84:87], a[4:7]
    v_exp_f32 v13, v13
    v_mfma_f32_16x16x32_bf16 a[20:23], a[164:167], v[84:87], a[20:23]
    s_add_u32 s28, s28, 8192
    s_mov_b32 s47, s28
    s_mov_b32 m0, 49152
    s_nop 0
    ds_read_b128 a[152:155], v194 offset:20480
    ds_read_b128 a[156:159], v195 offset:20480
    buffer_load_dwordx4 v204, s[8:11], s47 offen nt lds
    v_mfma_f32_16x16x32_bf16 a[8:11], a[160:163], v[88:91], a[8:11]
    v_exp_f32 v14, v14
    v_mfma_f32_16x16x32_bf16 a[24:27], a[164:167], v[88:91], a[24:27]
    buffer_load_dwordx4 v205, s[8:11], s47 offen offset:1024 nt lds
    v_cvt_pk_bf16_f32 v70, v12, v13
    v_mfma_f32_16x16x32_bf16 a[192:195], a[208:211], v[80:83], a[192:195]
    v_exp_f32 v15, v15
    v_mfma_f32_16x16x32_bf16 a[32:35], a[168:171], v[80:83], a[32:35]
    buffer_load_dwordx4 v206, s[8:11], s47 offen offset:2048 nt lds
    v_mfma_f32_16x16x32_bf16 a[48:51], a[172:175], v[80:83], a[48:51]
    v_exp_f32 v16, v16
    v_mfma_f32_16x16x32_bf16 a[36:39], a[168:171], v[84:87], a[36:39]
    buffer_load_dwordx4 v207, s[8:11], s47 offen offset:3072 nt lds
    v_cvt_pk_bf16_f32 v71, v14, v15
    v_mfma_f32_16x16x32_bf16 a[52:55], a[172:175], v[84:87], a[52:55]
    v_exp_f32 v17, v17
    v_mfma_f32_16x16x32_bf16 a[40:43], a[168:171], v[88:91], a[40:43]
    v_mfma_f32_16x16x32_bf16 a[56:59], a[172:175], v[88:91], a[56:59]
    v_exp_f32 v18, v18
    v_mfma_f32_16x16x32_bf16 a[196:199], a[208:211], v[84:87], a[196:199]
    s_add_u32 s47, s28, 4096
    s_mov_b32 m0, 53248
    s_nop 0
    buffer_load_dwordx4 v204, s[8:11], s47 offen nt lds
    v_cvt_pk_bf16_f32 v72, v16, v17
    v_mfma_f32_16x16x32_bf16 a[64:67], a[176:179], v[80:83], a[64:67]
    v_exp_f32 v19, v19
    v_mfma_f32_16x16x32_bf16 a[80:83], a[180:183], v[80:83], a[80:83]
    buffer_load_dwordx4 v205, s[8:11], s47 offen offset:1024 nt lds
    v_mfma_f32_16x16x32_bf16 a[68:71], a[176:179], v[84:87], a[68:71]
    v_exp_f32 v20, v20
    v_mfma_f32_16x16x32_bf16 a[84:87], a[180:183], v[84:87], a[84:87]
    v_cvt_pk_bf16_f32 v73, v18, v19
    v_mfma_f32_16x16x32_bf16 a[72:75], a[176:179], v[88:91], a[72:75]
    v_exp_f32 v21, v21
    v_mfma_f32_16x16x32_bf16 a[88:91], a[180:183], v[88:91], a[88:91]
    buffer_load_dwordx4 v206, s[8:11], s47 offen offset:2048 nt lds
    v_mfma_f32_16x16x32_bf16 a[200:203], a[208:211], v[88:91], a[200:203]
    v_exp_f32 v22, v22
    v_mfma_f32_16x16x32_bf16 a[96:99], a[184:187], v[80:83], a[96:99]
    s_waitcnt lgkmcnt(4)
    buffer_load_dwordx4 v207, s[8:11], s47 offen offset:3072 nt lds
    v_cvt_pk_bf16_f32 v74, v20, v21
    v_mfma_f32_16x16x32_bf16 a[112:115], a[188:191], v[80:83], a[112:115]
    v_exp_f32 v23, v23
    v_mfma_f32_16x16x32_bf16 a[100:103], a[184:187], v[84:87], a[100:103]
    v_mfma_f32_16x16x32_bf16 a[116:119], a[188:191], v[84:87], a[116:119]
    v_mfma_f32_16x16x32_bf16 a[104:107], a[184:187], v[88:91], a[104:107]
    v_cvt_pk_bf16_f32 v75, v22, v23
    v_mfma_f32_16x16x32_bf16 a[120:123], a[188:191], v[88:91], a[120:123]
    s_waitcnt vmcnt(48) lgkmcnt(0)
    s_barrier
L1_pos1b:
    v_mfma_f32_16x16x32_bf16 v[0:3], a[128:131], v[128:131], v[96:99]
    v_exp_f32 v32, v32
    v_mfma_f32_16x16x32_bf16 v[0:3], a[132:135], v[132:135], v[0:3]
    s_add_u32 s29, s29, 8192
    s_mov_b32 s47, s29
    s_mov_b32 m0, 98304
    s_nop 0
    ds_read_b64_tr_b16 a[160:161], v196 offset:0
    buffer_load_dwordx4 v208, s[12:15], s47 offen nt lds
    ds_read_b64_tr_b16 a[162:163], v196 offset:4096
    v_mfma_f32_16x16x32_bf16 v[0:3], a[136:139], v[136:139], v[0:3]
    v_exp_f32 v33, v33
    v_mfma_f32_16x16x32_bf16 v[0:3], a[140:143], v[140:143], v[0:3]
    ds_read_b64_tr_b16 a[164:165], v197 offset:0
    ds_read_b64_tr_b16 a[166:167], v197 offset:4096
    buffer_load_dwordx4 v209, s[12:15], s47 offen offset:1024 nt lds
    v_mfma_f32_16x16x32_bf16 v[8:11], a[128:131], v[144:147], v[100:103]
    v_exp_f32 v34, v34
    v_mfma_f32_16x16x32_bf16 v[8:11], a[132:135], v[148:151], v[8:11]
    ds_read_b64_tr_b16 a[168:169], v198 offset:0
    ds_read_b64_tr_b16 a[170:171], v198 offset:4096
    v_cvt_pk_bf16_f32 v80, v32, v33
    v_mfma_f32_16x16x32_bf16 v[8:11], a[136:139], v[152:155], v[8:11]
    v_exp_f32 v35, v35
    v_mfma_f32_16x16x32_bf16 v[8:11], a[140:143], v[156:159], v[8:11]
    ds_read_b64_tr_b16 a[172:173], v199 offset:0
    buffer_load_dwordx4 v208, s[12:15], s47 offen offset:2048 nt lds
    ds_read_b64_tr_b16 a[174:175], v199 offset:4096
    v_mfma_f32_16x16x32_bf16 v[16:19], a[128:131], v[160:163], v[104:107]
    v_exp_f32 v36, v36
    v_mfma_f32_16x16x32_bf16 v[16:19], a[132:135], v[164:167], v[16:19]
    ds_read_b64_tr_b16 a[176:177], v200 offset:0
    ds_read_b64_tr_b16 a[178:179], v200 offset:4096
    v_cvt_pk_bf16_f32 v81, v34, v35
    v_mfma_f32_16x16x32_bf16 v[16:19], a[136:139], v[168:171], v[16:19]
    v_exp_f32 v37, v37
    v_mfma_f32_16x16x32_bf16 v[16:19], a[140:143], v[172:175], v[16:19]
    buffer_load_dwordx4 v209, s[12:15], s47 offen offset:3072 nt lds
    ds_read_b64_tr_b16 a[180:181], v201 offset:0
    ds_read_b64_tr_b16 a[182:183], v201 offset:4096
    v_mfma_f32_16x16x32_bf16 v[4:7], a[144:147], v[128:131], v[96:99]
    v_exp_f32 v38, v38
    v_mfma_f32_16x16x32_bf16 v[4:7], a[148:151], v[132:135], v[4:7]
    ds_read_b64_tr_b16 a[184:185], v202 offset:0
    ds_read_b128 a[128:131], v192 offset:24576
    v_cvt_pk_bf16_f32 v82, v36, v37
    v_mfma_f32_16x16x32_bf16 v[4:7], a[152:155], v[136:139], v[4:7]
    v_exp_f32 v39, v39
    v_mfma_f32_16x16x32_bf16 v[4:7], a[156:159], v[140:143], v[4:7]
    ds_read_b128 a[132:135], v193 offset:24576
    ds_read_b128 a[136:139], v194 offset:24576
    ds_read_b128 a[140:143], v195 offset:24576
    v_mfma_f32_16x16x32_bf16 v[12:15], a[144:147], v[144:147], v[100:103]
    v_exp_f32 v40, v40
    v_mfma_f32_16x16x32_bf16 v[12:15], a[148:151], v[148:151], v[12:15]
    s_add_u32 s47, s29, 4096
    s_mov_b32 m0, 102400
    s_nop 0
    buffer_load_dwordx4 v208, s[12:15], s47 offen nt lds
    ds_read_b64_tr_b16 a[186:187], v202 offset:4096
    v_cvt_pk_bf16_f32 v83, v38, v39
    v_mfma_f32_16x16x32_bf16 v[12:15], a[152:155], v[152:155], v[12:15]
    v_exp_f32 v41, v41
    v_mfma_f32_16x16x32_bf16 v[12:15], a[156:159], v[156:159], v[12:15]
    ds_read_b64_tr_b16 a[188:189], v203 offset:0
    ds_read_b64_tr_b16 a[190:191], v203 offset:4096
    buffer_load_dwordx4 v209, s[12:15], s47 offen offset:1024 nt lds
    v_mfma_f32_16x16x32_bf16 v[20:23], a[144:147], v[160:163], v[104:107]
    v_exp_f32 v42, v42
    v_mfma_f32_16x16x32_bf16 v[20:23], a[148:151], v[164:167], v[20:23]
    buffer_load_dwordx4 v208, s[12:15], s47 offen offset:2048 nt lds
    buffer_load_dwordx4 v209, s[12:15], s47 offen offset:3072 nt lds
    v_cvt_pk_bf16_f32 v84, v40, v41
    v_mfma_f32_16x16x32_bf16 v[20:23], a[152:155], v[168:171], v[20:23]
    v_exp_f32 v43, v43
    v_mfma_f32_16x16x32_bf16 v[20:23], a[156:159], v[172:175], v[20:23]
    s_waitcnt lgkmcnt(2)
    v_mfma_f32_16x16x32_bf16 a[0:3], a[160:163], v[64:67], a[0:3]
    v_exp_f32 v44, v44
    v_mfma_f32_16x16x32_bf16 a[16:19], a[164:167], v[64:67], a[16:19]
    ds_read_b128 a[144:147], v192 offset:28672
    ds_read_b128 a[148:151], v193 offset:28672
    v_cvt_pk_bf16_f32 v85, v42, v43
    v_mfma_f32_16x16x32_bf16 a[4:7], a[160:163], v[68:71], a[4:7]
    v_exp_f32 v45, v45
    v_mfma_f32_16x16x32_bf16 a[20:23], a[164:167], v[68:71], a[20:23]
    s_add_u32 s28, s28, 8192
    s_mov_b32 s47, s28
    s_mov_b32 m0, 57344
    s_nop 0
    ds_read_b128 a[152:155], v194 offset:28672
    ds_read_b128 a[156:159], v195 offset:28672
    buffer_load_dwordx4 v204, s[8:11], s47 offen nt lds
    v_mfma_f32_16x16x32_bf16 a[8:11], a[160:163], v[72:75], a[8:11]
    v_exp_f32 v46, v46
    v_mfma_f32_16x16x32_bf16 a[24:27], a[164:167], v[72:75], a[24:27]
    buffer_load_dwordx4 v205, s[8:11], s47 offen offset:1024 nt lds
    v_cvt_pk_bf16_f32 v86, v44, v45
    v_mfma_f32_16x16x32_bf16 a[192:195], a[208:211], v[64:67], a[192:195]
    v_exp_f32 v47, v47
    v_mfma_f32_16x16x32_bf16 a[32:35], a[168:171], v[64:67], a[32:35]
    buffer_load_dwordx4 v206, s[8:11], s47 offen offset:2048 nt lds
    v_mfma_f32_16x16x32_bf16 a[48:51], a[172:175], v[64:67], a[48:51]
    v_exp_f32 v48, v48
    v_mfma_f32_16x16x32_bf16 a[36:39], a[168:171], v[68:71], a[36:39]
    buffer_load_dwordx4 v207, s[8:11], s47 offen offset:3072 nt lds
    v_cvt_pk_bf16_f32 v87, v46, v47
    v_mfma_f32_16x16x32_bf16 a[52:55], a[172:175], v[68:71], a[52:55]
    v_exp_f32 v49, v49
    v_mfma_f32_16x16x32_bf16 a[40:43], a[168:171], v[72:75], a[40:43]
    v_mfma_f32_16x16x32_bf16 a[56:59], a[172:175], v[72:75], a[56:59]
    v_exp_f32 v50, v50
    v_mfma_f32_16x16x32_bf16 a[196:199], a[208:211], v[68:71], a[196:199]
    s_add_u32 s47, s28, 4096
    s_mov_b32 m0, 61440
    s_nop 0
    buffer_load_dwordx4 v204, s[8:11], s47 offen nt lds
    v_cvt_pk_bf16_f32 v88, v48, v49
    v_mfma_f32_16x16x32_bf16 a[64:67], a[176:179], v[64:67], a[64:67]
    v_exp_f32 v51, v51
    v_mfma_f32_16x16x32_bf16 a[80:83], a[180:183], v[64:67], a[80:83]
    buffer_load_dwordx4 v205, s[8:11], s47 offen offset:1024 nt lds
    v_mfma_f32_16x16x32_bf16 a[68:71], a[176:179], v[68:71], a[68:71]
    v_exp_f32 v52, v52
    v_mfma_f32_16x16x32_bf16 a[84:87], a[180:183], v[68:71], a[84:87]
    v_cvt_pk_bf16_f32 v89, v50, v51
    v_mfma_f32_16x16x32_bf16 a[72:75], a[176:179], v[72:75], a[72:75]
    v_exp_f32 v53, v53
    v_mfma_f32_16x16x32_bf16 a[88:91], a[180:183], v[72:75], a[88:91]
    buffer_load_dwordx4 v206, s[8:11], s47 offen offset:2048 nt lds
    v_mfma_f32_16x16x32_bf16 a[200:203], a[208:211], v[72:75], a[200:203]
    v_exp_f32 v54, v54
    v_mfma_f32_16x16x32_bf16 a[96:99], a[184:187], v[64:67], a[96:99]
    s_waitcnt lgkmcnt(4)
    buffer_load_dwordx4 v207, s[8:11], s47 offen offset:3072 nt lds
    v_cvt_pk_bf16_f32 v90, v52, v53
    v_mfma_f32_16x16x32_bf16 a[112:115], a[188:191], v[64:67], a[112:115]
    v_exp_f32 v55, v55
    v_mfma_f32_16x16x32_bf16 a[100:103], a[184:187], v[68:71], a[100:103]
    v_mfma_f32_16x16x32_bf16 a[116:119], a[188:191], v[68:71], a[116:119]
    v_mfma_f32_16x16x32_bf16 a[104:107], a[184:187], v[72:75], a[104:107]
    v_cvt_pk_bf16_f32 v91, v54, v55
    v_mfma_f32_16x16x32_bf16 a[120:123], a[188:191], v[72:75], a[120:123]
    s_waitcnt vmcnt(48) lgkmcnt(0)
    s_barrier
L1_pos2b:
    v_mfma_f32_16x16x32_bf16 v[32:35], a[128:131], v[128:131], v[96:99]
    v_exp_f32 v0, v0
    v_mfma_f32_16x16x32_bf16 v[32:35], a[132:135], v[132:135], v[32:35]
    s_add_u32 s29, s29, 8192
    s_mov_b32 s47, s29
    s_mov_b32 m0, 106496
    s_nop 0
    ds_read_b64_tr_b16 a[160:161], v196 offset:8192
    buffer_load_dwordx4 v208, s[12:15], s47 offen nt lds
    ds_read_b64_tr_b16 a[162:163], v196 offset:12288
    v_mfma_f32_16x16x32_bf16 v[32:35], a[136:139], v[136:139], v[32:35]
    v_exp_f32 v1, v1
    v_mfma_f32_16x16x32_bf16 v[32:35], a[140:143], v[140:143], v[32:35]
    ds_read_b64_tr_b16 a[164:165], v197 offset:8192
    ds_read_b64_tr_b16 a[166:167], v197 offset:12288
    buffer_load_dwordx4 v209, s[12:15], s47 offen offset:1024 nt lds
    v_mfma_f32_16x16x32_bf16 v[40:43], a[128:131], v[144:147], v[100:103]
    v_exp_f32 v2, v2
    v_mfma_f32_16x16x32_bf16 v[40:43], a[132:135], v[148:151], v[40:43]
    ds_read_b64_tr_b16 a[168:169], v198 offset:8192
    ds_read_b64_tr_b16 a[170:171], v198 offset:12288
    v_cvt_pk_bf16_f32 v64, v0, v1
    v_mfma_f32_16x16x32_bf16 v[40:43], a[136:139], v[152:155], v[40:43]
    v_exp_f32 v3, v3
    v_mfma_f32_16x16x32_bf16 v[40:43], a[140:143], v[156:159], v[40:43]
    ds_read_b64_tr_b16 a[172:173], v199 offset:8192
    buffer_load_dwordx4 v208, s[12:15], s47 offen offset:2048 nt lds
    ds_read_b64_tr_b16 a[174:175], v199 offset:12288
    v_mfma_f32_16x16x32_bf16 v[48:51], a[128:131], v[160:163], v[104:107]
    v_exp_f32 v4, v4
    v_mfma_f32_16x16x32_bf16 v[48:51], a[132:135], v[164:167], v[48:51]
    ds_read_b64_tr_b16 a[176:177], v200 offset:8192
    ds_read_b64_tr_b16 a[178:179], v200 offset:12288
    v_cvt_pk_bf16_f32 v65, v2, v3
    v_mfma_f32_16x16x32_bf16 v[48:51], a[136:139], v[168:171], v[48:51]
    v_exp_f32 v5, v5
    v_mfma_f32_16x16x32_bf16 v[48:51], a[140:143], v[172:175], v[48:51]
    buffer_load_dwordx4 v209, s[12:15], s47 offen offset:3072 nt lds
    ds_read_b64_tr_b16 a[180:181], v201 offset:8192
    ds_read_b64_tr_b16 a[182:183], v201 offset:12288
    v_mfma_f32_16x16x32_bf16 v[36:39], a[144:147], v[128:131], v[96:99]
    v_exp_f32 v6, v6
    v_mfma_f32_16x16x32_bf16 v[36:39], a[148:151], v[132:135], v[36:39]
    ds_read_b64_tr_b16 a[184:185], v202 offset:8192
    ds_read_b128 a[128:131], v192 offset:32768
    v_cvt_pk_bf16_f32 v66, v4, v5
    v_mfma_f32_16x16x32_bf16 v[36:39], a[152:155], v[136:139], v[36:39]
    v_exp_f32 v7, v7
    v_mfma_f32_16x16x32_bf16 v[36:39], a[156:159], v[140:143], v[36:39]
    ds_read_b128 a[132:135], v193 offset:32768
    ds_read_b128 a[136:139], v194 offset:32768
    ds_read_b128 a[140:143], v195 offset:32768
    v_mfma_f32_16x16x32_bf16 v[44:47], a[144:147], v[144:147], v[100:103]
    v_exp_f32 v8, v8
    v_mfma_f32_16x16x32_bf16 v[44:47], a[148:151], v[148:151], v[44:47]
    s_add_u32 s47, s29, 4096
    s_mov_b32 m0, 110592
    s_nop 0
    buffer_load_dwordx4 v208, s[12:15], s47 offen nt lds
    ds_read_b64_tr_b16 a[186:187], v202 offset:12288
    v_cvt_pk_bf16_f32 v67, v6, v7
    v_mfma_f32_16x16x32_bf16 v[44:47], a[152:155], v[152:155], v[44:47]
    v_exp_f32 v9, v9
    v_mfma_f32_16x16x32_bf16 v[44:47], a[156:159], v[156:159], v[44:47]
    ds_read_b64_tr_b16 a[188:189], v203 offset:8192
    ds_read_b64_tr_b16 a[190:191], v203 offset:12288
    buffer_load_dwordx4 v209, s[12:15], s47 offen offset:1024 nt lds
    v_mfma_f32_16x16x32_bf16 v[52:55], a[144:147], v[160:163], v[104:107]
    v_exp_f32 v10, v10
    v_mfma_f32_16x16x32_bf16 v[52:55], a[148:151], v[164:167], v[52:55]
    buffer_load_dwordx4 v208, s[12:15], s47 offen offset:2048 nt lds
    buffer_load_dwordx4 v209, s[12:15], s47 offen offset:3072 nt lds
    v_cvt_pk_bf16_f32 v68, v8, v9
    v_mfma_f32_16x16x32_bf16 v[52:55], a[152:155], v[168:171], v[52:55]
    v_exp_f32 v11, v11
    v_mfma_f32_16x16x32_bf16 v[52:55], a[156:159], v[172:175], v[52:55]
    s_waitcnt lgkmcnt(2)
    v_mfma_f32_16x16x32_bf16 a[0:3], a[160:163], v[80:83], a[0:3]
    v_exp_f32 v12, v12
    v_mfma_f32_16x16x32_bf16 a[16:19], a[164:167], v[80:83], a[16:19]
    ds_read_b128 a[144:147], v192 offset:36864
    ds_read_b128 a[148:151], v193 offset:36864
    v_cvt_pk_bf16_f32 v69, v10, v11
    v_mfma_f32_16x16x32_bf16 a[4:7], a[160:163], v[84:87], a[4:7]
    v_exp_f32 v13, v13
    v_mfma_f32_16x16x32_bf16 a[20:23], a[164:167], v[84:87], a[20:23]
    s_add_u32 s28, s28, 8192
    s_mov_b32 s47, s28
    s_mov_b32 m0, 0
    s_nop 0
    ds_read_b128 a[152:155], v194 offset:36864
    ds_read_b128 a[156:159], v195 offset:36864
    buffer_load_dwordx4 v204, s[8:11], s47 offen nt lds
    v_mfma_f32_16x16x32_bf16 a[8:11], a[160:163], v[88:91], a[8:11]
    v_exp_f32 v14, v14
    v_mfma_f32_16x16x32_bf16 a[24:27], a[164:167], v[88:91], a[24:27]
    buffer_load_dwordx4 v205, s[8:11], s47 offen offset:1024 nt lds
    v_cvt_pk_bf16_f32 v70, v12, v13
    v_mfma_f32_16x16x32_bf16 a[192:195], a[208:211], v[80:83], a[192:195]
    v_exp_f32 v15, v15
    v_mfma_f32_16x16x32_bf16 a[32:35], a[168:171], v[80:83], a[32:35]
    buffer_load_dwordx4 v206, s[8:11], s47 offen offset:2048 nt lds
    v_mfma_f32_16x16x32_bf16 a[48:51], a[172:175], v[80:83], a[48:51]
    v_exp_f32 v16, v16
    v_mfma_f32_16x16x32_bf16 a[36:39], a[168:171], v[84:87], a[36:39]
    buffer_load_dwordx4 v207, s[8:11], s47 offen offset:3072 nt lds
    v_cvt_pk_bf16_f32 v71, v14, v15
    v_mfma_f32_16x16x32_bf16 a[52:55], a[172:175], v[84:87], a[52:55]
    v_exp_f32 v17, v17
    v_mfma_f32_16x16x32_bf16 a[40:43], a[168:171], v[88:91], a[40:43]
    v_mfma_f32_16x16x32_bf16 a[56:59], a[172:175], v[88:91], a[56:59]
    v_exp_f32 v18, v18
    v_mfma_f32_16x16x32_bf16 a[196:199], a[208:211], v[84:87], a[196:199]
    s_add_u32 s47, s28, 4096
    s_mov_b32 m0, 4096
    s_nop 0
    buffer_load_dwordx4 v204, s[8:11], s47 offen nt lds
    v_cvt_pk_bf16_f32 v72, v16, v17
    v_mfma_f32_16x16x32_bf16 a[64:67], a[176:179], v[80:83], a[64:67]
    v_exp_f32 v19, v19
    v_mfma_f32_16x16x32_bf16 a[80:83], a[180:183], v[80:83], a[80:83]
    buffer_load_dwordx4 v205, s[8:11], s47 offen offset:1024 nt lds
    v_mfma_f32_16x16x32_bf16 a[68:71], a[176:179], v[84:87], a[68:71]
    v_exp_f32 v20, v20
    v_mfma_f32_16x16x32_bf16 a[84:87], a[180:183], v[84:87], a[84:87]
    v_cvt_pk_bf16_f32 v73, v18, v19
    v_mfma_f32_16x16x32_bf16 a[72:75], a[176:179], v[88:91], a[72:75]
    v_exp_f32 v21, v21
    v_mfma_f32_16x16x32_bf16 a[88:91], a[180:183], v[88:91], a[88:91]
    buffer_load_dwordx4 v206, s[8:11], s47 offen offset:2048 nt lds
    v_mfma_f32_16x16x32_bf16 a[200:203], a[208:211], v[88:91], a[200:203]
    v_exp_f32 v22, v22
    v_mfma_f32_16x16x32_bf16 a[96:99], a[184:187], v[80:83], a[96:99]
    s_waitcnt lgkmcnt(4)
    buffer_load_dwordx4 v207, s[8:11], s47 offen offset:3072 nt lds
    v_cvt_pk_bf16_f32 v74, v20, v21
    v_mfma_f32_16x16x32_bf16 a[112:115], a[188:191], v[80:83], a[112:115]
    v_exp_f32 v23, v23
    v_mfma_f32_16x16x32_bf16 a[100:103], a[184:187], v[84:87], a[100:103]
    v_mfma_f32_16x16x32_bf16 a[116:119], a[188:191], v[84:87], a[116:119]
    v_mfma_f32_16x16x32_bf16 a[104:107], a[184:187], v[88:91], a[104:107]
    v_cvt_pk_bf16_f32 v75, v22, v23
    v_mfma_f32_16x16x32_bf16 a[120:123], a[188:191], v[88:91], a[120:123]
    s_waitcnt vmcnt(32) lgkmcnt(0)
    s_barrier
L1_pos3b:
    v_mfma_f32_16x16x32_bf16 v[0:3], a[128:131], v[128:131], v[96:99]
    v_exp_f32 v32, v32
    v_mfma_f32_16x16x32_bf16 v[0:3], a[132:135], v[132:135], v[0:3]
    s_add_u32 s29, s29, 8192
    s_mov_b32 s47, s29
    s_mov_b32 m0, 114688
    s_nop 0
    ds_read_b64_tr_b16 a[160:161], v196 offset:16384
    buffer_load_dwordx4 v208, s[12:15], s47 offen nt lds
    ds_read_b64_tr_b16 a[162:163], v196 offset:20480
    v_mfma_f32_16x16x32_bf16 v[0:3], a[136:139], v[136:139], v[0:3]
    v_exp_f32 v33, v33
    v_mfma_f32_16x16x32_bf16 v[0:3], a[140:143], v[140:143], v[0:3]
    ds_read_b64_tr_b16 a[164:165], v197 offset:16384
    ds_read_b64_tr_b16 a[166:167], v197 offset:20480
    buffer_load_dwordx4 v209, s[12:15], s47 offen offset:1024 nt lds
    v_mfma_f32_16x16x32_bf16 v[8:11], a[128:131], v[144:147], v[100:103]
    v_exp_f32 v34, v34
    v_mfma_f32_16x16x32_bf16 v[8:11], a[132:135], v[148:151], v[8:11]
    ds_read_b64_tr_b16 a[168:169], v198 offset:16384
    ds_read_b64_tr_b16 a[170:171], v198 offset:20480
    v_cvt_pk_bf16_f32 v80, v32, v33
    v_mfma_f32_16x16x32_bf16 v[8:11], a[136:139], v[152:155], v[8:11]
    v_exp_f32 v35, v35
    v_mfma_f32_16x16x32_bf16 v[8:11], a[140:143], v[156:159], v[8:11]
    ds_read_b64_tr_b16 a[172:173], v199 offset:16384
    buffer_load_dwordx4 v208, s[12:15], s47 offen offset:2048 nt lds
    ds_read_b64_tr_b16 a[174:175], v199 offset:20480
    v_mfma_f32_16x16x32_bf16 v[16:19], a[128:131], v[160:163], v[104:107]
    v_exp_f32 v36, v36
    v_mfma_f32_16x16x32_bf16 v[16:19], a[132:135], v[164:167], v[16:19]
    ds_read_b64_tr_b16 a[176:177], v200 offset:16384
    ds_read_b64_tr_b16 a[178:179], v200 offset:20480
    v_cvt_pk_bf16_f32 v81, v34, v35
    v_mfma_f32_16x16x32_bf16 v[16:19], a[136:139], v[168:171], v[16:19]
    v_exp_f32 v37, v37
    v_mfma_f32_16x16x32_bf16 v[16:19], a[140:143], v[172:175], v[16:19]
    buffer_load_dwordx4 v209, s[12:15], s47 offen offset:3072 nt lds
    ds_read_b64_tr_b16 a[180:181], v201 offset:16384
    ds_read_b64_tr_b16 a[182:183], v201 offset:20480
    v_mfma_f32_16x16x32_bf16 v[4:7], a[144:147], v[128:131], v[96:99]
    v_exp_f32 v38, v38
    v_mfma_f32_16x16x32_bf16 v[4:7], a[148:151], v[132:135], v[4:7]
    ds_read_b64_tr_b16 a[184:185], v202 offset:16384
    ds_read_b128 a[128:131], v192 offset:40960
    v_cvt_pk_bf16_f32 v82, v36, v37
    v_mfma_f32_16x16x32_bf16 v[4:7], a[152:155], v[136:139], v[4:7]
    v_exp_f32 v39, v39
    v_mfma_f32_16x16x32_bf16 v[4:7], a[156:159], v[140:143], v[4:7]
    ds_read_b128 a[132:135], v193 offset:40960
    ds_read_b128 a[136:139], v194 offset:40960
    ds_read_b128 a[140:143], v195 offset:40960
    v_mfma_f32_16x16x32_bf16 v[12:15], a[144:147], v[144:147], v[100:103]
    v_exp_f32 v40, v40
    v_mfma_f32_16x16x32_bf16 v[12:15], a[148:151], v[148:151], v[12:15]
    s_add_u32 s47, s29, 4096
    s_mov_b32 m0, 118784
    s_nop 0
    buffer_load_dwordx4 v208, s[12:15], s47 offen nt lds
    ds_read_b64_tr_b16 a[186:187], v202 offset:20480
    v_cvt_pk_bf16_f32 v83, v38, v39
    v_mfma_f32_16x16x32_bf16 v[12:15], a[152:155], v[152:155], v[12:15]
    v_exp_f32 v41, v41
    v_mfma_f32_16x16x32_bf16 v[12:15], a[156:159], v[156:159], v[12:15]
    ds_read_b64_tr_b16 a[188:189], v203 offset:16384
    ds_read_b64_tr_b16 a[190:191], v203 offset:20480
    buffer_load_dwordx4 v209, s[12:15], s47 offen offset:1024 nt lds
    v_mfma_f32_16x16x32_bf16 v[20:23], a[144:147], v[160:163], v[104:107]
    v_exp_f32 v42, v42
    v_mfma_f32_16x16x32_bf16 v[20:23], a[148:151], v[164:167], v[20:23]
    buffer_load_dwordx4 v208, s[12:15], s47 offen offset:2048 nt lds
    buffer_load_dwordx4 v209, s[12:15], s47 offen offset:3072 nt lds
    v_cvt_pk_bf16_f32 v84, v40, v41
    v_mfma_f32_16x16x32_bf16 v[20:23], a[152:155], v[168:171], v[20:23]
    v_exp_f32 v43, v43
    v_mfma_f32_16x16x32_bf16 v[20:23], a[156:159], v[172:175], v[20:23]
    s_waitcnt lgkmcnt(2)
    v_mfma_f32_16x16x32_bf16 a[0:3], a[160:163], v[64:67], a[0:3]
    v_exp_f32 v44, v44
    v_mfma_f32_16x16x32_bf16 a[16:19], a[164:167], v[64:67], a[16:19]
    ds_read_b128 a[144:147], v192 offset:45056
    ds_read_b128 a[148:151], v193 offset:45056
    v_cvt_pk_bf16_f32 v85, v42, v43
    v_mfma_f32_16x16x32_bf16 a[4:7], a[160:163], v[68:71], a[4:7]
    v_exp_f32 v45, v45
    v_mfma_f32_16x16x32_bf16 a[20:23], a[164:167], v[68:71], a[20:23]
    s_add_u32 s28, s28, 8192
    s_mov_b32 s47, s28
    s_mov_b32 m0, 8192
    s_nop 0
    ds_read_b128 a[152:155], v194 offset:45056
    ds_read_b128 a[156:159], v195 offset:45056
    buffer_load_dwordx4 v204, s[8:11], s47 offen nt lds
    v_mfma_f32_16x16x32_bf16 a[8:11], a[160:163], v[72:75], a[8:11]
    v_exp_f32 v46, v46
    v_mfma_f32_16x16x32_bf16 a[24:27], a[164:167], v[72:75], a[24:27]
    buffer_load_dwordx4 v205, s[8:11], s47 offen offset:1024 nt lds
    v_cvt_pk_bf16_f32 v86, v44, v45
    v_mfma_f32_16x16x32_bf16 a[192:195], a[208:211], v[64:67], a[192:195]
    v_exp_f32 v47, v47
    v_mfma_f32_16x16x32_bf16 a[32:35], a[168:171], v[64:67], a[32:35]
    buffer_load_dwordx4 v206, s[8:11], s47 offen offset:2048 nt lds
    v_mfma_f32_16x16x32_bf16 a[48:51], a[172:175], v[64:67], a[48:51]
    v_exp_f32 v48, v48
    v_mfma_f32_16x16x32_bf16 a[36:39], a[168:171], v[68:71], a[36:39]
    buffer_load_dwordx4 v207, s[8:11], s47 offen offset:3072 nt lds
    v_cvt_pk_bf16_f32 v87, v46, v47
    v_mfma_f32_16x16x32_bf16 a[52:55], a[172:175], v[68:71], a[52:55]
    v_exp_f32 v49, v49
    v_mfma_f32_16x16x32_bf16 a[40:43], a[168:171], v[72:75], a[40:43]
    v_mfma_f32_16x16x32_bf16 a[56:59], a[172:175], v[72:75], a[56:59]
    v_exp_f32 v50, v50
    v_mfma_f32_16x16x32_bf16 a[196:199], a[208:211], v[68:71], a[196:199]
    s_add_u32 s47, s28, 4096
    s_mov_b32 m0, 12288
    s_nop 0
    buffer_load_dwordx4 v204, s[8:11], s47 offen nt lds
    v_cvt_pk_bf16_f32 v88, v48, v49
    v_mfma_f32_16x16x32_bf16 a[64:67], a[176:179], v[64:67], a[64:67]
    v_exp_f32 v51, v51
    v_mfma_f32_16x16x32_bf16 a[80:83], a[180:183], v[64:67], a[80:83]
    buffer_load_dwordx4 v205, s[8:11], s47 offen offset:1024 nt lds
    v_mfma_f32_16x16x32_bf16 a[68:71], a[176:179], v[68:71], a[68:71]
    v_exp_f32 v52, v52
    v_mfma_f32_16x16x32_bf16 a[84:87], a[180:183], v[68:71], a[84:87]
    v_cvt_pk_bf16_f32 v89, v50, v51
    v_mfma_f32_16x16x32_bf16 a[72:75], a[176:179], v[72:75], a[72:75]
    v_exp_f32 v53, v53
    v_mfma_f32_16x16x32_bf16 a[88:91], a[180:183], v[72:75], a[88:91]
    buffer_load_dwordx4 v206, s[8:11], s47 offen offset:2048 nt lds
    v_mfma_f32_16x16x32_bf16 a[200:203], a[208:211], v[72:75], a[200:203]
    v_exp_f32 v54, v54
    v_mfma_f32_16x16x32_bf16 a[96:99], a[184:187], v[64:67], a[96:99]
    s_waitcnt lgkmcnt(4)
    buffer_load_dwordx4 v207, s[8:11], s47 offen offset:3072 nt lds
    v_cvt_pk_bf16_f32 v90, v52, v53
    v_mfma_f32_16x16x32_bf16 a[112:115], a[188:191], v[64:67], a[112:115]
    v_exp_f32 v55, v55
    v_mfma_f32_16x16x32_bf16 a[100:103], a[184:187], v[68:71], a[100:103]
    v_mfma_f32_16x16x32_bf16 a[116:119], a[188:191], v[68:71], a[116:119]
    v_mfma_f32_16x16x32_bf16 a[104:107], a[184:187], v[72:75], a[104:107]
    v_cvt_pk_bf16_f32 v91, v54, v55
    v_mfma_f32_16x16x32_bf16 a[120:123], a[188:191], v[72:75], a[120:123]
    s_waitcnt vmcnt(40) lgkmcnt(0)
    s_barrier
L1_pos4b:
    v_mfma_f32_16x16x32_bf16 v[32:35], a[128:131], v[128:131], v[96:99]
    v_exp_f32 v0, v0
    v_mfma_f32_16x16x32_bf16 v[32:35], a[132:135], v[132:135], v[32:35]
    s_add_u32 s29, s29, 8192
    s_mov_b32 s47, s29
    s_mov_b32 m0, 122880
    s_nop 0
    ds_read_b64_tr_b16 a[160:161], v196 offset:24576
    buffer_load_dwordx4 v208, s[12:15], s47 offen nt lds
    ds_read_b64_tr_b16 a[162:163], v196 offset:28672
    v_mfma_f32_16x16x32_bf16 v[32:35], a[136:139], v[136:139], v[32:35]
    v_exp_f32 v1, v1
    v_mfma_f32_16x16x32_bf16 v[32:35], a[140:143], v[140:143], v[32:35]
    ds_read_b64_tr_b16 a[164:165], v197 offset:24576
    ds_read_b64_tr_b16 a[166:167], v197 offset:28672
    buffer_load_dwordx4 v209, s[12:15], s47 offen offset:1024 nt lds
    v_mfma_f32_16x16x32_bf16 v[40:43], a[128:131], v[144:147], v[100:103]
    v_exp_f32 v2, v2
    v_mfma_f32_16x16x32_bf16 v[40:43], a[132:135], v[148:151], v[40:43]
    ds_read_b64_tr_b16 a[168:169], v198 offset:24576
    ds_read_b64_tr_b16 a[170:171], v198 offset:28672
    v_cvt_pk_bf16_f32 v64, v0, v1
    v_mfma_f32_16x16x32_bf16 v[40:43], a[136:139], v[152:155], v[40:43]
    v_exp_f32 v3, v3
    v_mfma_f32_16x16x32_bf16 v[40:43], a[140:143], v[156:159], v[40:43]
    ds_read_b64_tr_b16 a[172:173], v199 offset:24576
    buffer_load_dwordx4 v208, s[12:15], s47 offen offset:2048 nt lds
    ds_read_b64_tr_b16 a[174:175], v199 offset:28672
    v_mfma_f32_16x16x32_bf16 v[48:51], a[128:131], v[160:163], v[104:107]
    v_exp_f32 v4, v4
    v_mfma_f32_16x16x32_bf16 v[48:51], a[132:135], v[164:167], v[48:51]
    ds_read_b64_tr_b16 a[176:177], v200 offset:24576
    ds_read_b64_tr_b16 a[178:179], v200 offset:28672
    v_cvt_pk_bf16_f32 v65, v2, v3
    v_mfma_f32_16x16x32_bf16 v[48:51], a[136:139], v[168:171], v[48:51]
    v_exp_f32 v5, v5
    v_mfma_f32_16x16x32_bf16 v[48:51], a[140:143], v[172:175], v[48:51]
    buffer_load_dwordx4 v209, s[12:15], s47 offen offset:3072 nt lds
    ds_read_b64_tr_b16 a[180:181], v201 offset:24576
    ds_read_b64_tr_b16 a[182:183], v201 offset:28672
    v_mfma_f32_16x16x32_bf16 v[36:39], a[144:147], v[128:131], v[96:99]
    v_exp_f32 v6, v6
    v_mfma_f32_16x16x32_bf16 v[36:39], a[148:151], v[132:135], v[36:39]
    ds_read_b64_tr_b16 a[184:185], v202 offset:24576
    ds_read_b128 a[128:131], v192 offset:49152
    v_cvt_pk_bf16_f32 v66, v4, v5
    v_mfma_f32_16x16x32_bf16 v[36:39], a[152:155], v[136:139], v[36:39]
    v_exp_f32 v7, v7
    v_mfma_f32_16x16x32_bf16 v[36:39], a[156:159], v[140:143], v[36:39]
    ds_read_b128 a[132:135], v193 offset:49152
    ds_read_b128 a[136:139], v194 offset:49152
    ds_read_b128 a[140:143], v195 offset:49152
    v_mfma_f32_16x16x32_bf16 v[44:47], a[144:147], v[144:147], v[100:103]
    v_exp_f32 v8, v8
    v_mfma_f32_16x16x32_bf16 v[44:47], a[148:151], v[148:151], v[44:47]
    s_add_u32 s47, s29, 4096
    s_mov_b32 m0, 126976
    s_nop 0
    buffer_load_dwordx4 v208, s[12:15], s47 offen nt lds
    ds_read_b64_tr_b16 a[186:187], v202 offset:28672
    v_cvt_pk_bf16_f32 v67, v6, v7
    v_mfma_f32_16x16x32_bf16 v[44:47], a[152:155], v[152:155], v[44:47]
    v_exp_f32 v9, v9
    v_mfma_f32_16x16x32_bf16 v[44:47], a[156:159], v[156:159], v[44:47]
    ds_read_b64_tr_b16 a[188:189], v203 offset:24576
    ds_read_b64_tr_b16 a[190:191], v203 offset:28672
    buffer_load_dwordx4 v209, s[12:15], s47 offen offset:1024 nt lds
    v_mfma_f32_16x16x32_bf16 v[52:55], a[144:147], v[160:163], v[104:107]
    v_exp_f32 v10, v10
    v_mfma_f32_16x16x32_bf16 v[52:55], a[148:151], v[164:167], v[52:55]
    buffer_load_dwordx4 v208, s[12:15], s47 offen offset:2048 nt lds
    buffer_load_dwordx4 v209, s[12:15], s47 offen offset:3072 nt lds
    v_cvt_pk_bf16_f32 v68, v8, v9
    v_mfma_f32_16x16x32_bf16 v[52:55], a[152:155], v[168:171], v[52:55]
    v_exp_f32 v11, v11
    v_mfma_f32_16x16x32_bf16 v[52:55], a[156:159], v[172:175], v[52:55]
    s_waitcnt lgkmcnt(2)
    v_mfma_f32_16x16x32_bf16 a[0:3], a[160:163], v[80:83], a[0:3]
    v_exp_f32 v12, v12
    v_mfma_f32_16x16x32_bf16 a[16:19], a[164:167], v[80:83], a[16:19]
    ds_read_b128 a[144:147], v192 offset:53248
    ds_read_b128 a[148:151], v193 offset:53248
    v_cvt_pk_bf16_f32 v69, v10, v11
    v_mfma_f32_16x16x32_bf16 a[4:7], a[160:163], v[84:87], a[4:7]
    v_exp_f32 v13, v13
    v_mfma_f32_16x16x32_bf16 a[20:23], a[164:167], v[84:87], a[20:23]
    s_add_u32 s28, s28, 8192
    s_mov_b32 s47, s28
    s_mov_b32 m0, 16384
    s_nop 0
    ds_read_b128 a[152:155], v194 offset:53248
    ds_read_b128 a[156:159], v195 offset:53248
    buffer_load_dwordx4 v204, s[8:11], s47 offen nt lds
    v_mfma_f32_16x16x32_bf16 a[8:11], a[160:163], v[88:91], a[8:11]
    v_exp_f32 v14, v14
    v_mfma_f32_16x16x32_bf16 a[24:27], a[164:167], v[88:91], a[24:27]
    buffer_load_dwordx4 v205, s[8:11], s47 offen offset:1024 nt lds
    v_cvt_pk_bf16_f32 v70, v12, v13
    v_mfma_f32_16x16x32_bf16 a[192:195], a[208:211], v[80:83], a[192:195]
    v_exp_f32 v15, v15
    v_mfma_f32_16x16x32_bf16 a[32:35], a[168:171], v[80:83], a[32:35]
    buffer_load_dwordx4 v206, s[8:11], s47 offen offset:2048 nt lds
    v_mfma_f32_16x16x32_bf16 a[48:51], a[172:175], v[80:83], a[48:51]
    v_exp_f32 v16, v16
    v_mfma_f32_16x16x32_bf16 a[36:39], a[168:171], v[84:87], a[36:39]
    buffer_load_dwordx4 v207, s[8:11], s47 offen offset:3072 nt lds
    v_cvt_pk_bf16_f32 v71, v14, v15
    v_mfma_f32_16x16x32_bf16 a[52:55], a[172:175], v[84:87], a[52:55]
    v_exp_f32 v17, v17
    v_mfma_f32_16x16x32_bf16 a[40:43], a[168:171], v[88:91], a[40:43]
    v_mfma_f32_16x16x32_bf16 a[56:59], a[172:175], v[88:91], a[56:59]
    v_exp_f32 v18, v18
    v_mfma_f32_16x16x32_bf16 a[196:199], a[208:211], v[84:87], a[196:199]
    s_add_u32 s47, s28, 4096
    s_mov_b32 m0, 20480
    s_nop 0
    buffer_load_dwordx4 v204, s[8:11], s47 offen nt lds
    v_cvt_pk_bf16_f32 v72, v16, v17
    v_mfma_f32_16x16x32_bf16 a[64:67], a[176:179], v[80:83], a[64:67]
    v_exp_f32 v19, v19
    v_mfma_f32_16x16x32_bf16 a[80:83], a[180:183], v[80:83], a[80:83]
    buffer_load_dwordx4 v205, s[8:11], s47 offen offset:1024 nt lds
    v_mfma_f32_16x16x32_bf16 a[68:71], a[176:179], v[84:87], a[68:71]
    v_exp_f32 v20, v20
    v_mfma_f32_16x16x32_bf16 a[84:87], a[180:183], v[84:87], a[84:87]
    v_cvt_pk_bf16_f32 v73, v18, v19
    v_mfma_f32_16x16x32_bf16 a[72:75], a[176:179], v[88:91], a[72:75]
    v_exp_f32 v21, v21
    v_mfma_f32_16x16x32_bf16 a[88:91], a[180:183], v[88:91], a[88:91]
    buffer_load_dwordx4 v206, s[8:11], s47 offen offset:2048 nt lds
    v_mfma_f32_16x16x32_bf16 a[200:203], a[208:211], v[88:91], a[200:203]
    v_exp_f32 v22, v22
    v_mfma_f32_16x16x32_bf16 a[96:99], a[184:187], v[80:83], a[96:99]
    s_waitcnt lgkmcnt(4)
    buffer_load_dwordx4 v207, s[8:11], s47 offen offset:3072 nt lds
    v_cvt_pk_bf16_f32 v74, v20, v21
    v_mfma_f32_16x16x32_bf16 a[112:115], a[188:191], v[80:83], a[112:115]
    v_exp_f32 v23, v23
    v_mfma_f32_16x16x32_bf16 a[100:103], a[184:187], v[84:87], a[100:103]
    v_mfma_f32_16x16x32_bf16 a[116:119], a[188:191], v[84:87], a[116:119]
    v_mfma_f32_16x16x32_bf16 a[104:107], a[184:187], v[88:91], a[104:107]
    v_cvt_pk_bf16_f32 v75, v22, v23
    v_mfma_f32_16x16x32_bf16 a[120:123], a[188:191], v[88:91], a[120:123]
    s_waitcnt vmcnt(48) lgkmcnt(0)
    s_barrier
L1_pos5b:
    v_mfma_f32_16x16x32_bf16 v[0:3], a[128:131], v[128:131], v[96:99]
    v_exp_f32 v32, v32
    v_mfma_f32_16x16x32_bf16 v[0:3], a[132:135], v[132:135], v[0:3]
    s_add_u32 s29, s29, 8192
    s_mov_b32 s47, s29
    s_mov_b32 m0, 65536
    s_nop 0
    ds_read_b64_tr_b16 a[160:161], v196 offset:32768
    buffer_load_dwordx4 v208, s[12:15], s47 offen nt lds
    ds_read_b64_tr_b16 a[162:163], v196 offset:36864
    v_mfma_f32_16x16x32_bf16 v[0:3], a[136:139], v[136:139], v[0:3]
    v_exp_f32 v33, v33
    v_mfma_f32_16x16x32_bf16 v[0:3], a[140:143], v[140:143], v[0:3]
    ds_read_b64_tr_b16 a[164:165], v197 offset:32768
    ds_read_b64_tr_b16 a[166:167], v197 offset:36864
    buffer_load_dwordx4 v209, s[12:15], s47 offen offset:1024 nt lds
    v_mfma_f32_16x16x32_bf16 v[8:11], a[128:131], v[144:147], v[100:103]
    v_exp_f32 v34, v34
    v_mfma_f32_16x16x32_bf16 v[8:11], a[132:135], v[148:151], v[8:11]
    ds_read_b64_tr_b16 a[168:169], v198 offset:32768
    ds_read_b64_tr_b16 a[170:171], v198 offset:36864
    v_cvt_pk_bf16_f32 v80, v32, v33
    v_mfma_f32_16x16x32_bf16 v[8:11], a[136:139], v[152:155], v[8:11]
    v_exp_f32 v35, v35
    v_mfma_f32_16x16x32_bf16 v[8:11], a[140:143], v[156:159], v[8:11]
    ds_read_b64_tr_b16 a[172:173], v199 offset:32768
    buffer_load_dwordx4 v208, s[12:15], s47 offen offset:2048 nt lds
    ds_read_b64_tr_b16 a[174:175], v199 offset:36864
    v_mfma_f32_16x16x32_bf16 v[16:19], a[128:131], v[160:163], v[104:107]
    v_exp_f32 v36, v36
    v_mfma_f32_16x16x32_bf16 v[16:19], a[132:135], v[164:167], v[16:19]
    ds_read_b64_tr_b16 a[176:177], v200 offset:32768
    ds_read_b64_tr_b16 a[178:179], v200 offset:36864
    v_cvt_pk_bf16_f32 v81, v34, v35
    v_mfma_f32_16x16x32_bf16 v[16:19], a[136:139], v[168:171], v[16:19]
    v_exp_f32 v37, v37
    v_mfma_f32_16x16x32_bf16 v[16:19], a[140:143], v[172:175], v[16:19]
    buffer_load_dwordx4 v209, s[12:15], s47 offen offset:3072 nt lds
    ds_read_b64_tr_b16 a[180:181], v201 offset:32768
    ds_read_b64_tr_b16 a[182:183], v201 offset:36864
    v_mfma_f32_16x16x32_bf16 v[4:7], a[144:147], v[128:131], v[96:99]
    v_exp_f32 v38, v38
    v_mfma_f32_16x16x32_bf16 v[4:7], a[148:151], v[132:135], v[4:7]
    ds_read_b64_tr_b16 a[184:185], v202 offset:32768
    ds_read_b128 a[128:131], v192 offset:57344
    v_cvt_pk_bf16_f32 v82, v36, v37
    v_mfma_f32_16x16x32_bf16 v[4:7], a[152:155], v[136:139], v[4:7]
    v_exp_f32 v39, v39
    v_mfma_f32_16x16x32_bf16 v[4:7], a[156:159], v[140:143], v[4:7]
    ds_read_b128 a[132:135], v193 offset:57344
    ds_read_b128 a[136:139], v194 offset:57344
    ds_read_b128 a[140:143], v195 offset:57344
    v_mfma_f32_16x16x32_bf16 v[12:15], a[144:147], v[144:147], v[100:103]
    v_exp_f32 v40, v40
    v_mfma_f32_16x16x32_bf16 v[12:15], a[148:151], v[148:151], v[12:15]
    s_add_u32 s47, s29, 4096
    s_mov_b32 m0, 69632
    s_nop 0
    buffer_load_dwordx4 v208, s[12:15], s47 offen nt lds
    ds_read_b64_tr_b16 a[186:187], v202 offset:36864
    v_cvt_pk_bf16_f32 v83, v38, v39
    v_mfma_f32_16x16x32_bf16 v[12:15], a[152:155], v[152:155], v[12:15]
    v_exp_f32 v41, v41
    v_mfma_f32_16x16x32_bf16 v[12:15], a[156:159], v[156:159], v[12:15]
    ds_read_b64_tr_b16 a[188:189], v203 offset:32768
    ds_read_b64_tr_b16 a[190:191], v203 offset:36864
    buffer_load_dwordx4 v209, s[12:15], s47 offen offset:1024 nt lds
    v_mfma_f32_16x16x32_bf16 v[20:23], a[144:147], v[160:163], v[104:107]
    v_exp_f32 v42, v42
    v_mfma_f32_16x16x32_bf16 v[20:23], a[148:151], v[164:167], v[20:23]
    buffer_load_dwordx4 v208, s[12:15], s47 offen offset:2048 nt lds
    buffer_load_dwordx4 v209, s[12:15], s47 offen offset:3072 nt lds
    v_cvt_pk_bf16_f32 v84, v40, v41
    v_mfma_f32_16x16x32_bf16 v[20:23], a[152:155], v[168:171], v[20:23]
    v_exp_f32 v43, v43
    v_mfma_f32_16x16x32_bf16 v[20:23], a[156:159], v[172:175], v[20:23]
    s_waitcnt lgkmcnt(2)
    v_mfma_f32_16x16x32_bf16 a[0:3], a[160:163], v[64:67], a[0:3]
    v_exp_f32 v44, v44
    v_mfma_f32_16x16x32_bf16 a[16:19], a[164:167], v[64:67], a[16:19]
    ds_read_b128 a[144:147], v192 offset:61440
    ds_read_b128 a[148:151], v193 offset:61440
    v_cvt_pk_bf16_f32 v85, v42, v43
    v_mfma_f32_16x16x32_bf16 a[4:7], a[160:163], v[68:71], a[4:7]
    v_exp_f32 v45, v45
    v_mfma_f32_16x16x32_bf16 a[20:23], a[164:167], v[68:71], a[20:23]
    s_add_u32 s28, s28, 8192
    s_mov_b32 s47, s28
    s_mov_b32 m0, 24576
    s_nop 0
    ds_read_b128 a[152:155], v194 offset:61440
    ds_read_b128 a[156:159], v195 offset:61440
    buffer_load_dwordx4 v204, s[8:11], s47 offen nt lds
    v_mfma_f32_16x16x32_bf16 a[8:11], a[160:163], v[72:75], a[8:11]
    v_exp_f32 v46, v46
    v_mfma_f32_16x16x32_bf16 a[24:27], a[164:167], v[72:75], a[24:27]
    buffer_load_dwordx4 v205, s[8:11], s47 offen offset:1024 nt lds
    v_cvt_pk_bf16_f32 v86, v44, v45
    v_mfma_f32_16x16x32_bf16 a[192:195], a[208:211], v[64:67], a[192:195]
    v_exp_f32 v47, v47
    v_mfma_f32_16x16x32_bf16 a[32:35], a[168:171], v[64:67], a[32:35]
    buffer_load_dwordx4 v206, s[8:11], s47 offen offset:2048 nt lds
    v_mfma_f32_16x16x32_bf16 a[48:51], a[172:175], v[64:67], a[48:51]
    v_exp_f32 v48, v48
    v_mfma_f32_16x16x32_bf16 a[36:39], a[168:171], v[68:71], a[36:39]
    buffer_load_dwordx4 v207, s[8:11], s47 offen offset:3072 nt lds
    v_cvt_pk_bf16_f32 v87, v46, v47
    v_mfma_f32_16x16x32_bf16 a[52:55], a[172:175], v[68:71], a[52:55]
    v_exp_f32 v49, v49
    v_mfma_f32_16x16x32_bf16 a[40:43], a[168:171], v[72:75], a[40:43]
    v_mfma_f32_16x16x32_bf16 a[56:59], a[172:175], v[72:75], a[56:59]
    v_exp_f32 v50, v50
    v_mfma_f32_16x16x32_bf16 a[196:199], a[208:211], v[68:71], a[196:199]
    s_add_u32 s47, s28, 4096
    s_mov_b32 m0, 28672
    s_nop 0
    buffer_load_dwordx4 v204, s[8:11], s47 offen nt lds
    v_cvt_pk_bf16_f32 v88, v48, v49
    v_mfma_f32_16x16x32_bf16 a[64:67], a[176:179], v[64:67], a[64:67]
    v_exp_f32 v51, v51
    v_mfma_f32_16x16x32_bf16 a[80:83], a[180:183], v[64:67], a[80:83]
    buffer_load_dwordx4 v205, s[8:11], s47 offen offset:1024 nt lds
    v_mfma_f32_16x16x32_bf16 a[68:71], a[176:179], v[68:71], a[68:71]
    v_exp_f32 v52, v52
    v_mfma_f32_16x16x32_bf16 a[84:87], a[180:183], v[68:71], a[84:87]
    v_cvt_pk_bf16_f32 v89, v50, v51
    v_mfma_f32_16x16x32_bf16 a[72:75], a[176:179], v[72:75], a[72:75]
    v_exp_f32 v53, v53
    v_mfma_f32_16x16x32_bf16 a[88:91], a[180:183], v[72:75], a[88:91]
    buffer_load_dwordx4 v206, s[8:11], s47 offen offset:2048 nt lds
    v_mfma_f32_16x16x32_bf16 a[200:203], a[208:211], v[72:75], a[200:203]
    v_exp_f32 v54, v54
    v_mfma_f32_16x16x32_bf16 a[96:99], a[184:187], v[64:67], a[96:99]
    s_waitcnt lgkmcnt(4)
    buffer_load_dwordx4 v207, s[8:11], s47 offen offset:3072 nt lds
    v_cvt_pk_bf16_f32 v90, v52, v53
    v_mfma_f32_16x16x32_bf16 a[112:115], a[188:191], v[64:67], a[112:115]
    v_exp_f32 v55, v55
    v_mfma_f32_16x16x32_bf16 a[100:103], a[184:187], v[68:71], a[100:103]
    v_mfma_f32_16x16x32_bf16 a[116:119], a[188:191], v[68:71], a[116:119]
    v_mfma_f32_16x16x32_bf16 a[104:107], a[184:187], v[72:75], a[104:107]
    v_cvt_pk_bf16_f32 v91, v54, v55
    v_mfma_f32_16x16x32_bf16 a[120:123], a[188:191], v[72:75], a[120:123]
    s_waitcnt vmcnt(48) lgkmcnt(0)
    s_barrier
L1_pos6b:
    v_mfma_f32_16x16x32_bf16 v[32:35], a[128:131], v[128:131], v[96:99]
    v_exp_f32 v0, v0
    v_mfma_f32_16x16x32_bf16 v[32:35], a[132:135], v[132:135], v[32:35]
    s_add_u32 s29, s29, 8192
    s_mov_b32 s47, s29
    s_mov_b32 m0, 73728
    s_nop 0
    ds_read_b64_tr_b16 a[160:161], v196 offset:40960
    buffer_load_dwordx4 v208, s[12:15], s47 offen nt lds
    ds_read_b64_tr_b16 a[162:163], v196 offset:45056
    v_mfma_f32_16x16x32_bf16 v[32:35], a[136:139], v[136:139], v[32:35]
    v_exp_f32 v1, v1
    v_mfma_f32_16x16x32_bf16 v[32:35], a[140:143], v[140:143], v[32:35]
    ds_read_b64_tr_b16 a[164:165], v197 offset:40960
    ds_read_b64_tr_b16 a[166:167], v197 offset:45056
    buffer_load_dwordx4 v209, s[12:15], s47 offen offset:1024 nt lds
    v_mfma_f32_16x16x32_bf16 v[40:43], a[128:131], v[144:147], v[100:103]
    v_exp_f32 v2, v2
    v_mfma_f32_16x16x32_bf16 v[40:43], a[132:135], v[148:151], v[40:43]
    ds_read_b64_tr_b16 a[168:169], v198 offset:40960
    ds_read_b64_tr_b16 a[170:171], v198 offset:45056
    v_cvt_pk_bf16_f32 v64, v0, v1
    v_mfma_f32_16x16x32_bf16 v[40:43], a[136:139], v[152:155], v[40:43]
    v_exp_f32 v3, v3
    v_mfma_f32_16x16x32_bf16 v[40:43], a[140:143], v[156:159], v[40:43]
    ds_read_b64_tr_b16 a[172:173], v199 offset:40960
    buffer_load_dwordx4 v208, s[12:15], s47 offen offset:2048 nt lds
    ds_read_b64_tr_b16 a[174:175], v199 offset:45056
    v_mfma_f32_16x16x32_bf16 v[48:51], a[128:131], v[160:163], v[104:107]
    v_exp_f32 v4, v4
    v_mfma_f32_16x16x32_bf16 v[48:51], a[132:135], v[164:167], v[48:51]
    ds_read_b64_tr_b16 a[176:177], v200 offset:40960
    ds_read_b64_tr_b16 a[178:179], v200 offset:45056
    v_cvt_pk_bf16_f32 v65, v2, v3
    v_mfma_f32_16x16x32_bf16 v[48:51], a[136:139], v[168:171], v[48:51]
    v_exp_f32 v5, v5
    v_mfma_f32_16x16x32_bf16 v[48:51], a[140:143], v[172:175], v[48:51]
    buffer_load_dwordx4 v209, s[12:15], s47 offen offset:3072 nt lds
    ds_read_b64_tr_b16 a[180:181], v201 offset:40960
    ds_read_b64_tr_b16 a[182:183], v201 offset:45056
    v_mfma_f32_16x16x32_bf16 v[36:39], a[144:147], v[128:131], v[96:99]
    v_exp_f32 v6, v6
    v_mfma_f32_16x16x32_bf16 v[36:39], a[148:151], v[132:135], v[36:39]
    ds_read_b64_tr_b16 a[184:185], v202 offset:40960
    ds_read_b128 a[128:131], v192 offset:0
    v_cvt_pk_bf16_f32 v66, v4, v5
    v_mfma_f32_16x16x32_bf16 v[36:39], a[152:155], v[136:139], v[36:39]
    v_exp_f32 v7, v7
    v_mfma_f32_16x16x32_bf16 v[36:39], a[156:159], v[140:143], v[36:39]
    ds_read_b128 a[132:135], v193 offset:0
    ds_read_b128 a[136:139], v194 offset:0
    ds_read_b128 a[140:143], v195 offset:0
    v_mfma_f32_16x16x32_bf16 v[44:47], a[144:147], v[144:147], v[100:103]
    v_exp_f32 v8, v8
    v_mfma_f32_16x16x32_bf16 v[44:47], a[148:151], v[148:151], v[44:47]
    s_add_u32 s47, s29, 4096
    s_mov_b32 m0, 77824
    s_nop 0
    buffer_load_dwordx4 v208, s[12:15], s47 offen nt lds
    ds_read_b64_tr_b16 a[186:187], v202 offset:45056
    v_cvt_pk_bf16_f32 v67, v6, v7
    v_mfma_f32_16x16x32_bf16 v[44:47], a[152:155], v[152:155], v[44:47]
    v_exp_f32 v9, v9
    v_mfma_f32_16x16x32_bf16 v[44:47], a[156:159], v[156:159], v[44:47]
    ds_read_b64_tr_b16 a[188:189], v203 offset:40960
    ds_read_b64_tr_b16 a[190:191], v203 offset:45056
    buffer_load_dwordx4 v209, s[12:15], s47 offen offset:1024 nt lds
    v_mfma_f32_16x16x32_bf16 v[52:55], a[144:147], v[160:163], v[104:107]
    v_exp_f32 v10, v10
    v_mfma_f32_16x16x32_bf16 v[52:55], a[148:151], v[164:167], v[52:55]
    buffer_load_dwordx4 v208, s[12:15], s47 offen offset:2048 nt lds
    buffer_load_dwordx4 v209, s[12:15], s47 offen offset:3072 nt lds
    v_cvt_pk_bf16_f32 v68, v8, v9
    v_mfma_f32_16x16x32_bf16 v[52:55], a[152:155], v[168:171], v[52:55]
    v_exp_f32 v11, v11
    v_mfma_f32_16x16x32_bf16 v[52:55], a[156:159], v[172:175], v[52:55]
    s_waitcnt lgkmcnt(2)
    v_mfma_f32_16x16x32_bf16 a[0:3], a[160:163], v[80:83], a[0:3]
    v_exp_f32 v12, v12
    v_mfma_f32_16x16x32_bf16 a[16:19], a[164:167], v[80:83], a[16:19]
    ds_read_b128 a[144:147], v192 offset:4096
    ds_read_b128 a[148:151], v193 offset:4096
    v_cvt_pk_bf16_f32 v69, v10, v11
    v_mfma_f32_16x16x32_bf16 a[4:7], a[160:163], v[84:87], a[4:7]
    v_exp_f32 v13, v13
    v_mfma_f32_16x16x32_bf16 a[20:23], a[164:167], v[84:87], a[20:23]
    s_add_u32 s28, s28, 8192
    s_mov_b32 s47, s28
    s_mov_b32 m0, 32768
    s_nop 0
    ds_read_b128 a[152:155], v194 offset:4096
    ds_read_b128 a[156:159], v195 offset:4096
    buffer_load_dwordx4 v204, s[8:11], s47 offen nt lds
    v_mfma_f32_16x16x32_bf16 a[8:11], a[160:163], v[88:91], a[8:11]
    v_exp_f32 v14, v14
    v_mfma_f32_16x16x32_bf16 a[24:27], a[164:167], v[88:91], a[24:27]
    buffer_load_dwordx4 v205, s[8:11], s47 offen offset:1024 nt lds
    v_cvt_pk_bf16_f32 v70, v12, v13
    v_mfma_f32_16x16x32_bf16 a[192:195], a[208:211], v[80:83], a[192:195]
    v_exp_f32 v15, v15
    v_mfma_f32_16x16x32_bf16 a[32:35], a[168:171], v[80:83], a[32:35]
    buffer_load_dwordx4 v206, s[8:11], s47 offen offset:2048 nt lds
    v_mfma_f32_16x16x32_bf16 a[48:51], a[172:175], v[80:83], a[48:51]
    v_exp_f32 v16, v16
    v_mfma_f32_16x16x32_bf16 a[36:39], a[168:171], v[84:87], a[36:39]
    buffer_load_dwordx4 v207, s[8:11], s47 offen offset:3072 nt lds
    v_cvt_pk_bf16_f32 v71, v14, v15
    v_mfma_f32_16x16x32_bf16 a[52:55], a[172:175], v[84:87], a[52:55]
    v_exp_f32 v17, v17
    v_mfma_f32_16x16x32_bf16 a[40:43], a[168:171], v[88:91], a[40:43]
    v_mfma_f32_16x16x32_bf16 a[56:59], a[172:175], v[88:91], a[56:59]
    v_exp_f32 v18, v18
    v_mfma_f32_16x16x32_bf16 a[196:199], a[208:211], v[84:87], a[196:199]
    s_add_u32 s47, s28, 4096
    s_mov_b32 m0, 36864
    s_nop 0
    buffer_load_dwordx4 v204, s[8:11], s47 offen nt lds
    v_cvt_pk_bf16_f32 v72, v16, v17
    v_mfma_f32_16x16x32_bf16 a[64:67], a[176:179], v[80:83], a[64:67]
    v_exp_f32 v19, v19
    v_mfma_f32_16x16x32_bf16 a[80:83], a[180:183], v[80:83], a[80:83]
    buffer_load_dwordx4 v205, s[8:11], s47 offen offset:1024 nt lds
    v_mfma_f32_16x16x32_bf16 a[68:71], a[176:179], v[84:87], a[68:71]
    v_exp_f32 v20, v20
    v_mfma_f32_16x16x32_bf16 a[84:87], a[180:183], v[84:87], a[84:87]
    v_cvt_pk_bf16_f32 v73, v18, v19
    v_mfma_f32_16x16x32_bf16 a[72:75], a[176:179], v[88:91], a[72:75]
    v_exp_f32 v21, v21
    v_mfma_f32_16x16x32_bf16 a[88:91], a[180:183], v[88:91], a[88:91]
    buffer_load_dwordx4 v206, s[8:11], s47 offen offset:2048 nt lds
    v_mfma_f32_16x16x32_bf16 a[200:203], a[208:211], v[88:91], a[200:203]
    v_exp_f32 v22, v22
    v_mfma_f32_16x16x32_bf16 a[96:99], a[184:187], v[80:83], a[96:99]
    s_waitcnt lgkmcnt(4)
    buffer_load_dwordx4 v207, s[8:11], s47 offen offset:3072 nt lds
    v_cvt_pk_bf16_f32 v74, v20, v21
    v_mfma_f32_16x16x32_bf16 a[112:115], a[188:191], v[80:83], a[112:115]
    v_exp_f32 v23, v23
    v_mfma_f32_16x16x32_bf16 a[100:103], a[184:187], v[84:87], a[100:103]
    v_mfma_f32_16x16x32_bf16 a[116:119], a[188:191], v[84:87], a[116:119]
    v_mfma_f32_16x16x32_bf16 a[104:107], a[184:187], v[88:91], a[104:107]
    v_cvt_pk_bf16_f32 v75, v22, v23
    v_mfma_f32_16x16x32_bf16 a[120:123], a[188:191], v[88:91], a[120:123]
    s_waitcnt vmcnt(48) lgkmcnt(0)
    s_cmp_eq_u32 s30, 7
    s_barrier
    s_cbranch_scc1 L1_tailb
L1_pos7b:
    v_mfma_f32_16x16x32_bf16 v[0:3], a[128:131], v[128:131], v[96:99]
    v_exp_f32 v32, v32
    v_mfma_f32_16x16x32_bf16 v[0:3], a[132:135], v[132:135], v[0:3]
    s_add_u32 s29, s29, 8192
    s_mov_b32 s47, s29
    s_mov_b32 m0, 81920
    s_nop 0
    ds_read_b64_tr_b16 a[160:161], v196 offset:49152
    buffer_load_dwordx4 v208, s[12:15], s47 offen nt lds
    ds_read_b64_tr_b16 a[162:163], v196 offset:53248
    v_mfma_f32_16x16x32_bf16 v[0:3], a[136:139], v[136:139], v[0:3]
    v_exp_f32 v33, v33
    v_mfma_f32_16x16x32_bf16 v[0:3], a[140:143], v[140:143], v[0:3]
    ds_read_b64_tr_b16 a[164:165], v197 offset:49152
    ds_read_b64_tr_b16 a[166:167], v197 offset:53248
    buffer_load_dwordx4 v209, s[12:15], s47 offen offset:1024 nt lds
    v_mfma_f32_16x16x32_bf16 v[8:11], a[128:131], v[144:147], v[100:103]
    v_exp_f32 v34, v34
    v_mfma_f32_16x16x32_bf16 v[8:11], a[132:135], v[148:151], v[8:11]
    ds_read_b64_tr_b16 a[168:169], v198 offset:49152
    ds_read_b64_tr_b16 a[170:171], v198 offset:53248
    v_cvt_pk_bf16_f32 v80, v32, v33
    v_mfma_f32_16x16x32_bf16 v[8:11], a[136:139], v[152:155], v[8:11]
    v_exp_f32 v35, v35
    v_mfma_f32_16x16x32_bf16 v[8:11], a[140:143], v[156:159], v[8:11]
    ds_read_b64_tr_b16 a[172:173], v199 offset:49152
    buffer_load_dwordx4 v208, s[12:15], s47 offen offset:2048 nt lds
    ds_read_b64_tr_b16 a[174:175], v199 offset:53248
    v_mfma_f32_16x16x32_bf16 v[16:19], a[128:131], v[160:163], v[104:107]
    v_exp_f32 v36, v36
    v_mfma_f32_16x16x32_bf16 v[16:19], a[132:135], v[164:167], v[16:19]
    ds_read_b64_tr_b16 a[176:177], v200 offset:49152
    ds_read_b64_tr_b16 a[178:179], v200 offset:53248
    v_cvt_pk_bf16_f32 v81, v34, v35
    v_mfma_f32_16x16x32_bf16 v[16:19], a[136:139], v[168:171], v[16:19]
    v_exp_f32 v37, v37
    v_mfma_f32_16x16x32_bf16 v[16:19], a[140:143], v[172:175], v[16:19]
    buffer_load_dwordx4 v209, s[12:15], s47 offen offset:3072 nt lds
    ds_read_b64_tr_b16 a[180:181], v201 offset:49152
    ds_read_b64_tr_b16 a[182:183], v201 offset:53248
    v_mfma_f32_16x16x32_bf16 v[4:7], a[144:147], v[128:131], v[96:99]
    v_exp_f32 v38, v38
    v_mfma_f32_16x16x32_bf16 v[4:7], a[148:151], v[132:135], v[4:7]
    ds_read_b64_tr_b16 a[184:185], v202 offset:49152
    ds_read_b128 a[128:131], v192 offset:8192
    v_cvt_pk_bf16_f32 v82, v36, v37
    v_mfma_f32_16x16x32_bf16 v[4:7], a[152:155], v[136:139], v[4:7]
    v_exp_f32 v39, v39
    v_mfma_f32_16x16x32_bf16 v[4:7], a[156:159], v[140:143], v[4:7]
    ds_read_b128 a[132:135], v193 offset:8192
    ds_read_b128 a[136:139], v194 offset:8192
    ds_read_b128 a[140:143], v195 offset:8192
    v_mfma_f32_16x16x32_bf16 v[12:15], a[144:147], v[144:147], v[100:103]
    v_exp_f32 v40, v40
    v_mfma_f32_16x16x32_bf16 v[12:15], a[148:151], v[148:151], v[12:15]
    s_add_u32 s47, s29, 4096
    s_mov_b32 m0, 86016
    s_nop 0
    buffer_load_dwordx4 v208, s[12:15], s47 offen nt lds
    ds_read_b64_tr_b16 a[186:187], v202 offset:53248
    v_cvt_pk_bf16_f32 v83, v38, v39
    v_mfma_f32_16x16x32_bf16 v[12:15], a[152:155], v[152:155], v[12:15]
    v_exp_f32 v41, v41
    v_mfma_f32_16x16x32_bf16 v[12:15], a[156:159], v[156:159], v[12:15]
    ds_read_b64_tr_b16 a[188:189], v203 offset:49152
    ds_read_b64_tr_b16 a[190:191], v203 offset:53248
    buffer_load_dwordx4 v209, s[12:15], s47 offen offset:1024 nt lds
    v_mfma_f32_16x16x32_bf16 v[20:23], a[144:147], v[160:163], v[104:107]
    v_exp_f32 v42, v42
    v_mfma_f32_16x16x32_bf16 v[20:23], a[148:151], v[164:167], v[20:23]
    buffer_load_dwordx4 v208, s[12:15], s47 offen offset:2048 nt lds
    buffer_load_dwordx4 v209, s[12:15], s47 offen offset:3072 nt lds
    v_cvt_pk_bf16_f32 v84, v40, v41
    v_mfma_f32_16x16x32_bf16 v[20:23], a[152:155], v[168:171], v[20:23]
    v_exp_f32 v43, v43
    v_mfma_f32_16x16x32_bf16 v[20:23], a[156:159], v[172:175], v[20:23]
    s_waitcnt lgkmcnt(2)
    v_mfma_f32_16x16x32_bf16 a[0:3], a[160:163], v[64:67], a[0:3]
    v_exp_f32 v44, v44
    v_mfma_f32_16x16x32_bf16 a[16:19], a[164:167], v[64:67], a[16:19]
    ds_read_b128 a[144:147], v192 offset:12288
    ds_read_b128 a[148:151], v193 offset:12288
    v_cvt_pk_bf16_f32 v85, v42, v43
    v_mfma_f32_16x16x32_bf16 a[4:7], a[160:163], v[68:71], a[4:7]
    v_exp_f32 v45, v45
    v_mfma_f32_16x16x32_bf16 a[20:23], a[164:167], v[68:71], a[20:23]
    s_add_u32 s28, s28, 8192
    s_mov_b32 s47, s28
    s_mov_b32 m0, 40960
    s_nop 0
    ds_read_b128 a[152:155], v194 offset:12288
    ds_read_b128 a[156:159], v195 offset:12288
    buffer_load_dwordx4 v204, s[8:11], s47 offen nt lds
    v_mfma_f32_16x16x32_bf16 a[8:11], a[160:163], v[72:75], a[8:11]
    v_exp_f32 v46, v46
    v_mfma_f32_16x16x32_bf16 a[24:27], a[164:167], v[72:75], a[24:27]
    buffer_load_dwordx4 v205, s[8:11], s47 offen offset:1024 nt lds
    v_cvt_pk_bf16_f32 v86, v44, v45
    v_mfma_f32_16x16x32_bf16 a[192:195], a[208:211], v[64:67], a[192:195]
    v_exp_f32 v47, v47
    v_mfma_f32_16x16x32_bf16 a[32:35], a[168:171], v[64:67], a[32:35]
    buffer_load_dwordx4 v206, s[8:11], s47 offen offset:2048 nt lds
    v_mfma_f32_16x16x32_bf16 a[48:51], a[172:175], v[64:67], a[48:51]
    v_exp_f32 v48, v48
    v_mfma_f32_16x16x32_bf16 a[36:39], a[168:171], v[68:71], a[36:39]
    buffer_load_dwordx4 v207, s[8:11], s47 offen offset:3072 nt lds
    v_cvt_pk_bf16_f32 v87, v46, v47
    v_mfma_f32_16x16x32_bf16 a[52:55], a[172:175], v[68:71], a[52:55]
    v_exp_f32 v49, v49
    v_mfma_f32_16x16x32_bf16 a[40:43], a[168:171], v[72:75], a[40:43]
    v_mfma_f32_16x16x32_bf16 a[56:59], a[172:175], v[72:75], a[56:59]
    v_exp_f32 v50, v50
    v_mfma_f32_16x16x32_bf16 a[196:199], a[208:211], v[68:71], a[196:199]
    s_add_u32 s47, s28, 4096
    s_mov_b32 m0, 45056
    s_nop 0
    buffer_load_dwordx4 v204, s[8:11], s47 offen nt lds
    v_cvt_pk_bf16_f32 v88, v48, v49
    v_mfma_f32_16x16x32_bf16 a[64:67], a[176:179], v[64:67], a[64:67]
    v_exp_f32 v51, v51
    v_mfma_f32_16x16x32_bf16 a[80:83], a[180:183], v[64:67], a[80:83]
    buffer_load_dwordx4 v205, s[8:11], s47 offen offset:1024 nt lds
    v_mfma_f32_16x16x32_bf16 a[68:71], a[176:179], v[68:71], a[68:71]
    v_exp_f32 v52, v52
    v_mfma_f32_16x16x32_bf16 a[84:87], a[180:183], v[68:71], a[84:87]
    v_cvt_pk_bf16_f32 v89, v50, v51
    v_mfma_f32_16x16x32_bf16 a[72:75], a[176:179], v[72:75], a[72:75]
    v_exp_f32 v53, v53
    v_mfma_f32_16x16x32_bf16 a[88:91], a[180:183], v[72:75], a[88:91]
    buffer_load_dwordx4 v206, s[8:11], s47 offen offset:2048 nt lds
    v_mfma_f32_16x16x32_bf16 a[200:203], a[208:211], v[72:75], a[200:203]
    v_exp_f32 v54, v54
    v_mfma_f32_16x16x32_bf16 a[96:99], a[184:187], v[64:67], a[96:99]
    s_waitcnt lgkmcnt(4)
    buffer_load_dwordx4 v207, s[8:11], s47 offen offset:3072 nt lds
    v_cvt_pk_bf16_f32 v90, v52, v53
    v_mfma_f32_16x16x32_bf16 a[112:115], a[188:191], v[64:67], a[112:115]
    v_exp_f32 v55, v55
    v_mfma_f32_16x16x32_bf16 a[100:103], a[184:187], v[68:71], a[100:103]
    v_mfma_f32_16x16x32_bf16 a[116:119], a[188:191], v[68:71], a[116:119]
    v_mfma_f32_16x16x32_bf16 a[104:107], a[184:187], v[72:75], a[104:107]
    v_cvt_pk_bf16_f32 v91, v54, v55
    v_mfma_f32_16x16x32_bf16 a[120:123], a[188:191], v[72:75], a[120:123]
    s_waitcnt vmcnt(48) lgkmcnt(0)
    s_add_u32 s30, s30, 1
    s_barrier
    s_branch L1_pos0b
L1_tailb:
    ds_read_b64_tr_b16 a[160:161], v196 offset:49152
    ds_read_b64_tr_b16 a[162:163], v196 offset:53248
    ds_read_b64_tr_b16 a[164:165], v197 offset:49152
    ds_read_b64_tr_b16 a[166:167], v197 offset:53248
    ds_read_b64_tr_b16 a[168:169], v198 offset:49152
    ds_read_b64_tr_b16 a[170:171], v198 offset:53248
    ds_read_b64_tr_b16 a[172:173], v199 offset:49152
    ds_read_b64_tr_b16 a[174:175], v199 offset:53248
    ds_read_b64_tr_b16 a[176:177], v200 offset:49152
    ds_read_b64_tr_b16 a[178:179], v200 offset:53248
    ds_read_b64_tr_b16 a[180:181], v201 offset:49152
    ds_read_b64_tr_b16 a[182:183], v201 offset:53248
    ds_read_b64_tr_b16 a[184:185], v202 offset:49152
    ds_read_b64_tr_b16 a[186:187], v202 offset:53248
    ds_read_b64_tr_b16 a[188:189], v203 offset:49152
    ds_read_b64_tr_b16 a[190:191], v203 offset:53248
    v_exp_f32 v32, v32
    v_exp_f32 v33, v33
    s_nop 0
    v_cvt_pk_bf16_f32 v80, v32, v33
    v_exp_f32 v34, v34
    v_exp_f32 v35, v35
    s_nop 0
    v_cvt_pk_bf16_f32 v81, v34, v35
    s_waitcnt lgkmcnt(0)
    v_mfma_f32_16x16x32_bf16 a[0:3], a[160:163], v[64:67], a[0:3]
    v_exp_f32 v36, v36
    s_waitcnt vmcnt(0)
    s_barrier
    v_mfma_f32_16x16x32_bf16 a[16:19], a[164:167], v[64:67], a[16:19]
    v_exp_f32 v37, v37
    v_mfma_f32_16x16x32_bf16 a[4:7], a[160:163], v[68:71], a[4:7]
    v_cvt_pk_bf16_f32 v82, v36, v37
    v_mfma_f32_16x16x32_bf16 a[20:23], a[164:167], v[68:71], a[20:23]
    v_exp_f32 v38, v38
    v_mfma_f32_16x16x32_bf16 a[8:11], a[160:163], v[72:75], a[8:11]
    v_exp_f32 v39, v39
    v_mfma_f32_16x16x32_bf16 a[24:27], a[164:167], v[72:75], a[24:27]
    ds_read_b64_tr_b16 a[160:161], v196 offset:57344
    ds_read_b64_tr_b16 a[162:163], v196 offset:61440
    v_cvt_pk_bf16_f32 v83, v38, v39
    v_mfma_f32_16x16x32_bf16 a[192:195], a[208:211], v[64:67], a[192:195]
    v_exp_f32 v40, v40
    v_mfma_f32_16x16x32_bf16 a[32:35], a[168:171], v[64:67], a[32:35]
    ds_read_b64_tr_b16 a[164:165], v197 offset:57344
    ds_read_b64_tr_b16 a[166:167], v197 offset:61440
    v_mfma_f32_16x16x32_bf16 a[48:51], a[172:175], v[64:67], a[48:51]
    v_exp_f32 v41, v41
    v_mfma_f32_16x16x32_bf16 a[36:39], a[168:171], v[68:71], a[36:39]
    v_cvt_pk_bf16_f32 v84, v40, v41
    v_mfma_f32_16x16x32_bf16 a[52:55], a[172:175], v[68:71], a[52:55]
    v_exp_f32 v42, v42
    v_mfma_f32_16x16x32_bf16 a[40:43], a[168:171], v[72:75], a[40:43]
    v_exp_f32 v43, v43
    v_mfma_f32_16x16x32_bf16 a[56:59], a[172:175], v[72:75], a[56:59]
    ds_read_b64_tr_b16 a[168:169], v198 offset:57344
    ds_read_b64_tr_b16 a[170:171], v198 offset:61440
    v_cvt_pk_bf16_f32 v85, v42, v43
    v_mfma_f32_16x16x32_bf16 a[196:199], a[208:211], v[68:71], a[196:199]
    v_exp_f32 v44, v44
    v_mfma_f32_16x16x32_bf16 a[64:67], a[176:179], v[64:67], a[64:67]
    ds_read_b64_tr_b16 a[172:173], v199 offset:57344
    ds_read_b64_tr_b16 a[174:175], v199 offset:61440
    v_mfma_f32_16x16x32_bf16 a[80:83], a[180:183], v[64:67], a[80:83]
    v_exp_f32 v45, v45
    v_mfma_f32_16x16x32_bf16 a[68:71], a[176:179], v[68:71], a[68:71]
    v_cvt_pk_bf16_f32 v86, v44, v45
    v_mfma_f32_16x16x32_bf16 a[84:87], a[180:183], v[68:71], a[84:87]
    v_exp_f32 v46, v46
    v_mfma_f32_16x16x32_bf16 a[72:75], a[176:179], v[72:75], a[72:75]
    v_exp_f32 v47, v47
    v_mfma_f32_16x16x32_bf16 a[88:91], a[180:183], v[72:75], a[88:91]
    ds_read_b64_tr_b16 a[176:177], v200 offset:57344
    ds_read_b64_tr_b16 a[178:179], v200 offset:61440
    v_cvt_pk_bf16_f32 v87, v46, v47
    v_mfma_f32_16x16x32_bf16 a[200:203], a[208:211], v[72:75], a[200:203]
    v_exp_f32 v48, v48
    v_mfma_f32_16x16x32_bf16 a[96:99], a[184:187], v[64:67], a[96:99]
    v_exp_f32 v49, v49
    v_mfma_f32_16x16x32_bf16 a[112:115], a[188:191], v[64:67], a[112:115]
    ds_read_b64_tr_b16 a[180:181], v201 offset:57344
    ds_read_b64_tr_b16 a[182:183], v201 offset:61440
    v_cvt_pk_bf16_f32 v88, v48, v49
    v_mfma_f32_16x16x32_bf16 a[100:103], a[184:187], v[68:71], a[100:103]
    v_exp_f32 v50, v50
    v_mfma_f32_16x16x32_bf16 a[116:119], a[188:191], v[68:71], a[116:119]
    v_exp_f32 v51, v51
    v_mfma_f32_16x16x32_bf16 a[104:107], a[184:187], v[72:75], a[104:107]
    v_cvt_pk_bf16_f32 v89, v50, v51
    v_mfma_f32_16x16x32_bf16 a[120:123], a[188:191], v[72:75], a[120:123]
    v_exp_f32 v52, v52
    s_nop 0
    v_exp_f32 v53, v53
    s_nop 0
    v_cvt_pk_bf16_f32 v90, v52, v53
    v_exp_f32 v54, v54
    v_exp_f32 v55, v55
    s_nop 0
    v_cvt_pk_bf16_f32 v91, v54, v55
    ds_read_b64_tr_b16 a[184:185], v202 offset:57344
    ds_read_b64_tr_b16 a[186:187], v202 offset:61440
    ds_read_b64_tr_b16 a[188:189], v203 offset:57344
    ds_read_b64_tr_b16 a[190:191], v203 offset:61440
    s_waitcnt lgkmcnt(0)
    s_barrier
    v_mfma_f32_16x16x32_bf16 a[192:195], a[208:211], v[80:83], a[192:195]
    s_mul_i32 s46, s32, 15
    v_mfma_f32_16x16x32_bf16 a[196:199], a[208:211], v[84:87], a[196:199]
    s_lshl_b32 s47, s3, 2
    v_lshlrev_b32 v230, 4, v221
    v_mfma_f32_16x16x32_bf16 a[200:203], a[208:211], v[88:91], a[200:203]
    s_add_u32 s46, s46, s47
    v_mfma_f32_16x16x32_bf16 a[0:3], a[160:163], v[80:83], a[0:3]
    s_lshl_b32 s46, s46, 17
    v_mfma_f32_16x16x32_bf16 a[4:7], a[160:163], v[84:87], a[4:7]
    s_lshl_b32 s47, s33, 12
    v_mfma_f32_16x16x32_bf16 a[8:11], a[160:163], v[88:91], a[8:11]
    s_add_u32 s46, s46, s47
    v_mfma_f32_16x16x32_bf16 a[16:19], a[164:167], v[80:83], a[16:19]
    s_mov_b32 s55, 0x53800000
    v_mfma_f32_16x16x32_bf16 a[20:23], a[164:167], v[84:87], a[20:23]
    v_mfma_f32_16x16x32_bf16 a[24:27], a[164:167], v[88:91], a[24:27]
    v_mfma_f32_16x16x32_bf16 a[32:35], a[168:171], v[80:83], a[32:35]
    v_mfma_f32_16x16x32_bf16 a[36:39], a[168:171], v[84:87], a[36:39]
    v_mfma_f32_16x16x32_bf16 a[40:43], a[168:171], v[88:91], a[40:43]
    v_mfma_f32_16x16x32_bf16 a[48:51], a[172:175], v[80:83], a[48:51]
    v_accvgpr_read_b32 v222, a192
    v_accvgpr_read_b32 v223, a196
    v_mfma_f32_16x16x32_bf16 a[52:55], a[172:175], v[84:87], a[52:55]
    v_accvgpr_read_b32 v224, a200
    v_mfma_f32_16x16x32_bf16 a[56:59], a[172:175], v[88:91], a[56:59]
    v_mfma_f32_16x16x32_bf16 a[64:67], a[176:179], v[80:83], a[64:67]
    v_cmp_ngt_f32 s[48:49], s55, v222
    v_cmp_ngt_f32 s[50:51], s55, v223
    v_mfma_f32_16x16x32_bf16 a[68:71], a[176:179], v[84:87], a[68:71]
    v_cmp_ngt_f32 s[52:53], s55, v224
    v_mfma_f32_16x16x32_bf16 a[72:75], a[176:179], v[88:91], a[72:75]
    v_mfma_f32_16x16x32_bf16 a[80:83], a[180:183], v[80:83], a[80:83]
    v_rcp_f32 v226, v222
    v_mfma_f32_16x16x32_bf16 a[84:87], a[180:183], v[84:87], a[84:87]
    v_rcp_f32 v227, v223
    v_mfma_f32_16x16x32_bf16 a[88:91], a[180:183], v[88:91], a[88:91]
    v_rcp_f32 v228, v224
    v_mfma_f32_16x16x32_bf16 a[96:99], a[184:187], v[80:83], a[96:99]
    v_mfma_f32_16x16x32_bf16 a[100:103], a[184:187], v[84:87], a[100:103]
    v_mfma_f32_16x16x32_bf16 a[104:107], a[184:187], v[88:91], a[104:107]
    v_mfma_f32_16x16x32_bf16 a[112:115], a[188:191], v[80:83], a[112:115]
    v_mfma_f32_16x16x32_bf16 a[116:119], a[188:191], v[84:87], a[116:119]
    v_mfma_f32_16x16x32_bf16 a[120:123], a[188:191], v[88:91], a[120:123]
    s_or_b64 s[48:49], s[48:49], s[50:51]
    s_or_b64 s[48:49], s[48:49], s[52:53]
    s_cmp_eq_u64 s[48:49], 0
    s_cbranch_scc0 L1_slowb
L1_normb:
    s_nop 3
    s_add_u32 s47, s46, 0
    v_accvgpr_read_b32 v0, a0
    v_accvgpr_read_b32 v1, a1
    v_accvgpr_read_b32 v2, a2
    v_accvgpr_read_b32 v3, a3
    v_accvgpr_read_b32 v4, a16
    v_accvgpr_read_b32 v5, a17
    v_accvgpr_read_b32 v6, a18
    v_accvgpr_read_b32 v7, a19
    v_pk_mul_f32 v[0:1], v[0:1], v[226:227] op_sel:[0,0] op_sel_hi:[1,0]
    v_pk_mul_f32 v[2:3], v[2:3], v[226:227] op_sel:[0,0] op_sel_hi:[1,0]
    v_pk_mul_f32 v[4:5], v[4:5], v[226:227] op_sel:[0,0] op_sel_hi:[1,0]
    v_pk_mul_f32 v[6:7], v[6:7], v[226:227] op_sel:[0,0] op_sel_hi:[1,0]
    v_cvt_pk_bf16_f32 v8, v0, v1
    v_cvt_pk_bf16_f32 v9, v2, v3
    v_cvt_pk_bf16_f32 v10, v4, v5
    v_cvt_pk_bf16_f32 v11, v6, v7
    buffer_store_dwordx4 v[8:11], v230, s[24:27], s47 offen offset:0 sc1
    v_accvgpr_read_b32 v12, a32
    v_accvgpr_read_b32 v13, a33
    v_accvgpr_read_b32 v14, a34
    v_accvgpr_read_b32 v15, a35
    v_accvgpr_read_b32 v16, a48
    v_accvgpr_read_b32 v17, a49
    v_accvgpr_read_b32 v18, a50
    v_accvgpr_read_b32 v19, a51
    v_pk_mul_f32 v[12:13], v[12:13], v[226:227] op_sel:[0,0] op_sel_hi:[1,0]
    v_pk_mul_f32 v[14:15], v[14:15], v[226:227] op_sel:[0,0] op_sel_hi:[1,0]
    v_pk_mul_f32 v[16:17], v[16:17], v[226:227] op_sel:[0,0] op_sel_hi:[1,0]
    v_pk_mul_f32 v[18:19], v[18:19], v[226:227] op_sel:[0,0] op_sel_hi:[1,0]
    v_cvt_pk_bf16_f32 v20, v12, v13
    v_cvt_pk_bf16_f32 v21, v14, v15
    v_cvt_pk_bf16_f32 v22, v16, v17
    v_cvt_pk_bf16_f32 v23, v18, v19
    buffer_store_dwordx4 v[20:23], v230, s[24:27], s47 offen offset:1024 sc1
    v_accvgpr_read_b32 v24, a64
    v_accvgpr_read_b32 v25, a65
    v_accvgpr_read_b32 v26, a66
    v_accvgpr_read_b32 v27, a67
    v_accvgpr_read_b32 v28, a80
    v_accvgpr_read_b32 v29, a81
    v_accvgpr_read_b32 v30, a82
    v_accvgpr_read_b32 v31, a83
    v_pk_mul_f32 v[24:25], v[24:25], v[226:227] op_sel:[0,0] op_sel_hi:[1,0]
    v_pk_mul_f32 v[26:27], v[26:27], v[226:227] op_sel:[0,0] op_sel_hi:[1,0]
    v_pk_mul_f32 v[28:29], v[28:29], v[226:227] op_sel:[0,0] op_sel_hi:[1,0]
    v_pk_mul_f32 v[30:31], v[30:31], v[226:227] op_sel:[0,0] op_sel_hi:[1,0]
    v_cvt_pk_bf16_f32 v32, v24, v25
    v_cvt_pk_bf16_f32 v33, v26, v27
    v_cvt_pk_bf16_f32 v34, v28, v29
    v_cvt_pk_bf16_f32 v35, v30, v31
    buffer_store_dwordx4 v[32:35], v230, s[24:27], s47 offen offset:2048 sc1
    v_accvgpr_read_b32 v36, a96
    v_accvgpr_read_b32 v37, a97
    v_accvgpr_read_b32 v38, a98
    v_accvgpr_read_b32 v39, a99
    v_accvgpr_read_b32 v40, a112
    v_accvgpr_read_b32 v41, a113
    v_accvgpr_read_b32 v42, a114
    v_accvgpr_read_b32 v43, a115
    v_pk_mul_f32 v[36:37], v[36:37], v[226:227] op_sel:[0,0] op_sel_hi:[1,0]
    v_pk_mul_f32 v[38:39], v[38:39], v[226:227] op_sel:[0,0] op_sel_hi:[1,0]
    v_pk_mul_f32 v[40:41], v[40:41], v[226:227] op_sel:[0,0] op_sel_hi:[1,0]
    v_pk_mul_f32 v[42:43], v[42:43], v[226:227] op_sel:[0,0] op_sel_hi:[1,0]
    v_cvt_pk_bf16_f32 v44, v36, v37
    v_cvt_pk_bf16_f32 v45, v38, v39
    v_cvt_pk_bf16_f32 v46, v40, v41
    v_cvt_pk_bf16_f32 v47, v42, v43
    buffer_store_dwordx4 v[44:47], v230, s[24:27], s47 offen offset:3072 sc1
    s_add_u32 s47, s46, 131072
    v_accvgpr_read_b32 v48, a4
    v_accvgpr_read_b32 v49, a5
    v_accvgpr_read_b32 v50, a6
    v_accvgpr_read_b32 v51, a7
    v_accvgpr_read_b32 v52, a20
    v_accvgpr_read_b32 v53, a21
    v_accvgpr_read_b32 v54, a22
    v_accvgpr_read_b32 v55, a23
    v_pk_mul_f32 v[48:49], v[48:49], v[226:227] op_sel:[0,1] op_sel_hi:[1,1]
    v_pk_mul_f32 v[50:51], v[50:51], v[226:227] op_sel:[0,1] op_sel_hi:[1,1]
    v_pk_mul_f32 v[52:53], v[52:53], v[226:227] op_sel:[0,1] op_sel_hi:[1,1]
    v_pk_mul_f32 v[54:55], v[54:55], v[226:227] op_sel:[0,1] op_sel_hi:[1,1]
    v_cvt_pk_bf16_f32 v56, v48, v49
    v_cvt_pk_bf16_f32 v57, v50, v51
    v_cvt_pk_bf16_f32 v58, v52, v53
    v_cvt_pk_bf16_f32 v59, v54, v55
    buffer_store_dwordx4 v[56:59], v230, s[24:27], s47 offen offset:0 sc1
    v_accvgpr_read_b32 v60, a36
    v_accvgpr_read_b32 v61, a37
    v_accvgpr_read_b32 v62, a38
    v_accvgpr_read_b32 v63, a39
    v_accvgpr_read_b32 v64, a52
    v_accvgpr_read_b32 v65, a53
    v_accvgpr_read_b32 v66, a54
    v_accvgpr_read_b32 v67, a55
    v_pk_mul_f32 v[60:61], v[60:61], v[226:227] op_sel:[0,1] op_sel_hi:[1,1]
    v_pk_mul_f32 v[62:63], v[62:63], v[226:227] op_sel:[0,1] op_sel_hi:[1,1]
    v_pk_mul_f32 v[64:65], v[64:65], v[226:227] op_sel:[0,1] op_sel_hi:[1,1]
    v_pk_mul_f32 v[66:67], v[66:67], v[226:227] op_sel:[0,1] op_sel_hi:[1,1]
    v_cvt_pk_bf16_f32 v68, v60, v61
    v_cvt_pk_bf16_f32 v69, v62, v63
    v_cvt_pk_bf16_f32 v70, v64, v65
    v_cvt_pk_bf16_f32 v71, v66, v67
    buffer_store_dwordx4 v[68:71], v230, s[24:27], s47 offen offset:1024 sc1
    v_accvgpr_read_b32 v0, a68
    v_accvgpr_read_b32 v1, a69
    v_accvgpr_read_b32 v2, a70
    v_accvgpr_read_b32 v3, a71
    v_accvgpr_read_b32 v4, a84
    v_accvgpr_read_b32 v5, a85
    v_accvgpr_read_b32 v6, a86
    v_accvgpr_read_b32 v7, a87
    v_pk_mul_f32 v[0:1], v[0:1], v[226:227] op_sel:[0,1] op_sel_hi:[1,1]
    v_pk_mul_f32 v[2:3], v[2:3], v[226:227] op_sel:[0,1] op_sel_hi:[1,1]
    v_pk_mul_f32 v[4:5], v[4:5], v[226:227] op_sel:[0,1] op_sel_hi:[1,1]
    v_pk_mul_f32 v[6:7], v[6:7], v[226:227] op_sel:[0,1] op_sel_hi:[1,1]
    v_cvt_pk_bf16_f32 v8, v0, v1
    v_cvt_pk_bf16_f32 v9, v2, v3
    v_cvt_pk_bf16_f32 v10, v4, v5
    v_cvt_pk_bf16_f32 v11, v6, v7
    buffer_store_dwordx4 v[8:11], v230, s[24:27], s47 offen offset:2048 sc1
    v_accvgpr_read_b32 v12, a100
    v_accvgpr_read_b32 v13, a101
    v_accvgpr_read_b32 v14, a102
    v_accvgpr_read_b32 v15, a103
    v_accvgpr_read_b32 v16, a116
    v_accvgpr_read_b32 v17, a117
    v_accvgpr_read_b32 v18, a118
    v_accvgpr_read_b32 v19, a119
    v_pk_mul_f32 v[12:13], v[12:13], v[226:227] op_sel:[0,1] op_sel_hi:[1,1]
    v_pk_mul_f32 v[14:15], v[14:15], v[226:227] op_sel:[0,1] op_sel_hi:[1,1]
    v_pk_mul_f32 v[16:17], v[16:17], v[226:227] op_sel:[0,1] op_sel_hi:[1,1]
    v_pk_mul_f32 v[18:19], v[18:19], v[226:227] op_sel:[0,1] op_sel_hi:[1,1]
    v_cvt_pk_bf16_f32 v20, v12, v13
    v_cvt_pk_bf16_f32 v21, v14, v15
    v_cvt_pk_bf16_f32 v22, v16, v17
    v_cvt_pk_bf16_f32 v23, v18, v19
    buffer_store_dwordx4 v[20:23], v230, s[24:27], s47 offen offset:3072 sc1
    s_add_u32 s47, s46, 262144
    v_accvgpr_read_b32 v24, a8
    v_accvgpr_read_b32 v25, a9
    v_accvgpr_read_b32 v26, a10
    v_accvgpr_read_b32 v27, a11
    v_accvgpr_read_b32 v28, a24
    v_accvgpr_read_b32 v29, a25
    v_accvgpr_read_b32 v30, a26
    v_accvgpr_read_b32 v31, a27
    v_pk_mul_f32 v[24:25], v[24:25], v[228:229] op_sel:[0,0] op_sel_hi:[1,0]
    v_pk_mul_f32 v[26:27], v[26:27], v[228:229] op_sel:[0,0] op_sel_hi:[1,0]
    v_pk_mul_f32 v[28:29], v[28:29], v[228:229] op_sel:[0,0] op_sel_hi:[1,0]
    v_pk_mul_f32 v[30:31], v[30:31], v[228:229] op_sel:[0,0] op_sel_hi:[1,0]
    v_cvt_pk_bf16_f32 v32, v24, v25
    v_cvt_pk_bf16_f32 v33, v26, v27
    v_cvt_pk_bf16_f32 v34, v28, v29
    v_cvt_pk_bf16_f32 v35, v30, v31
    buffer_store_dwordx4 v[32:35], v230, s[24:27], s47 offen offset:0 sc1
    v_accvgpr_read_b32 v36, a40
    v_accvgpr_read_b32 v37, a41
    v_accvgpr_read_b32 v38, a42
    v_accvgpr_read_b32 v39, a43
    v_accvgpr_read_b32 v40, a56
    v_accvgpr_read_b32 v41, a57
    v_accvgpr_read_b32 v42, a58
    v_accvgpr_read_b32 v43, a59
    v_pk_mul_f32 v[36:37], v[36:37], v[228:229] op_sel:[0,0] op_sel_hi:[1,0]
    v_pk_mul_f32 v[38:39], v[38:39], v[228:229] op_sel:[0,0] op_sel_hi:[1,0]
    v_pk_mul_f32 v[40:41], v[40:41], v[228:229] op_sel:[0,0] op_sel_hi:[1,0]
    v_pk_mul_f32 v[42:43], v[42:43], v[228:229] op_sel:[0,0] op_sel_hi:[1,0]
    v_cvt_pk_bf16_f32 v44, v36, v37
    v_cvt_pk_bf16_f32 v45, v38, v39
    v_cvt_pk_bf16_f32 v46, v40, v41
    v_cvt_pk_bf16_f32 v47, v42, v43
    buffer_store_dwordx4 v[44:47], v230, s[24:27], s47 offen offset:1024 sc1
    v_accvgpr_read_b32 v48, a72
    v_accvgpr_read_b32 v49, a73
    v_accvgpr_read_b32 v50, a74
    v_accvgpr_read_b32 v51, a75
    v_accvgpr_read_b32 v52, a88
    v_accvgpr_read_b32 v53, a89
    v_accvgpr_read_b32 v54, a90
    v_accvgpr_read_b32 v55, a91
    v_pk_mul_f32 v[48:49], v[48:49], v[228:229] op_sel:[0,0] op_sel_hi:[1,0]
    v_pk_mul_f32 v[50:51], v[50:51], v[228:229] op_sel:[0,0] op_sel_hi:[1,0]
    v_pk_mul_f32 v[52:53], v[52:53], v[228:229] op_sel:[0,0] op_sel_hi:[1,0]
    v_pk_mul_f32 v[54:55], v[54:55], v[228:229] op_sel:[0,0] op_sel_hi:[1,0]
    v_cvt_pk_bf16_f32 v56, v48, v49
    v_cvt_pk_bf16_f32 v57, v50, v51
    v_cvt_pk_bf16_f32 v58, v52, v53
    v_cvt_pk_bf16_f32 v59, v54, v55
    buffer_store_dwordx4 v[56:59], v230, s[24:27], s47 offen offset:2048 sc1
    v_accvgpr_read_b32 v60, a104
    v_accvgpr_read_b32 v61, a105
    v_accvgpr_read_b32 v62, a106
    v_accvgpr_read_b32 v63, a107
    v_accvgpr_read_b32 v64, a120
    v_accvgpr_read_b32 v65, a121
    v_accvgpr_read_b32 v66, a122
    v_accvgpr_read_b32 v67, a123
    v_pk_mul_f32 v[60:61], v[60:61], v[228:229] op_sel:[0,0] op_sel_hi:[1,0]
    v_pk_mul_f32 v[62:63], v[62:63], v[228:229] op_sel:[0,0] op_sel_hi:[1,0]
    v_pk_mul_f32 v[64:65], v[64:65], v[228:229] op_sel:[0,0] op_sel_hi:[1,0]
    v_pk_mul_f32 v[66:67], v[66:67], v[228:229] op_sel:[0,0] op_sel_hi:[1,0]
    v_cvt_pk_bf16_f32 v68, v60, v61
    v_cvt_pk_bf16_f32 v69, v62, v63
    v_cvt_pk_bf16_f32 v70, v64, v65
    v_cvt_pk_bf16_f32 v71, v66, v67
    buffer_store_dwordx4 v[68:71], v230, s[24:27], s47 offen offset:3072 sc1
    s_branch L2_entry
L1_slowb:
    s_lshl_b32 s52, s3, 14
    s_add_u32 s52, s52, 98304
    v_add_u32 v192, s52, v192
    v_add_u32 v193, s52, v193
    v_add_u32 v194, s52, v194
    v_add_u32 v195, s52, v195
    s_sub_u32 s55, s52, 57344
    v_add_u32 v196, s55, v196
    v_add_u32 v197, s55, v197
    v_add_u32 v198, s55, v198
    v_add_u32 v199, s55, v199
    v_add_u32 v200, s55, v200
    v_add_u32 v201, s55, v201
    v_add_u32 v202, s55, v202
    v_add_u32 v203, s55, v203
    v_mov_b32 v222, 0xff800000
    v_mov_b32 v223, 0xff800000
    v_mov_b32 v224, 0xff800000
    s_mov_b32 s53, 0
L1_slow_maxb:
    s_add_u32 s54, s53, 0
    s_add_u32 m0, s52, 0
    s_nop 0
    buffer_load_dwordx4 v204, s[8:11], s54 offen lds
    buffer_load_dwordx4 v205, s[8:11], s54 offen offset:1024 lds
    buffer_load_dwordx4 v206, s[8:11], s54 offen offset:2048 lds
    buffer_load_dwordx4 v207, s[8:11], s54 offen offset:3072 lds
    s_add_u32 s54, s53, 4096
    s_add_u32 m0, s52, 4096
    s_nop 0
    buffer_load_dwordx4 v204, s[8:11], s54 offen lds
    buffer_load_dwordx4 v205, s[8:11], s54 offen offset:1024 lds
    buffer_load_dwordx4 v206, s[8:11], s54 offen offset:2048 lds
    buffer_load_dwordx4 v207, s[8:11], s54 offen offset:3072 lds
    s_waitcnt vmcnt(0)
    ds_read_b128 a[128:131], v192 offset:0
    ds_read_b128 a[132:135], v193 offset:0
    ds_read_b128 a[136:139], v194 offset:0
    ds_read_b128 a[140:143], v195 offset:0
    ds_read_b128 a[144:147], v192 offset:4096
    ds_read_b128 a[148:151], v193 offset:4096
    ds_read_b128 a[152:155], v194 offset:4096
    ds_read_b128 a[156:159], v195 offset:4096
    s_waitcnt lgkmcnt(0)
    v_mfma_f32_16x16x32_bf16 v[0:3], a[128:131], v[128:131], 0
    v_mfma_f32_16x16x32_bf16 v[0:3], a[132:135], v[132:135], v[0:3]
    v_mfma_f32_16x16x32_bf16 v[0:3], a[136:139], v[136:139], v[0:3]
    v_mfma_f32_16x16x32_bf16 v[0:3], a[140:143], v[140:143], v[0:3]
    v_mfma_f32_16x16x32_bf16 v[8:11], a[128:131], v[144:147], 0
    v_mfma_f32_16x16x32_bf16 v[8:11], a[132:135], v[148:151], v[8:11]
    v_mfma_f32_16x16x32_bf16 v[8:11], a[136:139], v[152:155], v[8:11]
    v_mfma_f32_16x16x32_bf16 v[8:11], a[140:143], v[156:159], v[8:11]
    v_mfma_f32_16x16x32_bf16 v[16:19], a[128:131], v[160:163], 0
    v_mfma_f32_16x16x32_bf16 v[16:19], a[132:135], v[164:167], v[16:19]
    v_mfma_f32_16x16x32_bf16 v[16:19], a[136:139], v[168:171], v[16:19]
    v_mfma_f32_16x16x32_bf16 v[16:19], a[140:143], v[172:175], v[16:19]
    v_mfma_f32_16x16x32_bf16 v[4:7], a[144:147], v[128:131], 0
    v_mfma_f32_16x16x32_bf16 v[4:7], a[148:151], v[132:135], v[4:7]
    v_mfma_f32_16x16x32_bf16 v[4:7], a[152:155], v[136:139], v[4:7]
    v_mfma_f32_16x16x32_bf16 v[4:7], a[156:159], v[140:143], v[4:7]
    v_mfma_f32_16x16x32_bf16 v[12:15], a[144:147], v[144:147], 0
    v_mfma_f32_16x16x32_bf16 v[12:15], a[148:151], v[148:151], v[12:15]
    v_mfma_f32_16x16x32_bf16 v[12:15], a[152:155], v[152:155], v[12:15]
    v_mfma_f32_16x16x32_bf16 v[12:15], a[156:159], v[156:159], v[12:15]
    v_mfma_f32_16x16x32_bf16 v[20:23], a[144:147], v[160:163], 0
    v_mfma_f32_16x16x32_bf16 v[20:23], a[148:151], v[164:167], v[20:23]
    v_mfma_f32_16x16x32_bf16 v[20:23], a[152:155], v[168:171], v[20:23]
    v_mfma_f32_16x16x32_bf16 v[20:23], a[156:159], v[172:175], v[20:23]
    s_nop 7
    s_nop 7
    v_max3_f32 v222, v222, v0, v1
    v_max3_f32 v222, v222, v2, v3
    v_max3_f32 v222, v222, v4, v5
    v_max3_f32 v222, v222, v6, v7
    v_max3_f32 v223, v223, v8, v9
    v_max3_f32 v223, v223, v10, v11
    v_max3_f32 v223, v223, v12, v13
    v_max3_f32 v223, v223, v14, v15
    v_max3_f32 v224, v224, v16, v17
    v_max3_f32 v224, v224, v18, v19
    v_max3_f32 v224, v224, v20, v21
    v_max3_f32 v224, v224, v22, v23
    s_add_u32 s53, s53, 8192
    s_cmp_lt_u32 s53, 524288
    s_cbranch_scc1 L1_slow_maxb
    v_mov_b32 v226, v222
    v_mov_b32 v227, v223
    v_mov_b32 v228, v224
    s_nop 1
    v_permlane16_swap_b32 v222, v226
    v_permlane16_swap_b32 v223, v227
    v_permlane16_swap_b32 v224, v228
    s_nop 1
    v_max_f32 v222, v222, v226
    v_max_f32 v223, v223, v227
    v_max_f32 v224, v224, v228
    v_mov_b32 v226, v222
    v_mov_b32 v227, v223
    v_mov_b32 v228, v224
    s_nop 1
    v_permlane32_swap_b32 v222, v226
    v_permlane32_swap_b32 v223, v227
    v_permlane32_swap_b32 v224, v228
    s_nop 1
    v_max_f32 v222, v222, v226
    v_max_f32 v223, v223, v227
    v_max_f32 v224, v224, v228
    v_sub_f32 v222, 0, v222
    v_sub_f32 v223, 0, v223
    v_sub_f32 v224, 0, v224
    v_mov_b32 v96, v222
    v_mov_b32 v97, v222
    v_mov_b32 v98, v222
    v_mov_b32 v99, v222
    v_mov_b32 v100, v223
    v_mov_b32 v101, v223
    v_mov_b32 v102, v223
    v_mov_b32 v103, v223
    v_mov_b32 v104, v224
    v_mov_b32 v105, v224
    v_mov_b32 v106, v224
    v_mov_b32 v107, v224
    v_accvgpr_write_b32 a0, 0
    v_accvgpr_write_b32 a1, 0
    v_accvgpr_write_b32 a2, 0
    v_accvgpr_write_b32 a3, 0
    v_accvgpr_write_b32 a4, 0
    v_accvgpr_write_b32 a5, 0
    v_accvgpr_write_b32 a6, 0
    v_accvgpr_write_b32 a7, 0
    v_accvgpr_write_b32 a8, 0
    v_accvgpr_write_b32 a9, 0
    v_accvgpr_write_b32 a10, 0
    v_accvgpr_write_b32 a11, 0
    v_accvgpr_write_b32 a16, 0
    v_accvgpr_write_b32 a17, 0
    v_accvgpr_write_b32 a18, 0
    v_accvgpr_write_b32 a19, 0
    v_accvgpr_write_b32 a20, 0
    v_accvgpr_write_b32 a21, 0
    v_accvgpr_write_b32 a22, 0
    v_accvgpr_write_b32 a23, 0
    v_accvgpr_write_b32 a24, 0
    v_accvgpr_write_b32 a25, 0
    v_accvgpr_write_b32 a26, 0
    v_accvgpr_write_b32 a27, 0
    v_accvgpr_write_b32 a32, 0
    v_accvgpr_write_b32 a33, 0
    v_accvgpr_write_b32 a34, 0
    v_accvgpr_write_b32 a35, 0
    v_accvgpr_write_b32 a36, 0
    v_accvgpr_write_b32 a37, 0
    v_accvgpr_write_b32 a38, 0
    v_accvgpr_write_b32 a39, 0
    v_accvgpr_write_b32 a40, 0
    v_accvgpr_write_b32 a41, 0
    v_accvgpr_write_b32 a42, 0
    v_accvgpr_write_b32 a43, 0
    v_accvgpr_write_b32 a48, 0
    v_accvgpr_write_b32 a49, 0
    v_accvgpr_write_b32 a50, 0
    v_accvgpr_write_b32 a51, 0
    v_accvgpr_write_b32 a52, 0
    v_accvgpr_write_b32 a53, 0
    v_accvgpr_write_b32 a54, 0
    v_accvgpr_write_b32 a55, 0
    v_accvgpr_write_b32 a56, 0
    v_accvgpr_write_b32 a57, 0
    v_accvgpr_write_b32 a58, 0
    v_accvgpr_write_b32 a59, 0
    v_accvgpr_write_b32 a64, 0
    v_accvgpr_write_b32 a65, 0
    v_accvgpr_write_b32 a66, 0
    v_accvgpr_write_b32 a67, 0
    v_accvgpr_write_b32 a68, 0
    v_accvgpr_write_b32 a69, 0
    v_accvgpr_write_b32 a70, 0
    v_accvgpr_write_b32 a71, 0
    v_accvgpr_write_b32 a72, 0
    v_accvgpr_write_b32 a73, 0
    v_accvgpr_write_b32 a74, 0
    v_accvgpr_write_b32 a75, 0
    v_accvgpr_write_b32 a80, 0
    v_accvgpr_write_b32 a81, 0
    v_accvgpr_write_b32 a82, 0
    v_accvgpr_write_b32 a83, 0
    v_accvgpr_write_b32 a84, 0
    v_accvgpr_write_b32 a85, 0
    v_accvgpr_write_b32 a86, 0
    v_accvgpr_write_b32 a87, 0
    v_accvgpr_write_b32 a88, 0
    v_accvgpr_write_b32 a89, 0
    v_accvgpr_write_b32 a90, 0
    v_accvgpr_write_b32 a91, 0
    v_accvgpr_write_b32 a96, 0
    v_accvgpr_write_b32 a97, 0
    v_accvgpr_write_b32 a98, 0
    v_accvgpr_write_b32 a99, 0
    v_accvgpr_write_b32 a100, 0
    v_accvgpr_write_b32 a101, 0
    v_accvgpr_write_b32 a102, 0
    v_accvgpr_write_b32 a103, 0
    v_accvgpr_write_b32 a104, 0
    v_accvgpr_write_b32 a105, 0
    v_accvgpr_write_b32 a106, 0
    v_accvgpr_write_b32 a107, 0
    v_accvgpr_write_b32 a112, 0
    v_accvgpr_write_b32 a113, 0
    v_accvgpr_write_b32 a114, 0
    v_accvgpr_write_b32 a115, 0
    v_accvgpr_write_b32 a116, 0
    v_accvgpr_write_b32 a117, 0
    v_accvgpr_write_b32 a118, 0
    v_accvgpr_write_b32 a119, 0
    v_accvgpr_write_b32 a120, 0
    v_accvgpr_write_b32 a121, 0
    v_accvgpr_write_b32 a122, 0
    v_accvgpr_write_b32 a123, 0
    v_accvgpr_write_b32 a192, 0
    v_accvgpr_write_b32 a193, 0
    v_accvgpr_write_b32 a194, 0
    v_accvgpr_write_b32 a195, 0
    v_accvgpr_write_b32 a196, 0
    v_accvgpr_write_b32 a197, 0
    v_accvgpr_write_b32 a198, 0
    v_accvgpr_write_b32 a199, 0
    v_accvgpr_write_b32 a200, 0
    v_accvgpr_write_b32 a201, 0
    v_accvgpr_write_b32 a202, 0
    v_accvgpr_write_b32 a203, 0
    s_mov_b32 s53, 0
L1_slow_mainb:
    s_add_u32 s54, s53, 0
    s_add_u32 m0, s52, 0
    s_nop 0
    buffer_load_dwordx4 v204, s[8:11], s54 offen lds
    buffer_load_dwordx4 v205, s[8:11], s54 offen offset:1024 lds
    buffer_load_dwordx4 v206, s[8:11], s54 offen offset:2048 lds
    buffer_load_dwordx4 v207, s[8:11], s54 offen offset:3072 lds
    s_add_u32 s54, s53, 4096
    s_add_u32 m0, s52, 4096
    s_nop 0
    buffer_load_dwordx4 v204, s[8:11], s54 offen lds
    buffer_load_dwordx4 v205, s[8:11], s54 offen offset:1024 lds
    buffer_load_dwordx4 v206, s[8:11], s54 offen offset:2048 lds
    buffer_load_dwordx4 v207, s[8:11], s54 offen offset:3072 lds
    s_add_u32 s54, s53, 0
    s_add_u32 m0, s52, 8192
    s_nop 0
    buffer_load_dwordx4 v208, s[12:15], s54 offen lds
    buffer_load_dwordx4 v209, s[12:15], s54 offen offset:1024 lds
    buffer_load_dwordx4 v208, s[12:15], s54 offen offset:2048 lds
    buffer_load_dwordx4 v209, s[12:15], s54 offen offset:3072 lds
    s_add_u32 s54, s53, 4096
    s_add_u32 m0, s52, 12288
    s_nop 0
    buffer_load_dwordx4 v208, s[12:15], s54 offen lds
    buffer_load_dwordx4 v209, s[12:15], s54 offen offset:1024 lds
    buffer_load_dwordx4 v208, s[12:15], s54 offen offset:2048 lds
    buffer_load_dwordx4 v209, s[12:15], s54 offen offset:3072 lds
    s_waitcnt vmcnt(0)
    ds_read_b128 a[128:131], v192 offset:0
    ds_read_b128 a[132:135], v193 offset:0
    ds_read_b128 a[136:139], v194 offset:0
    ds_read_b128 a[140:143], v195 offset:0
    ds_read_b128 a[144:147], v192 offset:4096
    ds_read_b128 a[148:151], v193 offset:4096
    ds_read_b128 a[152:155], v194 offset:4096
    ds_read_b128 a[156:159], v195 offset:4096
    ds_read_b64_tr_b16 a[160:161], v196 offset:0
    ds_read_b64_tr_b16 a[162:163], v196 offset:4096
    ds_read_b64_tr_b16 a[164:165], v197 offset:0
    ds_read_b64_tr_b16 a[166:167], v197 offset:4096
    ds_read_b64_tr_b16 a[168:169], v198 offset:0
    ds_read_b64_tr_b16 a[170:171], v198 offset:4096
    ds_read_b64_tr_b16 a[172:173], v199 offset:0
    ds_read_b64_tr_b16 a[174:175], v199 offset:4096
    ds_read_b64_tr_b16 a[176:177], v200 offset:0
    ds_read_b64_tr_b16 a[178:179], v200 offset:4096
    ds_read_b64_tr_b16 a[180:181], v201 offset:0
    ds_read_b64_tr_b16 a[182:183], v201 offset:4096
    ds_read_b64_tr_b16 a[184:185], v202 offset:0
    ds_read_b64_tr_b16 a[186:187], v202 offset:4096
    ds_read_b64_tr_b16 a[188:189], v203 offset:0
    ds_read_b64_tr_b16 a[190:191], v203 offset:4096
    s_waitcnt lgkmcnt(0)
    v_mfma_f32_16x16x32_bf16 v[0:3], a[128:131], v[128:131], v[96:99]
    v_mfma_f32_16x16x32_bf16 v[0:3], a[132:135], v[132:135], v[0:3]
    v_mfma_f32_16x16x32_bf16 v[0:3], a[136:139], v[136:139], v[0:3]
    v_mfma_f32_16x16x32_bf16 v[0:3], a[140:143], v[140:143], v[0:3]
    v_mfma_f32_16x16x32_bf16 v[8:11], a[128:131], v[144:147], v[100:103]
    v_mfma_f32_16x16x32_bf16 v[8:11], a[132:135], v[148:151], v[8:11]
    v_mfma_f32_16x16x32_bf16 v[8:11], a[136:139], v[152:155], v[8:11]
    v_mfma_f32_16x16x32_bf16 v[8:11], a[140:143], v[156:159], v[8:11]
    v_mfma_f32_16x16x32_bf16 v[16:19], a[128:131], v[160:163], v[104:107]
    v_mfma_f32_16x16x32_bf16 v[16:19], a[132:135], v[164:167], v[16:19]
    v_mfma_f32_16x16x32_bf16 v[16:19], a[136:139], v[168:171], v[16:19]
    v_mfma_f32_16x16x32_bf16 v[16:19], a[140:143], v[172:175], v[16:19]
    v_mfma_f32_16x16x32_bf16 v[4:7], a[144:147], v[128:131], v[96:99]
    v_mfma_f32_16x16x32_bf16 v[4:7], a[148:151], v[132:135], v[4:7]
    v_mfma_f32_16x16x32_bf16 v[4:7], a[152:155], v[136:139], v[4:7]
    v_mfma_f32_16x16x32_bf16 v[4:7], a[156:159], v[140:143], v[4:7]
    v_mfma_f32_16x16x32_bf16 v[12:15], a[144:147], v[144:147], v[100:103]
    v_mfma_f32_16x16x32_bf16 v[12:15], a[148:151], v[148:151], v[12:15]
    v_mfma_f32_16x16x32_bf16 v[12:15], a[152:155], v[152:155], v[12:15]
    v_mfma_f32_16x16x32_bf16 v[12:15], a[156:159], v[156:159], v[12:15]
    v_mfma_f32_16x16x32_bf16 v[20:23], a[144:147], v[160:163], v[104:107]
    v_mfma_f32_16x16x32_bf16 v[20:23], a[148:151], v[164:167], v[20:23]
    v_mfma_f32_16x16x32_bf16 v[20:23], a[152:155], v[168:171], v[20:23]
    v_mfma_f32_16x16x32_bf16 v[20:23], a[156:159], v[172:175], v[20:23]
    s_nop 7
    s_nop 7
    v_exp_f32 v0, v0
    v_exp_f32 v1, v1
    v_exp_f32 v2, v2
    v_exp_f32 v3, v3
    v_exp_f32 v4, v4
    v_exp_f32 v5, v5
    v_exp_f32 v6, v6
    v_exp_f32 v7, v7
    v_exp_f32 v8, v8
    v_exp_f32 v9, v9
    v_exp_f32 v10, v10
    v_exp_f32 v11, v11
    v_exp_f32 v12, v12
    v_exp_f32 v13, v13
    v_exp_f32 v14, v14
    v_exp_f32 v15, v15
    v_exp_f32 v16, v16
    v_exp_f32 v17, v17
    v_exp_f32 v18, v18
    v_exp_f32 v19, v19
    v_exp_f32 v20, v20
    v_exp_f32 v21, v21
    v_exp_f32 v22, v22
    v_exp_f32 v23, v23
    s_nop 0
    v_cvt_pk_bf16_f32 v64, v0, v1
    v_cvt_pk_bf16_f32 v65, v2, v3
    v_cvt_pk_bf16_f32 v66, v4, v5
    v_cvt_pk_bf16_f32 v67, v6, v7
    v_cvt_pk_bf16_f32 v68, v8, v9
    v_cvt_pk_bf16_f32 v69, v10, v11
    v_cvt_pk_bf16_f32 v70, v12, v13
    v_cvt_pk_bf16_f32 v71, v14, v15
    v_cvt_pk_bf16_f32 v72, v16, v17
    v_cvt_pk_bf16_f32 v73, v18, v19
    v_cvt_pk_bf16_f32 v74, v20, v21
    v_cvt_pk_bf16_f32 v75, v22, v23
    s_nop 1
    v_mfma_f32_16x16x32_bf16 a[0:3], a[160:163], v[64:67], a[0:3]
    v_mfma_f32_16x16x32_bf16 a[16:19], a[164:167], v[64:67], a[16:19]
    v_mfma_f32_16x16x32_bf16 a[4:7], a[160:163], v[68:71], a[4:7]
    v_mfma_f32_16x16x32_bf16 a[20:23], a[164:167], v[68:71], a[20:23]
    v_mfma_f32_16x16x32_bf16 a[8:11], a[160:163], v[72:75], a[8:11]
    v_mfma_f32_16x16x32_bf16 a[24:27], a[164:167], v[72:75], a[24:27]
    v_mfma_f32_16x16x32_bf16 a[192:195], a[208:211], v[64:67], a[192:195]
    v_mfma_f32_16x16x32_bf16 a[32:35], a[168:171], v[64:67], a[32:35]
    v_mfma_f32_16x16x32_bf16 a[48:51], a[172:175], v[64:67], a[48:51]
    v_mfma_f32_16x16x32_bf16 a[36:39], a[168:171], v[68:71], a[36:39]
    v_mfma_f32_16x16x32_bf16 a[52:55], a[172:175], v[68:71], a[52:55]
    v_mfma_f32_16x16x32_bf16 a[40:43], a[168:171], v[72:75], a[40:43]
    v_mfma_f32_16x16x32_bf16 a[56:59], a[172:175], v[72:75], a[56:59]
    v_mfma_f32_16x16x32_bf16 a[196:199], a[208:211], v[68:71], a[196:199]
    v_mfma_f32_16x16x32_bf16 a[64:67], a[176:179], v[64:67], a[64:67]
    v_mfma_f32_16x16x32_bf16 a[80:83], a[180:183], v[64:67], a[80:83]
    v_mfma_f32_16x16x32_bf16 a[68:71], a[176:179], v[68:71], a[68:71]
    v_mfma_f32_16x16x32_bf16 a[84:87], a[180:183], v[68:71], a[84:87]
    v_mfma_f32_16x16x32_bf16 a[72:75], a[176:179], v[72:75], a[72:75]
    v_mfma_f32_16x16x32_bf16 a[88:91], a[180:183], v[72:75], a[88:91]
    v_mfma_f32_16x16x32_bf16 a[200:203], a[208:211], v[72:75], a[200:203]
    v_mfma_f32_16x16x32_bf16 a[96:99], a[184:187], v[64:67], a[96:99]
    v_mfma_f32_16x16x32_bf16 a[112:115], a[188:191], v[64:67], a[112:115]
    v_mfma_f32_16x16x32_bf16 a[100:103], a[184:187], v[68:71], a[100:103]
    v_mfma_f32_16x16x32_bf16 a[116:119], a[188:191], v[68:71], a[116:119]
    v_mfma_f32_16x16x32_bf16 a[104:107], a[184:187], v[72:75], a[104:107]
    v_mfma_f32_16x16x32_bf16 a[120:123], a[188:191], v[72:75], a[120:123]
    s_add_u32 s53, s53, 8192
    s_cmp_lt_u32 s53, 524288
    s_cbranch_scc1 L1_slow_mainb
    s_nop 7
    s_nop 7
    v_accvgpr_read_b32 v222, a192
    v_accvgpr_read_b32 v223, a196
    v_accvgpr_read_b32 v224, a200
    s_nop 0
    v_rcp_f32 v226, v222
    v_rcp_f32 v227, v223
    v_rcp_f32 v228, v224
    s_mul_i32 s46, s32, 15
    s_lshl_b32 s47, s3, 2
    s_add_u32 s46, s46, s47
    s_lshl_b32 s46, s46, 17
    s_lshl_b32 s47, s33, 12
    s_add_u32 s46, s46, s47
    v_lshlrev_b32 v230, 4, v221
    s_branch L1_normb
    .p2align 6
L2_entry:
    s_mul_i32 s42, s90, 73728
    s_add_u32 m0, s95, 0
    s_nop 0
    buffer_load_dwordx4 v244, s[96:99], s42 offen lds
    s_add_u32 m0, s95, 1024
    s_nop 0
    buffer_load_dwordx4 v245, s[96:99], s42 offen lds
    s_add_u32 s90, s90, 1
    s_and_b32 s90, s90, 15
    s_add_u32 m0, s95, 2048
    s_nop 0
    buffer_load_dwordx4 v246, s[96:99], s42 offen lds
    s_mul_i32 s42, s90, 73728
    s_add_u32 m0, s95, 12288
    s_nop 0
    buffer_load_dwordx4 v244, s[96:99], s42 offen lds
    s_add_u32 m0, s95, 13312
    s_nop 0
    buffer_load_dwordx4 v245, s[96:99], s42 offen lds
    s_add_u32 s90, s90, 1
    s_and_b32 s90, s90, 15
    s_add_u32 m0, s95, 14336
    s_nop 0
    buffer_load_dwordx4 v246, s[96:99], s42 offen lds
    s_mul_i32 s42, s90, 73728
    s_add_u32 m0, s95, 24576
    s_nop 0
    buffer_load_dwordx4 v244, s[96:99], s42 offen lds
    s_add_u32 m0, s95, 25600
    s_nop 0
    buffer_load_dwordx4 v245, s[96:99], s42 offen lds
    s_add_u32 s90, s90, 1
    s_and_b32 s90, s90, 15
    s_add_u32 m0, s95, 26624
    s_nop 0
    buffer_load_dwordx4 v246, s[96:99], s42 offen lds
    s_mul_i32 s54, s2, 4224
    s_add_u32 s54, s54, 36700160
    s_mul_i32 s46, s94, 208
    s_lshr_b32 s46, s46, 8
    s_min_u32 s47, s94, 3
    v_and_b32 v223, 7, v221
    v_lshlrev_b32 v223, 2, v223
    v_mov_b32 v224, s46
    v_mov_b32 v225, s47
    v_and_b32 v226, 8, v221
    v_cmp_eq_u32 vcc, 0, v226
    s_and_b32 s46, s2, 7
    s_nop 0
    v_cndmask_b32 v224, v225, v224, vcc
    v_add_u32 v223, v223, v224
    v_lshlrev_b32 v223, 3, v223
    v_add_u32 v223, s46, v223
    v_mul_u32_u24 v223, 4224, v223
    v_mov_b32 v224, 0
    v_cmp_eq_u32 s[48:49], 0, v221
    s_waitcnt vmcnt(9)
    v_readfirstlane_b32 s92, v243
    s_barrier
    s_cmp_lg_u32 s92, 0
    s_cbranch_scc1 L2_have_nonce
    s_mov_b32 s50, 0
L2_nonce_poll:
    buffer_load_dword v243, v224, s[76:79], 0 offen sc1
    s_waitcnt vmcnt(0)
    v_readfirstlane_b32 s92, v243
    s_nop 3
    s_add_u32 s50, s50, 1
    s_cmp_lg_u32 s92, 0
    s_cbranch_scc1 L2_have_nonce
    s_cmp_lt_u32 s50, 0x200000
    s_cbranch_scc1 L2_nonce_poll
L2_have_nonce:
    s_cmp_lg_u32 s3, 0
    s_cbranch_scc1 L2_oflag_done
    v_mov_b32 v222, s92
    s_mov_b64 s[50:51], exec
    s_mov_b64 exec, s[48:49]
    buffer_store_dword v222, v224, s[24:27], s54 offen sc1
    s_mov_b64 exec, s[50:51]
L2_oflag_done:
    s_lshr_b32 s46, s2, 3
    s_cmp_ge_u32 s46, 30
    s_cbranch_scc1 L2_exit
    s_mul_i32 s42, s90, 73728
    s_add_u32 m0, s95, 36864
    s_nop 0
    buffer_load_dwordx4 v244, s[96:99], s42 offen lds
    s_add_u32 m0, s95, 37888
    s_nop 0
    buffer_load_dwordx4 v245, s[96:99], s42 offen lds
    s_add_u32 s90, s90, 1
    s_and_b32 s90, s90, 15
    s_add_u32 m0, s95, 38912
    s_nop 0
    buffer_load_dwordx4 v246, s[96:99], s42 offen lds
    s_mul_i32 s42, s90, 73728
    s_add_u32 m0, s95, 49152
    s_nop 0
    buffer_load_dwordx4 v244, s[96:99], s42 offen lds
    s_add_u32 m0, s95, 50176
    s_nop 0
    buffer_load_dwordx4 v245, s[96:99], s42 offen lds
    s_add_u32 s90, s90, 1
    s_and_b32 s90, s90, 15
    s_add_u32 m0, s95, 51200
    s_nop 0
    buffer_load_dwordx4 v246, s[96:99], s42 offen lds
    s_mul_i32 s42, s90, 73728
    s_add_u32 m0, s95, 61440
    s_nop 0
    buffer_load_dwordx4 v244, s[96:99], s42 offen lds
    s_add_u32 m0, s95, 62464
    s_nop 0
    buffer_load_dwordx4 v245, s[96:99], s42 offen lds
    s_add_u32 s90, s90, 1
    s_and_b32 s90, s90, 15
    s_add_u32 m0, s95, 63488
    s_nop 0
    buffer_load_dwordx4 v246, s[96:99], s42 offen lds
    s_cmp_lg_u32 s3, 0
    s_cbranch_scc1 L2_omatched
    s_mov_b32 s47, 36700160
    s_mov_b32 s50, 0
L2_opoll:
    buffer_load_dword v227, v223, s[24:27], s47 offen sc1
    s_waitcnt vmcnt(0)
    v_cmp_ne_u32 vcc, s92, v227
    s_add_u32 s50, s50, 1
    s_nop 3
    s_cmp_eq_u64 vcc, 0
    s_cbranch_scc1 L2_omatched
    s_cmp_lt_u32 s50, 0x400000
    s_cbranch_scc1 L2_opoll
L2_omatched:
    s_barrier
    s_lshl_b32 s43, s91, 11
    s_add_u32 s47, s43, 0
    buffer_load_dwordx4 v[32:35], v247, s[16:19], s47 offen sc1
    s_add_u32 s47, s43, 131072
    buffer_load_dwordx4 v[36:39], v247, s[16:19], s47 offen sc1
    s_add_u32 s47, s43, 262144
    buffer_load_dwordx4 v[40:43], v247, s[16:19], s47 offen sc1
    s_add_u32 s47, s43, 1024
    buffer_load_dwordx4 v[44:47], v247, s[16:19], s47 offen sc1
    s_add_u32 s47, s43, 132096
    buffer_load_dwordx4 v[48:51], v247, s[16:19], s47 offen sc1
    s_add_u32 s47, s43, 263168
    s_add_u32 s91, s91, 1
    s_and_b32 s91, s91, 15
    buffer_load_dwordx4 v[52:55], v247, s[16:19], s47 offen sc1
    s_lshl_b32 s43, s91, 11
    s_add_u32 s47, s43, 0
    buffer_load_dwordx4 v[56:59], v247, s[16:19], s47 offen sc1
    s_add_u32 s47, s43, 131072
    buffer_load_dwordx4 v[60:63], v247, s[16:19], s47 offen sc1
    s_add_u32 s47, s43, 262144
    buffer_load_dwordx4 v[64:67], v247, s[16:19], s47 offen sc1
    s_add_u32 s47, s43, 1024
    buffer_load_dwordx4 v[68:71], v247, s[16:19], s47 offen sc1
    s_add_u32 s47, s43, 132096
    buffer_load_dwordx4 v[72:75], v247, s[16:19], s47 offen sc1
    s_add_u32 s47, s43, 263168
    s_add_u32 s91, s91, 1
    s_and_b32 s91, s91, 15
    buffer_load_dwordx4 v[76:79], v247, s[16:19], s47 offen sc1
    s_waitcnt vmcnt(6)
    s_barrier
    ds_read_b64_tr_b16 a[0:1], v248 offset:0
    ds_read_b64_tr_b16 a[2:3], v248 offset:3072
    ds_read_b64_tr_b16 a[4:5], v249 offset:0
    ds_read_b64_tr_b16 a[6:7], v249 offset:3072
    ds_read_b64_tr_b16 a[8:9], v248 offset:64
    ds_read_b64_tr_b16 a[10:11], v248 offset:3136
    ds_read_b64_tr_b16 a[12:13], v249 offset:64
    ds_read_b64_tr_b16 a[14:15], v249 offset:3136
    ds_read_b64_tr_b16 a[16:17], v248 offset:128
    ds_read_b64_tr_b16 a[18:19], v248 offset:3200
    ds_read_b64_tr_b16 a[20:21], v249 offset:128
    ds_read_b64_tr_b16 a[22:23], v249 offset:3200
    s_waitcnt lgkmcnt(0)
    v_mfma_f32_16x16x32_bf16 a[48:51], a[0:3], v[32:35], 0
    s_mul_i32 s42, s90, 73728
    ds_read_b64_tr_b16 a[24:25], v248 offset:6144
    v_mfma_f32_16x16x32_bf16 a[72:75], a[0:3], v[36:39], 0
    s_add_u32 m0, s95, 73728
    ds_read_b64_tr_b16 a[26:27], v248 offset:9216
    v_mfma_f32_16x16x32_bf16 a[96:99], a[0:3], v[40:43], 0
    ds_read_b64_tr_b16 a[28:29], v249 offset:6144
    buffer_load_dwordx4 v244, s[96:99], s42 offen lds
    v_mfma_f32_16x16x32_bf16 a[52:55], a[4:7], v[32:35], 0
    ds_read_b64_tr_b16 a[30:31], v249 offset:9216
    v_mfma_f32_16x16x32_bf16 a[76:79], a[4:7], v[36:39], 0
    s_add_u32 m0, s95, 74752
    ds_read_b64_tr_b16 a[32:33], v248 offset:6208
    v_mfma_f32_16x16x32_bf16 a[100:103], a[4:7], v[40:43], 0
    ds_read_b64_tr_b16 a[34:35], v248 offset:9280
    buffer_load_dwordx4 v245, s[96:99], s42 offen lds
    v_mfma_f32_16x16x32_bf16 a[56:59], a[8:11], v[32:35], 0
    s_add_u32 s90, s90, 1
    s_and_b32 s90, s90, 15
    ds_read_b64_tr_b16 a[36:37], v249 offset:6208
    v_mfma_f32_16x16x32_bf16 a[80:83], a[8:11], v[36:39], 0
    s_add_u32 m0, s95, 75776
    ds_read_b64_tr_b16 a[38:39], v249 offset:9280
    v_mfma_f32_16x16x32_bf16 a[104:107], a[8:11], v[40:43], 0
    ds_read_b64_tr_b16 a[40:41], v248 offset:6272
    buffer_load_dwordx4 v246, s[96:99], s42 offen lds
    v_mfma_f32_16x16x32_bf16 a[60:63], a[12:15], v[32:35], 0
    ds_read_b64_tr_b16 a[42:43], v248 offset:9344
    v_mfma_f32_16x16x32_bf16 a[84:87], a[12:15], v[36:39], 0
    s_lshl_b32 s43, s91, 11
    ds_read_b64_tr_b16 a[44:45], v249 offset:6272
    v_mfma_f32_16x16x32_bf16 a[108:111], a[12:15], v[40:43], 0
    s_add_u32 s47, s43, 0
    ds_read_b64_tr_b16 a[46:47], v249 offset:9344
    buffer_load_dwordx4 v[80:83], v247, s[16:19], s47 offen sc1
    v_mfma_f32_16x16x32_bf16 a[64:67], a[16:19], v[32:35], 0
    v_mfma_f32_16x16x32_bf16 a[88:91], a[16:19], v[36:39], 0
    v_mfma_f32_16x16x32_bf16 a[112:115], a[16:19], v[40:43], 0
    s_add_u32 s47, s43, 131072
    buffer_load_dwordx4 v[84:87], v247, s[16:19], s47 offen sc1
    v_mfma_f32_16x16x32_bf16 a[68:71], a[20:23], v[32:35], 0
    v_mfma_f32_16x16x32_bf16 a[92:95], a[20:23], v[36:39], 0
    v_mfma_f32_16x16x32_bf16 a[116:119], a[20:23], v[40:43], 0
    s_add_u32 s47, s43, 262144
    buffer_load_dwordx4 v[88:91], v247, s[16:19], s47 offen sc1
    s_waitcnt lgkmcnt(0)
    s_waitcnt vmcnt(6)
    s_barrier
    v_mfma_f32_16x16x32_bf16 a[48:51], a[24:27], v[44:47], a[48:51]
    ds_read_b64_tr_b16 a[0:1], v248 offset:12288
    v_mfma_f32_16x16x32_bf16 a[72:75], a[24:27], v[48:51], a[72:75]
    ds_read_b64_tr_b16 a[2:3], v248 offset:15360
    v_mfma_f32_16x16x32_bf16 a[96:99], a[24:27], v[52:55], a[96:99]
    s_add_u32 s47, s43, 1024
    ds_read_b64_tr_b16 a[4:5], v249 offset:12288
    buffer_load_dwordx4 v[92:95], v247, s[16:19], s47 offen sc1
    v_mfma_f32_16x16x32_bf16 a[52:55], a[28:31], v[44:47], a[52:55]
    ds_read_b64_tr_b16 a[6:7], v249 offset:15360
    v_mfma_f32_16x16x32_bf16 a[76:79], a[28:31], v[48:51], a[76:79]
    ds_read_b64_tr_b16 a[8:9], v248 offset:12352
    v_mfma_f32_16x16x32_bf16 a[100:103], a[28:31], v[52:55], a[100:103]
    s_add_u32 s47, s43, 132096
    ds_read_b64_tr_b16 a[10:11], v248 offset:15424
    buffer_load_dwordx4 v[96:99], v247, s[16:19], s47 offen sc1
    v_mfma_f32_16x16x32_bf16 a[56:59], a[32:35], v[44:47], a[56:59]
    s_add_u32 s47, s43, 263168
    ds_read_b64_tr_b16 a[12:13], v249 offset:12352
    v_mfma_f32_16x16x32_bf16 a[80:83], a[32:35], v[48:51], a[80:83]
    s_add_u32 s91, s91, 1
    ds_read_b64_tr_b16 a[14:15], v249 offset:15424
    v_mfma_f32_16x16x32_bf16 a[104:107], a[32:35], v[52:55], a[104:107]
    s_and_b32 s91, s91, 15
    ds_read_b64_tr_b16 a[16:17], v248 offset:12416
    buffer_load_dwordx4 v[100:103], v247, s[16:19], s47 offen sc1
    v_mfma_f32_16x16x32_bf16 a[60:63], a[36:39], v[44:47], a[60:63]
    ds_read_b64_tr_b16 a[18:19], v248 offset:15488
    v_mfma_f32_16x16x32_bf16 a[84:87], a[36:39], v[48:51], a[84:87]
    s_lshl_b32 s43, s91, 11
    ds_read_b64_tr_b16 a[20:21], v249 offset:12416
    v_mfma_f32_16x16x32_bf16 a[108:111], a[36:39], v[52:55], a[108:111]
    s_add_u32 s47, s43, 0
    ds_read_b64_tr_b16 a[22:23], v249 offset:15488
    buffer_load_dwordx4 v[104:107], v247, s[16:19], s47 offen sc1
    v_mfma_f32_16x16x32_bf16 a[64:67], a[40:43], v[44:47], a[64:67]
    v_mfma_f32_16x16x32_bf16 a[88:91], a[40:43], v[48:51], a[88:91]
    v_mfma_f32_16x16x32_bf16 a[112:115], a[40:43], v[52:55], a[112:115]
    s_add_u32 s47, s43, 131072
    buffer_load_dwordx4 v[108:111], v247, s[16:19], s47 offen sc1
    v_mfma_f32_16x16x32_bf16 a[68:71], a[44:47], v[44:47], a[68:71]
    v_mfma_f32_16x16x32_bf16 a[92:95], a[44:47], v[48:51], a[92:95]
    v_mfma_f32_16x16x32_bf16 a[116:119], a[44:47], v[52:55], a[116:119]
    s_add_u32 s47, s43, 262144
    buffer_load_dwordx4 v[112:115], v247, s[16:19], s47 offen sc1
    s_waitcnt lgkmcnt(0)
    v_mfma_f32_16x16x32_bf16 a[48:51], a[0:3], v[56:59], a[48:51]
    ds_read_b64_tr_b16 a[24:25], v248 offset:18432
    v_mfma_f32_16x16x32_bf16 a[72:75], a[0:3], v[60:63], a[72:75]
    ds_read_b64_tr_b16 a[26:27], v248 offset:21504
    v_mfma_f32_16x16x32_bf16 a[96:99], a[0:3], v[64:67], a[96:99]
    s_add_u32 s47, s43, 1024
    ds_read_b64_tr_b16 a[28:29], v249 offset:18432
    buffer_load_dwordx4 v[116:119], v247, s[16:19], s47 offen sc1
    v_mfma_f32_16x16x32_bf16 a[52:55], a[4:7], v[56:59], a[52:55]
    ds_read_b64_tr_b16 a[30:31], v249 offset:21504
    v_mfma_f32_16x16x32_bf16 a[76:79], a[4:7], v[60:63], a[76:79]
    ds_read_b64_tr_b16 a[32:33], v248 offset:18496
    v_mfma_f32_16x16x32_bf16 a[100:103], a[4:7], v[64:67], a[100:103]
    s_add_u32 s47, s43, 132096
    ds_read_b64_tr_b16 a[34:35], v248 offset:21568
    buffer_load_dwordx4 v[120:123], v247, s[16:19], s47 offen sc1
    v_mfma_f32_16x16x32_bf16 a[56:59], a[8:11], v[56:59], a[56:59]
    s_add_u32 s47, s43, 263168
    ds_read_b64_tr_b16 a[36:37], v249 offset:18496
    v_mfma_f32_16x16x32_bf16 a[80:83], a[8:11], v[60:63], a[80:83]
    s_add_u32 s91, s91, 1
    ds_read_b64_tr_b16 a[38:39], v249 offset:21568
    v_mfma_f32_16x16x32_bf16 a[104:107], a[8:11], v[64:67], a[104:107]
    s_and_b32 s91, s91, 15
    ds_read_b64_tr_b16 a[40:41], v248 offset:18560
    buffer_load_dwordx4 v[124:127], v247, s[16:19], s47 offen sc1
    v_mfma_f32_16x16x32_bf16 a[60:63], a[12:15], v[56:59], a[60:63]
    s_mul_i32 s42, s90, 73728
    ds_read_b64_tr_b16 a[42:43], v248 offset:21632
    v_mfma_f32_16x16x32_bf16 a[84:87], a[12:15], v[60:63], a[84:87]
    s_add_u32 m0, s95, 86016
    ds_read_b64_tr_b16 a[44:45], v249 offset:18560
    v_mfma_f32_16x16x32_bf16 a[108:111], a[12:15], v[64:67], a[108:111]
    ds_read_b64_tr_b16 a[46:47], v249 offset:21632
    buffer_load_dwordx4 v244, s[96:99], s42 offen lds
    v_mfma_f32_16x16x32_bf16 a[64:67], a[16:19], v[56:59], a[64:67]
    v_mfma_f32_16x16x32_bf16 a[88:91], a[16:19], v[60:63], a[88:91]
    s_add_u32 m0, s95, 87040
    v_mfma_f32_16x16x32_bf16 a[112:115], a[16:19], v[64:67], a[112:115]
    buffer_load_dwordx4 v245, s[96:99], s42 offen lds
    v_mfma_f32_16x16x32_bf16 a[68:71], a[20:23], v[56:59], a[68:71]
    v_mfma_f32_16x16x32_bf16 a[92:95], a[20:23], v[60:63], a[92:95]
    v_mfma_f32_16x16x32_bf16 a[116:119], a[20:23], v[64:67], a[116:119]
    s_waitcnt lgkmcnt(0)
    s_waitcnt vmcnt(8)
    s_barrier
    v_mfma_f32_16x16x32_bf16 a[48:51], a[24:27], v[68:71], a[48:51]
    ds_read_b64_tr_b16 a[0:1], v248 offset:24576
    v_mfma_f32_16x16x32_bf16 a[72:75], a[24:27], v[72:75], a[72:75]
    s_lshl_b32 s43, s91, 11
    ds_read_b64_tr_b16 a[2:3], v248 offset:27648
    v_mfma_f32_16x16x32_bf16 a[96:99], a[24:27], v[76:79], a[96:99]
    s_add_u32 s47, s43, 0
    ds_read_b64_tr_b16 a[4:5], v249 offset:24576
    buffer_load_dwordx4 v[32:35], v247, s[16:19], s47 offen sc1
    v_mfma_f32_16x16x32_bf16 a[52:55], a[28:31], v[68:71], a[52:55]
    ds_read_b64_tr_b16 a[6:7], v249 offset:27648
    v_mfma_f32_16x16x32_bf16 a[76:79], a[28:31], v[72:75], a[76:79]
    ds_read_b64_tr_b16 a[8:9], v248 offset:24640
    v_mfma_f32_16x16x32_bf16 a[100:103], a[28:31], v[76:79], a[100:103]
    s_add_u32 s47, s43, 131072
    ds_read_b64_tr_b16 a[10:11], v248 offset:27712
    buffer_load_dwordx4 v[36:39], v247, s[16:19], s47 offen sc1
    v_mfma_f32_16x16x32_bf16 a[56:59], a[32:35], v[68:71], a[56:59]
    ds_read_b64_tr_b16 a[12:13], v249 offset:24640
    v_mfma_f32_16x16x32_bf16 a[80:83], a[32:35], v[72:75], a[80:83]
    ds_read_b64_tr_b16 a[14:15], v249 offset:27712
    v_mfma_f32_16x16x32_bf16 a[104:107], a[32:35], v[76:79], a[104:107]
    s_add_u32 s47, s43, 262144
    ds_read_b64_tr_b16 a[16:17], v248 offset:24704
    buffer_load_dwordx4 v[40:43], v247, s[16:19], s47 offen sc1
    v_mfma_f32_16x16x32_bf16 a[60:63], a[36:39], v[68:71], a[60:63]
    ds_read_b64_tr_b16 a[18:19], v248 offset:27776
    v_mfma_f32_16x16x32_bf16 a[84:87], a[36:39], v[72:75], a[84:87]
    ds_read_b64_tr_b16 a[20:21], v249 offset:24704
    v_mfma_f32_16x16x32_bf16 a[108:111], a[36:39], v[76:79], a[108:111]
    s_add_u32 s47, s43, 1024
    ds_read_b64_tr_b16 a[22:23], v249 offset:27776
    buffer_load_dwordx4 v[44:47], v247, s[16:19], s47 offen sc1
    v_mfma_f32_16x16x32_bf16 a[64:67], a[40:43], v[68:71], a[64:67]
    v_mfma_f32_16x16x32_bf16 a[88:91], a[40:43], v[72:75], a[88:91]
    v_mfma_f32_16x16x32_bf16 a[112:115], a[40:43], v[76:79], a[112:115]
    s_add_u32 s47, s43, 132096
    buffer_load_dwordx4 v[48:51], v247, s[16:19], s47 offen sc1
    v_mfma_f32_16x16x32_bf16 a[68:71], a[44:47], v[68:71], a[68:71]
    s_add_u32 s47, s43, 263168
    v_mfma_f32_16x16x32_bf16 a[92:95], a[44:47], v[72:75], a[92:95]
    s_add_u32 s91, s91, 1
    v_mfma_f32_16x16x32_bf16 a[116:119], a[44:47], v[76:79], a[116:119]
    s_and_b32 s91, s91, 15
    buffer_load_dwordx4 v[52:55], v247, s[16:19], s47 offen sc1
    s_waitcnt lgkmcnt(0)
    v_mfma_f32_16x16x32_bf16 a[48:51], a[0:3], v[80:83], a[48:51]
    s_add_u32 s90, s90, 1
    s_and_b32 s90, s90, 15
    ds_read_b64_tr_b16 a[24:25], v248 offset:30720
    v_mfma_f32_16x16x32_bf16 a[72:75], a[0:3], v[84:87], a[72:75]
    s_add_u32 m0, s95, 88064
    ds_read_b64_tr_b16 a[26:27], v248 offset:33792
    v_mfma_f32_16x16x32_bf16 a[96:99], a[0:3], v[88:91], a[96:99]
    ds_read_b64_tr_b16 a[28:29], v249 offset:30720
    buffer_load_dwordx4 v246, s[96:99], s42 offen lds
    v_mfma_f32_16x16x32_bf16 a[52:55], a[4:7], v[80:83], a[52:55]
    s_mul_i32 s42, s90, 73728
    ds_read_b64_tr_b16 a[30:31], v249 offset:33792
    v_mfma_f32_16x16x32_bf16 a[76:79], a[4:7], v[84:87], a[76:79]
    s_add_u32 m0, s95, 0
    ds_read_b64_tr_b16 a[32:33], v248 offset:30784
    v_mfma_f32_16x16x32_bf16 a[100:103], a[4:7], v[88:91], a[100:103]
    ds_read_b64_tr_b16 a[34:35], v248 offset:33856
    buffer_load_dwordx4 v244, s[96:99], s42 offen lds
    v_mfma_f32_16x16x32_bf16 a[56:59], a[8:11], v[80:83], a[56:59]
    ds_read_b64_tr_b16 a[36:37], v249 offset:30784
    v_mfma_f32_16x16x32_bf16 a[80:83], a[8:11], v[84:87], a[80:83]
    s_add_u32 m0, s95, 1024
    ds_read_b64_tr_b16 a[38:39], v249 offset:33856
    v_mfma_f32_16x16x32_bf16 a[104:107], a[8:11], v[88:91], a[104:107]
    ds_read_b64_tr_b16 a[40:41], v248 offset:30848
    buffer_load_dwordx4 v245, s[96:99], s42 offen lds
    v_mfma_f32_16x16x32_bf16 a[60:63], a[12:15], v[80:83], a[60:63]
    s_add_u32 s90, s90, 1
    s_and_b32 s90, s90, 15
    ds_read_b64_tr_b16 a[42:43], v248 offset:33920
    v_mfma_f32_16x16x32_bf16 a[84:87], a[12:15], v[84:87], a[84:87]
    s_add_u32 m0, s95, 2048
    ds_read_b64_tr_b16 a[44:45], v249 offset:30848
    v_mfma_f32_16x16x32_bf16 a[108:111], a[12:15], v[88:91], a[108:111]
    ds_read_b64_tr_b16 a[46:47], v249 offset:33920
    buffer_load_dwordx4 v246, s[96:99], s42 offen lds
    v_mfma_f32_16x16x32_bf16 a[64:67], a[16:19], v[80:83], a[64:67]
    s_mul_i32 s42, s90, 73728
    v_mfma_f32_16x16x32_bf16 a[88:91], a[16:19], v[84:87], a[88:91]
    s_add_u32 m0, s95, 12288
    v_mfma_f32_16x16x32_bf16 a[112:115], a[16:19], v[88:91], a[112:115]
    buffer_load_dwordx4 v244, s[96:99], s42 offen lds
    v_mfma_f32_16x16x32_bf16 a[68:71], a[20:23], v[80:83], a[68:71]
    v_mfma_f32_16x16x32_bf16 a[92:95], a[20:23], v[84:87], a[92:95]
    v_mfma_f32_16x16x32_bf16 a[116:119], a[20:23], v[88:91], a[116:119]
    s_waitcnt lgkmcnt(0)
    s_waitcnt vmcnt(13)
    s_barrier
    v_mfma_f32_16x16x32_bf16 a[48:51], a[24:27], v[92:95], a[48:51]
    ds_read_b64_tr_b16 a[0:1], v248 offset:36864
    v_mfma_f32_16x16x32_bf16 a[72:75], a[24:27], v[96:99], a[72:75]
    s_lshl_b32 s43, s91, 11
    ds_read_b64_tr_b16 a[2:3], v248 offset:39936
    v_mfma_f32_16x16x32_bf16 a[96:99], a[24:27], v[100:103], a[96:99]
    s_add_u32 s47, s43, 0
    ds_read_b64_tr_b16 a[4:5], v249 offset:36864
    buffer_load_dwordx4 v[56:59], v247, s[16:19], s47 offen sc1
    v_mfma_f32_16x16x32_bf16 a[52:55], a[28:31], v[92:95], a[52:55]
    ds_read_b64_tr_b16 a[6:7], v249 offset:39936
    v_mfma_f32_16x16x32_bf16 a[76:79], a[28:31], v[96:99], a[76:79]
    ds_read_b64_tr_b16 a[8:9], v248 offset:36928
    v_mfma_f32_16x16x32_bf16 a[100:103], a[28:31], v[100:103], a[100:103]
    s_add_u32 s47, s43, 131072
    ds_read_b64_tr_b16 a[10:11], v248 offset:40000
    buffer_load_dwordx4 v[60:63], v247, s[16:19], s47 offen sc1
    v_mfma_f32_16x16x32_bf16 a[56:59], a[32:35], v[92:95], a[56:59]
    ds_read_b64_tr_b16 a[12:13], v249 offset:36928
    v_mfma_f32_16x16x32_bf16 a[80:83], a[32:35], v[96:99], a[80:83]
    ds_read_b64_tr_b16 a[14:15], v249 offset:40000
    v_mfma_f32_16x16x32_bf16 a[104:107], a[32:35], v[100:103], a[104:107]
    s_add_u32 s47, s43, 262144
    ds_read_b64_tr_b16 a[16:17], v248 offset:36992
    buffer_load_dwordx4 v[64:67], v247, s[16:19], s47 offen sc1
    v_mfma_f32_16x16x32_bf16 a[60:63], a[36:39], v[92:95], a[60:63]
    ds_read_b64_tr_b16 a[18:19], v248 offset:40064
    v_mfma_f32_16x16x32_bf16 a[84:87], a[36:39], v[96:99], a[84:87]
    ds_read_b64_tr_b16 a[20:21], v249 offset:36992
    v_mfma_f32_16x16x32_bf16 a[108:111], a[36:39], v[100:103], a[108:111]
    s_add_u32 s47, s43, 1024
    ds_read_b64_tr_b16 a[22:23], v249 offset:40064
    buffer_load_dwordx4 v[68:71], v247, s[16:19], s47 offen sc1
    v_mfma_f32_16x16x32_bf16 a[64:67], a[40:43], v[92:95], a[64:67]
    v_mfma_f32_16x16x32_bf16 a[88:91], a[40:43], v[96:99], a[88:91]
    v_mfma_f32_16x16x32_bf16 a[112:115], a[40:43], v[100:103], a[112:115]
    s_add_u32 s47, s43, 132096
    buffer_load_dwordx4 v[72:75], v247, s[16:19], s47 offen sc1
    v_mfma_f32_16x16x32_bf16 a[68:71], a[44:47], v[92:95], a[68:71]
    s_add_u32 s47, s43, 263168
    v_mfma_f32_16x16x32_bf16 a[92:95], a[44:47], v[96:99], a[92:95]
    s_add_u32 s91, s91, 1
    v_mfma_f32_16x16x32_bf16 a[116:119], a[44:47], v[100:103], a[116:119]
    s_and_b32 s91, s91, 15
    buffer_load_dwordx4 v[76:79], v247, s[16:19], s47 offen sc1
    s_waitcnt lgkmcnt(0)
    v_mfma_f32_16x16x32_bf16 a[48:51], a[0:3], v[104:107], a[48:51]
    ds_read_b64_tr_b16 a[24:25], v248 offset:43008
    v_mfma_f32_16x16x32_bf16 a[72:75], a[0:3], v[108:111], a[72:75]
    s_add_u32 m0, s95, 13312
    ds_read_b64_tr_b16 a[26:27], v248 offset:46080
    v_mfma_f32_16x16x32_bf16 a[96:99], a[0:3], v[112:115], a[96:99]
    ds_read_b64_tr_b16 a[28:29], v249 offset:43008
    buffer_load_dwordx4 v245, s[96:99], s42 offen lds
    v_mfma_f32_16x16x32_bf16 a[52:55], a[4:7], v[104:107], a[52:55]
    s_add_u32 s90, s90, 1
    s_and_b32 s90, s90, 15
    ds_read_b64_tr_b16 a[30:31], v249 offset:46080
    v_mfma_f32_16x16x32_bf16 a[76:79], a[4:7], v[108:111], a[76:79]
    s_add_u32 m0, s95, 14336
    ds_read_b64_tr_b16 a[32:33], v248 offset:43072
    v_mfma_f32_16x16x32_bf16 a[100:103], a[4:7], v[112:115], a[100:103]
    ds_read_b64_tr_b16 a[34:35], v248 offset:46144
    buffer_load_dwordx4 v246, s[96:99], s42 offen lds
    v_mfma_f32_16x16x32_bf16 a[56:59], a[8:11], v[104:107], a[56:59]
    s_mul_i32 s42, s90, 73728
    ds_read_b64_tr_b16 a[36:37], v249 offset:43072
    v_mfma_f32_16x16x32_bf16 a[80:83], a[8:11], v[108:111], a[80:83]
    s_add_u32 m0, s95, 24576
    ds_read_b64_tr_b16 a[38:39], v249 offset:46144
    v_mfma_f32_16x16x32_bf16 a[104:107], a[8:11], v[112:115], a[104:107]
    ds_read_b64_tr_b16 a[40:41], v248 offset:43136
    buffer_load_dwordx4 v244, s[96:99], s42 offen lds
    v_mfma_f32_16x16x32_bf16 a[60:63], a[12:15], v[104:107], a[60:63]
    ds_read_b64_tr_b16 a[42:43], v248 offset:46208
    v_mfma_f32_16x16x32_bf16 a[84:87], a[12:15], v[108:111], a[84:87]
    s_add_u32 m0, s95, 25600
    ds_read_b64_tr_b16 a[44:45], v249 offset:43136
    v_mfma_f32_16x16x32_bf16 a[108:111], a[12:15], v[112:115], a[108:111]
    ds_read_b64_tr_b16 a[46:47], v249 offset:46208
    buffer_load_dwordx4 v245, s[96:99], s42 offen lds
    v_mfma_f32_16x16x32_bf16 a[64:67], a[16:19], v[104:107], a[64:67]
    s_add_u32 s90, s90, 1
    s_and_b32 s90, s90, 15
    v_mfma_f32_16x16x32_bf16 a[88:91], a[16:19], v[108:111], a[88:91]
    s_add_u32 m0, s95, 26624
    v_mfma_f32_16x16x32_bf16 a[112:115], a[16:19], v[112:115], a[112:115]
    buffer_load_dwordx4 v246, s[96:99], s42 offen lds
    v_mfma_f32_16x16x32_bf16 a[68:71], a[20:23], v[104:107], a[68:71]
    v_mfma_f32_16x16x32_bf16 a[92:95], a[20:23], v[108:111], a[92:95]
    v_mfma_f32_16x16x32_bf16 a[116:119], a[20:23], v[112:115], a[116:119]
    s_waitcnt lgkmcnt(0)
    s_waitcnt vmcnt(16)
    s_barrier
    v_mfma_f32_16x16x32_bf16 a[48:51], a[24:27], v[116:119], a[48:51]
    ds_read_b64_tr_b16 a[0:1], v248 offset:49152
    v_mfma_f32_16x16x32_bf16 a[72:75], a[24:27], v[120:123], a[72:75]
    s_lshl_b32 s43, s91, 11
    ds_read_b64_tr_b16 a[2:3], v248 offset:52224
    v_mfma_f32_16x16x32_bf16 a[96:99], a[24:27], v[124:127], a[96:99]
    s_add_u32 s47, s43, 0
    ds_read_b64_tr_b16 a[4:5], v249 offset:49152
    buffer_load_dwordx4 v[80:83], v247, s[16:19], s47 offen sc1
    v_mfma_f32_16x16x32_bf16 a[52:55], a[28:31], v[116:119], a[52:55]
    ds_read_b64_tr_b16 a[6:7], v249 offset:52224
    v_mfma_f32_16x16x32_bf16 a[76:79], a[28:31], v[120:123], a[76:79]
    ds_read_b64_tr_b16 a[8:9], v248 offset:49216
    v_mfma_f32_16x16x32_bf16 a[100:103], a[28:31], v[124:127], a[100:103]
    s_add_u32 s47, s43, 131072
    ds_read_b64_tr_b16 a[10:11], v248 offset:52288
    buffer_load_dwordx4 v[84:87], v247, s[16:19], s47 offen sc1
    v_mfma_f32_16x16x32_bf16 a[56:59], a[32:35], v[116:119], a[56:59]
    ds_read_b64_tr_b16 a[12:13], v249 offset:49216
    v_mfma_f32_16x16x32_bf16 a[80:83], a[32:35], v[120:123], a[80:83]
    ds_read_b64_tr_b16 a[14:15], v249 offset:52288
    v_mfma_f32_16x16x32_bf16 a[104:107], a[32:35], v[124:127], a[104:107]
    s_add_u32 s47, s43, 262144
    ds_read_b64_tr_b16 a[16:17], v248 offset:49280
    buffer_load_dwordx4 v[88:91], v247, s[16:19], s47 offen sc1
    v_mfma_f32_16x16x32_bf16 a[60:63], a[36:39], v[116:119], a[60:63]
    ds_read_b64_tr_b16 a[18:19], v248 offset:52352
    v_mfma_f32_16x16x32_bf16 a[84:87], a[36:39], v[120:123], a[84:87]
    ds_read_b64_tr_b16 a[20:21], v249 offset:49280
    v_mfma_f32_16x16x32_bf16 a[108:111], a[36:39], v[124:127], a[108:111]
    s_add_u32 s47, s43, 1024
    ds_read_b64_tr_b16 a[22:23], v249 offset:52352
    buffer_load_dwordx4 v[92:95], v247, s[16:19], s47 offen sc1
    v_mfma_f32_16x16x32_bf16 a[64:67], a[40:43], v[116:119], a[64:67]
    v_mfma_f32_16x16x32_bf16 a[88:91], a[40:43], v[120:123], a[88:91]
    v_mfma_f32_16x16x32_bf16 a[112:115], a[40:43], v[124:127], a[112:115]
    s_add_u32 s47, s43, 132096
    buffer_load_dwordx4 v[96:99], v247, s[16:19], s47 offen sc1
    v_mfma_f32_16x16x32_bf16 a[68:71], a[44:47], v[116:119], a[68:71]
    v_mfma_f32_16x16x32_bf16 a[92:95], a[44:47], v[120:123], a[92:95]
    v_mfma_f32_16x16x32_bf16 a[116:119], a[44:47], v[124:127], a[116:119]
    s_waitcnt lgkmcnt(0)
    v_mfma_f32_16x16x32_bf16 a[48:51], a[0:3], v[32:35], a[48:51]
    s_add_u32 s47, s43, 263168
    ds_read_b64_tr_b16 a[24:25], v248 offset:55296
    v_mfma_f32_16x16x32_bf16 a[72:75], a[0:3], v[36:39], a[72:75]
    s_add_u32 s91, s91, 1
    ds_read_b64_tr_b16 a[26:27], v248 offset:58368
    v_mfma_f32_16x16x32_bf16 a[96:99], a[0:3], v[40:43], a[96:99]
    s_and_b32 s91, s91, 15
    ds_read_b64_tr_b16 a[28:29], v249 offset:55296
    buffer_load_dwordx4 v[100:103], v247, s[16:19], s47 offen sc1
    v_mfma_f32_16x16x32_bf16 a[52:55], a[4:7], v[32:35], a[52:55]
    s_mul_i32 s42, s90, 73728
    ds_read_b64_tr_b16 a[30:31], v249 offset:58368
    v_mfma_f32_16x16x32_bf16 a[76:79], a[4:7], v[36:39], a[76:79]
    s_add_u32 m0, s95, 36864
    ds_read_b64_tr_b16 a[32:33], v248 offset:55360
    v_mfma_f32_16x16x32_bf16 a[100:103], a[4:7], v[40:43], a[100:103]
    ds_read_b64_tr_b16 a[34:35], v248 offset:58432
    buffer_load_dwordx4 v244, s[96:99], s42 offen lds
    v_mfma_f32_16x16x32_bf16 a[56:59], a[8:11], v[32:35], a[56:59]
    ds_read_b64_tr_b16 a[36:37], v249 offset:55360
    v_mfma_f32_16x16x32_bf16 a[80:83], a[8:11], v[36:39], a[80:83]
    s_add_u32 m0, s95, 37888
    ds_read_b64_tr_b16 a[38:39], v249 offset:58432
    v_mfma_f32_16x16x32_bf16 a[104:107], a[8:11], v[40:43], a[104:107]
    ds_read_b64_tr_b16 a[40:41], v248 offset:55424
    buffer_load_dwordx4 v245, s[96:99], s42 offen lds
    v_mfma_f32_16x16x32_bf16 a[60:63], a[12:15], v[32:35], a[60:63]
    s_add_u32 s90, s90, 1
    s_and_b32 s90, s90, 15
    ds_read_b64_tr_b16 a[42:43], v248 offset:58496
    v_mfma_f32_16x16x32_bf16 a[84:87], a[12:15], v[36:39], a[84:87]
    s_add_u32 m0, s95, 38912
    ds_read_b64_tr_b16 a[44:45], v249 offset:55424
    v_mfma_f32_16x16x32_bf16 a[108:111], a[12:15], v[40:43], a[108:111]
    ds_read_b64_tr_b16 a[46:47], v249 offset:58496
    buffer_load_dwordx4 v246, s[96:99], s42 offen lds
    v_mfma_f32_16x16x32_bf16 a[64:67], a[16:19], v[32:35], a[64:67]
    v_mfma_f32_16x16x32_bf16 a[88:91], a[16:19], v[36:39], a[88:91]
    v_mfma_f32_16x16x32_bf16 a[112:115], a[16:19], v[40:43], a[112:115]
    v_mfma_f32_16x16x32_bf16 a[68:71], a[20:23], v[32:35], a[68:71]
    v_mfma_f32_16x16x32_bf16 a[92:95], a[20:23], v[36:39], a[92:95]
    v_mfma_f32_16x16x32_bf16 a[116:119], a[20:23], v[40:43], a[116:119]
    s_waitcnt lgkmcnt(0)
    s_waitcnt vmcnt(14)
    s_barrier
    v_mfma_f32_16x16x32_bf16 a[48:51], a[24:27], v[44:47], a[48:51]
    ds_read_b64_tr_b16 a[0:1], v248 offset:61440
    v_mfma_f32_16x16x32_bf16 a[72:75], a[24:27], v[48:51], a[72:75]
    s_lshl_b32 s43, s91, 11
    ds_read_b64_tr_b16 a[2:3], v248 offset:64512
    v_mfma_f32_16x16x32_bf16 a[96:99], a[24:27], v[52:55], a[96:99]
    s_add_u32 s47, s43, 0
    ds_read_b64_tr_b16 a[4:5], v249 offset:61440
    buffer_load_dwordx4 v[104:107], v247, s[16:19], s47 offen sc1
    v_mfma_f32_16x16x32_bf16 a[52:55], a[28:31], v[44:47], a[52:55]
    ds_read_b64_tr_b16 a[6:7], v249 offset:64512
    v_mfma_f32_16x16x32_bf16 a[76:79], a[28:31], v[48:51], a[76:79]
    ds_read_b64_tr_b16 a[8:9], v248 offset:61504
    v_mfma_f32_16x16x32_bf16 a[100:103], a[28:31], v[52:55], a[100:103]
    s_add_u32 s47, s43, 131072
    ds_read_b64_tr_b16 a[10:11], v248 offset:64576
    buffer_load_dwordx4 v[108:111], v247, s[16:19], s47 offen sc1
    v_mfma_f32_16x16x32_bf16 a[56:59], a[32:35], v[44:47], a[56:59]
    ds_read_b64_tr_b16 a[12:13], v249 offset:61504
    v_mfma_f32_16x16x32_bf16 a[80:83], a[32:35], v[48:51], a[80:83]
    ds_read_b64_tr_b16 a[14:15], v249 offset:64576
    v_mfma_f32_16x16x32_bf16 a[104:107], a[32:35], v[52:55], a[104:107]
    s_add_u32 s47, s43, 262144
    ds_read_b64_tr_b16 a[16:17], v248 offset:61568
    buffer_load_dwordx4 v[112:115], v247, s[16:19], s47 offen sc1
    v_mfma_f32_16x16x32_bf16 a[60:63], a[36:39], v[44:47], a[60:63]
    ds_read_b64_tr_b16 a[18:19], v248 offset:64640
    v_mfma_f32_16x16x32_bf16 a[84:87], a[36:39], v[48:51], a[84:87]
    ds_read_b64_tr_b16 a[20:21], v249 offset:61568
    v_mfma_f32_16x16x32_bf16 a[108:111], a[36:39], v[52:55], a[108:111]
    s_add_u32 s47, s43, 1024
    ds_read_b64_tr_b16 a[22:23], v249 offset:64640
    buffer_load_dwordx4 v[116:119], v247, s[16:19], s47 offen sc1
    v_mfma_f32_16x16x32_bf16 a[64:67], a[40:43], v[44:47], a[64:67]
    v_mfma_f32_16x16x32_bf16 a[88:91], a[40:43], v[48:51], a[88:91]
    v_mfma_f32_16x16x32_bf16 a[112:115], a[40:43], v[52:55], a[112:115]
    s_add_u32 s47, s43, 132096
    buffer_load_dwordx4 v[120:123], v247, s[16:19], s47 offen sc1
    v_mfma_f32_16x16x32_bf16 a[68:71], a[44:47], v[44:47], a[68:71]
    v_mfma_f32_16x16x32_bf16 a[92:95], a[44:47], v[48:51], a[92:95]
    v_mfma_f32_16x16x32_bf16 a[116:119], a[44:47], v[52:55], a[116:119]
    s_waitcnt lgkmcnt(0)
    v_mfma_f32_16x16x32_bf16 a[48:51], a[0:3], v[56:59], a[48:51]
    s_add_u32 s47, s43, 263168
    ds_read_b64_tr_b16 a[24:25], v250 offset:2048
    v_mfma_f32_16x16x32_bf16 a[72:75], a[0:3], v[60:63], a[72:75]
    s_add_u32 s91, s91, 1
    ds_read_b64_tr_b16 a[26:27], v250 offset:5120
    v_mfma_f32_16x16x32_bf16 a[96:99], a[0:3], v[64:67], a[96:99]
    s_and_b32 s91, s91, 15
    ds_read_b64_tr_b16 a[28:29], v251 offset:2048
    buffer_load_dwordx4 v[124:127], v247, s[16:19], s47 offen sc1
    v_mfma_f32_16x16x32_bf16 a[52:55], a[4:7], v[56:59], a[52:55]
    s_mul_i32 s42, s90, 73728
    ds_read_b64_tr_b16 a[30:31], v251 offset:5120
    v_mfma_f32_16x16x32_bf16 a[76:79], a[4:7], v[60:63], a[76:79]
    s_add_u32 m0, s95, 49152
    ds_read_b64_tr_b16 a[32:33], v250 offset:2112
    v_mfma_f32_16x16x32_bf16 a[100:103], a[4:7], v[64:67], a[100:103]
    ds_read_b64_tr_b16 a[34:35], v250 offset:5184
    buffer_load_dwordx4 v244, s[96:99], s42 offen lds
    v_mfma_f32_16x16x32_bf16 a[56:59], a[8:11], v[56:59], a[56:59]
    ds_read_b64_tr_b16 a[36:37], v251 offset:2112
    v_mfma_f32_16x16x32_bf16 a[80:83], a[8:11], v[60:63], a[80:83]
    s_add_u32 m0, s95, 50176
    ds_read_b64_tr_b16 a[38:39], v251 offset:5184
    v_mfma_f32_16x16x32_bf16 a[104:107], a[8:11], v[64:67], a[104:107]
    ds_read_b64_tr_b16 a[40:41], v250 offset:2176
    buffer_load_dwordx4 v245, s[96:99], s42 offen lds
    v_mfma_f32_16x16x32_bf16 a[60:63], a[12:15], v[56:59], a[60:63]
    s_add_u32 s90, s90, 1
    s_and_b32 s90, s90, 15
    ds_read_b64_tr_b16 a[42:43], v250 offset:5248
    v_mfma_f32_16x16x32_bf16 a[84:87], a[12:15], v[60:63], a[84:87]
    s_add_u32 m0, s95, 51200
    ds_read_b64_tr_b16 a[44:45], v251 offset:2176
    v_mfma_f32_16x16x32_bf16 a[108:111], a[12:15], v[64:67], a[108:111]
    ds_read_b64_tr_b16 a[46:47], v251 offset:5248
    buffer_load_dwordx4 v246, s[96:99], s42 offen lds
    v_mfma_f32_16x16x32_bf16 a[64:67], a[16:19], v[56:59], a[64:67]
    v_mfma_f32_16x16x32_bf16 a[88:91], a[16:19], v[60:63], a[88:91]
    v_mfma_f32_16x16x32_bf16 a[112:115], a[16:19], v[64:67], a[112:115]
    v_mfma_f32_16x16x32_bf16 a[68:71], a[20:23], v[56:59], a[68:71]
    v_mfma_f32_16x16x32_bf16 a[92:95], a[20:23], v[60:63], a[92:95]
    v_mfma_f32_16x16x32_bf16 a[116:119], a[20:23], v[64:67], a[116:119]
    s_waitcnt lgkmcnt(0)
    s_waitcnt vmcnt(12)
    s_barrier
    v_mfma_f32_16x16x32_bf16 a[48:51], a[24:27], v[68:71], a[48:51]
    ds_read_b64_tr_b16 a[0:1], v250 offset:8192
    v_mfma_f32_16x16x32_bf16 a[72:75], a[24:27], v[72:75], a[72:75]
    s_lshl_b32 s43, s91, 11
    ds_read_b64_tr_b16 a[2:3], v250 offset:11264
    v_mfma_f32_16x16x32_bf16 a[96:99], a[24:27], v[76:79], a[96:99]
    s_add_u32 s47, s43, 0
    ds_read_b64_tr_b16 a[4:5], v251 offset:8192
    buffer_load_dwordx4 v[32:35], v247, s[16:19], s47 offen sc1
    v_mfma_f32_16x16x32_bf16 a[52:55], a[28:31], v[68:71], a[52:55]
    ds_read_b64_tr_b16 a[6:7], v251 offset:11264
    v_mfma_f32_16x16x32_bf16 a[76:79], a[28:31], v[72:75], a[76:79]
    ds_read_b64_tr_b16 a[8:9], v250 offset:8256
    v_mfma_f32_16x16x32_bf16 a[100:103], a[28:31], v[76:79], a[100:103]
    s_add_u32 s47, s43, 131072
    ds_read_b64_tr_b16 a[10:11], v250 offset:11328
    buffer_load_dwordx4 v[36:39], v247, s[16:19], s47 offen sc1
    v_mfma_f32_16x16x32_bf16 a[56:59], a[32:35], v[68:71], a[56:59]
    ds_read_b64_tr_b16 a[12:13], v251 offset:8256
    v_mfma_f32_16x16x32_bf16 a[80:83], a[32:35], v[72:75], a[80:83]
    ds_read_b64_tr_b16 a[14:15], v251 offset:11328
    v_mfma_f32_16x16x32_bf16 a[104:107], a[32:35], v[76:79], a[104:107]
    s_add_u32 s47, s43, 262144
    ds_read_b64_tr_b16 a[16:17], v250 offset:8320
    buffer_load_dwordx4 v[40:43], v247, s[16:19], s47 offen sc1
    v_mfma_f32_16x16x32_bf16 a[60:63], a[36:39], v[68:71], a[60:63]
    ds_read_b64_tr_b16 a[18:19], v250 offset:11392
    v_mfma_f32_16x16x32_bf16 a[84:87], a[36:39], v[72:75], a[84:87]
    ds_read_b64_tr_b16 a[20:21], v251 offset:8320
    v_mfma_f32_16x16x32_bf16 a[108:111], a[36:39], v[76:79], a[108:111]
    s_add_u32 s47, s43, 1024
    ds_read_b64_tr_b16 a[22:23], v251 offset:11392
    buffer_load_dwordx4 v[44:47], v247, s[16:19], s47 offen sc1
    v_mfma_f32_16x16x32_bf16 a[64:67], a[40:43], v[68:71], a[64:67]
    v_mfma_f32_16x16x32_bf16 a[88:91], a[40:43], v[72:75], a[88:91]
    v_mfma_f32_16x16x32_bf16 a[112:115], a[40:43], v[76:79], a[112:115]
    s_add_u32 s47, s43, 132096
    buffer_load_dwordx4 v[48:51], v247, s[16:19], s47 offen sc1
    v_mfma_f32_16x16x32_bf16 a[68:71], a[44:47], v[68:71], a[68:71]
    v_mfma_f32_16x16x32_bf16 a[92:95], a[44:47], v[72:75], a[92:95]
    v_mfma_f32_16x16x32_bf16 a[116:119], a[44:47], v[76:79], a[116:119]
    s_waitcnt lgkmcnt(0)
    v_mfma_f32_16x16x32_bf16 a[48:51], a[0:3], v[80:83], a[48:51]
    s_add_u32 s47, s43, 263168
    ds_read_b64_tr_b16 a[24:25], v250 offset:14336
    v_mfma_f32_16x16x32_bf16 a[72:75], a[0:3], v[84:87], a[72:75]
    s_add_u32 s91, s91, 1
    ds_read_b64_tr_b16 a[26:27], v250 offset:17408
    v_mfma_f32_16x16x32_bf16 a[96:99], a[0:3], v[88:91], a[96:99]
    s_and_b32 s91, s91, 15
    ds_read_b64_tr_b16 a[28:29], v251 offset:14336
    buffer_load_dwordx4 v[52:55], v247, s[16:19], s47 offen sc1
    v_mfma_f32_16x16x32_bf16 a[52:55], a[4:7], v[80:83], a[52:55]
    s_mul_i32 s42, s90, 73728
    ds_read_b64_tr_b16 a[30:31], v251 offset:17408
    v_mfma_f32_16x16x32_bf16 a[76:79], a[4:7], v[84:87], a[76:79]
    s_add_u32 m0, s95, 61440
    ds_read_b64_tr_b16 a[32:33], v250 offset:14400
    v_mfma_f32_16x16x32_bf16 a[100:103], a[4:7], v[88:91], a[100:103]
    ds_read_b64_tr_b16 a[34:35], v250 offset:17472
    buffer_load_dwordx4 v244, s[96:99], s42 offen lds
    v_mfma_f32_16x16x32_bf16 a[56:59], a[8:11], v[80:83], a[56:59]
    ds_read_b64_tr_b16 a[36:37], v251 offset:14400
    v_mfma_f32_16x16x32_bf16 a[80:83], a[8:11], v[84:87], a[80:83]
    s_add_u32 m0, s95, 62464
    ds_read_b64_tr_b16 a[38:39], v251 offset:17472
    v_mfma_f32_16x16x32_bf16 a[104:107], a[8:11], v[88:91], a[104:107]
    ds_read_b64_tr_b16 a[40:41], v250 offset:14464
    buffer_load_dwordx4 v245, s[96:99], s42 offen lds
    v_mfma_f32_16x16x32_bf16 a[60:63], a[12:15], v[80:83], a[60:63]
    s_add_u32 s90, s90, 1
    s_and_b32 s90, s90, 15
    ds_read_b64_tr_b16 a[42:43], v250 offset:17536
    v_mfma_f32_16x16x32_bf16 a[84:87], a[12:15], v[84:87], a[84:87]
    s_add_u32 m0, s95, 63488
    ds_read_b64_tr_b16 a[44:45], v251 offset:14464
    v_mfma_f32_16x16x32_bf16 a[108:111], a[12:15], v[88:91], a[108:111]
    ds_read_b64_tr_b16 a[46:47], v251 offset:17536
    buffer_load_dwordx4 v246, s[96:99], s42 offen lds
    v_mfma_f32_16x16x32_bf16 a[64:67], a[16:19], v[80:83], a[64:67]
    v_mfma_f32_16x16x32_bf16 a[88:91], a[16:19], v[84:87], a[88:91]
    v_mfma_f32_16x16x32_bf16 a[112:115], a[16:19], v[88:91], a[112:115]
    v_mfma_f32_16x16x32_bf16 a[68:71], a[20:23], v[80:83], a[68:71]
    v_mfma_f32_16x16x32_bf16 a[92:95], a[20:23], v[84:87], a[92:95]
    v_mfma_f32_16x16x32_bf16 a[116:119], a[20:23], v[88:91], a[116:119]
    s_waitcnt lgkmcnt(0)
    s_waitcnt vmcnt(12)
    s_barrier
    v_mfma_f32_16x16x32_bf16 a[48:51], a[24:27], v[92:95], a[48:51]
    ds_read_b64_tr_b16 a[0:1], v250 offset:20480
    v_mfma_f32_16x16x32_bf16 a[72:75], a[24:27], v[96:99], a[72:75]
    s_lshl_b32 s43, s91, 11
    ds_read_b64_tr_b16 a[2:3], v250 offset:23552
    v_mfma_f32_16x16x32_bf16 a[96:99], a[24:27], v[100:103], a[96:99]
    s_add_u32 s47, s43, 0
    ds_read_b64_tr_b16 a[4:5], v251 offset:20480
    buffer_load_dwordx4 v[56:59], v247, s[16:19], s47 offen sc1
    v_mfma_f32_16x16x32_bf16 a[52:55], a[28:31], v[92:95], a[52:55]
    ds_read_b64_tr_b16 a[6:7], v251 offset:23552
    v_mfma_f32_16x16x32_bf16 a[76:79], a[28:31], v[96:99], a[76:79]
    ds_read_b64_tr_b16 a[8:9], v250 offset:20544
    v_mfma_f32_16x16x32_bf16 a[100:103], a[28:31], v[100:103], a[100:103]
    s_add_u32 s47, s43, 131072
    ds_read_b64_tr_b16 a[10:11], v250 offset:23616
    buffer_load_dwordx4 v[60:63], v247, s[16:19], s47 offen sc1
    v_mfma_f32_16x16x32_bf16 a[56:59], a[32:35], v[92:95], a[56:59]
    ds_read_b64_tr_b16 a[12:13], v251 offset:20544
    v_mfma_f32_16x16x32_bf16 a[80:83], a[32:35], v[96:99], a[80:83]
    ds_read_b64_tr_b16 a[14:15], v251 offset:23616
    v_mfma_f32_16x16x32_bf16 a[104:107], a[32:35], v[100:103], a[104:107]
    s_add_u32 s47, s43, 262144
    ds_read_b64_tr_b16 a[16:17], v250 offset:20608
    buffer_load_dwordx4 v[64:67], v247, s[16:19], s47 offen sc1
    v_mfma_f32_16x16x32_bf16 a[60:63], a[36:39], v[92:95], a[60:63]
    ds_read_b64_tr_b16 a[18:19], v250 offset:23680
    v_mfma_f32_16x16x32_bf16 a[84:87], a[36:39], v[96:99], a[84:87]
    ds_read_b64_tr_b16 a[20:21], v251 offset:20608
    v_mfma_f32_16x16x32_bf16 a[108:111], a[36:39], v[100:103], a[108:111]
    s_add_u32 s47, s43, 1024
    ds_read_b64_tr_b16 a[22:23], v251 offset:23680
    buffer_load_dwordx4 v[68:71], v247, s[16:19], s47 offen sc1
    v_mfma_f32_16x16x32_bf16 a[64:67], a[40:43], v[92:95], a[64:67]
    v_mfma_f32_16x16x32_bf16 a[88:91], a[40:43], v[96:99], a[88:91]
    v_mfma_f32_16x16x32_bf16 a[112:115], a[40:43], v[100:103], a[112:115]
    s_add_u32 s47, s43, 132096
    buffer_load_dwordx4 v[72:75], v247, s[16:19], s47 offen sc1
    v_mfma_f32_16x16x32_bf16 a[68:71], a[44:47], v[92:95], a[68:71]
    v_mfma_f32_16x16x32_bf16 a[92:95], a[44:47], v[96:99], a[92:95]
    v_mfma_f32_16x16x32_bf16 a[116:119], a[44:47], v[100:103], a[116:119]
    s_waitcnt lgkmcnt(0)
    v_mfma_f32_16x16x32_bf16 a[48:51], a[0:3], v[104:107], a[48:51]
    s_add_u32 s47, s43, 263168
    ds_read_b64_tr_b16 a[24:25], v250 offset:26624
    v_mfma_f32_16x16x32_bf16 a[72:75], a[0:3], v[108:111], a[72:75]
    s_add_u32 s91, s91, 1
    ds_read_b64_tr_b16 a[26:27], v250 offset:29696
    v_mfma_f32_16x16x32_bf16 a[96:99], a[0:3], v[112:115], a[96:99]
    s_and_b32 s91, s91, 15
    ds_read_b64_tr_b16 a[28:29], v251 offset:26624
    buffer_load_dwordx4 v[76:79], v247, s[16:19], s47 offen sc1
    v_mfma_f32_16x16x32_bf16 a[52:55], a[4:7], v[104:107], a[52:55]
    s_mul_i32 s42, s90, 73728
    ds_read_b64_tr_b16 a[30:31], v251 offset:29696
    v_mfma_f32_16x16x32_bf16 a[76:79], a[4:7], v[108:111], a[76:79]
    s_add_u32 m0, s95, 73728
    ds_read_b64_tr_b16 a[32:33], v250 offset:26688
    v_mfma_f32_16x16x32_bf16 a[100:103], a[4:7], v[112:115], a[100:103]
    ds_read_b64_tr_b16 a[34:35], v250 offset:29760
    buffer_load_dwordx4 v244, s[96:99], s42 offen lds
    v_mfma_f32_16x16x32_bf16 a[56:59], a[8:11], v[104:107], a[56:59]
    ds_read_b64_tr_b16 a[36:37], v251 offset:26688
    v_mfma_f32_16x16x32_bf16 a[80:83], a[8:11], v[108:111], a[80:83]
    s_add_u32 m0, s95, 74752
    ds_read_b64_tr_b16 a[38:39], v251 offset:29760
    v_mfma_f32_16x16x32_bf16 a[104:107], a[8:11], v[112:115], a[104:107]
    ds_read_b64_tr_b16 a[40:41], v250 offset:26752
    buffer_load_dwordx4 v245, s[96:99], s42 offen lds
    v_mfma_f32_16x16x32_bf16 a[60:63], a[12:15], v[104:107], a[60:63]
    s_add_u32 s90, s90, 1
    s_and_b32 s90, s90, 15
    ds_read_b64_tr_b16 a[42:43], v250 offset:29824
    v_mfma_f32_16x16x32_bf16 a[84:87], a[12:15], v[108:111], a[84:87]
    s_add_u32 m0, s95, 75776
    ds_read_b64_tr_b16 a[44:45], v251 offset:26752
    v_mfma_f32_16x16x32_bf16 a[108:111], a[12:15], v[112:115], a[108:111]
    ds_read_b64_tr_b16 a[46:47], v251 offset:29824
    buffer_load_dwordx4 v246, s[96:99], s42 offen lds
    v_mfma_f32_16x16x32_bf16 a[64:67], a[16:19], v[104:107], a[64:67]
    v_mfma_f32_16x16x32_bf16 a[88:91], a[16:19], v[108:111], a[88:91]
    v_mfma_f32_16x16x32_bf16 a[112:115], a[16:19], v[112:115], a[112:115]
    v_mfma_f32_16x16x32_bf16 a[68:71], a[20:23], v[104:107], a[68:71]
    v_mfma_f32_16x16x32_bf16 a[92:95], a[20:23], v[108:111], a[92:95]
    v_mfma_f32_16x16x32_bf16 a[116:119], a[20:23], v[112:115], a[116:119]
    s_waitcnt lgkmcnt(0)
    s_waitcnt vmcnt(12)
    s_barrier
    v_mfma_f32_16x16x32_bf16 a[48:51], a[24:27], v[116:119], a[48:51]
    ds_read_b64_tr_b16 a[0:1], v248 offset:0
    v_mfma_f32_16x16x32_bf16 a[72:75], a[24:27], v[120:123], a[72:75]
    s_lshl_b32 s43, s91, 11
    ds_read_b64_tr_b16 a[2:3], v248 offset:3072
    v_mfma_f32_16x16x32_bf16 a[96:99], a[24:27], v[124:127], a[96:99]
    s_add_u32 s47, s43, 0
    ds_read_b64_tr_b16 a[4:5], v249 offset:0
    buffer_load_dwordx4 v[80:83], v247, s[16:19], s47 offen sc1
    v_mfma_f32_16x16x32_bf16 a[52:55], a[28:31], v[116:119], a[52:55]
    ds_read_b64_tr_b16 a[6:7], v249 offset:3072
    v_mfma_f32_16x16x32_bf16 a[76:79], a[28:31], v[120:123], a[76:79]
    ds_read_b64_tr_b16 a[8:9], v248 offset:64
    v_mfma_f32_16x16x32_bf16 a[100:103], a[28:31], v[124:127], a[100:103]
    s_add_u32 s47, s43, 131072
    ds_read_b64_tr_b16 a[10:11], v248 offset:3136
    buffer_load_dwordx4 v[84:87], v247, s[16:19], s47 offen sc1
    v_mfma_f32_16x16x32_bf16 a[56:59], a[32:35], v[116:119], a[56:59]
    ds_read_b64_tr_b16 a[12:13], v249 offset:64
    v_mfma_f32_16x16x32_bf16 a[80:83], a[32:35], v[120:123], a[80:83]
    ds_read_b64_tr_b16 a[14:15], v249 offset:3136
    v_mfma_f32_16x16x32_bf16 a[104:107], a[32:35], v[124:127], a[104:107]
    s_add_u32 s47, s43, 262144
    ds_read_b64_tr_b16 a[16:17], v248 offset:128
    buffer_load_dwordx4 v[88:91], v247, s[16:19], s47 offen sc1
    v_mfma_f32_16x16x32_bf16 a[60:63], a[36:39], v[116:119], a[60:63]
    ds_read_b64_tr_b16 a[18:19], v248 offset:3200
    v_mfma_f32_16x16x32_bf16 a[84:87], a[36:39], v[120:123], a[84:87]
    ds_read_b64_tr_b16 a[20:21], v249 offset:128
    v_mfma_f32_16x16x32_bf16 a[108:111], a[36:39], v[124:127], a[108:111]
    s_add_u32 s47, s43, 1024
    ds_read_b64_tr_b16 a[22:23], v249 offset:3200
    buffer_load_dwordx4 v[92:95], v247, s[16:19], s47 offen sc1
    v_mfma_f32_16x16x32_bf16 a[64:67], a[40:43], v[116:119], a[64:67]
    v_mfma_f32_16x16x32_bf16 a[88:91], a[40:43], v[120:123], a[88:91]
    v_mfma_f32_16x16x32_bf16 a[112:115], a[40:43], v[124:127], a[112:115]
    s_add_u32 s47, s43, 132096
    buffer_load_dwordx4 v[96:99], v247, s[16:19], s47 offen sc1
    v_mfma_f32_16x16x32_bf16 a[68:71], a[44:47], v[116:119], a[68:71]
    v_mfma_f32_16x16x32_bf16 a[92:95], a[44:47], v[120:123], a[92:95]
    v_mfma_f32_16x16x32_bf16 a[116:119], a[44:47], v[124:127], a[116:119]
    s_waitcnt lgkmcnt(0)
    v_mfma_f32_16x16x32_bf16 a[48:51], a[0:3], v[32:35], a[48:51]
    s_add_u32 s47, s43, 263168
    ds_read_b64_tr_b16 a[24:25], v248 offset:6144
    v_mfma_f32_16x16x32_bf16 a[72:75], a[0:3], v[36:39], a[72:75]
    s_add_u32 s91, s91, 1
    ds_read_b64_tr_b16 a[26:27], v248 offset:9216
    v_mfma_f32_16x16x32_bf16 a[96:99], a[0:3], v[40:43], a[96:99]
    s_and_b32 s91, s91, 15
    ds_read_b64_tr_b16 a[28:29], v249 offset:6144
    buffer_load_dwordx4 v[100:103], v247, s[16:19], s47 offen sc1
    v_mfma_f32_16x16x32_bf16 a[52:55], a[4:7], v[32:35], a[52:55]
    s_mul_i32 s42, s90, 73728
    ds_read_b64_tr_b16 a[30:31], v249 offset:9216
    v_mfma_f32_16x16x32_bf16 a[76:79], a[4:7], v[36:39], a[76:79]
    s_add_u32 m0, s95, 86016
    ds_read_b64_tr_b16 a[32:33], v248 offset:6208
    v_mfma_f32_16x16x32_bf16 a[100:103], a[4:7], v[40:43], a[100:103]
    ds_read_b64_tr_b16 a[34:35], v248 offset:9280
    buffer_load_dwordx4 v244, s[96:99], s42 offen lds
    v_mfma_f32_16x16x32_bf16 a[56:59], a[8:11], v[32:35], a[56:59]
    ds_read_b64_tr_b16 a[36:37], v249 offset:6208
    v_mfma_f32_16x16x32_bf16 a[80:83], a[8:11], v[36:39], a[80:83]
    s_add_u32 m0, s95, 87040
    ds_read_b64_tr_b16 a[38:39], v249 offset:9280
    v_mfma_f32_16x16x32_bf16 a[104:107], a[8:11], v[40:43], a[104:107]
    ds_read_b64_tr_b16 a[40:41], v248 offset:6272
    buffer_load_dwordx4 v245, s[96:99], s42 offen lds
    v_mfma_f32_16x16x32_bf16 a[60:63], a[12:15], v[32:35], a[60:63]
    s_add_u32 s90, s90, 1
    s_and_b32 s90, s90, 15
    ds_read_b64_tr_b16 a[42:43], v248 offset:9344
    v_mfma_f32_16x16x32_bf16 a[84:87], a[12:15], v[36:39], a[84:87]
    s_add_u32 m0, s95, 88064
    ds_read_b64_tr_b16 a[44:45], v249 offset:6272
    v_mfma_f32_16x16x32_bf16 a[108:111], a[12:15], v[40:43], a[108:111]
    ds_read_b64_tr_b16 a[46:47], v249 offset:9344
    buffer_load_dwordx4 v246, s[96:99], s42 offen lds
    v_mfma_f32_16x16x32_bf16 a[64:67], a[16:19], v[32:35], a[64:67]
    v_mfma_f32_16x16x32_bf16 a[88:91], a[16:19], v[36:39], a[88:91]
    v_mfma_f32_16x16x32_bf16 a[112:115], a[16:19], v[40:43], a[112:115]
    v_mfma_f32_16x16x32_bf16 a[68:71], a[20:23], v[32:35], a[68:71]
    v_mfma_f32_16x16x32_bf16 a[92:95], a[20:23], v[36:39], a[92:95]
    v_mfma_f32_16x16x32_bf16 a[116:119], a[20:23], v[40:43], a[116:119]
    s_waitcnt lgkmcnt(0)
    s_waitcnt vmcnt(12)
    s_barrier
    v_mfma_f32_16x16x32_bf16 a[48:51], a[24:27], v[44:47], a[48:51]
    ds_read_b64_tr_b16 a[0:1], v248 offset:12288
    v_mfma_f32_16x16x32_bf16 a[72:75], a[24:27], v[48:51], a[72:75]
    s_lshl_b32 s43, s91, 11
    ds_read_b64_tr_b16 a[2:3], v248 offset:15360
    v_mfma_f32_16x16x32_bf16 a[96:99], a[24:27], v[52:55], a[96:99]
    s_add_u32 s47, s43, 0
    ds_read_b64_tr_b16 a[4:5], v249 offset:12288
    buffer_load_dwordx4 v[104:107], v247, s[16:19], s47 offen sc1
    v_mfma_f32_16x16x32_bf16 a[52:55], a[28:31], v[44:47], a[52:55]
    ds_read_b64_tr_b16 a[6:7], v249 offset:15360
    v_mfma_f32_16x16x32_bf16 a[76:79], a[28:31], v[48:51], a[76:79]
    ds_read_b64_tr_b16 a[8:9], v248 offset:12352
    v_mfma_f32_16x16x32_bf16 a[100:103], a[28:31], v[52:55], a[100:103]
    s_add_u32 s47, s43, 131072
    ds_read_b64_tr_b16 a[10:11], v248 offset:15424
    buffer_load_dwordx4 v[108:111], v247, s[16:19], s47 offen sc1
    v_mfma_f32_16x16x32_bf16 a[56:59], a[32:35], v[44:47], a[56:59]
    ds_read_b64_tr_b16 a[12:13], v249 offset:12352
    v_mfma_f32_16x16x32_bf16 a[80:83], a[32:35], v[48:51], a[80:83]
    ds_read_b64_tr_b16 a[14:15], v249 offset:15424
    v_mfma_f32_16x16x32_bf16 a[104:107], a[32:35], v[52:55], a[104:107]
    s_add_u32 s47, s43, 262144
    ds_read_b64_tr_b16 a[16:17], v248 offset:12416
    buffer_load_dwordx4 v[112:115], v247, s[16:19], s47 offen sc1
    v_mfma_f32_16x16x32_bf16 a[60:63], a[36:39], v[44:47], a[60:63]
    ds_read_b64_tr_b16 a[18:19], v248 offset:15488
    v_mfma_f32_16x16x32_bf16 a[84:87], a[36:39], v[48:51], a[84:87]
    ds_read_b64_tr_b16 a[20:21], v249 offset:12416
    v_mfma_f32_16x16x32_bf16 a[108:111], a[36:39], v[52:55], a[108:111]
    s_add_u32 s47, s43, 1024
    ds_read_b64_tr_b16 a[22:23], v249 offset:15488
    buffer_load_dwordx4 v[116:119], v247, s[16:19], s47 offen sc1
    v_mfma_f32_16x16x32_bf16 a[64:67], a[40:43], v[44:47], a[64:67]
    v_mfma_f32_16x16x32_bf16 a[88:91], a[40:43], v[48:51], a[88:91]
    v_mfma_f32_16x16x32_bf16 a[112:115], a[40:43], v[52:55], a[112:115]
    s_add_u32 s47, s43, 132096
    buffer_load_dwordx4 v[120:123], v247, s[16:19], s47 offen sc1
    v_mfma_f32_16x16x32_bf16 a[68:71], a[44:47], v[44:47], a[68:71]
    v_mfma_f32_16x16x32_bf16 a[92:95], a[44:47], v[48:51], a[92:95]
    v_mfma_f32_16x16x32_bf16 a[116:119], a[44:47], v[52:55], a[116:119]
    s_waitcnt lgkmcnt(0)
    v_mfma_f32_16x16x32_bf16 a[48:51], a[0:3], v[56:59], a[48:51]
    s_add_u32 s47, s43, 263168
    ds_read_b64_tr_b16 a[24:25], v248 offset:18432
    v_mfma_f32_16x16x32_bf16 a[72:75], a[0:3], v[60:63], a[72:75]
    s_add_u32 s91, s91, 1
    ds_read_b64_tr_b16 a[26:27], v248 offset:21504
    v_mfma_f32_16x16x32_bf16 a[96:99], a[0:3], v[64:67], a[96:99]
    s_and_b32 s91, s91, 15
    ds_read_b64_tr_b16 a[28:29], v249 offset:18432
    buffer_load_dwordx4 v[124:127], v247, s[16:19], s47 offen sc1
    v_mfma_f32_16x16x32_bf16 a[52:55], a[4:7], v[56:59], a[52:55]
    ds_read_b64_tr_b16 a[30:31], v249 offset:21504
    v_mfma_f32_16x16x32_bf16 a[76:79], a[4:7], v[60:63], a[76:79]
    ds_read_b64_tr_b16 a[32:33], v248 offset:18496
    v_mfma_f32_16x16x32_bf16 a[100:103], a[4:7], v[64:67], a[100:103]
    ds_read_b64_tr_b16 a[34:35], v248 offset:21568
    v_mfma_f32_16x16x32_bf16 a[56:59], a[8:11], v[56:59], a[56:59]
    ds_read_b64_tr_b16 a[36:37], v249 offset:18496
    v_mfma_f32_16x16x32_bf16 a[80:83], a[8:11], v[60:63], a[80:83]
    ds_read_b64_tr_b16 a[38:39], v249 offset:21568
    v_mfma_f32_16x16x32_bf16 a[104:107], a[8:11], v[64:67], a[104:107]
    ds_read_b64_tr_b16 a[40:41], v248 offset:18560
    v_mfma_f32_16x16x32_bf16 a[60:63], a[12:15], v[56:59], a[60:63]
    ds_read_b64_tr_b16 a[42:43], v248 offset:21632
    v_mfma_f32_16x16x32_bf16 a[84:87], a[12:15], v[60:63], a[84:87]
    ds_read_b64_tr_b16 a[44:45], v249 offset:18560
    v_mfma_f32_16x16x32_bf16 a[108:111], a[12:15], v[64:67], a[108:111]
    ds_read_b64_tr_b16 a[46:47], v249 offset:21632
    v_mfma_f32_16x16x32_bf16 a[64:67], a[16:19], v[56:59], a[64:67]
    v_mfma_f32_16x16x32_bf16 a[88:91], a[16:19], v[60:63], a[88:91]
    v_mfma_f32_16x16x32_bf16 a[112:115], a[16:19], v[64:67], a[112:115]
    v_mfma_f32_16x16x32_bf16 a[68:71], a[20:23], v[56:59], a[68:71]
    v_mfma_f32_16x16x32_bf16 a[92:95], a[20:23], v[60:63], a[92:95]
    v_mfma_f32_16x16x32_bf16 a[116:119], a[20:23], v[64:67], a[116:119]
    s_waitcnt lgkmcnt(0)
    s_waitcnt vmcnt(9)
    s_barrier
    v_mfma_f32_16x16x32_bf16 a[48:51], a[24:27], v[68:71], a[48:51]
    ds_read_b64_tr_b16 a[0:1], v248 offset:24576
    v_mfma_f32_16x16x32_bf16 a[72:75], a[24:27], v[72:75], a[72:75]
    s_lshl_b32 s43, s91, 11
    ds_read_b64_tr_b16 a[2:3], v248 offset:27648
    v_mfma_f32_16x16x32_bf16 a[96:99], a[24:27], v[76:79], a[96:99]
    s_add_u32 s47, s43, 0
    ds_read_b64_tr_b16 a[4:5], v249 offset:24576
    buffer_load_dwordx4 v[32:35], v247, s[16:19], s47 offen sc1
    v_mfma_f32_16x16x32_bf16 a[52:55], a[28:31], v[68:71], a[52:55]
    ds_read_b64_tr_b16 a[6:7], v249 offset:27648
    v_mfma_f32_16x16x32_bf16 a[76:79], a[28:31], v[72:75], a[76:79]
    ds_read_b64_tr_b16 a[8:9], v248 offset:24640
    v_mfma_f32_16x16x32_bf16 a[100:103], a[28:31], v[76:79], a[100:103]
    s_add_u32 s47, s43, 131072
    ds_read_b64_tr_b16 a[10:11], v248 offset:27712
    buffer_load_dwordx4 v[36:39], v247, s[16:19], s47 offen sc1
    v_mfma_f32_16x16x32_bf16 a[56:59], a[32:35], v[68:71], a[56:59]
    ds_read_b64_tr_b16 a[12:13], v249 offset:24640
    v_mfma_f32_16x16x32_bf16 a[80:83], a[32:35], v[72:75], a[80:83]
    ds_read_b64_tr_b16 a[14:15], v249 offset:27712
    v_mfma_f32_16x16x32_bf16 a[104:107], a[32:35], v[76:79], a[104:107]
    s_add_u32 s47, s43, 262144
    ds_read_b64_tr_b16 a[16:17], v248 offset:24704
    buffer_load_dwordx4 v[40:43], v247, s[16:19], s47 offen sc1
    v_mfma_f32_16x16x32_bf16 a[60:63], a[36:39], v[68:71], a[60:63]
    ds_read_b64_tr_b16 a[18:19], v248 offset:27776
    v_mfma_f32_16x16x32_bf16 a[84:87], a[36:39], v[72:75], a[84:87]
    ds_read_b64_tr_b16 a[20:21], v249 offset:24704
    v_mfma_f32_16x16x32_bf16 a[108:111], a[36:39], v[76:79], a[108:111]
    s_add_u32 s47, s43, 1024
    ds_read_b64_tr_b16 a[22:23], v249 offset:27776
    buffer_load_dwordx4 v[44:47], v247, s[16:19], s47 offen sc1
    v_mfma_f32_16x16x32_bf16 a[64:67], a[40:43], v[68:71], a[64:67]
    v_mfma_f32_16x16x32_bf16 a[88:91], a[40:43], v[72:75], a[88:91]
    v_mfma_f32_16x16x32_bf16 a[112:115], a[40:43], v[76:79], a[112:115]
    s_add_u32 s47, s43, 132096
    buffer_load_dwordx4 v[48:51], v247, s[16:19], s47 offen sc1
    v_mfma_f32_16x16x32_bf16 a[68:71], a[44:47], v[68:71], a[68:71]
    v_mfma_f32_16x16x32_bf16 a[92:95], a[44:47], v[72:75], a[92:95]
    v_mfma_f32_16x16x32_bf16 a[116:119], a[44:47], v[76:79], a[116:119]
    s_waitcnt lgkmcnt(0)
    v_mfma_f32_16x16x32_bf16 a[48:51], a[0:3], v[80:83], a[48:51]
    s_add_u32 s47, s43, 263168
    ds_read_b64_tr_b16 a[24:25], v248 offset:30720
    v_mfma_f32_16x16x32_bf16 a[72:75], a[0:3], v[84:87], a[72:75]
    s_add_u32 s91, s91, 1
    ds_read_b64_tr_b16 a[26:27], v248 offset:33792
    v_mfma_f32_16x16x32_bf16 a[96:99], a[0:3], v[88:91], a[96:99]
    s_and_b32 s91, s91, 15
    ds_read_b64_tr_b16 a[28:29], v249 offset:30720
    buffer_load_dwordx4 v[52:55], v247, s[16:19], s47 offen sc1
    v_mfma_f32_16x16x32_bf16 a[52:55], a[4:7], v[80:83], a[52:55]
    ds_read_b64_tr_b16 a[30:31], v249 offset:33792
    v_mfma_f32_16x16x32_bf16 a[76:79], a[4:7], v[84:87], a[76:79]
    ds_read_b64_tr_b16 a[32:33], v248 offset:30784
    v_mfma_f32_16x16x32_bf16 a[100:103], a[4:7], v[88:91], a[100:103]
    ds_read_b64_tr_b16 a[34:35], v248 offset:33856
    v_mfma_f32_16x16x32_bf16 a[56:59], a[8:11], v[80:83], a[56:59]
    ds_read_b64_tr_b16 a[36:37], v249 offset:30784
    v_mfma_f32_16x16x32_bf16 a[80:83], a[8:11], v[84:87], a[80:83]
    ds_read_b64_tr_b16 a[38:39], v249 offset:33856
    v_mfma_f32_16x16x32_bf16 a[104:107], a[8:11], v[88:91], a[104:107]
    ds_read_b64_tr_b16 a[40:41], v248 offset:30848
    v_mfma_f32_16x16x32_bf16 a[60:63], a[12:15], v[80:83], a[60:63]
    ds_read_b64_tr_b16 a[42:43], v248 offset:33920
    v_mfma_f32_16x16x32_bf16 a[84:87], a[12:15], v[84:87], a[84:87]
    ds_read_b64_tr_b16 a[44:45], v249 offset:30848
    v_mfma_f32_16x16x32_bf16 a[108:111], a[12:15], v[88:91], a[108:111]
    ds_read_b64_tr_b16 a[46:47], v249 offset:33920
    v_mfma_f32_16x16x32_bf16 a[64:67], a[16:19], v[80:83], a[64:67]
    v_mfma_f32_16x16x32_bf16 a[88:91], a[16:19], v[84:87], a[88:91]
    v_mfma_f32_16x16x32_bf16 a[112:115], a[16:19], v[88:91], a[112:115]
    v_mfma_f32_16x16x32_bf16 a[68:71], a[20:23], v[80:83], a[68:71]
    v_mfma_f32_16x16x32_bf16 a[92:95], a[20:23], v[84:87], a[92:95]
    v_mfma_f32_16x16x32_bf16 a[116:119], a[20:23], v[88:91], a[116:119]
    s_waitcnt lgkmcnt(0)
    s_waitcnt vmcnt(6)
    s_barrier
    v_mfma_f32_16x16x32_bf16 a[48:51], a[24:27], v[92:95], a[48:51]
    ds_read_b64_tr_b16 a[0:1], v248 offset:36864
    v_mfma_f32_16x16x32_bf16 a[72:75], a[24:27], v[96:99], a[72:75]
    s_lshl_b32 s43, s91, 11
    ds_read_b64_tr_b16 a[2:3], v248 offset:39936
    v_mfma_f32_16x16x32_bf16 a[96:99], a[24:27], v[100:103], a[96:99]
    s_add_u32 s47, s43, 0
    ds_read_b64_tr_b16 a[4:5], v249 offset:36864
    buffer_load_dwordx4 v[56:59], v247, s[16:19], s47 offen sc1
    v_mfma_f32_16x16x32_bf16 a[52:55], a[28:31], v[92:95], a[52:55]
    ds_read_b64_tr_b16 a[6:7], v249 offset:39936
    v_mfma_f32_16x16x32_bf16 a[76:79], a[28:31], v[96:99], a[76:79]
    ds_read_b64_tr_b16 a[8:9], v248 offset:36928
    v_mfma_f32_16x16x32_bf16 a[100:103], a[28:31], v[100:103], a[100:103]
    s_add_u32 s47, s43, 131072
    ds_read_b64_tr_b16 a[10:11], v248 offset:40000
    buffer_load_dwordx4 v[60:63], v247, s[16:19], s47 offen sc1
    v_mfma_f32_16x16x32_bf16 a[56:59], a[32:35], v[92:95], a[56:59]
    ds_read_b64_tr_b16 a[12:13], v249 offset:36928
    v_mfma_f32_16x16x32_bf16 a[80:83], a[32:35], v[96:99], a[80:83]
    ds_read_b64_tr_b16 a[14:15], v249 offset:40000
    v_mfma_f32_16x16x32_bf16 a[104:107], a[32:35], v[100:103], a[104:107]
    s_add_u32 s47, s43, 262144
    ds_read_b64_tr_b16 a[16:17], v248 offset:36992
    buffer_load_dwordx4 v[64:67], v247, s[16:19], s47 offen sc1
    v_mfma_f32_16x16x32_bf16 a[60:63], a[36:39], v[92:95], a[60:63]
    ds_read_b64_tr_b16 a[18:19], v248 offset:40064
    v_mfma_f32_16x16x32_bf16 a[84:87], a[36:39], v[96:99], a[84:87]
    ds_read_b64_tr_b16 a[20:21], v249 offset:36992
    v_mfma_f32_16x16x32_bf16 a[108:111], a[36:39], v[100:103], a[108:111]
    s_add_u32 s47, s43, 1024
    ds_read_b64_tr_b16 a[22:23], v249 offset:40064
    buffer_load_dwordx4 v[68:71], v247, s[16:19], s47 offen sc1
    v_mfma_f32_16x16x32_bf16 a[64:67], a[40:43], v[92:95], a[64:67]
    v_mfma_f32_16x16x32_bf16 a[88:91], a[40:43], v[96:99], a[88:91]
    v_mfma_f32_16x16x32_bf16 a[112:115], a[40:43], v[100:103], a[112:115]
    s_add_u32 s47, s43, 132096
    buffer_load_dwordx4 v[72:75], v247, s[16:19], s47 offen sc1
    v_mfma_f32_16x16x32_bf16 a[68:71], a[44:47], v[92:95], a[68:71]
    v_mfma_f32_16x16x32_bf16 a[92:95], a[44:47], v[96:99], a[92:95]
    v_mfma_f32_16x16x32_bf16 a[116:119], a[44:47], v[100:103], a[116:119]
    s_waitcnt lgkmcnt(0)
    v_mfma_f32_16x16x32_bf16 a[48:51], a[0:3], v[104:107], a[48:51]
    s_add_u32 s47, s43, 263168
    ds_read_b64_tr_b16 a[24:25], v248 offset:43008
    v_mfma_f32_16x16x32_bf16 a[72:75], a[0:3], v[108:111], a[72:75]
    s_add_u32 s91, s91, 1
    ds_read_b64_tr_b16 a[26:27], v248 offset:46080
    v_mfma_f32_16x16x32_bf16 a[96:99], a[0:3], v[112:115], a[96:99]
    s_and_b32 s91, s91, 15
    ds_read_b64_tr_b16 a[28:29], v249 offset:43008
    buffer_load_dwordx4 v[76:79], v247, s[16:19], s47 offen sc1
    v_mfma_f32_16x16x32_bf16 a[52:55], a[4:7], v[104:107], a[52:55]
    ds_read_b64_tr_b16 a[30:31], v249 offset:46080
    v_mfma_f32_16x16x32_bf16 a[76:79], a[4:7], v[108:111], a[76:79]
    ds_read_b64_tr_b16 a[32:33], v248 offset:43072
    v_mfma_f32_16x16x32_bf16 a[100:103], a[4:7], v[112:115], a[100:103]
    ds_read_b64_tr_b16 a[34:35], v248 offset:46144
    v_mfma_f32_16x16x32_bf16 a[56:59], a[8:11], v[104:107], a[56:59]
    ds_read_b64_tr_b16 a[36:37], v249 offset:43072
    v_mfma_f32_16x16x32_bf16 a[80:83], a[8:11], v[108:111], a[80:83]
    ds_read_b64_tr_b16 a[38:39], v249 offset:46144
    v_mfma_f32_16x16x32_bf16 a[104:107], a[8:11], v[112:115], a[104:107]
    ds_read_b64_tr_b16 a[40:41], v248 offset:43136
    v_mfma_f32_16x16x32_bf16 a[60:63], a[12:15], v[104:107], a[60:63]
    ds_read_b64_tr_b16 a[42:43], v248 offset:46208
    v_mfma_f32_16x16x32_bf16 a[84:87], a[12:15], v[108:111], a[84:87]
    ds_read_b64_tr_b16 a[44:45], v249 offset:43136
    v_mfma_f32_16x16x32_bf16 a[108:111], a[12:15], v[112:115], a[108:111]
    ds_read_b64_tr_b16 a[46:47], v249 offset:46208
    v_mfma_f32_16x16x32_bf16 a[64:67], a[16:19], v[104:107], a[64:67]
    v_mfma_f32_16x16x32_bf16 a[88:91], a[16:19], v[108:111], a[88:91]
    v_mfma_f32_16x16x32_bf16 a[112:115], a[16:19], v[112:115], a[112:115]
    v_mfma_f32_16x16x32_bf16 a[68:71], a[20:23], v[104:107], a[68:71]
    v_mfma_f32_16x16x32_bf16 a[92:95], a[20:23], v[108:111], a[92:95]
    v_mfma_f32_16x16x32_bf16 a[116:119], a[20:23], v[112:115], a[116:119]
    s_waitcnt lgkmcnt(0)
    s_waitcnt vmcnt(6)
    s_barrier
    v_mfma_f32_16x16x32_bf16 a[48:51], a[24:27], v[116:119], a[48:51]
    ds_read_b64_tr_b16 a[0:1], v248 offset:49152
    v_mfma_f32_16x16x32_bf16 a[72:75], a[24:27], v[120:123], a[72:75]
    s_lshl_b32 s43, s91, 11
    ds_read_b64_tr_b16 a[2:3], v248 offset:52224
    v_mfma_f32_16x16x32_bf16 a[96:99], a[24:27], v[124:127], a[96:99]
    s_add_u32 s47, s43, 0
    ds_read_b64_tr_b16 a[4:5], v249 offset:49152
    buffer_load_dwordx4 v[80:83], v247, s[16:19], s47 offen sc1
    v_mfma_f32_16x16x32_bf16 a[52:55], a[28:31], v[116:119], a[52:55]
    ds_read_b64_tr_b16 a[6:7], v249 offset:52224
    v_mfma_f32_16x16x32_bf16 a[76:79], a[28:31], v[120:123], a[76:79]
    ds_read_b64_tr_b16 a[8:9], v248 offset:49216
    v_mfma_f32_16x16x32_bf16 a[100:103], a[28:31], v[124:127], a[100:103]
    s_add_u32 s47, s43, 131072
    ds_read_b64_tr_b16 a[10:11], v248 offset:52288
    buffer_load_dwordx4 v[84:87], v247, s[16:19], s47 offen sc1
    v_mfma_f32_16x16x32_bf16 a[56:59], a[32:35], v[116:119], a[56:59]
    ds_read_b64_tr_b16 a[12:13], v249 offset:49216
    v_mfma_f32_16x16x32_bf16 a[80:83], a[32:35], v[120:123], a[80:83]
    ds_read_b64_tr_b16 a[14:15], v249 offset:52288
    v_mfma_f32_16x16x32_bf16 a[104:107], a[32:35], v[124:127], a[104:107]
    s_add_u32 s47, s43, 262144
    ds_read_b64_tr_b16 a[16:17], v248 offset:49280
    buffer_load_dwordx4 v[88:91], v247, s[16:19], s47 offen sc1
    v_mfma_f32_16x16x32_bf16 a[60:63], a[36:39], v[116:119], a[60:63]
    ds_read_b64_tr_b16 a[18:19], v248 offset:52352
    v_mfma_f32_16x16x32_bf16 a[84:87], a[36:39], v[120:123], a[84:87]
    ds_read_b64_tr_b16 a[20:21], v249 offset:49280
    v_mfma_f32_16x16x32_bf16 a[108:111], a[36:39], v[124:127], a[108:111]
    s_add_u32 s47, s43, 1024
    ds_read_b64_tr_b16 a[22:23], v249 offset:52352
    buffer_load_dwordx4 v[92:95], v247, s[16:19], s47 offen sc1
    v_mfma_f32_16x16x32_bf16 a[64:67], a[40:43], v[116:119], a[64:67]
    v_mfma_f32_16x16x32_bf16 a[88:91], a[40:43], v[120:123], a[88:91]
    v_mfma_f32_16x16x32_bf16 a[112:115], a[40:43], v[124:127], a[112:115]
    s_add_u32 s47, s43, 132096
    buffer_load_dwordx4 v[96:99], v247, s[16:19], s47 offen sc1
    v_mfma_f32_16x16x32_bf16 a[68:71], a[44:47], v[116:119], a[68:71]
    v_mfma_f32_16x16x32_bf16 a[92:95], a[44:47], v[120:123], a[92:95]
    v_mfma_f32_16x16x32_bf16 a[116:119], a[44:47], v[124:127], a[116:119]
    s_waitcnt lgkmcnt(0)
    v_mfma_f32_16x16x32_bf16 a[48:51], a[0:3], v[32:35], a[48:51]
    s_add_u32 s47, s43, 263168
    ds_read_b64_tr_b16 a[24:25], v248 offset:55296
    v_mfma_f32_16x16x32_bf16 a[72:75], a[0:3], v[36:39], a[72:75]
    s_add_u32 s91, s91, 1
    ds_read_b64_tr_b16 a[26:27], v248 offset:58368
    v_mfma_f32_16x16x32_bf16 a[96:99], a[0:3], v[40:43], a[96:99]
    s_and_b32 s91, s91, 15
    ds_read_b64_tr_b16 a[28:29], v249 offset:55296
    buffer_load_dwordx4 v[100:103], v247, s[16:19], s47 offen sc1
    v_mfma_f32_16x16x32_bf16 a[52:55], a[4:7], v[32:35], a[52:55]
    ds_read_b64_tr_b16 a[30:31], v249 offset:58368
    v_mfma_f32_16x16x32_bf16 a[76:79], a[4:7], v[36:39], a[76:79]
    ds_read_b64_tr_b16 a[32:33], v248 offset:55360
    v_mfma_f32_16x16x32_bf16 a[100:103], a[4:7], v[40:43], a[100:103]
    ds_read_b64_tr_b16 a[34:35], v248 offset:58432
    v_mfma_f32_16x16x32_bf16 a[56:59], a[8:11], v[32:35], a[56:59]
    ds_read_b64_tr_b16 a[36:37], v249 offset:55360
    v_mfma_f32_16x16x32_bf16 a[80:83], a[8:11], v[36:39], a[80:83]
    ds_read_b64_tr_b16 a[38:39], v249 offset:58432
    v_mfma_f32_16x16x32_bf16 a[104:107], a[8:11], v[40:43], a[104:107]
    ds_read_b64_tr_b16 a[40:41], v248 offset:55424
    v_mfma_f32_16x16x32_bf16 a[60:63], a[12:15], v[32:35], a[60:63]
    ds_read_b64_tr_b16 a[42:43], v248 offset:58496
    v_mfma_f32_16x16x32_bf16 a[84:87], a[12:15], v[36:39], a[84:87]
    ds_read_b64_tr_b16 a[44:45], v249 offset:55424
    v_mfma_f32_16x16x32_bf16 a[108:111], a[12:15], v[40:43], a[108:111]
    ds_read_b64_tr_b16 a[46:47], v249 offset:58496
    v_mfma_f32_16x16x32_bf16 a[64:67], a[16:19], v[32:35], a[64:67]
    v_mfma_f32_16x16x32_bf16 a[88:91], a[16:19], v[36:39], a[88:91]
    v_mfma_f32_16x16x32_bf16 a[112:115], a[16:19], v[40:43], a[112:115]
    v_mfma_f32_16x16x32_bf16 a[68:71], a[20:23], v[32:35], a[68:71]
    v_mfma_f32_16x16x32_bf16 a[92:95], a[20:23], v[36:39], a[92:95]
    v_mfma_f32_16x16x32_bf16 a[116:119], a[20:23], v[40:43], a[116:119]
    s_waitcnt lgkmcnt(0)
    s_waitcnt vmcnt(6)
    s_barrier
    v_mfma_f32_16x16x32_bf16 a[48:51], a[24:27], v[44:47], a[48:51]
    ds_read_b64_tr_b16 a[0:1], v248 offset:61440
    v_mfma_f32_16x16x32_bf16 a[72:75], a[24:27], v[48:51], a[72:75]
    s_lshl_b32 s43, s91, 11
    ds_read_b64_tr_b16 a[2:3], v248 offset:64512
    v_mfma_f32_16x16x32_bf16 a[96:99], a[24:27], v[52:55], a[96:99]
    s_add_u32 s47, s43, 0
    ds_read_b64_tr_b16 a[4:5], v249 offset:61440
    buffer_load_dwordx4 v[104:107], v247, s[16:19], s47 offen sc1
    v_mfma_f32_16x16x32_bf16 a[52:55], a[28:31], v[44:47], a[52:55]
    ds_read_b64_tr_b16 a[6:7], v249 offset:64512
    v_mfma_f32_16x16x32_bf16 a[76:79], a[28:31], v[48:51], a[76:79]
    ds_read_b64_tr_b16 a[8:9], v248 offset:61504
    v_mfma_f32_16x16x32_bf16 a[100:103], a[28:31], v[52:55], a[100:103]
    s_add_u32 s47, s43, 131072
    ds_read_b64_tr_b16 a[10:11], v248 offset:64576
    buffer_load_dwordx4 v[108:111], v247, s[16:19], s47 offen sc1
    v_mfma_f32_16x16x32_bf16 a[56:59], a[32:35], v[44:47], a[56:59]
    ds_read_b64_tr_b16 a[12:13], v249 offset:61504
    v_mfma_f32_16x16x32_bf16 a[80:83], a[32:35], v[48:51], a[80:83]
    ds_read_b64_tr_b16 a[14:15], v249 offset:64576
    v_mfma_f32_16x16x32_bf16 a[104:107], a[32:35], v[52:55], a[104:107]
    s_add_u32 s47, s43, 262144
    ds_read_b64_tr_b16 a[16:17], v248 offset:61568
    buffer_load_dwordx4 v[112:115], v247, s[16:19], s47 offen sc1
    v_mfma_f32_16x16x32_bf16 a[60:63], a[36:39], v[44:47], a[60:63]
    ds_read_b64_tr_b16 a[18:19], v248 offset:64640
    v_mfma_f32_16x16x32_bf16 a[84:87], a[36:39], v[48:51], a[84:87]
    ds_read_b64_tr_b16 a[20:21], v249 offset:61568
    v_mfma_f32_16x16x32_bf16 a[108:111], a[36:39], v[52:55], a[108:111]
    s_add_u32 s47, s43, 1024
    ds_read_b64_tr_b16 a[22:23], v249 offset:64640
    buffer_load_dwordx4 v[116:119], v247, s[16:19], s47 offen sc1
    v_mfma_f32_16x16x32_bf16 a[64:67], a[40:43], v[44:47], a[64:67]
    v_mfma_f32_16x16x32_bf16 a[88:91], a[40:43], v[48:51], a[88:91]
    v_mfma_f32_16x16x32_bf16 a[112:115], a[40:43], v[52:55], a[112:115]
    s_add_u32 s47, s43, 132096
    buffer_load_dwordx4 v[120:123], v247, s[16:19], s47 offen sc1
    v_mfma_f32_16x16x32_bf16 a[68:71], a[44:47], v[44:47], a[68:71]
    v_mfma_f32_16x16x32_bf16 a[92:95], a[44:47], v[48:51], a[92:95]
    v_mfma_f32_16x16x32_bf16 a[116:119], a[44:47], v[52:55], a[116:119]
    s_waitcnt lgkmcnt(0)
    v_mfma_f32_16x16x32_bf16 a[48:51], a[0:3], v[56:59], a[48:51]
    s_add_u32 s47, s43, 263168
    ds_read_b64_tr_b16 a[24:25], v250 offset:2048
    v_mfma_f32_16x16x32_bf16 a[72:75], a[0:3], v[60:63], a[72:75]
    s_add_u32 s91, s91, 1
    ds_read_b64_tr_b16 a[26:27], v250 offset:5120
    v_mfma_f32_16x16x32_bf16 a[96:99], a[0:3], v[64:67], a[96:99]
    s_and_b32 s91, s91, 15
    ds_read_b64_tr_b16 a[28:29], v251 offset:2048
    buffer_load_dwordx4 v[124:127], v247, s[16:19], s47 offen sc1
    v_mfma_f32_16x16x32_bf16 a[52:55], a[4:7], v[56:59], a[52:55]
    ds_read_b64_tr_b16 a[30:31], v251 offset:5120
    v_mfma_f32_16x16x32_bf16 a[76:79], a[4:7], v[60:63], a[76:79]
    ds_read_b64_tr_b16 a[32:33], v250 offset:2112
    v_mfma_f32_16x16x32_bf16 a[100:103], a[4:7], v[64:67], a[100:103]
    ds_read_b64_tr_b16 a[34:35], v250 offset:5184
    v_mfma_f32_16x16x32_bf16 a[56:59], a[8:11], v[56:59], a[56:59]
    ds_read_b64_tr_b16 a[36:37], v251 offset:2112
    v_mfma_f32_16x16x32_bf16 a[80:83], a[8:11], v[60:63], a[80:83]
    ds_read_b64_tr_b16 a[38:39], v251 offset:5184
    v_mfma_f32_16x16x32_bf16 a[104:107], a[8:11], v[64:67], a[104:107]
    ds_read_b64_tr_b16 a[40:41], v250 offset:2176
    v_mfma_f32_16x16x32_bf16 a[60:63], a[12:15], v[56:59], a[60:63]
    ds_read_b64_tr_b16 a[42:43], v250 offset:5248
    v_mfma_f32_16x16x32_bf16 a[84:87], a[12:15], v[60:63], a[84:87]
    ds_read_b64_tr_b16 a[44:45], v251 offset:2176
    v_mfma_f32_16x16x32_bf16 a[108:111], a[12:15], v[64:67], a[108:111]
    ds_read_b64_tr_b16 a[46:47], v251 offset:5248
    v_mfma_f32_16x16x32_bf16 a[64:67], a[16:19], v[56:59], a[64:67]
    v_mfma_f32_16x16x32_bf16 a[88:91], a[16:19], v[60:63], a[88:91]
    v_mfma_f32_16x16x32_bf16 a[112:115], a[16:19], v[64:67], a[112:115]
    v_mfma_f32_16x16x32_bf16 a[68:71], a[20:23], v[56:59], a[68:71]
    v_mfma_f32_16x16x32_bf16 a[92:95], a[20:23], v[60:63], a[92:95]
    v_mfma_f32_16x16x32_bf16 a[116:119], a[20:23], v[64:67], a[116:119]
    s_waitcnt lgkmcnt(0)
    s_waitcnt vmcnt(6)
    s_barrier
    v_mfma_f32_16x16x32_bf16 a[48:51], a[24:27], v[68:71], a[48:51]
    ds_read_b64_tr_b16 a[0:1], v250 offset:8192
    v_mfma_f32_16x16x32_bf16 a[72:75], a[24:27], v[72:75], a[72:75]
    ds_read_b64_tr_b16 a[2:3], v250 offset:11264
    v_mfma_f32_16x16x32_bf16 a[96:99], a[24:27], v[76:79], a[96:99]
    ds_read_b64_tr_b16 a[4:5], v251 offset:8192
    v_mfma_f32_16x16x32_bf16 a[52:55], a[28:31], v[68:71], a[52:55]
    ds_read_b64_tr_b16 a[6:7], v251 offset:11264
    v_mfma_f32_16x16x32_bf16 a[76:79], a[28:31], v[72:75], a[76:79]
    ds_read_b64_tr_b16 a[8:9], v250 offset:8256
    v_mfma_f32_16x16x32_bf16 a[100:103], a[28:31], v[76:79], a[100:103]
    ds_read_b64_tr_b16 a[10:11], v250 offset:11328
    v_mfma_f32_16x16x32_bf16 a[56:59], a[32:35], v[68:71], a[56:59]
    ds_read_b64_tr_b16 a[12:13], v251 offset:8256
    v_mfma_f32_16x16x32_bf16 a[80:83], a[32:35], v[72:75], a[80:83]
    ds_read_b64_tr_b16 a[14:15], v251 offset:11328
    v_mfma_f32_16x16x32_bf16 a[104:107], a[32:35], v[76:79], a[104:107]
    ds_read_b64_tr_b16 a[16:17], v250 offset:8320
    v_mfma_f32_16x16x32_bf16 a[60:63], a[36:39], v[68:71], a[60:63]
    ds_read_b64_tr_b16 a[18:19], v250 offset:11392
    v_mfma_f32_16x16x32_bf16 a[84:87], a[36:39], v[72:75], a[84:87]
    ds_read_b64_tr_b16 a[20:21], v251 offset:8320
    v_mfma_f32_16x16x32_bf16 a[108:111], a[36:39], v[76:79], a[108:111]
    ds_read_b64_tr_b16 a[22:23], v251 offset:11392
    v_mfma_f32_16x16x32_bf16 a[64:67], a[40:43], v[68:71], a[64:67]
    v_mfma_f32_16x16x32_bf16 a[88:91], a[40:43], v[72:75], a[88:91]
    v_mfma_f32_16x16x32_bf16 a[112:115], a[40:43], v[76:79], a[112:115]
    v_mfma_f32_16x16x32_bf16 a[68:71], a[44:47], v[68:71], a[68:71]
    v_mfma_f32_16x16x32_bf16 a[92:95], a[44:47], v[72:75], a[92:95]
    v_mfma_f32_16x16x32_bf16 a[116:119], a[44:47], v[76:79], a[116:119]
    s_waitcnt lgkmcnt(0)
    v_mfma_f32_16x16x32_bf16 a[48:51], a[0:3], v[80:83], a[48:51]
    ds_read_b64_tr_b16 a[24:25], v250 offset:14336
    v_mfma_f32_16x16x32_bf16 a[72:75], a[0:3], v[84:87], a[72:75]
    ds_read_b64_tr_b16 a[26:27], v250 offset:17408
    v_mfma_f32_16x16x32_bf16 a[96:99], a[0:3], v[88:91], a[96:99]
    ds_read_b64_tr_b16 a[28:29], v251 offset:14336
    v_mfma_f32_16x16x32_bf16 a[52:55], a[4:7], v[80:83], a[52:55]
    ds_read_b64_tr_b16 a[30:31], v251 offset:17408
    v_mfma_f32_16x16x32_bf16 a[76:79], a[4:7], v[84:87], a[76:79]
    ds_read_b64_tr_b16 a[32:33], v250 offset:14400
    v_mfma_f32_16x16x32_bf16 a[100:103], a[4:7], v[88:91], a[100:103]
    ds_read_b64_tr_b16 a[34:35], v250 offset:17472
    v_mfma_f32_16x16x32_bf16 a[56:59], a[8:11], v[80:83], a[56:59]
    ds_read_b64_tr_b16 a[36:37], v251 offset:14400
    v_mfma_f32_16x16x32_bf16 a[80:83], a[8:11], v[84:87], a[80:83]
    ds_read_b64_tr_b16 a[38:39], v251 offset:17472
    v_mfma_f32_16x16x32_bf16 a[104:107], a[8:11], v[88:91], a[104:107]
    ds_read_b64_tr_b16 a[40:41], v250 offset:14464
    v_mfma_f32_16x16x32_bf16 a[60:63], a[12:15], v[80:83], a[60:63]
    ds_read_b64_tr_b16 a[42:43], v250 offset:17536
    v_mfma_f32_16x16x32_bf16 a[84:87], a[12:15], v[84:87], a[84:87]
    ds_read_b64_tr_b16 a[44:45], v251 offset:14464
    v_mfma_f32_16x16x32_bf16 a[108:111], a[12:15], v[88:91], a[108:111]
    ds_read_b64_tr_b16 a[46:47], v251 offset:17536
    v_mfma_f32_16x16x32_bf16 a[64:67], a[16:19], v[80:83], a[64:67]
    v_mfma_f32_16x16x32_bf16 a[88:91], a[16:19], v[84:87], a[88:91]
    v_mfma_f32_16x16x32_bf16 a[112:115], a[16:19], v[88:91], a[112:115]
    v_mfma_f32_16x16x32_bf16 a[68:71], a[20:23], v[80:83], a[68:71]
    v_mfma_f32_16x16x32_bf16 a[92:95], a[20:23], v[84:87], a[92:95]
    v_mfma_f32_16x16x32_bf16 a[116:119], a[20:23], v[88:91], a[116:119]
    s_waitcnt lgkmcnt(0)
    s_waitcnt vmcnt(0)
    s_barrier
    v_mfma_f32_16x16x32_bf16 a[48:51], a[24:27], v[92:95], a[48:51]
    ds_read_b64_tr_b16 a[0:1], v250 offset:20480
    v_mfma_f32_16x16x32_bf16 a[72:75], a[24:27], v[96:99], a[72:75]
    ds_read_b64_tr_b16 a[2:3], v250 offset:23552
    v_mfma_f32_16x16x32_bf16 a[96:99], a[24:27], v[100:103], a[96:99]
    ds_read_b64_tr_b16 a[4:5], v251 offset:20480
    v_mfma_f32_16x16x32_bf16 a[52:55], a[28:31], v[92:95], a[52:55]
    ds_read_b64_tr_b16 a[6:7], v251 offset:23552
    v_mfma_f32_16x16x32_bf16 a[76:79], a[28:31], v[96:99], a[76:79]
    ds_read_b64_tr_b16 a[8:9], v250 offset:20544
    v_mfma_f32_16x16x32_bf16 a[100:103], a[28:31], v[100:103], a[100:103]
    ds_read_b64_tr_b16 a[10:11], v250 offset:23616
    v_mfma_f32_16x16x32_bf16 a[56:59], a[32:35], v[92:95], a[56:59]
    ds_read_b64_tr_b16 a[12:13], v251 offset:20544
    v_mfma_f32_16x16x32_bf16 a[80:83], a[32:35], v[96:99], a[80:83]
    ds_read_b64_tr_b16 a[14:15], v251 offset:23616
    v_mfma_f32_16x16x32_bf16 a[104:107], a[32:35], v[100:103], a[104:107]
    ds_read_b64_tr_b16 a[16:17], v250 offset:20608
    v_mfma_f32_16x16x32_bf16 a[60:63], a[36:39], v[92:95], a[60:63]
    ds_read_b64_tr_b16 a[18:19], v250 offset:23680
    v_mfma_f32_16x16x32_bf16 a[84:87], a[36:39], v[96:99], a[84:87]
    ds_read_b64_tr_b16 a[20:21], v251 offset:20608
    v_mfma_f32_16x16x32_bf16 a[108:111], a[36:39], v[100:103], a[108:111]
    ds_read_b64_tr_b16 a[22:23], v251 offset:23680
    v_mfma_f32_16x16x32_bf16 a[64:67], a[40:43], v[92:95], a[64:67]
    v_mfma_f32_16x16x32_bf16 a[88:91], a[40:43], v[96:99], a[88:91]
    v_mfma_f32_16x16x32_bf16 a[112:115], a[40:43], v[100:103], a[112:115]
    v_mfma_f32_16x16x32_bf16 a[68:71], a[44:47], v[92:95], a[68:71]
    v_mfma_f32_16x16x32_bf16 a[92:95], a[44:47], v[96:99], a[92:95]
    v_mfma_f32_16x16x32_bf16 a[116:119], a[44:47], v[100:103], a[116:119]
    s_waitcnt lgkmcnt(0)
    v_mfma_f32_16x16x32_bf16 a[48:51], a[0:3], v[104:107], a[48:51]
    ds_read_b64_tr_b16 a[24:25], v250 offset:26624
    v_mfma_f32_16x16x32_bf16 a[72:75], a[0:3], v[108:111], a[72:75]
    ds_read_b64_tr_b16 a[26:27], v250 offset:29696
    v_mfma_f32_16x16x32_bf16 a[96:99], a[0:3], v[112:115], a[96:99]
    ds_read_b64_tr_b16 a[28:29], v251 offset:26624
    v_mfma_f32_16x16x32_bf16 a[52:55], a[4:7], v[104:107], a[52:55]
    ds_read_b64_tr_b16 a[30:31], v251 offset:29696
    v_mfma_f32_16x16x32_bf16 a[76:79], a[4:7], v[108:111], a[76:79]
    ds_read_b64_tr_b16 a[32:33], v250 offset:26688
    v_mfma_f32_16x16x32_bf16 a[100:103], a[4:7], v[112:115], a[100:103]
    ds_read_b64_tr_b16 a[34:35], v250 offset:29760
    v_mfma_f32_16x16x32_bf16 a[56:59], a[8:11], v[104:107], a[56:59]
    ds_read_b64_tr_b16 a[36:37], v251 offset:26688
    v_mfma_f32_16x16x32_bf16 a[80:83], a[8:11], v[108:111], a[80:83]
    ds_read_b64_tr_b16 a[38:39], v251 offset:29760
    v_mfma_f32_16x16x32_bf16 a[104:107], a[8:11], v[112:115], a[104:107]
    ds_read_b64_tr_b16 a[40:41], v250 offset:26752
    v_mfma_f32_16x16x32_bf16 a[60:63], a[12:15], v[104:107], a[60:63]
    ds_read_b64_tr_b16 a[42:43], v250 offset:29824
    v_mfma_f32_16x16x32_bf16 a[84:87], a[12:15], v[108:111], a[84:87]
    ds_read_b64_tr_b16 a[44:45], v251 offset:26752
    v_mfma_f32_16x16x32_bf16 a[108:111], a[12:15], v[112:115], a[108:111]
    ds_read_b64_tr_b16 a[46:47], v251 offset:29824
    v_mfma_f32_16x16x32_bf16 a[64:67], a[16:19], v[104:107], a[64:67]
    v_mfma_f32_16x16x32_bf16 a[88:91], a[16:19], v[108:111], a[88:91]
    v_mfma_f32_16x16x32_bf16 a[112:115], a[16:19], v[112:115], a[112:115]
    v_mfma_f32_16x16x32_bf16 a[68:71], a[20:23], v[104:107], a[68:71]
    v_mfma_f32_16x16x32_bf16 a[92:95], a[20:23], v[108:111], a[92:95]
    v_mfma_f32_16x16x32_bf16 a[116:119], a[20:23], v[112:115], a[116:119]
    s_waitcnt lgkmcnt(0)
    v_mfma_f32_16x16x32_bf16 a[48:51], a[24:27], v[116:119], a[48:51]
    v_mfma_f32_16x16x32_bf16 a[72:75], a[24:27], v[120:123], a[72:75]
    v_mfma_f32_16x16x32_bf16 a[96:99], a[24:27], v[124:127], a[96:99]
    v_mfma_f32_16x16x32_bf16 a[52:55], a[28:31], v[116:119], a[52:55]
    v_mfma_f32_16x16x32_bf16 a[76:79], a[28:31], v[120:123], a[76:79]
    v_mfma_f32_16x16x32_bf16 a[100:103], a[28:31], v[124:127], a[100:103]
    v_mfma_f32_16x16x32_bf16 a[56:59], a[32:35], v[116:119], a[56:59]
    v_mfma_f32_16x16x32_bf16 a[80:83], a[32:35], v[120:123], a[80:83]
    v_mfma_f32_16x16x32_bf16 a[104:107], a[32:35], v[124:127], a[104:107]
    v_mfma_f32_16x16x32_bf16 a[60:63], a[36:39], v[116:119], a[60:63]
    v_mfma_f32_16x16x32_bf16 a[84:87], a[36:39], v[120:123], a[84:87]
    v_mfma_f32_16x16x32_bf16 a[108:111], a[36:39], v[124:127], a[108:111]
    v_mfma_f32_16x16x32_bf16 a[64:67], a[40:43], v[116:119], a[64:67]
    v_mfma_f32_16x16x32_bf16 a[88:91], a[40:43], v[120:123], a[88:91]
    v_mfma_f32_16x16x32_bf16 a[112:115], a[40:43], v[124:127], a[112:115]
    v_mfma_f32_16x16x32_bf16 a[68:71], a[44:47], v[116:119], a[68:71]
    v_mfma_f32_16x16x32_bf16 a[92:95], a[44:47], v[120:123], a[92:95]
    v_mfma_f32_16x16x32_bf16 a[116:119], a[44:47], v[124:127], a[116:119]
    s_lshl_b32 s46, s89, 2
    s_nop 7
    s_cmp_eq_u32 s3, s86
    s_cbranch_scc1 L2_keep
    s_add_u32 s48, s46, s3
    s_lshl_b32 s48, s48, 2
    s_add_u32 s48, s48, s86
    s_mul_i32 s47, s48, 18432
    s_add_u32 s47, s47, 18874368
    buffer_store_dwordx4 a[48:51], v247, s[24:27], s47 offen offset:0 sc1
    buffer_store_dwordx4 a[52:55], v247, s[24:27], s47 offen offset:1024 sc1
    buffer_store_dwordx4 a[56:59], v247, s[24:27], s47 offen offset:2048 sc1
    buffer_store_dwordx4 a[60:63], v247, s[24:27], s47 offen offset:3072 sc1
    s_add_u32 s47, s47, 4096
    buffer_store_dwordx4 a[64:67], v247, s[24:27], s47 offen offset:0 sc1
    buffer_store_dwordx4 a[68:71], v247, s[24:27], s47 offen offset:1024 sc1
    buffer_store_dwordx4 a[72:75], v247, s[24:27], s47 offen offset:2048 sc1
    buffer_store_dwordx4 a[76:79], v247, s[24:27], s47 offen offset:3072 sc1
    s_add_u32 s47, s47, 4096
    buffer_store_dwordx4 a[80:83], v247, s[24:27], s47 offen offset:0 sc1
    buffer_store_dwordx4 a[84:87], v247, s[24:27], s47 offen offset:1024 sc1
    buffer_store_dwordx4 a[88:91], v247, s[24:27], s47 offen offset:2048 sc1
    buffer_store_dwordx4 a[92:95], v247, s[24:27], s47 offen offset:3072 sc1
    s_add_u32 s47, s47, 4096
    buffer_store_dwordx4 a[96:99], v247, s[24:27], s47 offen offset:0 sc1
    buffer_store_dwordx4 a[100:103], v247, s[24:27], s47 offen offset:1024 sc1
    buffer_store_dwordx4 a[104:107], v247, s[24:27], s47 offen offset:2048 sc1
    buffer_store_dwordx4 a[108:111], v247, s[24:27], s47 offen offset:3072 sc1
    s_add_u32 s47, s47, 4096
    buffer_store_dwordx4 a[112:115], v247, s[24:27], s47 offen offset:0 sc1
    buffer_store_dwordx4 a[116:119], v247, s[24:27], s47 offen offset:1024 sc1
    s_mul_i32 s55, s48, 4224
    s_add_u32 s55, s55, 38797312
    s_add_u32 s47, s46, s86
    s_lshl_b32 s47, s47, 2
    s_add_u32 s48, s86, 1
    s_and_b32 s48, s48, 3
    s_add_u32 s48, s48, s47
    s_mul_i32 s48, s48, 18432
    s_add_u32 s56, s48, 18874368
    s_add_u32 s48, s86, 2
    s_and_b32 s48, s48, 3
    s_add_u32 s48, s48, s47
    s_mul_i32 s48, s48, 18432
    s_add_u32 s57, s48, 18874368
    s_add_u32 s48, s86, 3
    s_and_b32 s48, s48, 3
    s_add_u32 s48, s48, s47
    s_mul_i32 s48, s48, 18432
    s_add_u32 s58, s48, 18874368
    s_lshl_b32 s45, s3, 10
    v_add_u32 v230, s45, v247
    v_add_u32 v231, s45, v247
    v_add_u32 v231, 4096, v231
    v_add_u32 v232, s45, v247
    v_add_u32 v232, 8192, v232
    v_add_u32 v233, s45, v247
    v_add_u32 v233, 12288, v233
    v_add_u32 v234, s45, v247
    v_add_u32 v234, 16384, v234
    v_and_b32 v235, 15, v221
    v_mul_u32_u24 v235, 1152, v235
    v_lshrrev_b32 v236, 4, v221
    v_lshl_add_u32 v235, v236, 3, v235
    s_lshl_b32 s59, s88, 4
    s_mul_i32 s47, s86, 48
    s_add_u32 s59, s59, s47
    s_mul_i32 s59, s59, 1152
    s_mul_i32 s47, s87, 192
    s_add_u32 s59, s59, s47
    s_add_u32 s47, s3, 0
    s_mul_i32 s48, s47, 43
    s_lshr_b32 s48, s48, 8
    s_mul_i32 s49, s48, 6
    s_sub_u32 s49, s47, s49
    s_mul_i32 s48, s48, 18432
    s_lshl_b32 s49, s49, 5
    s_add_u32 s48, s48, s49
    s_add_u32 s42, s48, s59
    s_add_u32 s47, s3, 4
    s_mul_i32 s48, s47, 43
    s_lshr_b32 s48, s48, 8
    s_mul_i32 s49, s48, 6
    s_sub_u32 s49, s47, s49
    s_mul_i32 s48, s48, 18432
    s_lshl_b32 s49, s49, 5
    s_add_u32 s48, s48, s49
    s_add_u32 s43, s48, s59
    s_add_u32 s47, s3, 8
    s_mul_i32 s48, s47, 43
    s_lshr_b32 s48, s48, 8
    s_mul_i32 s49, s48, 6
    s_sub_u32 s49, s47, s49
    s_mul_i32 s48, s48, 18432
    s_lshl_b32 s49, s49, 5
    s_add_u32 s48, s48, s49
    s_add_u32 s44, s48, s59
    s_add_u32 s47, s3, 12
    s_mul_i32 s48, s47, 43
    s_lshr_b32 s48, s48, 8
    s_mul_i32 s49, s48, 6
    s_sub_u32 s49, s47, s49
    s_mul_i32 s48, s48, 18432
    s_lshl_b32 s49, s49, 5
    s_add_u32 s48, s48, s49
    s_add_u32 s45, s48, s59
    s_add_u32 s47, s3, 16
    s_mul_i32 s48, s47, 43
    s_lshr_b32 s48, s48, 8
    s_mul_i32 s49, s48, 6
    s_sub_u32 s49, s47, s49
    s_mul_i32 s48, s48, 18432
    s_lshl_b32 s49, s49, 5
    s_add_u32 s48, s48, s49
    s_add_u32 s94, s48, s59
    v_mov_b32 v222, s92
    v_mov_b32 v223, 0
    v_cmp_eq_u32 vcc, 0, v221
    s_waitcnt vmcnt(0)
    s_and_saveexec_b64 s[50:51], vcc
    buffer_store_dword v222, v223, s[24:27], s55 offen sc1
    s_mov_b64 exec, s[50:51]
    s_branch L2_polled
L2_keep:
    ds_write_b128 v247, a[48:51] offset:0
    ds_write_b128 v247, a[52:55] offset:1024
    ds_write_b128 v247, a[56:59] offset:2048
    ds_write_b128 v247, a[60:63] offset:3072
    ds_write_b128 v247, a[64:67] offset:4096
    ds_write_b128 v247, a[68:71] offset:5120
    ds_write_b128 v247, a[72:75] offset:6144
    ds_write_b128 v247, a[76:79] offset:7168
    ds_write_b128 v247, a[80:83] offset:8192
    ds_write_b128 v247, a[84:87] offset:9216
    ds_write_b128 v247, a[88:91] offset:10240
    ds_write_b128 v247, a[92:95] offset:11264
    ds_write_b128 v247, a[96:99] offset:12288
    ds_write_b128 v247, a[100:103] offset:13312
    ds_write_b128 v247, a[104:107] offset:14336
    ds_write_b128 v247, a[108:111] offset:15360
    ds_write_b128 v247, a[112:115] offset:16384
    ds_write_b128 v247, a[116:119] offset:17408
    s_add_u32 s47, s46, s86
    s_lshl_b32 s47, s47, 2
    s_add_u32 s48, s86, 1
    s_and_b32 s48, s48, 3
    s_add_u32 s48, s48, s47
    s_mul_i32 s48, s48, 18432
    s_add_u32 s56, s48, 18874368
    s_add_u32 s48, s86, 2
    s_and_b32 s48, s48, 3
    s_add_u32 s48, s48, s47
    s_mul_i32 s48, s48, 18432
    s_add_u32 s57, s48, 18874368
    s_add_u32 s48, s86, 3
    s_and_b32 s48, s48, 3
    s_add_u32 s48, s48, s47
    s_mul_i32 s48, s48, 18432
    s_add_u32 s58, s48, 18874368
    s_lshl_b32 s45, s3, 10
    v_add_u32 v230, s45, v247
    v_add_u32 v231, s45, v247
    v_add_u32 v231, 4096, v231
    v_add_u32 v232, s45, v247
    v_add_u32 v232, 8192, v232
    v_add_u32 v233, s45, v247
    v_add_u32 v233, 12288, v233
    v_add_u32 v234, s45, v247
    v_add_u32 v234, 16384, v234
    v_and_b32 v235, 15, v221
    v_mul_u32_u24 v235, 1152, v235
    v_lshrrev_b32 v236, 4, v221
    v_lshl_add_u32 v235, v236, 3, v235
    s_lshl_b32 s59, s88, 4
    s_mul_i32 s47, s86, 48
    s_add_u32 s59, s59, s47
    s_mul_i32 s59, s59, 1152
    s_mul_i32 s47, s87, 192
    s_add_u32 s59, s59, s47
    s_add_u32 s47, s3, 0
    s_mul_i32 s48, s47, 43
    s_lshr_b32 s48, s48, 8
    s_mul_i32 s49, s48, 6
    s_sub_u32 s49, s47, s49
    s_mul_i32 s48, s48, 18432
    s_lshl_b32 s49, s49, 5
    s_add_u32 s48, s48, s49
    s_add_u32 s42, s48, s59
    s_add_u32 s47, s3, 4
    s_mul_i32 s48, s47, 43
    s_lshr_b32 s48, s48, 8
    s_mul_i32 s49, s48, 6
    s_sub_u32 s49, s47, s49
    s_mul_i32 s48, s48, 18432
    s_lshl_b32 s49, s49, 5
    s_add_u32 s48, s48, s49
    s_add_u32 s43, s48, s59
    s_add_u32 s47, s3, 8
    s_mul_i32 s48, s47, 43
    s_lshr_b32 s48, s48, 8
    s_mul_i32 s49, s48, 6
    s_sub_u32 s49, s47, s49
    s_mul_i32 s48, s48, 18432
    s_lshl_b32 s49, s49, 5
    s_add_u32 s48, s48, s49
    s_add_u32 s44, s48, s59
    s_add_u32 s47, s3, 12
    s_mul_i32 s48, s47, 43
    s_lshr_b32 s48, s48, 8
    s_mul_i32 s49, s48, 6
    s_sub_u32 s49, s47, s49
    s_mul_i32 s48, s48, 18432
    s_lshl_b32 s49, s49, 5
    s_add_u32 s48, s48, s49
    s_add_u32 s45, s48, s59
    s_add_u32 s47, s3, 16
    s_mul_i32 s48, s47, 43
    s_lshr_b32 s48, s48, 8
    s_mul_i32 s49, s48, 6
    s_sub_u32 s49, s47, s49
    s_mul_i32 s48, s48, 18432
    s_lshl_b32 s49, s49, 5
    s_add_u32 s48, s48, s49
    s_add_u32 s94, s48, s59
    s_add_u32 s47, s46, s86
    s_mul_i32 s47, s47, 16896
    s_add_u32 s47, s47, 38797312
    v_and_b32 v225, 3, v221
    v_mul_u32_u24 v223, 4224, v225
    v_cmp_ne_u32 s[52:53], s86, v225
    s_mov_b32 s50, 0
L2_poll:
    buffer_load_dword v227, v223, s[24:27], s47 offen sc1
    s_waitcnt vmcnt(0)
    v_cmp_ne_u32 vcc, s92, v227
    s_add_u32 s50, s50, 1
    s_nop 3
    s_and_b64 vcc, vcc, s[52:53]
    s_cmp_eq_u64 vcc, 0
    s_cbranch_scc1 L2_kept
    s_cmp_lt_u32 s50, 0x400000
    s_cbranch_scc1 L2_poll
L2_kept:
    s_waitcnt lgkmcnt(0)
L2_polled:
    s_barrier
    s_cmp_ge_u32 s3, 2
    s_cbranch_scc1 L2_four
    buffer_load_dwordx4 v[36:39], v230, s[24:27], s56 offen sc1
    buffer_load_dwordx4 v[40:43], v230, s[24:27], s57 offen sc1
    buffer_load_dwordx4 v[44:47], v230, s[24:27], s58 offen sc1
    ds_read_b128 v[32:35], v230
    buffer_load_dwordx4 v[52:55], v231, s[24:27], s56 offen sc1
    buffer_load_dwordx4 v[56:59], v231, s[24:27], s57 offen sc1
    buffer_load_dwordx4 v[60:63], v231, s[24:27], s58 offen sc1
    ds_read_b128 v[48:51], v231
    buffer_load_dwordx4 v[68:71], v232, s[24:27], s56 offen sc1
    buffer_load_dwordx4 v[72:75], v232, s[24:27], s57 offen sc1
    buffer_load_dwordx4 v[76:79], v232, s[24:27], s58 offen sc1
    ds_read_b128 v[64:67], v232
    buffer_load_dwordx4 v[84:87], v233, s[24:27], s56 offen sc1
    buffer_load_dwordx4 v[88:91], v233, s[24:27], s57 offen sc1
    buffer_load_dwordx4 v[92:95], v233, s[24:27], s58 offen sc1
    ds_read_b128 v[80:83], v233
    buffer_load_dwordx4 v[100:103], v234, s[24:27], s56 offen sc1
    buffer_load_dwordx4 v[104:107], v234, s[24:27], s57 offen sc1
    buffer_load_dwordx4 v[108:111], v234, s[24:27], s58 offen sc1
    ds_read_b128 v[96:99], v234
    s_waitcnt vmcnt(12) lgkmcnt(0)
    v_add_f32 v32, v32, v36
    v_add_f32 v40, v40, v44
    v_add_f32 v33, v33, v37
    v_add_f32 v41, v41, v45
    v_add_f32 v34, v34, v38
    v_add_f32 v42, v42, v46
    v_add_f32 v35, v35, v39
    v_add_f32 v43, v43, v47
    v_add_f32 v32, v32, v40
    v_add_f32 v33, v33, v41
    v_add_f32 v34, v34, v42
    v_add_f32 v35, v35, v43
    v_cvt_pk_bf16_f32 v36, v32, v33
    v_cvt_pk_bf16_f32 v37, v34, v35
    buffer_store_dwordx2 v[36:37], v235, s[20:23], s42 offen
    s_waitcnt vmcnt(10) lgkmcnt(0)
    v_add_f32 v48, v48, v52
    v_add_f32 v56, v56, v60
    v_add_f32 v49, v49, v53
    v_add_f32 v57, v57, v61
    v_add_f32 v50, v50, v54
    v_add_f32 v58, v58, v62
    v_add_f32 v51, v51, v55
    v_add_f32 v59, v59, v63
    v_add_f32 v48, v48, v56
    v_add_f32 v49, v49, v57
    v_add_f32 v50, v50, v58
    v_add_f32 v51, v51, v59
    v_cvt_pk_bf16_f32 v52, v48, v49
    v_cvt_pk_bf16_f32 v53, v50, v51
    buffer_store_dwordx2 v[52:53], v235, s[20:23], s43 offen
    s_waitcnt vmcnt(8) lgkmcnt(0)
    v_add_f32 v64, v64, v68
    v_add_f32 v72, v72, v76
    v_add_f32 v65, v65, v69
    v_add_f32 v73, v73, v77
    v_add_f32 v66, v66, v70
    v_add_f32 v74, v74, v78
    v_add_f32 v67, v67, v71
    v_add_f32 v75, v75, v79
    v_add_f32 v64, v64, v72
    v_add_f32 v65, v65, v73
    v_add_f32 v66, v66, v74
    v_add_f32 v67, v67, v75
    v_cvt_pk_bf16_f32 v68, v64, v65
    v_cvt_pk_bf16_f32 v69, v66, v67
    buffer_store_dwordx2 v[68:69], v235, s[20:23], s44 offen
    s_waitcnt vmcnt(6) lgkmcnt(0)
    v_add_f32 v80, v80, v84
    v_add_f32 v88, v88, v92
    v_add_f32 v81, v81, v85
    v_add_f32 v89, v89, v93
    v_add_f32 v82, v82, v86
    v_add_f32 v90, v90, v94
    v_add_f32 v83, v83, v87
    v_add_f32 v91, v91, v95
    v_add_f32 v80, v80, v88
    v_add_f32 v81, v81, v89
    v_add_f32 v82, v82, v90
    v_add_f32 v83, v83, v91
    v_cvt_pk_bf16_f32 v84, v80, v81
    v_cvt_pk_bf16_f32 v85, v82, v83
    buffer_store_dwordx2 v[84:85], v235, s[20:23], s45 offen
    s_waitcnt vmcnt(4) lgkmcnt(0)
    v_add_f32 v96, v96, v100
    v_add_f32 v104, v104, v108
    v_add_f32 v97, v97, v101
    v_add_f32 v105, v105, v109
    v_add_f32 v98, v98, v102
    v_add_f32 v106, v106, v110
    v_add_f32 v99, v99, v103
    v_add_f32 v107, v107, v111
    v_add_f32 v96, v96, v104
    v_add_f32 v97, v97, v105
    v_add_f32 v98, v98, v106
    v_add_f32 v99, v99, v107
    v_cvt_pk_bf16_f32 v100, v96, v97
    v_cvt_pk_bf16_f32 v101, v98, v99
    buffer_store_dwordx2 v[100:101], v235, s[20:23], s94 offen
    s_branch L2_fin
L2_four:
    buffer_load_dwordx4 v[36:39], v230, s[24:27], s56 offen sc1
    buffer_load_dwordx4 v[40:43], v230, s[24:27], s57 offen sc1
    buffer_load_dwordx4 v[44:47], v230, s[24:27], s58 offen sc1
    ds_read_b128 v[32:35], v230
    buffer_load_dwordx4 v[52:55], v231, s[24:27], s56 offen sc1
    buffer_load_dwordx4 v[56:59], v231, s[24:27], s57 offen sc1
    buffer_load_dwordx4 v[60:63], v231, s[24:27], s58 offen sc1
    ds_read_b128 v[48:51], v231
    buffer_load_dwordx4 v[68:71], v232, s[24:27], s56 offen sc1
    buffer_load_dwordx4 v[72:75], v232, s[24:27], s57 offen sc1
    buffer_load_dwordx4 v[76:79], v232, s[24:27], s58 offen sc1
    ds_read_b128 v[64:67], v232
    buffer_load_dwordx4 v[84:87], v233, s[24:27], s56 offen sc1
    buffer_load_dwordx4 v[88:91], v233, s[24:27], s57 offen sc1
    buffer_load_dwordx4 v[92:95], v233, s[24:27], s58 offen sc1
    ds_read_b128 v[80:83], v233
    s_waitcnt vmcnt(9) lgkmcnt(0)
    v_add_f32 v32, v32, v36
    v_add_f32 v40, v40, v44
    v_add_f32 v33, v33, v37
    v_add_f32 v41, v41, v45
    v_add_f32 v34, v34, v38
    v_add_f32 v42, v42, v46
    v_add_f32 v35, v35, v39
    v_add_f32 v43, v43, v47
    v_add_f32 v32, v32, v40
    v_add_f32 v33, v33, v41
    v_add_f32 v34, v34, v42
    v_add_f32 v35, v35, v43
    v_cvt_pk_bf16_f32 v36, v32, v33
    v_cvt_pk_bf16_f32 v37, v34, v35
    buffer_store_dwordx2 v[36:37], v235, s[20:23], s42 offen
    s_waitcnt vmcnt(7) lgkmcnt(0)
    v_add_f32 v48, v48, v52
    v_add_f32 v56, v56, v60
    v_add_f32 v49, v49, v53
    v_add_f32 v57, v57, v61
    v_add_f32 v50, v50, v54
    v_add_f32 v58, v58, v62
    v_add_f32 v51, v51, v55
    v_add_f32 v59, v59, v63
    v_add_f32 v48, v48, v56
    v_add_f32 v49, v49, v57
    v_add_f32 v50, v50, v58
    v_add_f32 v51, v51, v59
    v_cvt_pk_bf16_f32 v52, v48, v49
    v_cvt_pk_bf16_f32 v53, v50, v51
    buffer_store_dwordx2 v[52:53], v235, s[20:23], s43 offen
    s_waitcnt vmcnt(5) lgkmcnt(0)
    v_add_f32 v64, v64, v68
    v_add_f32 v72, v72, v76
    v_add_f32 v65, v65, v69
    v_add_f32 v73, v73, v77
    v_add_f32 v66, v66, v70
    v_add_f32 v74, v74, v78
    v_add_f32 v67, v67, v71
    v_add_f32 v75, v75, v79
    v_add_f32 v64, v64, v72
    v_add_f32 v65, v65, v73
    v_add_f32 v66, v66, v74
    v_add_f32 v67, v67, v75
    v_cvt_pk_bf16_f32 v68, v64, v65
    v_cvt_pk_bf16_f32 v69, v66, v67
    buffer_store_dwordx2 v[68:69], v235, s[20:23], s44 offen
    s_waitcnt vmcnt(3) lgkmcnt(0)
    v_add_f32 v80, v80, v84
    v_add_f32 v88, v88, v92
    v_add_f32 v81, v81, v85
    v_add_f32 v89, v89, v93
    v_add_f32 v82, v82, v86
    v_add_f32 v90, v90, v94
    v_add_f32 v83, v83, v87
    v_add_f32 v91, v91, v95
    v_add_f32 v80, v80, v88
    v_add_f32 v81, v81, v89
    v_add_f32 v82, v82, v90
    v_add_f32 v83, v83, v91
    v_cvt_pk_bf16_f32 v84, v80, v81
    v_cvt_pk_bf16_f32 v85, v82, v83
    buffer_store_dwordx2 v[84:85], v235, s[20:23], s45 offen
L2_fin:
    s_branch L1_done
L2_exit:
L1_done:
    s_endpgm
.section .rodata,"a"
.p2align 6
.amdhsa_kernel standalone__mha_block_cached__near_ridge_kernel
  .amdhsa_next_free_vgpr 512
  .amdhsa_next_free_sgpr 102
  .amdhsa_accum_offset 256
  .amdhsa_group_segment_fixed_size 0
  .amdhsa_kernarg_size 64
  .amdhsa_user_sgpr_count 2
  .amdhsa_user_sgpr_kernarg_segment_ptr 1
  .amdhsa_system_sgpr_workgroup_id_x 1
  .amdhsa_float_denorm_mode_32 3
.end_amdhsa_kernel
```
